```python
import torch

def _softmax(x, axis=-1):
    return torch.softmax(x, dim=axis)
def _gelu(x):
    return torch.nn.functional.gelu(x, approximate="tanh")
def _silu(x):
    return torch.nn.functional.silu(x)
def _sigmoid(x):
    return torch.sigmoid(x)
def _layernorm(x, axis=-1, eps=1e-5):
    m = x.mean(dim=axis, keepdim=True)
    v = x.var(dim=axis, keepdim=True, unbiased=False)
    return (x - m) / torch.sqrt(v + eps)
def _scatter_add(tgt, idx, src, axis=0):
    return tgt.clone().index_add_(axis, idx, src)
def _segment_sum(src, seg, n):
    out = torch.zeros((n,) + src.shape[1:], dtype=src.dtype)
    return out.index_add_(0, seg, src)
def _pad(x, pw):
    flat = tuple(v for pair in reversed(pw) for v in pair)
    return torch.nn.functional.pad(x, flat)

kernel_name = 'sequential_preLN__sliding_block__glu_gated_glu__prompt'

def setup_inputs():

    _w = (lambda a: (lambda t: t.to(torch.bfloat16) if t.is_floating_point() else t)(torch.as_tensor(a)))
    def _A_setup():
        B, S, D = 1, 2048, 576
        return {
            "x": _w((lambda *s: torch.randn(*s, dtype=torch.bfloat16) * 0.05)(B, S, D)),
            "wqkv": _w((lambda *s: torch.randn(*s, dtype=torch.bfloat16) * 0.05)(D, 3 * D)),
            "wo": _w((lambda *s: torch.randn(*s, dtype=torch.bfloat16) * 0.05)(D, D)),
        }
    _A_in = _A_setup()

    def _B_setup():
        B, S, D, F = 1, 2048, 576, 4608
        return {
            "x": _w((lambda *s: torch.randn(*s, dtype=torch.bfloat16) * 0.05)(B, S, D)),
            "w_gate": _w((lambda *s: torch.randn(*s, dtype=torch.bfloat16) * 0.05)(D, F)),
            "w_up": _w((lambda *s: torch.randn(*s, dtype=torch.bfloat16) * 0.05)(D, F)),
            "w_down": _w((lambda *s: torch.randn(*s, dtype=torch.bfloat16) * 0.05)(F, D)),
        }
    _B_in = _B_setup()

    return {
        "A_x": _A_in["x"],
        "A_wqkv": _A_in["wqkv"],
        "A_wo": _A_in["wo"],
        "B_x": _B_in["x"],
        "B_w_gate": _B_in["w_gate"],
        "B_w_up": _B_in["w_up"],
        "B_w_down": _B_in["w_down"],
    }

def reference(A_x, A_wqkv, A_wo, B_x, B_w_gate, B_w_up, B_w_down):
    def _A_ref(x, wqkv, wo):
        B, S, D = x.shape
        H = 32; Dh = D // H; W = 256
        qkv = (lambda x, *d: x.permute(*d))((x @ wqkv).reshape(B, S, 3, H, Dh), 2, 0, 3, 1, 4)
        q, k, v = qkv[0], qkv[1], qkv[2]
        scores = torch.einsum("bhqd,bhkd->bhqk", q, k) * (Dh ** -0.5)
        idx = torch.arange(S)
        mask = (idx[:, None] - idx[None, :] >= 0) & (idx[:, None] - idx[None, :] < W)
        scores = torch.where(mask[None, None], scores, -1e9)
        p = _softmax(scores, axis=-1)
        o = torch.einsum("bhqk,bhkd->bhqd", p, v)
        return (lambda x, *d: x.permute(*d))(o, 0, 2, 1, 3).reshape(B, S, D) @ wo

    def _B_ref(x, w_gate, w_up, w_down):
        g = torch.einsum("bsd,df->bsf", x, w_gate)
        u = torch.einsum("bsd,df->bsf", x, w_up)
        h = _sigmoid(g) * u
        return torch.einsum("bsf,fd->bsd", h, w_down)

    x = A_x
    h = x + _A_ref(_layernorm(x, axis=-1), A_wqkv, A_wo)
    h2 = h + _B_ref(_layernorm(h, axis=-1), B_w_gate, B_w_up, B_w_down)
    return h2
```

```asm
; @launch grid=(256,1,1) block=(512,1,1) lds=163840
.amdgcn_target "amdgcn-amd-amdhsa--gfx950"
.text
.globl sequential_preLN__sliding_block__glu_gated_glu__prompt_kernel
.p2align 8
.type sequential_preLN__sliding_block__glu_gated_glu__prompt_kernel,@function
sequential_preLN__sliding_block__glu_gated_glu__prompt_kernel:
  s_cmp_ge_u32 s2, 256
  s_cbranch_scc1 .L_end
  s_load_dwordx16 s[16:31], s[0:1], 0
  s_load_dwordx4 s[32:35], s[0:1], 64
  v_lshrrev_b32 v1, 6, v0
  v_and_b32 v0, 63, v0
  v_readfirstlane_b32 s3, v1
  v_lshlrev_b32 v1, 4, v0
  s_and_b32 s44, s2, 7
  s_lshr_b32 s45, s2, 3
  s_and_b32 s40, s44, 1
  s_lshl_b32 s40, s40, 2
  s_and_b32 s46, s45, 3
  s_add_u32 s40, s40, s46
  s_lshr_b32 s41, s44, 1
  s_lshr_b32 s42, s45, 2
  s_lshl_b32 s43, s41, 3
  s_add_u32 s43, s43, s42
  s_waitcnt lgkmcnt(0)
  s_mov_b32 s4, s34
  s_and_b32 s5, s35, 0xffff
  s_mov_b32 s6, 0x10000000
  s_mov_b32 s7, 0x00020000
  s_add_u32 s44, s34, 0
  s_addc_u32 s45, s35, 0
  s_load_dword s101, s[44:45], 0
  s_cmp_lt_u32 s42, 6
  s_cbranch_scc1 .L_s1_qkv
  s_lshl_b32 s52, s40, 2
  s_add_u32 s52, s52, s41
  s_lshl_b32 s52, s52, 1
  s_and_b32 s44, s42, 1
  s_add_u32 s52, s52, s44
  v_lshrrev_b32 v16, 3, v0
  v_and_b32 v17, 7, v0
  v_lshlrev_b32 v17, 4, v17
  s_cmp_ge_u32 s3, 4
  s_cbranch_scc1 .L_pp_cs
  s_mov_b32 s8, s16
  s_and_b32 s9, s17, 0xffff
  s_mov_b32 s10, 0x00240000
  s_mov_b32 s11, 0x00020000
  v_mul_u32_u24 v18, 1152, v16
  v_add_u32 v18, v18, v17
  s_lshl_b32 s45, s52, 2
  s_add_u32 s45, s45, s3
  s_mul_i32 s46, s45, 9216
  buffer_load_dwordx4 v[64:67], v18, s[8:11], s46 offen offset:0
  buffer_load_dwordx4 v[68:71], v18, s[8:11], s46 offen offset:128
  buffer_load_dwordx4 v[72:75], v18, s[8:11], s46 offen offset:256
  buffer_load_dwordx4 v[76:79], v18, s[8:11], s46 offen offset:384
  buffer_load_dwordx4 v[80:83], v18, s[8:11], s46 offen offset:512
  buffer_load_dwordx4 v[84:87], v18, s[8:11], s46 offen offset:640
  buffer_load_dwordx4 v[88:91], v18, s[8:11], s46 offen offset:768
  buffer_load_dwordx4 v[92:95], v18, s[8:11], s46 offen offset:896
  buffer_load_dwordx4 v[96:99], v18, s[8:11], s46 offen offset:1024
  s_branch .L_pp_A2
.L_pp_cs:
  s_mov_b32 s12, s18
  s_and_b32 s13, s19, 0xffff
  s_mov_b32 s14, 0x001e6000
  s_mov_b32 s15, 0x00020000
  v_mul_u32_u24 v18, 3456, v16
  v_add_u32 v18, v18, v17
  s_lshl_b32 s45, s44, 2
  s_add_u32 s45, s45, s3
  s_sub_u32 s45, s45, 4
  s_mul_i32 s46, s45, 248832
  s_lshr_b32 s47, s52, 1
  s_lshl_b32 s48, s47, 7
  s_add_u32 s46, s46, s48
  s_cmp_ge_u32 s52, 54
  s_cselect_b32 s46, 0x7f000000, s46
  buffer_load_dwordx4 v[64:67], v18, s[12:15], s46 offen
  s_add_u32 s46, s46, 27648
  buffer_load_dwordx4 v[68:71], v18, s[12:15], s46 offen
  s_add_u32 s46, s46, 27648
  buffer_load_dwordx4 v[72:75], v18, s[12:15], s46 offen
  s_add_u32 s46, s46, 27648
  buffer_load_dwordx4 v[76:79], v18, s[12:15], s46 offen
  s_add_u32 s46, s46, 27648
  buffer_load_dwordx4 v[80:83], v18, s[12:15], s46 offen
  s_add_u32 s46, s46, 27648
  buffer_load_dwordx4 v[84:87], v18, s[12:15], s46 offen
  s_add_u32 s46, s46, 27648
  buffer_load_dwordx4 v[88:91], v18, s[12:15], s46 offen
  s_add_u32 s46, s46, 27648
  buffer_load_dwordx4 v[92:95], v18, s[12:15], s46 offen
  s_add_u32 s46, s46, 27648
  buffer_load_dwordx4 v[96:99], v18, s[12:15], s46 offen
  s_add_u32 s46, s46, 27648
  s_branch .L_pp_B2
.L_s1_qkv:
  s_mul_i32 s53, s41, 3
  s_lshr_b32 s44, s42, 1
  s_add_u32 s53, s53, s44
  s_lshl_b32 s52, s40, 1
  s_and_b32 s44, s42, 1
  s_add_u32 s52, s52, s44
  s_and_b32 s56, s3, 3
  s_lshl_b32 s54, s56, 12
  s_cmp_lt_u32 s3, 4
  s_cbranch_scc1 .L_s1_comp
  s_mov_b32 s8, s16
  s_and_b32 s9, s17, 0xffff
  s_mov_b32 s10, 0x00240000
  s_mov_b32 s11, 0x00020000
  s_mov_b32 s12, s18
  s_and_b32 s13, s19, 0xffff
  s_mov_b32 s14, 0x001e6000
  s_mov_b32 s15, 0x00020000
  s_lshl_b32 s44, s52, 7
  s_lshl_b32 s45, s56, 5
  s_add_u32 s44, s44, s45
  v_lshrrev_b32 v19, 3, v0
  v_add_u32 v19, s44, v19
  v_mul_u32_u24 v19, 1152, v19
  v_lshrrev_b32 v20, 4, v0
  v_and_b32 v21, 7, v0
  v_xor_b32 v21, v21, v20
  v_xor_b32 v22, 4, v21
  v_lshl_add_u32 v2, v21, 4, v19
  v_lshl_add_u32 v3, v22, 4, v19
  v_add_u32 v3, 8192, v3
  v_lshl_add_u32 v4, v21, 4, v19
  v_add_u32 v4, 16384, v4
  v_lshl_add_u32 v5, v22, 4, v19
  v_add_u32 v5, 24576, v5
  s_add_u32 m0, s54, 0
  s_mov_b32 s44, 0
  buffer_load_dwordx4 v2, s[8:11], s44 offen offset:0 lds
  buffer_load_dwordx4 v3, s[8:11], s44 offen offset:1024 lds
  buffer_load_dwordx4 v4, s[8:11], s44 offen offset:2048 lds
  buffer_load_dwordx4 v5, s[8:11], s44 offen offset:3072 lds
  s_mul_i32 s46, s56, 55296
  s_mul_i32 s47, s53, 288
  s_add_u32 s46, s46, s47
  s_mul_i32 s55, s56, 5120
  s_add_u32 s55, s55, 16384
  v_add_u32 v19, 0, v0
  v_mul_u32_u24 v20, 3641, v19
  v_lshrrev_b32 v20, 16, v20
  v_mul_u32_u24 v21, 18, v20
  v_sub_u32 v19, v19, v21
  v_and_b32 v21, 3, v20
  v_and_b32 v22, 4, v20
  v_lshl_or_b32 v21, v22, 1, v21
  v_bfe_u32 v22, v20, 3, 1
  v_lshl_or_b32 v20, v22, 2, v21
  v_mul_u32_u24 v21, 3456, v20
  v_lshl_add_u32 v6, v19, 4, v21
  v_add_u32 v6, s46, v6
  v_add_u32 v19, 64, v0
  v_mul_u32_u24 v20, 3641, v19
  v_lshrrev_b32 v20, 16, v20
  v_mul_u32_u24 v21, 18, v20
  v_sub_u32 v19, v19, v21
  v_and_b32 v21, 3, v20
  v_and_b32 v22, 4, v20
  v_lshl_or_b32 v21, v22, 1, v21
  v_bfe_u32 v22, v20, 3, 1
  v_lshl_or_b32 v20, v22, 2, v21
  v_mul_u32_u24 v21, 3456, v20
  v_lshl_add_u32 v7, v19, 4, v21
  v_add_u32 v7, s46, v7
  v_subrev_u32 v7, 1024, v7
  v_add_u32 v19, 128, v0
  v_mul_u32_u24 v20, 3641, v19
  v_lshrrev_b32 v20, 16, v20
  v_mul_u32_u24 v21, 18, v20
  v_sub_u32 v19, v19, v21
  v_and_b32 v21, 3, v20
  v_and_b32 v22, 4, v20
  v_lshl_or_b32 v21, v22, 1, v21
  v_bfe_u32 v22, v20, 3, 1
  v_lshl_or_b32 v20, v22, 2, v21
  v_mul_u32_u24 v21, 3456, v20
  v_lshl_add_u32 v8, v19, 4, v21
  v_add_u32 v8, s46, v8
  v_subrev_u32 v8, 2048, v8
  v_add_u32 v19, 192, v0
  v_mul_u32_u24 v20, 3641, v19
  v_lshrrev_b32 v20, 16, v20
  v_mul_u32_u24 v21, 18, v20
  v_sub_u32 v19, v19, v21
  v_and_b32 v21, 3, v20
  v_and_b32 v22, 4, v20
  v_lshl_or_b32 v21, v22, 1, v21
  v_bfe_u32 v22, v20, 3, 1
  v_lshl_or_b32 v20, v22, 2, v21
  v_mul_u32_u24 v21, 3456, v20
  v_lshl_add_u32 v9, v19, 4, v21
  v_add_u32 v9, s46, v9
  v_subrev_u32 v9, 3072, v9
  v_add_u32 v19, 256, v0
  v_mul_u32_u24 v20, 3641, v19
  v_lshrrev_b32 v20, 16, v20
  v_mul_u32_u24 v21, 18, v20
  v_sub_u32 v19, v19, v21
  v_and_b32 v21, 3, v20
  v_and_b32 v22, 4, v20
  v_lshl_or_b32 v21, v22, 1, v21
  v_bfe_u32 v22, v20, 3, 1
  v_lshl_or_b32 v20, v22, 2, v21
  v_mul_u32_u24 v21, 3456, v20
  v_lshl_add_u32 v10, v19, 4, v21
  v_add_u32 v10, s46, v10
  v_mov_b32 v21, 0x7ff00000
  v_cmp_gt_u32 vcc, 32, v0
  s_nop 1
  v_cndmask_b32 v10, v21, v10, vcc
  s_add_u32 m0, s55, 0
  s_mov_b32 s45, 0
  buffer_load_dwordx4 v6, s[12:15], s45 offen offset:0 lds
  buffer_load_dwordx4 v7, s[12:15], s45 offen offset:1024 lds
  buffer_load_dwordx4 v8, s[12:15], s45 offen offset:2048 lds
  buffer_load_dwordx4 v9, s[12:15], s45 offen offset:3072 lds
  s_add_u32 m0, s55, 4096
  s_nop 0
  buffer_load_dwordx4 v10, s[12:15], s45 offen lds
  s_add_u32 m0, s54, 36864
  s_mov_b32 s44, 128
  buffer_load_dwordx4 v2, s[8:11], s44 offen offset:0 lds
  buffer_load_dwordx4 v3, s[8:11], s44 offen offset:1024 lds
  buffer_load_dwordx4 v4, s[8:11], s44 offen offset:2048 lds
  buffer_load_dwordx4 v5, s[8:11], s44 offen offset:3072 lds
  s_add_u32 m0, s55, 36864
  s_mov_b32 s45, 221184
  buffer_load_dwordx4 v6, s[12:15], s45 offen offset:0 lds
  buffer_load_dwordx4 v7, s[12:15], s45 offen offset:1024 lds
  buffer_load_dwordx4 v8, s[12:15], s45 offen offset:2048 lds
  buffer_load_dwordx4 v9, s[12:15], s45 offen offset:3072 lds
  s_add_u32 m0, s55, 40960
  s_nop 0
  buffer_load_dwordx4 v10, s[12:15], s45 offen lds
  s_waitcnt vmcnt(9)
  s_barrier
  s_add_u32 m0, s54, 73728
  s_mov_b32 s44, 256
  buffer_load_dwordx4 v2, s[8:11], s44 offen offset:0 lds
  buffer_load_dwordx4 v3, s[8:11], s44 offen offset:1024 lds
  buffer_load_dwordx4 v4, s[8:11], s44 offen offset:2048 lds
  buffer_load_dwordx4 v5, s[8:11], s44 offen offset:3072 lds
  s_add_u32 m0, s55, 73728
  s_mov_b32 s45, 442368
  buffer_load_dwordx4 v6, s[12:15], s45 offen offset:0 lds
  buffer_load_dwordx4 v7, s[12:15], s45 offen offset:1024 lds
  buffer_load_dwordx4 v8, s[12:15], s45 offen offset:2048 lds
  buffer_load_dwordx4 v9, s[12:15], s45 offen offset:3072 lds
  s_add_u32 m0, s55, 77824
  s_nop 0
  buffer_load_dwordx4 v10, s[12:15], s45 offen lds
  s_add_u32 m0, s54, 110592
  s_mov_b32 s44, 384
  buffer_load_dwordx4 v2, s[8:11], s44 offen offset:0 lds
  buffer_load_dwordx4 v3, s[8:11], s44 offen offset:1024 lds
  buffer_load_dwordx4 v4, s[8:11], s44 offen offset:2048 lds
  buffer_load_dwordx4 v5, s[8:11], s44 offen offset:3072 lds
  s_add_u32 m0, s55, 110592
  s_mov_b32 s45, 663552
  buffer_load_dwordx4 v6, s[12:15], s45 offen offset:0 lds
  buffer_load_dwordx4 v7, s[12:15], s45 offen offset:1024 lds
  buffer_load_dwordx4 v8, s[12:15], s45 offen offset:2048 lds
  buffer_load_dwordx4 v9, s[12:15], s45 offen offset:3072 lds
  s_add_u32 m0, s55, 114688
  s_nop 0
  buffer_load_dwordx4 v10, s[12:15], s45 offen lds
  s_waitcnt vmcnt(18)
  s_barrier
  s_add_u32 m0, s54, 0
  s_mov_b32 s44, 512
  buffer_load_dwordx4 v2, s[8:11], s44 offen offset:0 lds
  buffer_load_dwordx4 v3, s[8:11], s44 offen offset:1024 lds
  buffer_load_dwordx4 v4, s[8:11], s44 offen offset:2048 lds
  buffer_load_dwordx4 v5, s[8:11], s44 offen offset:3072 lds
  s_add_u32 m0, s55, 0
  s_mov_b32 s45, 884736
  buffer_load_dwordx4 v6, s[12:15], s45 offen offset:0 lds
  buffer_load_dwordx4 v7, s[12:15], s45 offen offset:1024 lds
  buffer_load_dwordx4 v8, s[12:15], s45 offen offset:2048 lds
  buffer_load_dwordx4 v9, s[12:15], s45 offen offset:3072 lds
  s_add_u32 m0, s55, 4096
  s_nop 0
  buffer_load_dwordx4 v10, s[12:15], s45 offen lds
  s_waitcnt vmcnt(18)
  s_barrier
  s_add_u32 m0, s54, 36864
  s_mov_b32 s44, 640
  buffer_load_dwordx4 v2, s[8:11], s44 offen offset:0 lds
  buffer_load_dwordx4 v3, s[8:11], s44 offen offset:1024 lds
  buffer_load_dwordx4 v4, s[8:11], s44 offen offset:2048 lds
  buffer_load_dwordx4 v5, s[8:11], s44 offen offset:3072 lds
  s_add_u32 m0, s55, 36864
  s_mov_b32 s45, 1105920
  buffer_load_dwordx4 v6, s[12:15], s45 offen offset:0 lds
  buffer_load_dwordx4 v7, s[12:15], s45 offen offset:1024 lds
  buffer_load_dwordx4 v8, s[12:15], s45 offen offset:2048 lds
  buffer_load_dwordx4 v9, s[12:15], s45 offen offset:3072 lds
  s_add_u32 m0, s55, 40960
  s_nop 0
  buffer_load_dwordx4 v10, s[12:15], s45 offen lds
  s_waitcnt vmcnt(18)
  s_barrier
  s_add_u32 m0, s54, 73728
  s_mov_b32 s44, 768
  buffer_load_dwordx4 v2, s[8:11], s44 offen offset:0 lds
  buffer_load_dwordx4 v3, s[8:11], s44 offen offset:1024 lds
  buffer_load_dwordx4 v4, s[8:11], s44 offen offset:2048 lds
  buffer_load_dwordx4 v5, s[8:11], s44 offen offset:3072 lds
  s_add_u32 m0, s55, 73728
  s_mov_b32 s45, 1327104
  buffer_load_dwordx4 v6, s[12:15], s45 offen offset:0 lds
  buffer_load_dwordx4 v7, s[12:15], s45 offen offset:1024 lds
  buffer_load_dwordx4 v8, s[12:15], s45 offen offset:2048 lds
  buffer_load_dwordx4 v9, s[12:15], s45 offen offset:3072 lds
  s_add_u32 m0, s55, 77824
  s_nop 0
  buffer_load_dwordx4 v10, s[12:15], s45 offen lds
  s_waitcnt vmcnt(18)
  s_barrier
  s_add_u32 m0, s54, 110592
  s_mov_b32 s44, 896
  buffer_load_dwordx4 v2, s[8:11], s44 offen offset:0 lds
  buffer_load_dwordx4 v3, s[8:11], s44 offen offset:1024 lds
  buffer_load_dwordx4 v4, s[8:11], s44 offen offset:2048 lds
  buffer_load_dwordx4 v5, s[8:11], s44 offen offset:3072 lds
  s_add_u32 m0, s55, 110592
  s_mov_b32 s45, 1548288
  buffer_load_dwordx4 v6, s[12:15], s45 offen offset:0 lds
  buffer_load_dwordx4 v7, s[12:15], s45 offen offset:1024 lds
  buffer_load_dwordx4 v8, s[12:15], s45 offen offset:2048 lds
  buffer_load_dwordx4 v9, s[12:15], s45 offen offset:3072 lds
  s_add_u32 m0, s55, 114688
  s_nop 0
  buffer_load_dwordx4 v10, s[12:15], s45 offen lds
  s_waitcnt vmcnt(18)
  s_barrier
  s_add_u32 m0, s54, 0
  s_mov_b32 s44, 1024
  buffer_load_dwordx4 v2, s[8:11], s44 offen offset:0 lds
  buffer_load_dwordx4 v3, s[8:11], s44 offen offset:1024 lds
  buffer_load_dwordx4 v4, s[8:11], s44 offen offset:2048 lds
  buffer_load_dwordx4 v5, s[8:11], s44 offen offset:3072 lds
  s_add_u32 m0, s55, 0
  s_mov_b32 s45, 1769472
  buffer_load_dwordx4 v6, s[12:15], s45 offen offset:0 lds
  buffer_load_dwordx4 v7, s[12:15], s45 offen offset:1024 lds
  buffer_load_dwordx4 v8, s[12:15], s45 offen offset:2048 lds
  buffer_load_dwordx4 v9, s[12:15], s45 offen offset:3072 lds
  s_add_u32 m0, s55, 4096
  s_nop 0
  buffer_load_dwordx4 v10, s[12:15], s45 offen lds
  s_waitcnt vmcnt(18)
  s_barrier
  s_waitcnt vmcnt(9)
  s_barrier
  s_waitcnt vmcnt(0)
  s_barrier
  s_barrier
  s_cmp_lg_u32 s53, 11
  s_cbranch_scc1 .L_s1_done
  s_cmp_lg_u32 s56, 1
  s_cbranch_scc1 .L_s1_done
  v_mov_b32 v40, 0x3f803f80
  v_mov_b32 v41, 0x3f803f80
  v_mov_b32 v42, 0x3f803f80
  v_mov_b32 v43, 0x3f803f80
  v_lshrrev_b32 v19, 2, v0
  v_mul_u32_u24 v19, 9344, v19
  v_and_b32 v20, 3, v0
  v_lshl_add_u32 v19, v20, 4, v19
  s_mul_i32 s44, s52, 149504
  s_add_u32 s44, s44, 7414784
  buffer_store_dwordx4 v[40:43], v19, s[4:7], s44 offen sc1
  s_branch .L_s1_done
.L_s1_comp:
  s_cmp_lg_u32 s42, 0
  s_cbranch_scc1 .Lm_1
  s_getpc_b64 s[44:45]
.L_pcref:
  s_sub_u32 s44, s44, .L_pcref-sequential_preLN__sliding_block__glu_gated_glu__prompt_kernel
  s_subb_u32 s45, s45, 0
  s_lshl_b32 s46, s3, 13
  v_lshlrev_b32 v8, 7, v0
  v_add_u32 v8, s46, v8
  v_min_u32 v9, .L_end-sequential_preLN__sliding_block__glu_gated_glu__prompt_kernel, v8
  global_load_dword v180, v9, s[44:45]
  v_add_u32 v8, 32768, v8
  v_min_u32 v10, .L_end-sequential_preLN__sliding_block__glu_gated_glu__prompt_kernel, v8
  global_load_dword v181, v10, s[44:45]
  v_add_u32 v8, 32768, v8
  v_min_u32 v11, .L_end-sequential_preLN__sliding_block__glu_gated_glu__prompt_kernel, v8
  global_load_dword v182, v11, s[44:45]
  v_add_u32 v8, 32768, v8
.Lm_1:
  v_and_b32 v8, 15, v0
  v_lshrrev_b32 v9, 4, v0
  v_lshrrev_b32 v10, 1, v8
  v_xor_b32 v10, v10, v9
  v_lshlrev_b32 v11, 7, v8
  v_add_u32 v11, s54, v11
  v_lshl_add_u32 v2, v10, 4, v11
  v_xor_b32 v10, 4, v10
  v_lshl_add_u32 v4, v10, 4, v11
  v_add_u32 v3, 73728, v2
  v_add_u32 v5, 73728, v4
  v_bfe_u32 v8, v0, 5, 1
  v_mul_u32_u24 v8, 5120, v8
  v_bfe_u32 v9, v0, 2, 3
  v_mul_u32_u24 v9, 288, v9
  v_and_b32 v10, 3, v0
  v_lshlrev_b32 v10, 3, v10
  v_add3_u32 v6, v8, v9, v10
  v_add_u32 v6, 16384, v6
  v_add_u32 v7, 73728, v6
  v_mov_b32 v232, 0
  s_cmp_ge_u32 s53, 8
  s_cbranch_scc1 .L_s1_v
  s_barrier
  ds_read_b128 v[16:19], v2 offset:0
  ds_read_b128 v[20:23], v2 offset:2048
  ds_read_b64_tr_b16 v[32:33], v6 offset:0
  ds_read_b64_tr_b16 v[34:35], v6 offset:2304
  ds_read_b64_tr_b16 v[36:37], v6 offset:32
  ds_read_b64_tr_b16 v[38:39], v6 offset:2336
  ds_read_b64_tr_b16 v[40:41], v6 offset:64
  ds_read_b64_tr_b16 v[42:43], v6 offset:2368
  ds_read_b64_tr_b16 v[44:45], v6 offset:96
  ds_read_b64_tr_b16 v[46:47], v6 offset:2400
  ds_read_b64_tr_b16 v[48:49], v6 offset:128
  ds_read_b64_tr_b16 v[50:51], v6 offset:2432
  ds_read_b64_tr_b16 v[52:53], v6 offset:160
  ds_read_b64_tr_b16 v[54:55], v6 offset:2464
  ds_read_b64_tr_b16 v[56:57], v6 offset:192
  ds_read_b64_tr_b16 v[58:59], v6 offset:2496
  ds_read_b64_tr_b16 v[60:61], v6 offset:224
  ds_read_b64_tr_b16 v[62:63], v6 offset:2528
  ds_read_b64_tr_b16 v[64:65], v6 offset:256
  ds_read_b64_tr_b16 v[66:67], v6 offset:2560
  s_waitcnt lgkmcnt(0)
  v_mfma_f32_16x16x32_bf16 v[104:107], v[32:35], v[16:19], 0
  ds_read_b128 v[24:27], v4 offset:0
  ds_read_b128 v[28:31], v4 offset:2048
  v_mfma_f32_16x16x32_bf16 v[140:143], v[32:35], v[20:23], 0
  ds_read_b64_tr_b16 v[68:69], v6 offset:10240
  ds_read_b64_tr_b16 v[70:71], v6 offset:12544
  v_mfma_f32_16x16x32_bf16 v[108:111], v[36:39], v[16:19], 0
  ds_read_b64_tr_b16 v[72:73], v6 offset:10272
  v_mfma_f32_16x16x32_bf16 v[144:147], v[36:39], v[20:23], 0
  ds_read_b64_tr_b16 v[74:75], v6 offset:12576
  v_mfma_f32_16x16x32_bf16 v[112:115], v[40:43], v[16:19], 0
  ds_read_b64_tr_b16 v[76:77], v6 offset:10304
  v_mfma_f32_16x16x32_bf16 v[148:151], v[40:43], v[20:23], 0
  ds_read_b64_tr_b16 v[78:79], v6 offset:12608
  v_mfma_f32_16x16x32_bf16 v[116:119], v[44:47], v[16:19], 0
  ds_read_b64_tr_b16 v[80:81], v6 offset:10336
  v_mfma_f32_16x16x32_bf16 v[152:155], v[44:47], v[20:23], 0
  ds_read_b64_tr_b16 v[82:83], v6 offset:12640
  v_mfma_f32_16x16x32_bf16 v[120:123], v[48:51], v[16:19], 0
  ds_read_b64_tr_b16 v[84:85], v6 offset:10368
  v_mfma_f32_16x16x32_bf16 v[156:159], v[48:51], v[20:23], 0
  ds_read_b64_tr_b16 v[86:87], v6 offset:12672
  v_mfma_f32_16x16x32_bf16 v[124:127], v[52:55], v[16:19], 0
  ds_read_b64_tr_b16 v[88:89], v6 offset:10400
  v_mfma_f32_16x16x32_bf16 v[160:163], v[52:55], v[20:23], 0
  ds_read_b64_tr_b16 v[90:91], v6 offset:12704
  v_mfma_f32_16x16x32_bf16 v[128:131], v[56:59], v[16:19], 0
  ds_read_b64_tr_b16 v[92:93], v6 offset:10432
  v_mfma_f32_16x16x32_bf16 v[164:167], v[56:59], v[20:23], 0
  ds_read_b64_tr_b16 v[94:95], v6 offset:12736
  v_mfma_f32_16x16x32_bf16 v[132:135], v[60:63], v[16:19], 0
  ds_read_b64_tr_b16 v[96:97], v6 offset:10464
  v_mfma_f32_16x16x32_bf16 v[168:171], v[60:63], v[20:23], 0
  ds_read_b64_tr_b16 v[98:99], v6 offset:12768
  v_mfma_f32_16x16x32_bf16 v[136:139], v[64:67], v[16:19], 0
  ds_read_b64_tr_b16 v[100:101], v6 offset:10496
  v_mfma_f32_16x16x32_bf16 v[172:175], v[64:67], v[20:23], 0
  ds_read_b64_tr_b16 v[102:103], v6 offset:12800
  s_waitcnt lgkmcnt(0)
  s_barrier
  v_mfma_f32_16x16x32_bf16 v[104:107], v[68:71], v[24:27], v[104:107]
  ds_read_b128 v[16:19], v2 offset:36864
  ds_read_b128 v[20:23], v2 offset:38912
  v_mfma_f32_16x16x32_bf16 v[140:143], v[68:71], v[28:31], v[140:143]
  ds_read_b64_tr_b16 v[32:33], v6 offset:36864
  ds_read_b64_tr_b16 v[34:35], v6 offset:39168
  v_mfma_f32_16x16x32_bf16 v[108:111], v[72:75], v[24:27], v[108:111]
  ds_read_b64_tr_b16 v[36:37], v6 offset:36896
  v_mfma_f32_16x16x32_bf16 v[144:147], v[72:75], v[28:31], v[144:147]
  ds_read_b64_tr_b16 v[38:39], v6 offset:39200
  v_mfma_f32_16x16x32_bf16 v[112:115], v[76:79], v[24:27], v[112:115]
  ds_read_b64_tr_b16 v[40:41], v6 offset:36928
  v_mfma_f32_16x16x32_bf16 v[148:151], v[76:79], v[28:31], v[148:151]
  ds_read_b64_tr_b16 v[42:43], v6 offset:39232
  v_mfma_f32_16x16x32_bf16 v[116:119], v[80:83], v[24:27], v[116:119]
  ds_read_b64_tr_b16 v[44:45], v6 offset:36960
  v_mfma_f32_16x16x32_bf16 v[152:155], v[80:83], v[28:31], v[152:155]
  ds_read_b64_tr_b16 v[46:47], v6 offset:39264
  v_mfma_f32_16x16x32_bf16 v[120:123], v[84:87], v[24:27], v[120:123]
  ds_read_b64_tr_b16 v[48:49], v6 offset:36992
  v_mfma_f32_16x16x32_bf16 v[156:159], v[84:87], v[28:31], v[156:159]
  ds_read_b64_tr_b16 v[50:51], v6 offset:39296
  v_mfma_f32_16x16x32_bf16 v[124:127], v[88:91], v[24:27], v[124:127]
  ds_read_b64_tr_b16 v[52:53], v6 offset:37024
  v_mfma_f32_16x16x32_bf16 v[160:163], v[88:91], v[28:31], v[160:163]
  ds_read_b64_tr_b16 v[54:55], v6 offset:39328
  v_mfma_f32_16x16x32_bf16 v[128:131], v[92:95], v[24:27], v[128:131]
  ds_read_b64_tr_b16 v[56:57], v6 offset:37056
  v_mfma_f32_16x16x32_bf16 v[164:167], v[92:95], v[28:31], v[164:167]
  ds_read_b64_tr_b16 v[58:59], v6 offset:39360
  v_mfma_f32_16x16x32_bf16 v[132:135], v[96:99], v[24:27], v[132:135]
  ds_read_b64_tr_b16 v[60:61], v6 offset:37088
  v_mfma_f32_16x16x32_bf16 v[168:171], v[96:99], v[28:31], v[168:171]
  ds_read_b64_tr_b16 v[62:63], v6 offset:39392
  v_mfma_f32_16x16x32_bf16 v[136:139], v[100:103], v[24:27], v[136:139]
  ds_read_b64_tr_b16 v[64:65], v6 offset:37120
  v_mfma_f32_16x16x32_bf16 v[172:175], v[100:103], v[28:31], v[172:175]
  ds_read_b64_tr_b16 v[66:67], v6 offset:39424
  s_waitcnt lgkmcnt(0)
  v_mfma_f32_16x16x32_bf16 v[104:107], v[32:35], v[16:19], v[104:107]
  ds_read_b128 v[24:27], v4 offset:36864
  ds_read_b128 v[28:31], v4 offset:38912
  v_mfma_f32_16x16x32_bf16 v[140:143], v[32:35], v[20:23], v[140:143]
  ds_read_b64_tr_b16 v[68:69], v6 offset:47104
  ds_read_b64_tr_b16 v[70:71], v6 offset:49408
  v_mfma_f32_16x16x32_bf16 v[108:111], v[36:39], v[16:19], v[108:111]
  ds_read_b64_tr_b16 v[72:73], v6 offset:47136
  v_mfma_f32_16x16x32_bf16 v[144:147], v[36:39], v[20:23], v[144:147]
  ds_read_b64_tr_b16 v[74:75], v6 offset:49440
  v_mfma_f32_16x16x32_bf16 v[112:115], v[40:43], v[16:19], v[112:115]
  ds_read_b64_tr_b16 v[76:77], v6 offset:47168
  v_mfma_f32_16x16x32_bf16 v[148:151], v[40:43], v[20:23], v[148:151]
  ds_read_b64_tr_b16 v[78:79], v6 offset:49472
  v_mfma_f32_16x16x32_bf16 v[116:119], v[44:47], v[16:19], v[116:119]
  ds_read_b64_tr_b16 v[80:81], v6 offset:47200
  v_mfma_f32_16x16x32_bf16 v[152:155], v[44:47], v[20:23], v[152:155]
  ds_read_b64_tr_b16 v[82:83], v6 offset:49504
  v_mfma_f32_16x16x32_bf16 v[120:123], v[48:51], v[16:19], v[120:123]
  ds_read_b64_tr_b16 v[84:85], v6 offset:47232
  v_mfma_f32_16x16x32_bf16 v[156:159], v[48:51], v[20:23], v[156:159]
  ds_read_b64_tr_b16 v[86:87], v6 offset:49536
  v_mfma_f32_16x16x32_bf16 v[124:127], v[52:55], v[16:19], v[124:127]
  ds_read_b64_tr_b16 v[88:89], v6 offset:47264
  v_mfma_f32_16x16x32_bf16 v[160:163], v[52:55], v[20:23], v[160:163]
  ds_read_b64_tr_b16 v[90:91], v6 offset:49568
  v_mfma_f32_16x16x32_bf16 v[128:131], v[56:59], v[16:19], v[128:131]
  ds_read_b64_tr_b16 v[92:93], v6 offset:47296
  v_mfma_f32_16x16x32_bf16 v[164:167], v[56:59], v[20:23], v[164:167]
  ds_read_b64_tr_b16 v[94:95], v6 offset:49600
  v_mfma_f32_16x16x32_bf16 v[132:135], v[60:63], v[16:19], v[132:135]
  ds_read_b64_tr_b16 v[96:97], v6 offset:47328
  v_mfma_f32_16x16x32_bf16 v[168:171], v[60:63], v[20:23], v[168:171]
  ds_read_b64_tr_b16 v[98:99], v6 offset:49632
  v_mfma_f32_16x16x32_bf16 v[136:139], v[64:67], v[16:19], v[136:139]
  ds_read_b64_tr_b16 v[100:101], v6 offset:47360
  v_mfma_f32_16x16x32_bf16 v[172:175], v[64:67], v[20:23], v[172:175]
  ds_read_b64_tr_b16 v[102:103], v6 offset:49664
  s_waitcnt lgkmcnt(0)
  s_barrier
  v_mfma_f32_16x16x32_bf16 v[104:107], v[68:71], v[24:27], v[104:107]
  ds_read_b128 v[16:19], v3 offset:0
  ds_read_b128 v[20:23], v3 offset:2048
  v_mfma_f32_16x16x32_bf16 v[140:143], v[68:71], v[28:31], v[140:143]
  ds_read_b64_tr_b16 v[32:33], v7 offset:0
  ds_read_b64_tr_b16 v[34:35], v7 offset:2304
  v_mfma_f32_16x16x32_bf16 v[108:111], v[72:75], v[24:27], v[108:111]
  ds_read_b64_tr_b16 v[36:37], v7 offset:32
  v_mfma_f32_16x16x32_bf16 v[144:147], v[72:75], v[28:31], v[144:147]
  ds_read_b64_tr_b16 v[38:39], v7 offset:2336
  v_mfma_f32_16x16x32_bf16 v[112:115], v[76:79], v[24:27], v[112:115]
  ds_read_b64_tr_b16 v[40:41], v7 offset:64
  v_mfma_f32_16x16x32_bf16 v[148:151], v[76:79], v[28:31], v[148:151]
  ds_read_b64_tr_b16 v[42:43], v7 offset:2368
  v_mfma_f32_16x16x32_bf16 v[116:119], v[80:83], v[24:27], v[116:119]
  ds_read_b64_tr_b16 v[44:45], v7 offset:96
  v_mfma_f32_16x16x32_bf16 v[152:155], v[80:83], v[28:31], v[152:155]
  ds_read_b64_tr_b16 v[46:47], v7 offset:2400
  v_mfma_f32_16x16x32_bf16 v[120:123], v[84:87], v[24:27], v[120:123]
  ds_read_b64_tr_b16 v[48:49], v7 offset:128
  v_mfma_f32_16x16x32_bf16 v[156:159], v[84:87], v[28:31], v[156:159]
  ds_read_b64_tr_b16 v[50:51], v7 offset:2432
  v_mfma_f32_16x16x32_bf16 v[124:127], v[88:91], v[24:27], v[124:127]
  ds_read_b64_tr_b16 v[52:53], v7 offset:160
  v_mfma_f32_16x16x32_bf16 v[160:163], v[88:91], v[28:31], v[160:163]
  ds_read_b64_tr_b16 v[54:55], v7 offset:2464
  v_mfma_f32_16x16x32_bf16 v[128:131], v[92:95], v[24:27], v[128:131]
  ds_read_b64_tr_b16 v[56:57], v7 offset:192
  v_mfma_f32_16x16x32_bf16 v[164:167], v[92:95], v[28:31], v[164:167]
  ds_read_b64_tr_b16 v[58:59], v7 offset:2496
  v_mfma_f32_16x16x32_bf16 v[132:135], v[96:99], v[24:27], v[132:135]
  ds_read_b64_tr_b16 v[60:61], v7 offset:224
  v_mfma_f32_16x16x32_bf16 v[168:171], v[96:99], v[28:31], v[168:171]
  ds_read_b64_tr_b16 v[62:63], v7 offset:2528
  v_mfma_f32_16x16x32_bf16 v[136:139], v[100:103], v[24:27], v[136:139]
  ds_read_b64_tr_b16 v[64:65], v7 offset:256
  v_mfma_f32_16x16x32_bf16 v[172:175], v[100:103], v[28:31], v[172:175]
  ds_read_b64_tr_b16 v[66:67], v7 offset:2560
  s_waitcnt lgkmcnt(0)
  v_mfma_f32_16x16x32_bf16 v[104:107], v[32:35], v[16:19], v[104:107]
  ds_read_b128 v[24:27], v5 offset:0
  ds_read_b128 v[28:31], v5 offset:2048
  v_mfma_f32_16x16x32_bf16 v[140:143], v[32:35], v[20:23], v[140:143]
  ds_read_b64_tr_b16 v[68:69], v7 offset:10240
  ds_read_b64_tr_b16 v[70:71], v7 offset:12544
  v_mfma_f32_16x16x32_bf16 v[108:111], v[36:39], v[16:19], v[108:111]
  ds_read_b64_tr_b16 v[72:73], v7 offset:10272
  v_mfma_f32_16x16x32_bf16 v[144:147], v[36:39], v[20:23], v[144:147]
  ds_read_b64_tr_b16 v[74:75], v7 offset:12576
  v_mfma_f32_16x16x32_bf16 v[112:115], v[40:43], v[16:19], v[112:115]
  ds_read_b64_tr_b16 v[76:77], v7 offset:10304
  v_mfma_f32_16x16x32_bf16 v[148:151], v[40:43], v[20:23], v[148:151]
  ds_read_b64_tr_b16 v[78:79], v7 offset:12608
  v_mfma_f32_16x16x32_bf16 v[116:119], v[44:47], v[16:19], v[116:119]
  ds_read_b64_tr_b16 v[80:81], v7 offset:10336
  v_mfma_f32_16x16x32_bf16 v[152:155], v[44:47], v[20:23], v[152:155]
  ds_read_b64_tr_b16 v[82:83], v7 offset:12640
  v_mfma_f32_16x16x32_bf16 v[120:123], v[48:51], v[16:19], v[120:123]
  ds_read_b64_tr_b16 v[84:85], v7 offset:10368
  v_mfma_f32_16x16x32_bf16 v[156:159], v[48:51], v[20:23], v[156:159]
  ds_read_b64_tr_b16 v[86:87], v7 offset:12672
  v_mfma_f32_16x16x32_bf16 v[124:127], v[52:55], v[16:19], v[124:127]
  ds_read_b64_tr_b16 v[88:89], v7 offset:10400
  v_mfma_f32_16x16x32_bf16 v[160:163], v[52:55], v[20:23], v[160:163]
  ds_read_b64_tr_b16 v[90:91], v7 offset:12704
  v_mfma_f32_16x16x32_bf16 v[128:131], v[56:59], v[16:19], v[128:131]
  ds_read_b64_tr_b16 v[92:93], v7 offset:10432
  v_mfma_f32_16x16x32_bf16 v[164:167], v[56:59], v[20:23], v[164:167]
  ds_read_b64_tr_b16 v[94:95], v7 offset:12736
  v_mfma_f32_16x16x32_bf16 v[132:135], v[60:63], v[16:19], v[132:135]
  ds_read_b64_tr_b16 v[96:97], v7 offset:10464
  v_mfma_f32_16x16x32_bf16 v[168:171], v[60:63], v[20:23], v[168:171]
  ds_read_b64_tr_b16 v[98:99], v7 offset:12768
  v_mfma_f32_16x16x32_bf16 v[136:139], v[64:67], v[16:19], v[136:139]
  ds_read_b64_tr_b16 v[100:101], v7 offset:10496
  v_mfma_f32_16x16x32_bf16 v[172:175], v[64:67], v[20:23], v[172:175]
  ds_read_b64_tr_b16 v[102:103], v7 offset:12800
  s_waitcnt lgkmcnt(0)
  s_barrier
  v_mfma_f32_16x16x32_bf16 v[104:107], v[68:71], v[24:27], v[104:107]
  ds_read_b128 v[16:19], v3 offset:36864
  ds_read_b128 v[20:23], v3 offset:38912
  v_mfma_f32_16x16x32_bf16 v[140:143], v[68:71], v[28:31], v[140:143]
  ds_read_b64_tr_b16 v[32:33], v7 offset:36864
  ds_read_b64_tr_b16 v[34:35], v7 offset:39168
  v_mfma_f32_16x16x32_bf16 v[108:111], v[72:75], v[24:27], v[108:111]
  ds_read_b64_tr_b16 v[36:37], v7 offset:36896
  v_mfma_f32_16x16x32_bf16 v[144:147], v[72:75], v[28:31], v[144:147]
  ds_read_b64_tr_b16 v[38:39], v7 offset:39200
  v_mfma_f32_16x16x32_bf16 v[112:115], v[76:79], v[24:27], v[112:115]
  ds_read_b64_tr_b16 v[40:41], v7 offset:36928
  v_mfma_f32_16x16x32_bf16 v[148:151], v[76:79], v[28:31], v[148:151]
  ds_read_b64_tr_b16 v[42:43], v7 offset:39232
  v_mfma_f32_16x16x32_bf16 v[116:119], v[80:83], v[24:27], v[116:119]
  ds_read_b64_tr_b16 v[44:45], v7 offset:36960
  v_mfma_f32_16x16x32_bf16 v[152:155], v[80:83], v[28:31], v[152:155]
  ds_read_b64_tr_b16 v[46:47], v7 offset:39264
  v_mfma_f32_16x16x32_bf16 v[120:123], v[84:87], v[24:27], v[120:123]
  ds_read_b64_tr_b16 v[48:49], v7 offset:36992
  v_mfma_f32_16x16x32_bf16 v[156:159], v[84:87], v[28:31], v[156:159]
  ds_read_b64_tr_b16 v[50:51], v7 offset:39296
  v_mfma_f32_16x16x32_bf16 v[124:127], v[88:91], v[24:27], v[124:127]
  ds_read_b64_tr_b16 v[52:53], v7 offset:37024
  v_mfma_f32_16x16x32_bf16 v[160:163], v[88:91], v[28:31], v[160:163]
  ds_read_b64_tr_b16 v[54:55], v7 offset:39328
  v_mfma_f32_16x16x32_bf16 v[128:131], v[92:95], v[24:27], v[128:131]
  ds_read_b64_tr_b16 v[56:57], v7 offset:37056
  v_mfma_f32_16x16x32_bf16 v[164:167], v[92:95], v[28:31], v[164:167]
  ds_read_b64_tr_b16 v[58:59], v7 offset:39360
  v_mfma_f32_16x16x32_bf16 v[132:135], v[96:99], v[24:27], v[132:135]
  ds_read_b64_tr_b16 v[60:61], v7 offset:37088
  v_mfma_f32_16x16x32_bf16 v[168:171], v[96:99], v[28:31], v[168:171]
  ds_read_b64_tr_b16 v[62:63], v7 offset:39392
  v_mfma_f32_16x16x32_bf16 v[136:139], v[100:103], v[24:27], v[136:139]
  ds_read_b64_tr_b16 v[64:65], v7 offset:37120
  v_mfma_f32_16x16x32_bf16 v[172:175], v[100:103], v[28:31], v[172:175]
  ds_read_b64_tr_b16 v[66:67], v7 offset:39424
  s_waitcnt lgkmcnt(0)
  v_mfma_f32_16x16x32_bf16 v[104:107], v[32:35], v[16:19], v[104:107]
  ds_read_b128 v[24:27], v5 offset:36864
  ds_read_b128 v[28:31], v5 offset:38912
  v_mfma_f32_16x16x32_bf16 v[140:143], v[32:35], v[20:23], v[140:143]
  ds_read_b64_tr_b16 v[68:69], v7 offset:47104
  ds_read_b64_tr_b16 v[70:71], v7 offset:49408
  v_mfma_f32_16x16x32_bf16 v[108:111], v[36:39], v[16:19], v[108:111]
  ds_read_b64_tr_b16 v[72:73], v7 offset:47136
  v_mfma_f32_16x16x32_bf16 v[144:147], v[36:39], v[20:23], v[144:147]
  ds_read_b64_tr_b16 v[74:75], v7 offset:49440
  v_mfma_f32_16x16x32_bf16 v[112:115], v[40:43], v[16:19], v[112:115]
  ds_read_b64_tr_b16 v[76:77], v7 offset:47168
  v_mfma_f32_16x16x32_bf16 v[148:151], v[40:43], v[20:23], v[148:151]
  ds_read_b64_tr_b16 v[78:79], v7 offset:49472
  v_mfma_f32_16x16x32_bf16 v[116:119], v[44:47], v[16:19], v[116:119]
  ds_read_b64_tr_b16 v[80:81], v7 offset:47200
  v_mfma_f32_16x16x32_bf16 v[152:155], v[44:47], v[20:23], v[152:155]
  ds_read_b64_tr_b16 v[82:83], v7 offset:49504
  v_mfma_f32_16x16x32_bf16 v[120:123], v[48:51], v[16:19], v[120:123]
  ds_read_b64_tr_b16 v[84:85], v7 offset:47232
  v_mfma_f32_16x16x32_bf16 v[156:159], v[48:51], v[20:23], v[156:159]
  ds_read_b64_tr_b16 v[86:87], v7 offset:49536
  v_mfma_f32_16x16x32_bf16 v[124:127], v[52:55], v[16:19], v[124:127]
  ds_read_b64_tr_b16 v[88:89], v7 offset:47264
  v_mfma_f32_16x16x32_bf16 v[160:163], v[52:55], v[20:23], v[160:163]
  ds_read_b64_tr_b16 v[90:91], v7 offset:49568
  v_mfma_f32_16x16x32_bf16 v[128:131], v[56:59], v[16:19], v[128:131]
  ds_read_b64_tr_b16 v[92:93], v7 offset:47296
  v_mfma_f32_16x16x32_bf16 v[164:167], v[56:59], v[20:23], v[164:167]
  ds_read_b64_tr_b16 v[94:95], v7 offset:49600
  v_mfma_f32_16x16x32_bf16 v[132:135], v[60:63], v[16:19], v[132:135]
  ds_read_b64_tr_b16 v[96:97], v7 offset:47328
  v_mfma_f32_16x16x32_bf16 v[168:171], v[60:63], v[20:23], v[168:171]
  ds_read_b64_tr_b16 v[98:99], v7 offset:49632
  v_mfma_f32_16x16x32_bf16 v[136:139], v[64:67], v[16:19], v[136:139]
  ds_read_b64_tr_b16 v[100:101], v7 offset:47360
  v_mfma_f32_16x16x32_bf16 v[172:175], v[64:67], v[20:23], v[172:175]
  ds_read_b64_tr_b16 v[102:103], v7 offset:49664
  s_waitcnt lgkmcnt(0)
  s_barrier
  v_mfma_f32_16x16x32_bf16 v[104:107], v[68:71], v[24:27], v[104:107]
  ds_read_b128 v[16:19], v2 offset:0
  ds_read_b128 v[20:23], v2 offset:2048
  v_mfma_f32_16x16x32_bf16 v[140:143], v[68:71], v[28:31], v[140:143]
  ds_read_b64_tr_b16 v[32:33], v6 offset:0
  ds_read_b64_tr_b16 v[34:35], v6 offset:2304
  v_mfma_f32_16x16x32_bf16 v[108:111], v[72:75], v[24:27], v[108:111]
  ds_read_b64_tr_b16 v[36:37], v6 offset:32
  v_mfma_f32_16x16x32_bf16 v[144:147], v[72:75], v[28:31], v[144:147]
  ds_read_b64_tr_b16 v[38:39], v6 offset:2336
  v_mfma_f32_16x16x32_bf16 v[112:115], v[76:79], v[24:27], v[112:115]
  ds_read_b64_tr_b16 v[40:41], v6 offset:64
  v_mfma_f32_16x16x32_bf16 v[148:151], v[76:79], v[28:31], v[148:151]
  ds_read_b64_tr_b16 v[42:43], v6 offset:2368
  v_mfma_f32_16x16x32_bf16 v[116:119], v[80:83], v[24:27], v[116:119]
  ds_read_b64_tr_b16 v[44:45], v6 offset:96
  v_mfma_f32_16x16x32_bf16 v[152:155], v[80:83], v[28:31], v[152:155]
  ds_read_b64_tr_b16 v[46:47], v6 offset:2400
  v_mfma_f32_16x16x32_bf16 v[120:123], v[84:87], v[24:27], v[120:123]
  ds_read_b64_tr_b16 v[48:49], v6 offset:128
  v_mfma_f32_16x16x32_bf16 v[156:159], v[84:87], v[28:31], v[156:159]
  ds_read_b64_tr_b16 v[50:51], v6 offset:2432
  v_mfma_f32_16x16x32_bf16 v[124:127], v[88:91], v[24:27], v[124:127]
  ds_read_b64_tr_b16 v[52:53], v6 offset:160
  v_mfma_f32_16x16x32_bf16 v[160:163], v[88:91], v[28:31], v[160:163]
  ds_read_b64_tr_b16 v[54:55], v6 offset:2464
  v_mfma_f32_16x16x32_bf16 v[128:131], v[92:95], v[24:27], v[128:131]
  ds_read_b64_tr_b16 v[56:57], v6 offset:192
  v_mfma_f32_16x16x32_bf16 v[164:167], v[92:95], v[28:31], v[164:167]
  ds_read_b64_tr_b16 v[58:59], v6 offset:2496
  v_mfma_f32_16x16x32_bf16 v[132:135], v[96:99], v[24:27], v[132:135]
  ds_read_b64_tr_b16 v[60:61], v6 offset:224
  v_mfma_f32_16x16x32_bf16 v[168:171], v[96:99], v[28:31], v[168:171]
  ds_read_b64_tr_b16 v[62:63], v6 offset:2528
  v_mfma_f32_16x16x32_bf16 v[136:139], v[100:103], v[24:27], v[136:139]
  ds_read_b64_tr_b16 v[64:65], v6 offset:256
  v_mfma_f32_16x16x32_bf16 v[172:175], v[100:103], v[28:31], v[172:175]
  ds_read_b64_tr_b16 v[66:67], v6 offset:2560
  s_waitcnt lgkmcnt(0)
  s_cmp_lg_u32 s3, 0
  s_cbranch_scc1 .Lm_2
  s_add_u32 s101, s101, 16
  s_and_b32 s101, s101, 0xfffffff0
  s_mov_b32 s59, 0
  s_lshr_b32 s46, s2, 3
  s_mul_i32 s46, s46, 4352
  s_add_u32 s46, s46, 4096
  v_lshlrev_b32 v232, 2, v0
  v_add_u32 v232, s46, v232
  s_mov_b64 vcc, -1
  s_mul_i32 s46, s53, 9
  s_lshr_b32 s47, s46, 2
  v_lshrrev_b32 v233, 1, v0
  v_subrev_u32 v233, s47, v233
  v_cmp_gt_u32 vcc, 3, v233
  v_lshrrev_b32 v233, 2, v0
  v_cmp_eq_u32 s[46:47], s52, v233
  s_nop 3
  s_or_b64 vcc, vcc, s[46:47]
  s_mov_b64 s[48:49], vcc
  buffer_load_dword v234, v232, s[4:7], 0 offen sc1
.Lm_2:
  v_mfma_f32_16x16x32_bf16 v[104:107], v[32:35], v[16:19], v[104:107]
  ds_read_b128 v[24:27], v4 offset:0
  ds_read_b128 v[28:31], v4 offset:2048
  v_mfma_f32_16x16x32_bf16 v[140:143], v[32:35], v[20:23], v[140:143]
  ds_read_b64_tr_b16 v[68:69], v6 offset:10240
  ds_read_b64_tr_b16 v[70:71], v6 offset:12544
  v_mfma_f32_16x16x32_bf16 v[108:111], v[36:39], v[16:19], v[108:111]
  ds_read_b64_tr_b16 v[72:73], v6 offset:10272
  v_mfma_f32_16x16x32_bf16 v[144:147], v[36:39], v[20:23], v[144:147]
  ds_read_b64_tr_b16 v[74:75], v6 offset:12576
  v_mfma_f32_16x16x32_bf16 v[112:115], v[40:43], v[16:19], v[112:115]
  ds_read_b64_tr_b16 v[76:77], v6 offset:10304
  v_mfma_f32_16x16x32_bf16 v[148:151], v[40:43], v[20:23], v[148:151]
  ds_read_b64_tr_b16 v[78:79], v6 offset:12608
  v_mfma_f32_16x16x32_bf16 v[116:119], v[44:47], v[16:19], v[116:119]
  ds_read_b64_tr_b16 v[80:81], v6 offset:10336
  v_mfma_f32_16x16x32_bf16 v[152:155], v[44:47], v[20:23], v[152:155]
  ds_read_b64_tr_b16 v[82:83], v6 offset:12640
  v_mfma_f32_16x16x32_bf16 v[120:123], v[48:51], v[16:19], v[120:123]
  ds_read_b64_tr_b16 v[84:85], v6 offset:10368
  v_mfma_f32_16x16x32_bf16 v[156:159], v[48:51], v[20:23], v[156:159]
  ds_read_b64_tr_b16 v[86:87], v6 offset:12672
  v_mfma_f32_16x16x32_bf16 v[124:127], v[52:55], v[16:19], v[124:127]
  ds_read_b64_tr_b16 v[88:89], v6 offset:10400
  v_mfma_f32_16x16x32_bf16 v[160:163], v[52:55], v[20:23], v[160:163]
  ds_read_b64_tr_b16 v[90:91], v6 offset:12704
  v_mfma_f32_16x16x32_bf16 v[128:131], v[56:59], v[16:19], v[128:131]
  ds_read_b64_tr_b16 v[92:93], v6 offset:10432
  v_mfma_f32_16x16x32_bf16 v[164:167], v[56:59], v[20:23], v[164:167]
  ds_read_b64_tr_b16 v[94:95], v6 offset:12736
  v_mfma_f32_16x16x32_bf16 v[132:135], v[60:63], v[16:19], v[132:135]
  ds_read_b64_tr_b16 v[96:97], v6 offset:10464
  v_mfma_f32_16x16x32_bf16 v[168:171], v[60:63], v[20:23], v[168:171]
  ds_read_b64_tr_b16 v[98:99], v6 offset:12768
  v_mfma_f32_16x16x32_bf16 v[136:139], v[64:67], v[16:19], v[136:139]
  ds_read_b64_tr_b16 v[100:101], v6 offset:10496
  v_mfma_f32_16x16x32_bf16 v[172:175], v[64:67], v[20:23], v[172:175]
  ds_read_b64_tr_b16 v[102:103], v6 offset:12800
  s_waitcnt lgkmcnt(0)
  s_barrier
  v_mfma_f32_16x16x32_bf16 v[104:107], v[68:71], v[24:27], v[104:107]
  ds_read_b128 v[16:19], v2 offset:36864
  ds_read_b128 v[20:23], v2 offset:38912
  v_mfma_f32_16x16x32_bf16 v[140:143], v[68:71], v[28:31], v[140:143]
  ds_read_b64_tr_b16 v[32:33], v6 offset:36864
  ds_read_b64_tr_b16 v[34:35], v6 offset:39168
  v_mfma_f32_16x16x32_bf16 v[108:111], v[72:75], v[24:27], v[108:111]
  ds_read_b64_tr_b16 v[36:37], v6 offset:36896
  v_mfma_f32_16x16x32_bf16 v[144:147], v[72:75], v[28:31], v[144:147]
  ds_read_b64_tr_b16 v[38:39], v6 offset:39200
  v_mfma_f32_16x16x32_bf16 v[112:115], v[76:79], v[24:27], v[112:115]
  ds_read_b64_tr_b16 v[40:41], v6 offset:36928
  v_mfma_f32_16x16x32_bf16 v[148:151], v[76:79], v[28:31], v[148:151]
  ds_read_b64_tr_b16 v[42:43], v6 offset:39232
  v_mfma_f32_16x16x32_bf16 v[116:119], v[80:83], v[24:27], v[116:119]
  ds_read_b64_tr_b16 v[44:45], v6 offset:36960
  v_mfma_f32_16x16x32_bf16 v[152:155], v[80:83], v[28:31], v[152:155]
  ds_read_b64_tr_b16 v[46:47], v6 offset:39264
  v_mfma_f32_16x16x32_bf16 v[120:123], v[84:87], v[24:27], v[120:123]
  ds_read_b64_tr_b16 v[48:49], v6 offset:36992
  v_mfma_f32_16x16x32_bf16 v[156:159], v[84:87], v[28:31], v[156:159]
  ds_read_b64_tr_b16 v[50:51], v6 offset:39296
  v_mfma_f32_16x16x32_bf16 v[124:127], v[88:91], v[24:27], v[124:127]
  ds_read_b64_tr_b16 v[52:53], v6 offset:37024
  v_mfma_f32_16x16x32_bf16 v[160:163], v[88:91], v[28:31], v[160:163]
  ds_read_b64_tr_b16 v[54:55], v6 offset:39328
  v_mfma_f32_16x16x32_bf16 v[128:131], v[92:95], v[24:27], v[128:131]
  ds_read_b64_tr_b16 v[56:57], v6 offset:37056
  v_mfma_f32_16x16x32_bf16 v[164:167], v[92:95], v[28:31], v[164:167]
  ds_read_b64_tr_b16 v[58:59], v6 offset:39360
  v_mfma_f32_16x16x32_bf16 v[132:135], v[96:99], v[24:27], v[132:135]
  ds_read_b64_tr_b16 v[60:61], v6 offset:37088
  v_mfma_f32_16x16x32_bf16 v[168:171], v[96:99], v[28:31], v[168:171]
  ds_read_b64_tr_b16 v[62:63], v6 offset:39392
  v_mfma_f32_16x16x32_bf16 v[136:139], v[100:103], v[24:27], v[136:139]
  ds_read_b64_tr_b16 v[64:65], v6 offset:37120
  v_mfma_f32_16x16x32_bf16 v[172:175], v[100:103], v[28:31], v[172:175]
  ds_read_b64_tr_b16 v[66:67], v6 offset:39424
  s_waitcnt lgkmcnt(0)
  v_mfma_f32_16x16x32_bf16 v[104:107], v[32:35], v[16:19], v[104:107]
  ds_read_b128 v[24:27], v4 offset:36864
  ds_read_b128 v[28:31], v4 offset:38912
  v_mfma_f32_16x16x32_bf16 v[140:143], v[32:35], v[20:23], v[140:143]
  ds_read_b64_tr_b16 v[68:69], v6 offset:47104
  ds_read_b64_tr_b16 v[70:71], v6 offset:49408
  v_mfma_f32_16x16x32_bf16 v[108:111], v[36:39], v[16:19], v[108:111]
  ds_read_b64_tr_b16 v[72:73], v6 offset:47136
  v_mfma_f32_16x16x32_bf16 v[144:147], v[36:39], v[20:23], v[144:147]
  ds_read_b64_tr_b16 v[74:75], v6 offset:49440
  v_mfma_f32_16x16x32_bf16 v[112:115], v[40:43], v[16:19], v[112:115]
  ds_read_b64_tr_b16 v[76:77], v6 offset:47168
  v_mfma_f32_16x16x32_bf16 v[148:151], v[40:43], v[20:23], v[148:151]
  ds_read_b64_tr_b16 v[78:79], v6 offset:49472
  v_mfma_f32_16x16x32_bf16 v[116:119], v[44:47], v[16:19], v[116:119]
  ds_read_b64_tr_b16 v[80:81], v6 offset:47200
  v_mfma_f32_16x16x32_bf16 v[152:155], v[44:47], v[20:23], v[152:155]
  ds_read_b64_tr_b16 v[82:83], v6 offset:49504
  v_mfma_f32_16x16x32_bf16 v[120:123], v[48:51], v[16:19], v[120:123]
  ds_read_b64_tr_b16 v[84:85], v6 offset:47232
  v_mfma_f32_16x16x32_bf16 v[156:159], v[48:51], v[20:23], v[156:159]
  ds_read_b64_tr_b16 v[86:87], v6 offset:49536
  v_mfma_f32_16x16x32_bf16 v[124:127], v[52:55], v[16:19], v[124:127]
  ds_read_b64_tr_b16 v[88:89], v6 offset:47264
  v_mfma_f32_16x16x32_bf16 v[160:163], v[52:55], v[20:23], v[160:163]
  ds_read_b64_tr_b16 v[90:91], v6 offset:49568
  v_mfma_f32_16x16x32_bf16 v[128:131], v[56:59], v[16:19], v[128:131]
  ds_read_b64_tr_b16 v[92:93], v6 offset:47296
  v_mfma_f32_16x16x32_bf16 v[164:167], v[56:59], v[20:23], v[164:167]
  ds_read_b64_tr_b16 v[94:95], v6 offset:49600
  v_mfma_f32_16x16x32_bf16 v[132:135], v[60:63], v[16:19], v[132:135]
  ds_read_b64_tr_b16 v[96:97], v6 offset:47328
  v_mfma_f32_16x16x32_bf16 v[168:171], v[60:63], v[20:23], v[168:171]
  ds_read_b64_tr_b16 v[98:99], v6 offset:49632
  v_mfma_f32_16x16x32_bf16 v[136:139], v[64:67], v[16:19], v[136:139]
  ds_read_b64_tr_b16 v[100:101], v6 offset:47360
  v_mfma_f32_16x16x32_bf16 v[172:175], v[64:67], v[20:23], v[172:175]
  ds_read_b64_tr_b16 v[102:103], v6 offset:49664
  s_waitcnt lgkmcnt(0)
  s_cmp_lg_u32 s3, 0
  s_cbranch_scc1 .Lm_3
  s_cmp_lg_u32 s59, 0
  s_cbranch_scc1 .Lm_3
  s_add_u32 s45, s101, 1
  s_waitcnt vmcnt(0)
  v_subrev_u32 v233, s45, v234
  v_cmp_le_u32 vcc, 15, v233
  s_nop 3
  s_and_b64 vcc, vcc, s[48:49]
  s_cbranch_scc1 .Lm_4
  s_mov_b32 s59, 1
  v_lshlrev_b32 v236, 3, v0
  s_lshl_b32 s44, s52, 9
  s_add_u32 s44, s44, 155648
  buffer_load_dwordx2 v[240:241], v236, s[4:7], s44 offen sc1
  s_add_u32 s44, s44, 8192
  buffer_load_dwordx2 v[242:243], v236, s[4:7], s44 offen sc1
  s_mul_i32 s44, s53, 576
  s_add_u32 s44, s44, 184320
  v_min_u32 v237, 560, v1
  buffer_load_dwordx4 v[244:247], v237, s[4:7], s44 offen sc1
  s_add_u32 s44, s44, 6912
  buffer_load_dwordx4 v[248:251], v237, s[4:7], s44 offen sc1
  s_branch .Lm_3
.Lm_4:
  buffer_load_dword v234, v232, s[4:7], 0 offen sc1
.Lm_3:
  s_barrier
  v_mfma_f32_16x16x32_bf16 v[104:107], v[68:71], v[24:27], v[104:107]
  ds_read_b128 v[16:19], v3 offset:0
  ds_read_b128 v[20:23], v3 offset:2048
  v_mfma_f32_16x16x32_bf16 v[140:143], v[68:71], v[28:31], v[140:143]
  ds_read_b64_tr_b16 v[32:33], v7 offset:0
  ds_read_b64_tr_b16 v[34:35], v7 offset:2304
  v_mfma_f32_16x16x32_bf16 v[108:111], v[72:75], v[24:27], v[108:111]
  ds_read_b64_tr_b16 v[36:37], v7 offset:32
  v_mfma_f32_16x16x32_bf16 v[144:147], v[72:75], v[28:31], v[144:147]
  ds_read_b64_tr_b16 v[38:39], v7 offset:2336
  v_mfma_f32_16x16x32_bf16 v[112:115], v[76:79], v[24:27], v[112:115]
  ds_read_b64_tr_b16 v[40:41], v7 offset:64
  v_mfma_f32_16x16x32_bf16 v[148:151], v[76:79], v[28:31], v[148:151]
  ds_read_b64_tr_b16 v[42:43], v7 offset:2368
  v_mfma_f32_16x16x32_bf16 v[116:119], v[80:83], v[24:27], v[116:119]
  ds_read_b64_tr_b16 v[44:45], v7 offset:96
  v_mfma_f32_16x16x32_bf16 v[152:155], v[80:83], v[28:31], v[152:155]
  ds_read_b64_tr_b16 v[46:47], v7 offset:2400
  v_mfma_f32_16x16x32_bf16 v[120:123], v[84:87], v[24:27], v[120:123]
  ds_read_b64_tr_b16 v[48:49], v7 offset:128
  v_mfma_f32_16x16x32_bf16 v[156:159], v[84:87], v[28:31], v[156:159]
  ds_read_b64_tr_b16 v[50:51], v7 offset:2432
  v_mfma_f32_16x16x32_bf16 v[124:127], v[88:91], v[24:27], v[124:127]
  ds_read_b64_tr_b16 v[52:53], v7 offset:160
  v_mfma_f32_16x16x32_bf16 v[160:163], v[88:91], v[28:31], v[160:163]
  ds_read_b64_tr_b16 v[54:55], v7 offset:2464
  v_mfma_f32_16x16x32_bf16 v[128:131], v[92:95], v[24:27], v[128:131]
  ds_read_b64_tr_b16 v[56:57], v7 offset:192
  v_mfma_f32_16x16x32_bf16 v[164:167], v[92:95], v[28:31], v[164:167]
  ds_read_b64_tr_b16 v[58:59], v7 offset:2496
  v_mfma_f32_16x16x32_bf16 v[132:135], v[96:99], v[24:27], v[132:135]
  ds_read_b64_tr_b16 v[60:61], v7 offset:224
  v_mfma_f32_16x16x32_bf16 v[168:171], v[96:99], v[28:31], v[168:171]
  ds_read_b64_tr_b16 v[62:63], v7 offset:2528
  v_mfma_f32_16x16x32_bf16 v[136:139], v[100:103], v[24:27], v[136:139]
  ds_read_b64_tr_b16 v[64:65], v7 offset:256
  v_mfma_f32_16x16x32_bf16 v[172:175], v[100:103], v[28:31], v[172:175]
  ds_read_b64_tr_b16 v[66:67], v7 offset:2560
  s_waitcnt lgkmcnt(0)
  v_mfma_f32_16x16x32_bf16 v[104:107], v[32:35], v[16:19], v[104:107]
  ds_read_b128 v[24:27], v5 offset:0
  ds_read_b128 v[28:31], v5 offset:2048
  v_mfma_f32_16x16x32_bf16 v[140:143], v[32:35], v[20:23], v[140:143]
  ds_read_b64_tr_b16 v[68:69], v7 offset:10240
  ds_read_b64_tr_b16 v[70:71], v7 offset:12544
  v_mfma_f32_16x16x32_bf16 v[108:111], v[36:39], v[16:19], v[108:111]
  ds_read_b64_tr_b16 v[72:73], v7 offset:10272
  v_mfma_f32_16x16x32_bf16 v[144:147], v[36:39], v[20:23], v[144:147]
  ds_read_b64_tr_b16 v[74:75], v7 offset:12576
  v_mfma_f32_16x16x32_bf16 v[112:115], v[40:43], v[16:19], v[112:115]
  ds_read_b64_tr_b16 v[76:77], v7 offset:10304
  v_mfma_f32_16x16x32_bf16 v[148:151], v[40:43], v[20:23], v[148:151]
  ds_read_b64_tr_b16 v[78:79], v7 offset:12608
  v_mfma_f32_16x16x32_bf16 v[116:119], v[44:47], v[16:19], v[116:119]
  ds_read_b64_tr_b16 v[80:81], v7 offset:10336
  v_mfma_f32_16x16x32_bf16 v[152:155], v[44:47], v[20:23], v[152:155]
  ds_read_b64_tr_b16 v[82:83], v7 offset:12640
  v_mfma_f32_16x16x32_bf16 v[120:123], v[48:51], v[16:19], v[120:123]
  ds_read_b64_tr_b16 v[84:85], v7 offset:10368
  v_mfma_f32_16x16x32_bf16 v[156:159], v[48:51], v[20:23], v[156:159]
  ds_read_b64_tr_b16 v[86:87], v7 offset:12672
  v_mfma_f32_16x16x32_bf16 v[124:127], v[52:55], v[16:19], v[124:127]
  ds_read_b64_tr_b16 v[88:89], v7 offset:10400
  v_mfma_f32_16x16x32_bf16 v[160:163], v[52:55], v[20:23], v[160:163]
  ds_read_b64_tr_b16 v[90:91], v7 offset:12704
  v_mfma_f32_16x16x32_bf16 v[128:131], v[56:59], v[16:19], v[128:131]
  ds_read_b64_tr_b16 v[92:93], v7 offset:10432
  v_mfma_f32_16x16x32_bf16 v[164:167], v[56:59], v[20:23], v[164:167]
  ds_read_b64_tr_b16 v[94:95], v7 offset:12736
  v_mfma_f32_16x16x32_bf16 v[132:135], v[60:63], v[16:19], v[132:135]
  ds_read_b64_tr_b16 v[96:97], v7 offset:10464
  v_mfma_f32_16x16x32_bf16 v[168:171], v[60:63], v[20:23], v[168:171]
  ds_read_b64_tr_b16 v[98:99], v7 offset:12768
  v_mfma_f32_16x16x32_bf16 v[136:139], v[64:67], v[16:19], v[136:139]
  ds_read_b64_tr_b16 v[100:101], v7 offset:10496
  v_mfma_f32_16x16x32_bf16 v[172:175], v[64:67], v[20:23], v[172:175]
  ds_read_b64_tr_b16 v[102:103], v7 offset:12800
  s_waitcnt lgkmcnt(0)
  s_barrier
  v_mfma_f32_16x16x32_bf16 v[104:107], v[68:71], v[24:27], v[104:107]
  ds_read_b128 v[16:19], v3 offset:36864
  ds_read_b128 v[20:23], v3 offset:38912
  v_mfma_f32_16x16x32_bf16 v[140:143], v[68:71], v[28:31], v[140:143]
  ds_read_b64_tr_b16 v[32:33], v7 offset:36864
  ds_read_b64_tr_b16 v[34:35], v7 offset:39168
  v_mfma_f32_16x16x32_bf16 v[108:111], v[72:75], v[24:27], v[108:111]
  ds_read_b64_tr_b16 v[36:37], v7 offset:36896
  v_mfma_f32_16x16x32_bf16 v[144:147], v[72:75], v[28:31], v[144:147]
  ds_read_b64_tr_b16 v[38:39], v7 offset:39200
  v_mfma_f32_16x16x32_bf16 v[112:115], v[76:79], v[24:27], v[112:115]
  ds_read_b64_tr_b16 v[40:41], v7 offset:36928
  v_mfma_f32_16x16x32_bf16 v[148:151], v[76:79], v[28:31], v[148:151]
  ds_read_b64_tr_b16 v[42:43], v7 offset:39232
  v_mfma_f32_16x16x32_bf16 v[116:119], v[80:83], v[24:27], v[116:119]
  ds_read_b64_tr_b16 v[44:45], v7 offset:36960
  v_mfma_f32_16x16x32_bf16 v[152:155], v[80:83], v[28:31], v[152:155]
  ds_read_b64_tr_b16 v[46:47], v7 offset:39264
  v_mfma_f32_16x16x32_bf16 v[120:123], v[84:87], v[24:27], v[120:123]
  ds_read_b64_tr_b16 v[48:49], v7 offset:36992
  v_mfma_f32_16x16x32_bf16 v[156:159], v[84:87], v[28:31], v[156:159]
  ds_read_b64_tr_b16 v[50:51], v7 offset:39296
  v_mfma_f32_16x16x32_bf16 v[124:127], v[88:91], v[24:27], v[124:127]
  ds_read_b64_tr_b16 v[52:53], v7 offset:37024
  v_mfma_f32_16x16x32_bf16 v[160:163], v[88:91], v[28:31], v[160:163]
  ds_read_b64_tr_b16 v[54:55], v7 offset:39328
  v_mfma_f32_16x16x32_bf16 v[128:131], v[92:95], v[24:27], v[128:131]
  ds_read_b64_tr_b16 v[56:57], v7 offset:37056
  v_mfma_f32_16x16x32_bf16 v[164:167], v[92:95], v[28:31], v[164:167]
  ds_read_b64_tr_b16 v[58:59], v7 offset:39360
  v_mfma_f32_16x16x32_bf16 v[132:135], v[96:99], v[24:27], v[132:135]
  ds_read_b64_tr_b16 v[60:61], v7 offset:37088
  v_mfma_f32_16x16x32_bf16 v[168:171], v[96:99], v[28:31], v[168:171]
  ds_read_b64_tr_b16 v[62:63], v7 offset:39392
  v_mfma_f32_16x16x32_bf16 v[136:139], v[100:103], v[24:27], v[136:139]
  ds_read_b64_tr_b16 v[64:65], v7 offset:37120
  v_mfma_f32_16x16x32_bf16 v[172:175], v[100:103], v[28:31], v[172:175]
  ds_read_b64_tr_b16 v[66:67], v7 offset:39424
  s_waitcnt lgkmcnt(0)
  s_cmp_lg_u32 s3, 0
  s_cbranch_scc1 .Lm_5
  s_cmp_lg_u32 s59, 0
  s_cbranch_scc1 .Lm_5
  s_add_u32 s45, s101, 1
  s_waitcnt vmcnt(0)
  v_subrev_u32 v233, s45, v234
  v_cmp_le_u32 vcc, 15, v233
  s_nop 3
  s_and_b64 vcc, vcc, s[48:49]
  s_cbranch_scc1 .Lm_6
  s_mov_b32 s59, 1
  v_lshlrev_b32 v236, 3, v0
  s_lshl_b32 s44, s52, 9
  s_add_u32 s44, s44, 155648
  buffer_load_dwordx2 v[240:241], v236, s[4:7], s44 offen sc1
  s_add_u32 s44, s44, 8192
  buffer_load_dwordx2 v[242:243], v236, s[4:7], s44 offen sc1
  s_mul_i32 s44, s53, 576
  s_add_u32 s44, s44, 184320
  v_min_u32 v237, 560, v1
  buffer_load_dwordx4 v[244:247], v237, s[4:7], s44 offen sc1
  s_add_u32 s44, s44, 6912
  buffer_load_dwordx4 v[248:251], v237, s[4:7], s44 offen sc1
  s_branch .Lm_5
.Lm_6:
.Lm_5:
  v_mfma_f32_16x16x32_bf16 v[104:107], v[32:35], v[16:19], v[104:107]
  ds_read_b128 v[24:27], v5 offset:36864
  ds_read_b128 v[28:31], v5 offset:38912
  v_mfma_f32_16x16x32_bf16 v[140:143], v[32:35], v[20:23], v[140:143]
  ds_read_b64_tr_b16 v[68:69], v7 offset:47104
  ds_read_b64_tr_b16 v[70:71], v7 offset:49408
  v_mfma_f32_16x16x32_bf16 v[108:111], v[36:39], v[16:19], v[108:111]
  ds_read_b64_tr_b16 v[72:73], v7 offset:47136
  v_mfma_f32_16x16x32_bf16 v[144:147], v[36:39], v[20:23], v[144:147]
  ds_read_b64_tr_b16 v[74:75], v7 offset:49440
  v_mfma_f32_16x16x32_bf16 v[112:115], v[40:43], v[16:19], v[112:115]
  ds_read_b64_tr_b16 v[76:77], v7 offset:47168
  v_mfma_f32_16x16x32_bf16 v[148:151], v[40:43], v[20:23], v[148:151]
  ds_read_b64_tr_b16 v[78:79], v7 offset:49472
  v_mfma_f32_16x16x32_bf16 v[116:119], v[44:47], v[16:19], v[116:119]
  ds_read_b64_tr_b16 v[80:81], v7 offset:47200
  v_mfma_f32_16x16x32_bf16 v[152:155], v[44:47], v[20:23], v[152:155]
  ds_read_b64_tr_b16 v[82:83], v7 offset:49504
  v_mfma_f32_16x16x32_bf16 v[120:123], v[48:51], v[16:19], v[120:123]
  ds_read_b64_tr_b16 v[84:85], v7 offset:47232
  v_mfma_f32_16x16x32_bf16 v[156:159], v[48:51], v[20:23], v[156:159]
  ds_read_b64_tr_b16 v[86:87], v7 offset:49536
  v_mfma_f32_16x16x32_bf16 v[124:127], v[52:55], v[16:19], v[124:127]
  ds_read_b64_tr_b16 v[88:89], v7 offset:47264
  v_mfma_f32_16x16x32_bf16 v[160:163], v[52:55], v[20:23], v[160:163]
  ds_read_b64_tr_b16 v[90:91], v7 offset:49568
  v_mfma_f32_16x16x32_bf16 v[128:131], v[56:59], v[16:19], v[128:131]
  ds_read_b64_tr_b16 v[92:93], v7 offset:47296
  v_mfma_f32_16x16x32_bf16 v[164:167], v[56:59], v[20:23], v[164:167]
  ds_read_b64_tr_b16 v[94:95], v7 offset:49600
  v_mfma_f32_16x16x32_bf16 v[132:135], v[60:63], v[16:19], v[132:135]
  ds_read_b64_tr_b16 v[96:97], v7 offset:47328
  v_mfma_f32_16x16x32_bf16 v[168:171], v[60:63], v[20:23], v[168:171]
  ds_read_b64_tr_b16 v[98:99], v7 offset:49632
  v_mfma_f32_16x16x32_bf16 v[136:139], v[64:67], v[16:19], v[136:139]
  ds_read_b64_tr_b16 v[100:101], v7 offset:47360
  v_mfma_f32_16x16x32_bf16 v[172:175], v[64:67], v[20:23], v[172:175]
  ds_read_b64_tr_b16 v[102:103], v7 offset:49664
  s_waitcnt lgkmcnt(0)
  s_barrier
  v_mfma_f32_16x16x32_bf16 v[104:107], v[68:71], v[24:27], v[104:107]
  ds_read_b128 v[16:19], v2 offset:0
  ds_read_b128 v[20:23], v2 offset:2048
  v_mfma_f32_16x16x32_bf16 v[140:143], v[68:71], v[28:31], v[140:143]
  ds_read_b64_tr_b16 v[32:33], v6 offset:0
  ds_read_b64_tr_b16 v[34:35], v6 offset:2304
  v_mfma_f32_16x16x32_bf16 v[108:111], v[72:75], v[24:27], v[108:111]
  ds_read_b64_tr_b16 v[36:37], v6 offset:32
  v_mfma_f32_16x16x32_bf16 v[144:147], v[72:75], v[28:31], v[144:147]
  ds_read_b64_tr_b16 v[38:39], v6 offset:2336
  v_mfma_f32_16x16x32_bf16 v[112:115], v[76:79], v[24:27], v[112:115]
  ds_read_b64_tr_b16 v[40:41], v6 offset:64
  v_mfma_f32_16x16x32_bf16 v[148:151], v[76:79], v[28:31], v[148:151]
  ds_read_b64_tr_b16 v[42:43], v6 offset:2368
  v_mfma_f32_16x16x32_bf16 v[116:119], v[80:83], v[24:27], v[116:119]
  ds_read_b64_tr_b16 v[44:45], v6 offset:96
  v_mfma_f32_16x16x32_bf16 v[152:155], v[80:83], v[28:31], v[152:155]
  ds_read_b64_tr_b16 v[46:47], v6 offset:2400
  v_mfma_f32_16x16x32_bf16 v[120:123], v[84:87], v[24:27], v[120:123]
  ds_read_b64_tr_b16 v[48:49], v6 offset:128
  v_mfma_f32_16x16x32_bf16 v[156:159], v[84:87], v[28:31], v[156:159]
  ds_read_b64_tr_b16 v[50:51], v6 offset:2432
  v_mfma_f32_16x16x32_bf16 v[124:127], v[88:91], v[24:27], v[124:127]
  ds_read_b64_tr_b16 v[52:53], v6 offset:160
  v_mfma_f32_16x16x32_bf16 v[160:163], v[88:91], v[28:31], v[160:163]
  ds_read_b64_tr_b16 v[54:55], v6 offset:2464
  v_mfma_f32_16x16x32_bf16 v[128:131], v[92:95], v[24:27], v[128:131]
  ds_read_b64_tr_b16 v[56:57], v6 offset:192
  v_mfma_f32_16x16x32_bf16 v[164:167], v[92:95], v[28:31], v[164:167]
  ds_read_b64_tr_b16 v[58:59], v6 offset:2496
  v_mfma_f32_16x16x32_bf16 v[132:135], v[96:99], v[24:27], v[132:135]
  ds_read_b64_tr_b16 v[60:61], v6 offset:224
  v_mfma_f32_16x16x32_bf16 v[168:171], v[96:99], v[28:31], v[168:171]
  ds_read_b64_tr_b16 v[62:63], v6 offset:2528
  v_mfma_f32_16x16x32_bf16 v[136:139], v[100:103], v[24:27], v[136:139]
  ds_read_b64_tr_b16 v[64:65], v6 offset:256
  v_mfma_f32_16x16x32_bf16 v[172:175], v[100:103], v[28:31], v[172:175]
  ds_read_b64_tr_b16 v[66:67], v6 offset:2560
  s_waitcnt lgkmcnt(0)
  v_mfma_f32_16x16x32_bf16 v[104:107], v[32:35], v[16:19], v[104:107]
  ds_read_b128 v[24:27], v4 offset:0
  ds_read_b128 v[28:31], v4 offset:2048
  v_mfma_f32_16x16x32_bf16 v[140:143], v[32:35], v[20:23], v[140:143]
  ds_read_b64_tr_b16 v[68:69], v6 offset:10240
  ds_read_b64_tr_b16 v[70:71], v6 offset:12544
  v_mfma_f32_16x16x32_bf16 v[108:111], v[36:39], v[16:19], v[108:111]
  ds_read_b64_tr_b16 v[72:73], v6 offset:10272
  v_mfma_f32_16x16x32_bf16 v[144:147], v[36:39], v[20:23], v[144:147]
  ds_read_b64_tr_b16 v[74:75], v6 offset:12576
  v_mfma_f32_16x16x32_bf16 v[112:115], v[40:43], v[16:19], v[112:115]
  ds_read_b64_tr_b16 v[76:77], v6 offset:10304
  v_mfma_f32_16x16x32_bf16 v[148:151], v[40:43], v[20:23], v[148:151]
  ds_read_b64_tr_b16 v[78:79], v6 offset:12608
  v_mfma_f32_16x16x32_bf16 v[116:119], v[44:47], v[16:19], v[116:119]
  ds_read_b64_tr_b16 v[80:81], v6 offset:10336
  v_mfma_f32_16x16x32_bf16 v[152:155], v[44:47], v[20:23], v[152:155]
  ds_read_b64_tr_b16 v[82:83], v6 offset:12640
  v_mfma_f32_16x16x32_bf16 v[120:123], v[48:51], v[16:19], v[120:123]
  ds_read_b64_tr_b16 v[84:85], v6 offset:10368
  v_mfma_f32_16x16x32_bf16 v[156:159], v[48:51], v[20:23], v[156:159]
  ds_read_b64_tr_b16 v[86:87], v6 offset:12672
  v_mfma_f32_16x16x32_bf16 v[124:127], v[52:55], v[16:19], v[124:127]
  ds_read_b64_tr_b16 v[88:89], v6 offset:10400
  v_mfma_f32_16x16x32_bf16 v[160:163], v[52:55], v[20:23], v[160:163]
  ds_read_b64_tr_b16 v[90:91], v6 offset:12704
  v_mfma_f32_16x16x32_bf16 v[128:131], v[56:59], v[16:19], v[128:131]
  ds_read_b64_tr_b16 v[92:93], v6 offset:10432
  v_mfma_f32_16x16x32_bf16 v[164:167], v[56:59], v[20:23], v[164:167]
  ds_read_b64_tr_b16 v[94:95], v6 offset:12736
  v_mfma_f32_16x16x32_bf16 v[132:135], v[60:63], v[16:19], v[132:135]
  ds_read_b64_tr_b16 v[96:97], v6 offset:10464
  v_mfma_f32_16x16x32_bf16 v[168:171], v[60:63], v[20:23], v[168:171]
  ds_read_b64_tr_b16 v[98:99], v6 offset:12768
  v_mfma_f32_16x16x32_bf16 v[136:139], v[64:67], v[16:19], v[136:139]
  ds_read_b64_tr_b16 v[100:101], v6 offset:10496
  v_mfma_f32_16x16x32_bf16 v[172:175], v[64:67], v[20:23], v[172:175]
  ds_read_b64_tr_b16 v[102:103], v6 offset:12800
  s_waitcnt lgkmcnt(0)
  v_mfma_f32_16x16x32_bf16 v[104:107], v[68:71], v[24:27], v[104:107]
  v_mfma_f32_16x16x32_bf16 v[140:143], v[68:71], v[28:31], v[140:143]
  v_mfma_f32_16x16x32_bf16 v[108:111], v[72:75], v[24:27], v[108:111]
  v_mfma_f32_16x16x32_bf16 v[144:147], v[72:75], v[28:31], v[144:147]
  v_mfma_f32_16x16x32_bf16 v[112:115], v[76:79], v[24:27], v[112:115]
  v_mfma_f32_16x16x32_bf16 v[148:151], v[76:79], v[28:31], v[148:151]
  v_mfma_f32_16x16x32_bf16 v[116:119], v[80:83], v[24:27], v[116:119]
  v_mfma_f32_16x16x32_bf16 v[152:155], v[80:83], v[28:31], v[152:155]
  v_mfma_f32_16x16x32_bf16 v[120:123], v[84:87], v[24:27], v[120:123]
  v_mfma_f32_16x16x32_bf16 v[156:159], v[84:87], v[28:31], v[156:159]
  v_mfma_f32_16x16x32_bf16 v[124:127], v[88:91], v[24:27], v[124:127]
  v_mfma_f32_16x16x32_bf16 v[160:163], v[88:91], v[28:31], v[160:163]
  v_mfma_f32_16x16x32_bf16 v[128:131], v[92:95], v[24:27], v[128:131]
  v_mfma_f32_16x16x32_bf16 v[164:167], v[92:95], v[28:31], v[164:167]
  v_mfma_f32_16x16x32_bf16 v[132:135], v[96:99], v[24:27], v[132:135]
  v_mfma_f32_16x16x32_bf16 v[168:171], v[96:99], v[28:31], v[168:171]
  v_mfma_f32_16x16x32_bf16 v[136:139], v[100:103], v[24:27], v[136:139]
  v_mfma_f32_16x16x32_bf16 v[172:175], v[100:103], v[28:31], v[172:175]
  s_cmp_lg_u32 s3, 0
  s_cbranch_scc1 .Lm_7
  s_cmp_lg_u32 s59, 0
  s_cbranch_scc1 .Lm_8
  s_lshr_b32 s46, s2, 3
  s_mul_i32 s46, s46, 4352
  s_add_u32 s46, s46, 4096
  v_lshlrev_b32 v232, 2, v0
  v_add_u32 v232, s46, v232
  s_mov_b64 vcc, -1
  s_mul_i32 s46, s53, 9
  s_lshr_b32 s47, s46, 2
  v_lshrrev_b32 v233, 1, v0
  v_subrev_u32 v233, s47, v233
  v_cmp_gt_u32 vcc, 3, v233
  v_lshrrev_b32 v233, 2, v0
  v_cmp_eq_u32 s[46:47], s52, v233
  s_nop 3
  s_or_b64 vcc, vcc, s[46:47]
  s_add_u32 s45, s101, 1
  s_mov_b32 s44, 0
  s_nop 2
  s_mov_b64 exec, vcc
.Lm_9:
  buffer_load_dword v234, v232, s[4:7], 0 offen sc1
  s_waitcnt vmcnt(0)
  v_subrev_u32 v233, s45, v234
  v_cmp_le_u32 vcc, 15, v233
  s_add_u32 s44, s44, 1
  s_nop 2
  s_cmp_eq_u64 vcc, 0
  s_cbranch_scc1 .Lm_10
  s_sleep 1
  s_cmp_lt_u32 s44, 0x40000
  s_cbranch_scc1 .Lm_9
.Lm_10:
  s_mov_b64 exec, -1
  v_lshlrev_b32 v236, 3, v0
  s_lshl_b32 s44, s52, 9
  s_add_u32 s44, s44, 155648
  buffer_load_dwordx2 v[240:241], v236, s[4:7], s44 offen sc1
  s_add_u32 s44, s44, 8192
  buffer_load_dwordx2 v[242:243], v236, s[4:7], s44 offen sc1
  s_mul_i32 s44, s53, 576
  s_add_u32 s44, s44, 184320
  v_min_u32 v237, 560, v1
  buffer_load_dwordx4 v[244:247], v237, s[4:7], s44 offen sc1
  s_add_u32 s44, s44, 6912
  buffer_load_dwordx4 v[248:251], v237, s[4:7], s44 offen sc1
.Lm_8:
  s_mov_b32 s46, 1.0
  s_cmp_lt_u32 s53, 4
  s_cselect_b32 s46, 0x3eae1a93, s46
  v_add_u32 v236, 147456, v236
  v_add_u32 v237, 148480, v237
  s_waitcnt vmcnt(0)
  v_mul_f32 v240, s46, v240
  v_mul_f32 v241, s46, v241
  v_mul_f32 v242, s46, v242
  v_mul_f32 v243, s46, v243
  v_add_f32 v244, v244, v248
  v_add_f32 v245, v245, v249
  v_add_f32 v246, v246, v250
  v_add_f32 v247, v247, v251
  ds_write_b64 v236, v[240:241]
  ds_write_b64 v236, v[242:243] offset:512
  ds_write_b128 v237, v[244:247]
  s_waitcnt lgkmcnt(0)
.Lm_7:
  s_waitcnt vmcnt(0)
  v_and_b32 v8, 15, v0
  v_lshrrev_b32 v9, 4, v0
  s_lshl_b32 s44, s3, 7
  s_add_u32 s44, s44, 147456
  v_lshlrev_b32 v10, 2, v8
  v_add_u32 v10, s44, v10
  v_lshlrev_b32 v11, 4, v9
  v_add_u32 v11, 148480, v11
  s_and_b32 s44, s53, 3
  s_mul_i32 s44, s44, 18
  s_lshl_b32 s45, s52, 2
  s_add_u32 s45, s45, s3
  s_mul_i32 s45, s45, 72
  s_add_u32 s44, s44, s45
  s_lshl_b32 s44, s44, 9
  s_mov_b32 s45, 2359296
  s_cmp_lt_u32 s53, 4
  s_cselect_b32 s45, s45, 4718592
  s_add_u32 s44, s44, s45
  s_barrier
  ds_read_b32 v212, v10 offset:0
  ds_read_b32 v213, v10 offset:512
  ds_read_b32 v214, v10 offset:64
  ds_read_b32 v215, v10 offset:576
  ds_read_b128 v[176:179], v11 offset:0
  ds_read_b128 v[180:183], v11 offset:64
  ds_read_b128 v[184:187], v11 offset:128
  ds_read_b128 v[188:191], v11 offset:192
  ds_read_b128 v[192:195], v11 offset:256
  ds_read_b128 v[196:199], v11 offset:320
  ds_read_b128 v[200:203], v11 offset:384
  ds_read_b128 v[204:207], v11 offset:448
  ds_read_b128 v[208:211], v11 offset:512
  s_waitcnt lgkmcnt(8)
  v_pk_mul_f32 v[104:105], v[104:105], v[212:213] op_sel_hi:[1,0]
  v_pk_mul_f32 v[106:107], v[106:107], v[212:213] op_sel_hi:[1,0]
  v_pk_fma_f32 v[104:105], v[176:177], v[212:213], v[104:105] op_sel:[0,1,0]
  v_pk_fma_f32 v[106:107], v[178:179], v[212:213], v[106:107] op_sel:[0,1,0]
  v_pk_mul_f32 v[140:141], v[140:141], v[214:215] op_sel_hi:[1,0]
  v_pk_mul_f32 v[142:143], v[142:143], v[214:215] op_sel_hi:[1,0]
  v_pk_fma_f32 v[140:141], v[176:177], v[214:215], v[140:141] op_sel:[0,1,0]
  v_pk_fma_f32 v[142:143], v[178:179], v[214:215], v[142:143] op_sel:[0,1,0]
  v_cvt_pk_bf16_f32 v32, v104, v105
  v_cvt_pk_bf16_f32 v33, v106, v107
  v_cvt_pk_bf16_f32 v34, v140, v141
  v_cvt_pk_bf16_f32 v35, v142, v143
  s_nop 1
  v_permlane16_swap_b32 v32, v34
  v_permlane16_swap_b32 v33, v35
  s_nop 0
  buffer_store_dwordx4 v[32:35], v1, s[4:7], s44 offen offset:0 sc1
  s_waitcnt lgkmcnt(7)
  v_pk_mul_f32 v[108:109], v[108:109], v[212:213] op_sel_hi:[1,0]
  v_pk_mul_f32 v[110:111], v[110:111], v[212:213] op_sel_hi:[1,0]
  v_pk_fma_f32 v[108:109], v[180:181], v[212:213], v[108:109] op_sel:[0,1,0]
  v_pk_fma_f32 v[110:111], v[182:183], v[212:213], v[110:111] op_sel:[0,1,0]
  v_pk_mul_f32 v[144:145], v[144:145], v[214:215] op_sel_hi:[1,0]
  v_pk_mul_f32 v[146:147], v[146:147], v[214:215] op_sel_hi:[1,0]
  v_pk_fma_f32 v[144:145], v[180:181], v[214:215], v[144:145] op_sel:[0,1,0]
  v_pk_fma_f32 v[146:147], v[182:183], v[214:215], v[146:147] op_sel:[0,1,0]
  v_cvt_pk_bf16_f32 v36, v108, v109
  v_cvt_pk_bf16_f32 v37, v110, v111
  v_cvt_pk_bf16_f32 v38, v144, v145
  v_cvt_pk_bf16_f32 v39, v146, v147
  s_nop 1
  v_permlane16_swap_b32 v36, v38
  v_permlane16_swap_b32 v37, v39
  s_nop 0
  buffer_store_dwordx4 v[36:39], v1, s[4:7], s44 offen offset:1024 sc1
  s_waitcnt lgkmcnt(6)
  v_pk_mul_f32 v[112:113], v[112:113], v[212:213] op_sel_hi:[1,0]
  v_pk_mul_f32 v[114:115], v[114:115], v[212:213] op_sel_hi:[1,0]
  v_pk_fma_f32 v[112:113], v[184:185], v[212:213], v[112:113] op_sel:[0,1,0]
  v_pk_fma_f32 v[114:115], v[186:187], v[212:213], v[114:115] op_sel:[0,1,0]
  v_pk_mul_f32 v[148:149], v[148:149], v[214:215] op_sel_hi:[1,0]
  v_pk_mul_f32 v[150:151], v[150:151], v[214:215] op_sel_hi:[1,0]
  v_pk_fma_f32 v[148:149], v[184:185], v[214:215], v[148:149] op_sel:[0,1,0]
  v_pk_fma_f32 v[150:151], v[186:187], v[214:215], v[150:151] op_sel:[0,1,0]
  v_cvt_pk_bf16_f32 v40, v112, v113
  v_cvt_pk_bf16_f32 v41, v114, v115
  v_cvt_pk_bf16_f32 v42, v148, v149
  v_cvt_pk_bf16_f32 v43, v150, v151
  s_nop 1
  v_permlane16_swap_b32 v40, v42
  v_permlane16_swap_b32 v41, v43
  s_nop 0
  buffer_store_dwordx4 v[40:43], v1, s[4:7], s44 offen offset:2048 sc1
  s_waitcnt lgkmcnt(5)
  v_pk_mul_f32 v[116:117], v[116:117], v[212:213] op_sel_hi:[1,0]
  v_pk_mul_f32 v[118:119], v[118:119], v[212:213] op_sel_hi:[1,0]
  v_pk_fma_f32 v[116:117], v[188:189], v[212:213], v[116:117] op_sel:[0,1,0]
  v_pk_fma_f32 v[118:119], v[190:191], v[212:213], v[118:119] op_sel:[0,1,0]
  v_pk_mul_f32 v[152:153], v[152:153], v[214:215] op_sel_hi:[1,0]
  v_pk_mul_f32 v[154:155], v[154:155], v[214:215] op_sel_hi:[1,0]
  v_pk_fma_f32 v[152:153], v[188:189], v[214:215], v[152:153] op_sel:[0,1,0]
  v_pk_fma_f32 v[154:155], v[190:191], v[214:215], v[154:155] op_sel:[0,1,0]
  v_cvt_pk_bf16_f32 v44, v116, v117
  v_cvt_pk_bf16_f32 v45, v118, v119
  v_cvt_pk_bf16_f32 v46, v152, v153
  v_cvt_pk_bf16_f32 v47, v154, v155
  s_nop 1
  v_permlane16_swap_b32 v44, v46
  v_permlane16_swap_b32 v45, v47
  s_nop 0
  buffer_store_dwordx4 v[44:47], v1, s[4:7], s44 offen offset:3072 sc1
  s_waitcnt lgkmcnt(4)
  v_pk_mul_f32 v[120:121], v[120:121], v[212:213] op_sel_hi:[1,0]
  v_pk_mul_f32 v[122:123], v[122:123], v[212:213] op_sel_hi:[1,0]
  v_pk_fma_f32 v[120:121], v[192:193], v[212:213], v[120:121] op_sel:[0,1,0]
  v_pk_fma_f32 v[122:123], v[194:195], v[212:213], v[122:123] op_sel:[0,1,0]
  v_pk_mul_f32 v[156:157], v[156:157], v[214:215] op_sel_hi:[1,0]
  v_pk_mul_f32 v[158:159], v[158:159], v[214:215] op_sel_hi:[1,0]
  v_pk_fma_f32 v[156:157], v[192:193], v[214:215], v[156:157] op_sel:[0,1,0]
  v_pk_fma_f32 v[158:159], v[194:195], v[214:215], v[158:159] op_sel:[0,1,0]
  v_cvt_pk_bf16_f32 v48, v120, v121
  v_cvt_pk_bf16_f32 v49, v122, v123
  v_cvt_pk_bf16_f32 v50, v156, v157
  v_cvt_pk_bf16_f32 v51, v158, v159
  s_nop 1
  v_permlane16_swap_b32 v48, v50
  v_permlane16_swap_b32 v49, v51
  s_add_u32 s44, s44, 4096
  s_nop 0
  buffer_store_dwordx4 v[48:51], v1, s[4:7], s44 offen offset:0 sc1
  s_waitcnt lgkmcnt(3)
  v_pk_mul_f32 v[124:125], v[124:125], v[212:213] op_sel_hi:[1,0]
  v_pk_mul_f32 v[126:127], v[126:127], v[212:213] op_sel_hi:[1,0]
  v_pk_fma_f32 v[124:125], v[196:197], v[212:213], v[124:125] op_sel:[0,1,0]
  v_pk_fma_f32 v[126:127], v[198:199], v[212:213], v[126:127] op_sel:[0,1,0]
  v_pk_mul_f32 v[160:161], v[160:161], v[214:215] op_sel_hi:[1,0]
  v_pk_mul_f32 v[162:163], v[162:163], v[214:215] op_sel_hi:[1,0]
  v_pk_fma_f32 v[160:161], v[196:197], v[214:215], v[160:161] op_sel:[0,1,0]
  v_pk_fma_f32 v[162:163], v[198:199], v[214:215], v[162:163] op_sel:[0,1,0]
  v_cvt_pk_bf16_f32 v52, v124, v125
  v_cvt_pk_bf16_f32 v53, v126, v127
  v_cvt_pk_bf16_f32 v54, v160, v161
  v_cvt_pk_bf16_f32 v55, v162, v163
  s_nop 1
  v_permlane16_swap_b32 v52, v54
  v_permlane16_swap_b32 v53, v55
  s_nop 0
  buffer_store_dwordx4 v[52:55], v1, s[4:7], s44 offen offset:1024 sc1
  s_waitcnt lgkmcnt(2)
  v_pk_mul_f32 v[128:129], v[128:129], v[212:213] op_sel_hi:[1,0]
  v_pk_mul_f32 v[130:131], v[130:131], v[212:213] op_sel_hi:[1,0]
  v_pk_fma_f32 v[128:129], v[200:201], v[212:213], v[128:129] op_sel:[0,1,0]
  v_pk_fma_f32 v[130:131], v[202:203], v[212:213], v[130:131] op_sel:[0,1,0]
  v_pk_mul_f32 v[164:165], v[164:165], v[214:215] op_sel_hi:[1,0]
  v_pk_mul_f32 v[166:167], v[166:167], v[214:215] op_sel_hi:[1,0]
  v_pk_fma_f32 v[164:165], v[200:201], v[214:215], v[164:165] op_sel:[0,1,0]
  v_pk_fma_f32 v[166:167], v[202:203], v[214:215], v[166:167] op_sel:[0,1,0]
  v_cvt_pk_bf16_f32 v56, v128, v129
  v_cvt_pk_bf16_f32 v57, v130, v131
  v_cvt_pk_bf16_f32 v58, v164, v165
  v_cvt_pk_bf16_f32 v59, v166, v167
  s_nop 1
  v_permlane16_swap_b32 v56, v58
  v_permlane16_swap_b32 v57, v59
  s_nop 0
  buffer_store_dwordx4 v[56:59], v1, s[4:7], s44 offen offset:2048 sc1
  s_waitcnt lgkmcnt(1)
  v_pk_mul_f32 v[132:133], v[132:133], v[212:213] op_sel_hi:[1,0]
  v_pk_mul_f32 v[134:135], v[134:135], v[212:213] op_sel_hi:[1,0]
  v_pk_fma_f32 v[132:133], v[204:205], v[212:213], v[132:133] op_sel:[0,1,0]
  v_pk_fma_f32 v[134:135], v[206:207], v[212:213], v[134:135] op_sel:[0,1,0]
  v_pk_mul_f32 v[168:169], v[168:169], v[214:215] op_sel_hi:[1,0]
  v_pk_mul_f32 v[170:171], v[170:171], v[214:215] op_sel_hi:[1,0]
  v_pk_fma_f32 v[168:169], v[204:205], v[214:215], v[168:169] op_sel:[0,1,0]
  v_pk_fma_f32 v[170:171], v[206:207], v[214:215], v[170:171] op_sel:[0,1,0]
  v_cvt_pk_bf16_f32 v60, v132, v133
  v_cvt_pk_bf16_f32 v61, v134, v135
  v_cvt_pk_bf16_f32 v62, v168, v169
  v_cvt_pk_bf16_f32 v63, v170, v171
  s_nop 1
  v_permlane16_swap_b32 v60, v62
  v_permlane16_swap_b32 v61, v63
  s_nop 0
  buffer_store_dwordx4 v[60:63], v1, s[4:7], s44 offen offset:3072 sc1
  s_waitcnt lgkmcnt(0)
  v_pk_mul_f32 v[136:137], v[136:137], v[212:213] op_sel_hi:[1,0]
  v_pk_mul_f32 v[138:139], v[138:139], v[212:213] op_sel_hi:[1,0]
  v_pk_fma_f32 v[136:137], v[208:209], v[212:213], v[136:137] op_sel:[0,1,0]
  v_pk_fma_f32 v[138:139], v[210:211], v[212:213], v[138:139] op_sel:[0,1,0]
  v_pk_mul_f32 v[172:173], v[172:173], v[214:215] op_sel_hi:[1,0]
  v_pk_mul_f32 v[174:175], v[174:175], v[214:215] op_sel_hi:[1,0]
  v_pk_fma_f32 v[172:173], v[208:209], v[214:215], v[172:173] op_sel:[0,1,0]
  v_pk_fma_f32 v[174:175], v[210:211], v[214:215], v[174:175] op_sel:[0,1,0]
  v_cvt_pk_bf16_f32 v64, v136, v137
  v_cvt_pk_bf16_f32 v65, v138, v139
  v_cvt_pk_bf16_f32 v66, v172, v173
  v_cvt_pk_bf16_f32 v67, v174, v175
  s_nop 1
  v_permlane16_swap_b32 v64, v66
  v_permlane16_swap_b32 v65, v67
  s_add_u32 s44, s44, 4096
  s_nop 0
  buffer_store_dwordx4 v[64:67], v1, s[4:7], s44 offen offset:0 sc1
  s_branch .L_s1_done
.L_s1_v:
  s_barrier
  ds_read_b128 v[16:19], v2 offset:0
  ds_read_b128 v[20:23], v2 offset:2048
  ds_read_b64_tr_b16 v[32:33], v6 offset:0
  ds_read_b64_tr_b16 v[34:35], v6 offset:2304
  ds_read_b64_tr_b16 v[36:37], v6 offset:32
  ds_read_b64_tr_b16 v[38:39], v6 offset:2336
  ds_read_b64_tr_b16 v[40:41], v6 offset:64
  ds_read_b64_tr_b16 v[42:43], v6 offset:2368
  ds_read_b64_tr_b16 v[44:45], v6 offset:96
  ds_read_b64_tr_b16 v[46:47], v6 offset:2400
  ds_read_b64_tr_b16 v[48:49], v6 offset:128
  ds_read_b64_tr_b16 v[50:51], v6 offset:2432
  ds_read_b64_tr_b16 v[52:53], v6 offset:160
  ds_read_b64_tr_b16 v[54:55], v6 offset:2464
  ds_read_b64_tr_b16 v[56:57], v6 offset:192
  ds_read_b64_tr_b16 v[58:59], v6 offset:2496
  ds_read_b64_tr_b16 v[60:61], v6 offset:224
  ds_read_b64_tr_b16 v[62:63], v6 offset:2528
  ds_read_b64_tr_b16 v[64:65], v6 offset:256
  ds_read_b64_tr_b16 v[66:67], v6 offset:2560
  s_waitcnt lgkmcnt(0)
  v_mfma_f32_16x16x32_bf16 v[104:107], v[16:19], v[32:35], 0
  ds_read_b128 v[24:27], v4 offset:0
  ds_read_b128 v[28:31], v4 offset:2048
  v_mfma_f32_16x16x32_bf16 v[140:143], v[20:23], v[32:35], 0
  ds_read_b64_tr_b16 v[68:69], v6 offset:10240
  ds_read_b64_tr_b16 v[70:71], v6 offset:12544
  v_mfma_f32_16x16x32_bf16 v[108:111], v[16:19], v[36:39], 0
  ds_read_b64_tr_b16 v[72:73], v6 offset:10272
  v_mfma_f32_16x16x32_bf16 v[144:147], v[20:23], v[36:39], 0
  ds_read_b64_tr_b16 v[74:75], v6 offset:12576
  v_mfma_f32_16x16x32_bf16 v[112:115], v[16:19], v[40:43], 0
  ds_read_b64_tr_b16 v[76:77], v6 offset:10304
  v_mfma_f32_16x16x32_bf16 v[148:151], v[20:23], v[40:43], 0
  ds_read_b64_tr_b16 v[78:79], v6 offset:12608
  v_mfma_f32_16x16x32_bf16 v[116:119], v[16:19], v[44:47], 0
  ds_read_b64_tr_b16 v[80:81], v6 offset:10336
  v_mfma_f32_16x16x32_bf16 v[152:155], v[20:23], v[44:47], 0
  ds_read_b64_tr_b16 v[82:83], v6 offset:12640
  v_mfma_f32_16x16x32_bf16 v[120:123], v[16:19], v[48:51], 0
  ds_read_b64_tr_b16 v[84:85], v6 offset:10368
  v_mfma_f32_16x16x32_bf16 v[156:159], v[20:23], v[48:51], 0
  ds_read_b64_tr_b16 v[86:87], v6 offset:12672
  v_mfma_f32_16x16x32_bf16 v[124:127], v[16:19], v[52:55], 0
  ds_read_b64_tr_b16 v[88:89], v6 offset:10400
  v_mfma_f32_16x16x32_bf16 v[160:163], v[20:23], v[52:55], 0
  ds_read_b64_tr_b16 v[90:91], v6 offset:12704
  v_mfma_f32_16x16x32_bf16 v[128:131], v[16:19], v[56:59], 0
  ds_read_b64_tr_b16 v[92:93], v6 offset:10432
  v_mfma_f32_16x16x32_bf16 v[164:167], v[20:23], v[56:59], 0
  ds_read_b64_tr_b16 v[94:95], v6 offset:12736
  v_mfma_f32_16x16x32_bf16 v[132:135], v[16:19], v[60:63], 0
  ds_read_b64_tr_b16 v[96:97], v6 offset:10464
  v_mfma_f32_16x16x32_bf16 v[168:171], v[20:23], v[60:63], 0
  ds_read_b64_tr_b16 v[98:99], v6 offset:12768
  v_mfma_f32_16x16x32_bf16 v[136:139], v[16:19], v[64:67], 0
  ds_read_b64_tr_b16 v[100:101], v6 offset:10496
  v_mfma_f32_16x16x32_bf16 v[172:175], v[20:23], v[64:67], 0
  ds_read_b64_tr_b16 v[102:103], v6 offset:12800
  s_waitcnt lgkmcnt(0)
  s_barrier
  v_mfma_f32_16x16x32_bf16 v[104:107], v[24:27], v[68:71], v[104:107]
  ds_read_b128 v[16:19], v2 offset:36864
  ds_read_b128 v[20:23], v2 offset:38912
  v_mfma_f32_16x16x32_bf16 v[140:143], v[28:31], v[68:71], v[140:143]
  ds_read_b64_tr_b16 v[32:33], v6 offset:36864
  ds_read_b64_tr_b16 v[34:35], v6 offset:39168
  v_mfma_f32_16x16x32_bf16 v[108:111], v[24:27], v[72:75], v[108:111]
  ds_read_b64_tr_b16 v[36:37], v6 offset:36896
  v_mfma_f32_16x16x32_bf16 v[144:147], v[28:31], v[72:75], v[144:147]
  ds_read_b64_tr_b16 v[38:39], v6 offset:39200
  v_mfma_f32_16x16x32_bf16 v[112:115], v[24:27], v[76:79], v[112:115]
  ds_read_b64_tr_b16 v[40:41], v6 offset:36928
  v_mfma_f32_16x16x32_bf16 v[148:151], v[28:31], v[76:79], v[148:151]
  ds_read_b64_tr_b16 v[42:43], v6 offset:39232
  v_mfma_f32_16x16x32_bf16 v[116:119], v[24:27], v[80:83], v[116:119]
  ds_read_b64_tr_b16 v[44:45], v6 offset:36960
  v_mfma_f32_16x16x32_bf16 v[152:155], v[28:31], v[80:83], v[152:155]
  ds_read_b64_tr_b16 v[46:47], v6 offset:39264
  v_mfma_f32_16x16x32_bf16 v[120:123], v[24:27], v[84:87], v[120:123]
  ds_read_b64_tr_b16 v[48:49], v6 offset:36992
  v_mfma_f32_16x16x32_bf16 v[156:159], v[28:31], v[84:87], v[156:159]
  ds_read_b64_tr_b16 v[50:51], v6 offset:39296
  v_mfma_f32_16x16x32_bf16 v[124:127], v[24:27], v[88:91], v[124:127]
  ds_read_b64_tr_b16 v[52:53], v6 offset:37024
  v_mfma_f32_16x16x32_bf16 v[160:163], v[28:31], v[88:91], v[160:163]
  ds_read_b64_tr_b16 v[54:55], v6 offset:39328
  v_mfma_f32_16x16x32_bf16 v[128:131], v[24:27], v[92:95], v[128:131]
  ds_read_b64_tr_b16 v[56:57], v6 offset:37056
  v_mfma_f32_16x16x32_bf16 v[164:167], v[28:31], v[92:95], v[164:167]
  ds_read_b64_tr_b16 v[58:59], v6 offset:39360
  v_mfma_f32_16x16x32_bf16 v[132:135], v[24:27], v[96:99], v[132:135]
  ds_read_b64_tr_b16 v[60:61], v6 offset:37088
  v_mfma_f32_16x16x32_bf16 v[168:171], v[28:31], v[96:99], v[168:171]
  ds_read_b64_tr_b16 v[62:63], v6 offset:39392
  v_mfma_f32_16x16x32_bf16 v[136:139], v[24:27], v[100:103], v[136:139]
  ds_read_b64_tr_b16 v[64:65], v6 offset:37120
  v_mfma_f32_16x16x32_bf16 v[172:175], v[28:31], v[100:103], v[172:175]
  ds_read_b64_tr_b16 v[66:67], v6 offset:39424
  s_waitcnt lgkmcnt(0)
  v_mfma_f32_16x16x32_bf16 v[104:107], v[16:19], v[32:35], v[104:107]
  ds_read_b128 v[24:27], v4 offset:36864
  ds_read_b128 v[28:31], v4 offset:38912
  v_mfma_f32_16x16x32_bf16 v[140:143], v[20:23], v[32:35], v[140:143]
  ds_read_b64_tr_b16 v[68:69], v6 offset:47104
  ds_read_b64_tr_b16 v[70:71], v6 offset:49408
  v_mfma_f32_16x16x32_bf16 v[108:111], v[16:19], v[36:39], v[108:111]
  ds_read_b64_tr_b16 v[72:73], v6 offset:47136
  v_mfma_f32_16x16x32_bf16 v[144:147], v[20:23], v[36:39], v[144:147]
  ds_read_b64_tr_b16 v[74:75], v6 offset:49440
  v_mfma_f32_16x16x32_bf16 v[112:115], v[16:19], v[40:43], v[112:115]
  ds_read_b64_tr_b16 v[76:77], v6 offset:47168
  v_mfma_f32_16x16x32_bf16 v[148:151], v[20:23], v[40:43], v[148:151]
  ds_read_b64_tr_b16 v[78:79], v6 offset:49472
  v_mfma_f32_16x16x32_bf16 v[116:119], v[16:19], v[44:47], v[116:119]
  ds_read_b64_tr_b16 v[80:81], v6 offset:47200
  v_mfma_f32_16x16x32_bf16 v[152:155], v[20:23], v[44:47], v[152:155]
  ds_read_b64_tr_b16 v[82:83], v6 offset:49504
  v_mfma_f32_16x16x32_bf16 v[120:123], v[16:19], v[48:51], v[120:123]
  ds_read_b64_tr_b16 v[84:85], v6 offset:47232
  v_mfma_f32_16x16x32_bf16 v[156:159], v[20:23], v[48:51], v[156:159]
  ds_read_b64_tr_b16 v[86:87], v6 offset:49536
  v_mfma_f32_16x16x32_bf16 v[124:127], v[16:19], v[52:55], v[124:127]
  ds_read_b64_tr_b16 v[88:89], v6 offset:47264
  v_mfma_f32_16x16x32_bf16 v[160:163], v[20:23], v[52:55], v[160:163]
  ds_read_b64_tr_b16 v[90:91], v6 offset:49568
  v_mfma_f32_16x16x32_bf16 v[128:131], v[16:19], v[56:59], v[128:131]
  ds_read_b64_tr_b16 v[92:93], v6 offset:47296
  v_mfma_f32_16x16x32_bf16 v[164:167], v[20:23], v[56:59], v[164:167]
  ds_read_b64_tr_b16 v[94:95], v6 offset:49600
  v_mfma_f32_16x16x32_bf16 v[132:135], v[16:19], v[60:63], v[132:135]
  ds_read_b64_tr_b16 v[96:97], v6 offset:47328
  v_mfma_f32_16x16x32_bf16 v[168:171], v[20:23], v[60:63], v[168:171]
  ds_read_b64_tr_b16 v[98:99], v6 offset:49632
  v_mfma_f32_16x16x32_bf16 v[136:139], v[16:19], v[64:67], v[136:139]
  ds_read_b64_tr_b16 v[100:101], v6 offset:47360
  v_mfma_f32_16x16x32_bf16 v[172:175], v[20:23], v[64:67], v[172:175]
  ds_read_b64_tr_b16 v[102:103], v6 offset:49664
  s_waitcnt lgkmcnt(0)
  s_barrier
  v_mfma_f32_16x16x32_bf16 v[104:107], v[24:27], v[68:71], v[104:107]
  ds_read_b128 v[16:19], v3 offset:0
  ds_read_b128 v[20:23], v3 offset:2048
  v_mfma_f32_16x16x32_bf16 v[140:143], v[28:31], v[68:71], v[140:143]
  ds_read_b64_tr_b16 v[32:33], v7 offset:0
  ds_read_b64_tr_b16 v[34:35], v7 offset:2304
  v_mfma_f32_16x16x32_bf16 v[108:111], v[24:27], v[72:75], v[108:111]
  ds_read_b64_tr_b16 v[36:37], v7 offset:32
  v_mfma_f32_16x16x32_bf16 v[144:147], v[28:31], v[72:75], v[144:147]
  ds_read_b64_tr_b16 v[38:39], v7 offset:2336
  v_mfma_f32_16x16x32_bf16 v[112:115], v[24:27], v[76:79], v[112:115]
  ds_read_b64_tr_b16 v[40:41], v7 offset:64
  v_mfma_f32_16x16x32_bf16 v[148:151], v[28:31], v[76:79], v[148:151]
  ds_read_b64_tr_b16 v[42:43], v7 offset:2368
  v_mfma_f32_16x16x32_bf16 v[116:119], v[24:27], v[80:83], v[116:119]
  ds_read_b64_tr_b16 v[44:45], v7 offset:96
  v_mfma_f32_16x16x32_bf16 v[152:155], v[28:31], v[80:83], v[152:155]
  ds_read_b64_tr_b16 v[46:47], v7 offset:2400
  v_mfma_f32_16x16x32_bf16 v[120:123], v[24:27], v[84:87], v[120:123]
  ds_read_b64_tr_b16 v[48:49], v7 offset:128
  v_mfma_f32_16x16x32_bf16 v[156:159], v[28:31], v[84:87], v[156:159]
  ds_read_b64_tr_b16 v[50:51], v7 offset:2432
  v_mfma_f32_16x16x32_bf16 v[124:127], v[24:27], v[88:91], v[124:127]
  ds_read_b64_tr_b16 v[52:53], v7 offset:160
  v_mfma_f32_16x16x32_bf16 v[160:163], v[28:31], v[88:91], v[160:163]
  ds_read_b64_tr_b16 v[54:55], v7 offset:2464
  v_mfma_f32_16x16x32_bf16 v[128:131], v[24:27], v[92:95], v[128:131]
  ds_read_b64_tr_b16 v[56:57], v7 offset:192
  v_mfma_f32_16x16x32_bf16 v[164:167], v[28:31], v[92:95], v[164:167]
  ds_read_b64_tr_b16 v[58:59], v7 offset:2496
  v_mfma_f32_16x16x32_bf16 v[132:135], v[24:27], v[96:99], v[132:135]
  ds_read_b64_tr_b16 v[60:61], v7 offset:224
  v_mfma_f32_16x16x32_bf16 v[168:171], v[28:31], v[96:99], v[168:171]
  ds_read_b64_tr_b16 v[62:63], v7 offset:2528
  v_mfma_f32_16x16x32_bf16 v[136:139], v[24:27], v[100:103], v[136:139]
  ds_read_b64_tr_b16 v[64:65], v7 offset:256
  v_mfma_f32_16x16x32_bf16 v[172:175], v[28:31], v[100:103], v[172:175]
  ds_read_b64_tr_b16 v[66:67], v7 offset:2560
  s_waitcnt lgkmcnt(0)
  v_mfma_f32_16x16x32_bf16 v[104:107], v[16:19], v[32:35], v[104:107]
  ds_read_b128 v[24:27], v5 offset:0
  ds_read_b128 v[28:31], v5 offset:2048
  v_mfma_f32_16x16x32_bf16 v[140:143], v[20:23], v[32:35], v[140:143]
  ds_read_b64_tr_b16 v[68:69], v7 offset:10240
  ds_read_b64_tr_b16 v[70:71], v7 offset:12544
  v_mfma_f32_16x16x32_bf16 v[108:111], v[16:19], v[36:39], v[108:111]
  ds_read_b64_tr_b16 v[72:73], v7 offset:10272
  v_mfma_f32_16x16x32_bf16 v[144:147], v[20:23], v[36:39], v[144:147]
  ds_read_b64_tr_b16 v[74:75], v7 offset:12576
  v_mfma_f32_16x16x32_bf16 v[112:115], v[16:19], v[40:43], v[112:115]
  ds_read_b64_tr_b16 v[76:77], v7 offset:10304
  v_mfma_f32_16x16x32_bf16 v[148:151], v[20:23], v[40:43], v[148:151]
  ds_read_b64_tr_b16 v[78:79], v7 offset:12608
  v_mfma_f32_16x16x32_bf16 v[116:119], v[16:19], v[44:47], v[116:119]
  ds_read_b64_tr_b16 v[80:81], v7 offset:10336
  v_mfma_f32_16x16x32_bf16 v[152:155], v[20:23], v[44:47], v[152:155]
  ds_read_b64_tr_b16 v[82:83], v7 offset:12640
  v_mfma_f32_16x16x32_bf16 v[120:123], v[16:19], v[48:51], v[120:123]
  ds_read_b64_tr_b16 v[84:85], v7 offset:10368
  v_mfma_f32_16x16x32_bf16 v[156:159], v[20:23], v[48:51], v[156:159]
  ds_read_b64_tr_b16 v[86:87], v7 offset:12672
  v_mfma_f32_16x16x32_bf16 v[124:127], v[16:19], v[52:55], v[124:127]
  ds_read_b64_tr_b16 v[88:89], v7 offset:10400
  v_mfma_f32_16x16x32_bf16 v[160:163], v[20:23], v[52:55], v[160:163]
  ds_read_b64_tr_b16 v[90:91], v7 offset:12704
  v_mfma_f32_16x16x32_bf16 v[128:131], v[16:19], v[56:59], v[128:131]
  ds_read_b64_tr_b16 v[92:93], v7 offset:10432
  v_mfma_f32_16x16x32_bf16 v[164:167], v[20:23], v[56:59], v[164:167]
  ds_read_b64_tr_b16 v[94:95], v7 offset:12736
  v_mfma_f32_16x16x32_bf16 v[132:135], v[16:19], v[60:63], v[132:135]
  ds_read_b64_tr_b16 v[96:97], v7 offset:10464
  v_mfma_f32_16x16x32_bf16 v[168:171], v[20:23], v[60:63], v[168:171]
  ds_read_b64_tr_b16 v[98:99], v7 offset:12768
  v_mfma_f32_16x16x32_bf16 v[136:139], v[16:19], v[64:67], v[136:139]
  ds_read_b64_tr_b16 v[100:101], v7 offset:10496
  v_mfma_f32_16x16x32_bf16 v[172:175], v[20:23], v[64:67], v[172:175]
  ds_read_b64_tr_b16 v[102:103], v7 offset:12800
  s_waitcnt lgkmcnt(0)
  s_barrier
  v_mfma_f32_16x16x32_bf16 v[104:107], v[24:27], v[68:71], v[104:107]
  ds_read_b128 v[16:19], v3 offset:36864
  ds_read_b128 v[20:23], v3 offset:38912
  v_mfma_f32_16x16x32_bf16 v[140:143], v[28:31], v[68:71], v[140:143]
  ds_read_b64_tr_b16 v[32:33], v7 offset:36864
  ds_read_b64_tr_b16 v[34:35], v7 offset:39168
  v_mfma_f32_16x16x32_bf16 v[108:111], v[24:27], v[72:75], v[108:111]
  ds_read_b64_tr_b16 v[36:37], v7 offset:36896
  v_mfma_f32_16x16x32_bf16 v[144:147], v[28:31], v[72:75], v[144:147]
  ds_read_b64_tr_b16 v[38:39], v7 offset:39200
  v_mfma_f32_16x16x32_bf16 v[112:115], v[24:27], v[76:79], v[112:115]
  ds_read_b64_tr_b16 v[40:41], v7 offset:36928
  v_mfma_f32_16x16x32_bf16 v[148:151], v[28:31], v[76:79], v[148:151]
  ds_read_b64_tr_b16 v[42:43], v7 offset:39232
  v_mfma_f32_16x16x32_bf16 v[116:119], v[24:27], v[80:83], v[116:119]
  ds_read_b64_tr_b16 v[44:45], v7 offset:36960
  v_mfma_f32_16x16x32_bf16 v[152:155], v[28:31], v[80:83], v[152:155]
  ds_read_b64_tr_b16 v[46:47], v7 offset:39264
  v_mfma_f32_16x16x32_bf16 v[120:123], v[24:27], v[84:87], v[120:123]
  ds_read_b64_tr_b16 v[48:49], v7 offset:36992
  v_mfma_f32_16x16x32_bf16 v[156:159], v[28:31], v[84:87], v[156:159]
  ds_read_b64_tr_b16 v[50:51], v7 offset:39296
  v_mfma_f32_16x16x32_bf16 v[124:127], v[24:27], v[88:91], v[124:127]
  ds_read_b64_tr_b16 v[52:53], v7 offset:37024
  v_mfma_f32_16x16x32_bf16 v[160:163], v[28:31], v[88:91], v[160:163]
  ds_read_b64_tr_b16 v[54:55], v7 offset:39328
  v_mfma_f32_16x16x32_bf16 v[128:131], v[24:27], v[92:95], v[128:131]
  ds_read_b64_tr_b16 v[56:57], v7 offset:37056
  v_mfma_f32_16x16x32_bf16 v[164:167], v[28:31], v[92:95], v[164:167]
  ds_read_b64_tr_b16 v[58:59], v7 offset:39360
  v_mfma_f32_16x16x32_bf16 v[132:135], v[24:27], v[96:99], v[132:135]
  ds_read_b64_tr_b16 v[60:61], v7 offset:37088
  v_mfma_f32_16x16x32_bf16 v[168:171], v[28:31], v[96:99], v[168:171]
  ds_read_b64_tr_b16 v[62:63], v7 offset:39392
  v_mfma_f32_16x16x32_bf16 v[136:139], v[24:27], v[100:103], v[136:139]
  ds_read_b64_tr_b16 v[64:65], v7 offset:37120
  v_mfma_f32_16x16x32_bf16 v[172:175], v[28:31], v[100:103], v[172:175]
  ds_read_b64_tr_b16 v[66:67], v7 offset:39424
  s_waitcnt lgkmcnt(0)
  v_mfma_f32_16x16x32_bf16 v[104:107], v[16:19], v[32:35], v[104:107]
  ds_read_b128 v[24:27], v5 offset:36864
  ds_read_b128 v[28:31], v5 offset:38912
  v_mfma_f32_16x16x32_bf16 v[140:143], v[20:23], v[32:35], v[140:143]
  ds_read_b64_tr_b16 v[68:69], v7 offset:47104
  ds_read_b64_tr_b16 v[70:71], v7 offset:49408
  v_mfma_f32_16x16x32_bf16 v[108:111], v[16:19], v[36:39], v[108:111]
  ds_read_b64_tr_b16 v[72:73], v7 offset:47136
  v_mfma_f32_16x16x32_bf16 v[144:147], v[20:23], v[36:39], v[144:147]
  ds_read_b64_tr_b16 v[74:75], v7 offset:49440
  v_mfma_f32_16x16x32_bf16 v[112:115], v[16:19], v[40:43], v[112:115]
  ds_read_b64_tr_b16 v[76:77], v7 offset:47168
  v_mfma_f32_16x16x32_bf16 v[148:151], v[20:23], v[40:43], v[148:151]
  ds_read_b64_tr_b16 v[78:79], v7 offset:49472
  v_mfma_f32_16x16x32_bf16 v[116:119], v[16:19], v[44:47], v[116:119]
  ds_read_b64_tr_b16 v[80:81], v7 offset:47200
  v_mfma_f32_16x16x32_bf16 v[152:155], v[20:23], v[44:47], v[152:155]
  ds_read_b64_tr_b16 v[82:83], v7 offset:49504
  v_mfma_f32_16x16x32_bf16 v[120:123], v[16:19], v[48:51], v[120:123]
  ds_read_b64_tr_b16 v[84:85], v7 offset:47232
  v_mfma_f32_16x16x32_bf16 v[156:159], v[20:23], v[48:51], v[156:159]
  ds_read_b64_tr_b16 v[86:87], v7 offset:49536
  v_mfma_f32_16x16x32_bf16 v[124:127], v[16:19], v[52:55], v[124:127]
  ds_read_b64_tr_b16 v[88:89], v7 offset:47264
  v_mfma_f32_16x16x32_bf16 v[160:163], v[20:23], v[52:55], v[160:163]
  ds_read_b64_tr_b16 v[90:91], v7 offset:49568
  v_mfma_f32_16x16x32_bf16 v[128:131], v[16:19], v[56:59], v[128:131]
  ds_read_b64_tr_b16 v[92:93], v7 offset:47296
  v_mfma_f32_16x16x32_bf16 v[164:167], v[20:23], v[56:59], v[164:167]
  ds_read_b64_tr_b16 v[94:95], v7 offset:49600
  v_mfma_f32_16x16x32_bf16 v[132:135], v[16:19], v[60:63], v[132:135]
  ds_read_b64_tr_b16 v[96:97], v7 offset:47328
  v_mfma_f32_16x16x32_bf16 v[168:171], v[20:23], v[60:63], v[168:171]
  ds_read_b64_tr_b16 v[98:99], v7 offset:49632
  v_mfma_f32_16x16x32_bf16 v[136:139], v[16:19], v[64:67], v[136:139]
  ds_read_b64_tr_b16 v[100:101], v7 offset:47360
  v_mfma_f32_16x16x32_bf16 v[172:175], v[20:23], v[64:67], v[172:175]
  ds_read_b64_tr_b16 v[102:103], v7 offset:49664
  s_waitcnt lgkmcnt(0)
  s_barrier
  v_mfma_f32_16x16x32_bf16 v[104:107], v[24:27], v[68:71], v[104:107]
  ds_read_b128 v[16:19], v2 offset:0
  ds_read_b128 v[20:23], v2 offset:2048
  v_mfma_f32_16x16x32_bf16 v[140:143], v[28:31], v[68:71], v[140:143]
  ds_read_b64_tr_b16 v[32:33], v6 offset:0
  ds_read_b64_tr_b16 v[34:35], v6 offset:2304
  v_mfma_f32_16x16x32_bf16 v[108:111], v[24:27], v[72:75], v[108:111]
  ds_read_b64_tr_b16 v[36:37], v6 offset:32
  v_mfma_f32_16x16x32_bf16 v[144:147], v[28:31], v[72:75], v[144:147]
  ds_read_b64_tr_b16 v[38:39], v6 offset:2336
  v_mfma_f32_16x16x32_bf16 v[112:115], v[24:27], v[76:79], v[112:115]
  ds_read_b64_tr_b16 v[40:41], v6 offset:64
  v_mfma_f32_16x16x32_bf16 v[148:151], v[28:31], v[76:79], v[148:151]
  ds_read_b64_tr_b16 v[42:43], v6 offset:2368
  v_mfma_f32_16x16x32_bf16 v[116:119], v[24:27], v[80:83], v[116:119]
  ds_read_b64_tr_b16 v[44:45], v6 offset:96
  v_mfma_f32_16x16x32_bf16 v[152:155], v[28:31], v[80:83], v[152:155]
  ds_read_b64_tr_b16 v[46:47], v6 offset:2400
  v_mfma_f32_16x16x32_bf16 v[120:123], v[24:27], v[84:87], v[120:123]
  ds_read_b64_tr_b16 v[48:49], v6 offset:128
  v_mfma_f32_16x16x32_bf16 v[156:159], v[28:31], v[84:87], v[156:159]
  ds_read_b64_tr_b16 v[50:51], v6 offset:2432
  v_mfma_f32_16x16x32_bf16 v[124:127], v[24:27], v[88:91], v[124:127]
  ds_read_b64_tr_b16 v[52:53], v6 offset:160
  v_mfma_f32_16x16x32_bf16 v[160:163], v[28:31], v[88:91], v[160:163]
  ds_read_b64_tr_b16 v[54:55], v6 offset:2464
  v_mfma_f32_16x16x32_bf16 v[128:131], v[24:27], v[92:95], v[128:131]
  ds_read_b64_tr_b16 v[56:57], v6 offset:192
  v_mfma_f32_16x16x32_bf16 v[164:167], v[28:31], v[92:95], v[164:167]
  ds_read_b64_tr_b16 v[58:59], v6 offset:2496
  v_mfma_f32_16x16x32_bf16 v[132:135], v[24:27], v[96:99], v[132:135]
  ds_read_b64_tr_b16 v[60:61], v6 offset:224
  v_mfma_f32_16x16x32_bf16 v[168:171], v[28:31], v[96:99], v[168:171]
  ds_read_b64_tr_b16 v[62:63], v6 offset:2528
  v_mfma_f32_16x16x32_bf16 v[136:139], v[24:27], v[100:103], v[136:139]
  ds_read_b64_tr_b16 v[64:65], v6 offset:256
  v_mfma_f32_16x16x32_bf16 v[172:175], v[28:31], v[100:103], v[172:175]
  ds_read_b64_tr_b16 v[66:67], v6 offset:2560
  s_waitcnt lgkmcnt(0)
  s_cmp_lg_u32 s3, 0
  s_cbranch_scc1 .Lm_11
  s_add_u32 s101, s101, 16
  s_and_b32 s101, s101, 0xfffffff0
  s_mov_b32 s59, 0
  s_lshr_b32 s46, s2, 3
  s_mul_i32 s46, s46, 4352
  s_add_u32 s46, s46, 4096
  v_lshlrev_b32 v232, 2, v0
  v_add_u32 v232, s46, v232
  s_mov_b64 vcc, -1
  s_mul_i32 s46, s53, 9
  s_lshr_b32 s47, s46, 2
  v_lshrrev_b32 v233, 1, v0
  v_subrev_u32 v233, s47, v233
  v_cmp_gt_u32 vcc, 3, v233
  v_lshrrev_b32 v233, 2, v0
  v_cmp_eq_u32 s[46:47], s52, v233
  s_nop 3
  s_or_b64 vcc, vcc, s[46:47]
  s_mov_b64 s[48:49], vcc
  buffer_load_dword v234, v232, s[4:7], 0 offen sc1
.Lm_11:
  v_mfma_f32_16x16x32_bf16 v[104:107], v[16:19], v[32:35], v[104:107]
  ds_read_b128 v[24:27], v4 offset:0
  ds_read_b128 v[28:31], v4 offset:2048
  v_mfma_f32_16x16x32_bf16 v[140:143], v[20:23], v[32:35], v[140:143]
  ds_read_b64_tr_b16 v[68:69], v6 offset:10240
  ds_read_b64_tr_b16 v[70:71], v6 offset:12544
  v_mfma_f32_16x16x32_bf16 v[108:111], v[16:19], v[36:39], v[108:111]
  ds_read_b64_tr_b16 v[72:73], v6 offset:10272
  v_mfma_f32_16x16x32_bf16 v[144:147], v[20:23], v[36:39], v[144:147]
  ds_read_b64_tr_b16 v[74:75], v6 offset:12576
  v_mfma_f32_16x16x32_bf16 v[112:115], v[16:19], v[40:43], v[112:115]
  ds_read_b64_tr_b16 v[76:77], v6 offset:10304
  v_mfma_f32_16x16x32_bf16 v[148:151], v[20:23], v[40:43], v[148:151]
  ds_read_b64_tr_b16 v[78:79], v6 offset:12608
  v_mfma_f32_16x16x32_bf16 v[116:119], v[16:19], v[44:47], v[116:119]
  ds_read_b64_tr_b16 v[80:81], v6 offset:10336
  v_mfma_f32_16x16x32_bf16 v[152:155], v[20:23], v[44:47], v[152:155]
  ds_read_b64_tr_b16 v[82:83], v6 offset:12640
  v_mfma_f32_16x16x32_bf16 v[120:123], v[16:19], v[48:51], v[120:123]
  ds_read_b64_tr_b16 v[84:85], v6 offset:10368
  v_mfma_f32_16x16x32_bf16 v[156:159], v[20:23], v[48:51], v[156:159]
  ds_read_b64_tr_b16 v[86:87], v6 offset:12672
  v_mfma_f32_16x16x32_bf16 v[124:127], v[16:19], v[52:55], v[124:127]
  ds_read_b64_tr_b16 v[88:89], v6 offset:10400
  v_mfma_f32_16x16x32_bf16 v[160:163], v[20:23], v[52:55], v[160:163]
  ds_read_b64_tr_b16 v[90:91], v6 offset:12704
  v_mfma_f32_16x16x32_bf16 v[128:131], v[16:19], v[56:59], v[128:131]
  ds_read_b64_tr_b16 v[92:93], v6 offset:10432
  v_mfma_f32_16x16x32_bf16 v[164:167], v[20:23], v[56:59], v[164:167]
  ds_read_b64_tr_b16 v[94:95], v6 offset:12736
  v_mfma_f32_16x16x32_bf16 v[132:135], v[16:19], v[60:63], v[132:135]
  ds_read_b64_tr_b16 v[96:97], v6 offset:10464
  v_mfma_f32_16x16x32_bf16 v[168:171], v[20:23], v[60:63], v[168:171]
  ds_read_b64_tr_b16 v[98:99], v6 offset:12768
  v_mfma_f32_16x16x32_bf16 v[136:139], v[16:19], v[64:67], v[136:139]
  ds_read_b64_tr_b16 v[100:101], v6 offset:10496
  v_mfma_f32_16x16x32_bf16 v[172:175], v[20:23], v[64:67], v[172:175]
  ds_read_b64_tr_b16 v[102:103], v6 offset:12800
  s_waitcnt lgkmcnt(0)
  s_barrier
  v_mfma_f32_16x16x32_bf16 v[104:107], v[24:27], v[68:71], v[104:107]
  ds_read_b128 v[16:19], v2 offset:36864
  ds_read_b128 v[20:23], v2 offset:38912
  v_mfma_f32_16x16x32_bf16 v[140:143], v[28:31], v[68:71], v[140:143]
  ds_read_b64_tr_b16 v[32:33], v6 offset:36864
  ds_read_b64_tr_b16 v[34:35], v6 offset:39168
  v_mfma_f32_16x16x32_bf16 v[108:111], v[24:27], v[72:75], v[108:111]
  ds_read_b64_tr_b16 v[36:37], v6 offset:36896
  v_mfma_f32_16x16x32_bf16 v[144:147], v[28:31], v[72:75], v[144:147]
  ds_read_b64_tr_b16 v[38:39], v6 offset:39200
  v_mfma_f32_16x16x32_bf16 v[112:115], v[24:27], v[76:79], v[112:115]
  ds_read_b64_tr_b16 v[40:41], v6 offset:36928
  v_mfma_f32_16x16x32_bf16 v[148:151], v[28:31], v[76:79], v[148:151]
  ds_read_b64_tr_b16 v[42:43], v6 offset:39232
  v_mfma_f32_16x16x32_bf16 v[116:119], v[24:27], v[80:83], v[116:119]
  ds_read_b64_tr_b16 v[44:45], v6 offset:36960
  v_mfma_f32_16x16x32_bf16 v[152:155], v[28:31], v[80:83], v[152:155]
  ds_read_b64_tr_b16 v[46:47], v6 offset:39264
  v_mfma_f32_16x16x32_bf16 v[120:123], v[24:27], v[84:87], v[120:123]
  ds_read_b64_tr_b16 v[48:49], v6 offset:36992
  v_mfma_f32_16x16x32_bf16 v[156:159], v[28:31], v[84:87], v[156:159]
  ds_read_b64_tr_b16 v[50:51], v6 offset:39296
  v_mfma_f32_16x16x32_bf16 v[124:127], v[24:27], v[88:91], v[124:127]
  ds_read_b64_tr_b16 v[52:53], v6 offset:37024
  v_mfma_f32_16x16x32_bf16 v[160:163], v[28:31], v[88:91], v[160:163]
  ds_read_b64_tr_b16 v[54:55], v6 offset:39328
  v_mfma_f32_16x16x32_bf16 v[128:131], v[24:27], v[92:95], v[128:131]
  ds_read_b64_tr_b16 v[56:57], v6 offset:37056
  v_mfma_f32_16x16x32_bf16 v[164:167], v[28:31], v[92:95], v[164:167]
  ds_read_b64_tr_b16 v[58:59], v6 offset:39360
  v_mfma_f32_16x16x32_bf16 v[132:135], v[24:27], v[96:99], v[132:135]
  ds_read_b64_tr_b16 v[60:61], v6 offset:37088
  v_mfma_f32_16x16x32_bf16 v[168:171], v[28:31], v[96:99], v[168:171]
  ds_read_b64_tr_b16 v[62:63], v6 offset:39392
  v_mfma_f32_16x16x32_bf16 v[136:139], v[24:27], v[100:103], v[136:139]
  ds_read_b64_tr_b16 v[64:65], v6 offset:37120
  v_mfma_f32_16x16x32_bf16 v[172:175], v[28:31], v[100:103], v[172:175]
  ds_read_b64_tr_b16 v[66:67], v6 offset:39424
  s_waitcnt lgkmcnt(0)
  v_mfma_f32_16x16x32_bf16 v[104:107], v[16:19], v[32:35], v[104:107]
  ds_read_b128 v[24:27], v4 offset:36864
  ds_read_b128 v[28:31], v4 offset:38912
  v_mfma_f32_16x16x32_bf16 v[140:143], v[20:23], v[32:35], v[140:143]
  ds_read_b64_tr_b16 v[68:69], v6 offset:47104
  ds_read_b64_tr_b16 v[70:71], v6 offset:49408
  v_mfma_f32_16x16x32_bf16 v[108:111], v[16:19], v[36:39], v[108:111]
  ds_read_b64_tr_b16 v[72:73], v6 offset:47136
  v_mfma_f32_16x16x32_bf16 v[144:147], v[20:23], v[36:39], v[144:147]
  ds_read_b64_tr_b16 v[74:75], v6 offset:49440
  v_mfma_f32_16x16x32_bf16 v[112:115], v[16:19], v[40:43], v[112:115]
  ds_read_b64_tr_b16 v[76:77], v6 offset:47168
  v_mfma_f32_16x16x32_bf16 v[148:151], v[20:23], v[40:43], v[148:151]
  ds_read_b64_tr_b16 v[78:79], v6 offset:49472
  v_mfma_f32_16x16x32_bf16 v[116:119], v[16:19], v[44:47], v[116:119]
  ds_read_b64_tr_b16 v[80:81], v6 offset:47200
  v_mfma_f32_16x16x32_bf16 v[152:155], v[20:23], v[44:47], v[152:155]
  ds_read_b64_tr_b16 v[82:83], v6 offset:49504
  v_mfma_f32_16x16x32_bf16 v[120:123], v[16:19], v[48:51], v[120:123]
  ds_read_b64_tr_b16 v[84:85], v6 offset:47232
  v_mfma_f32_16x16x32_bf16 v[156:159], v[20:23], v[48:51], v[156:159]
  ds_read_b64_tr_b16 v[86:87], v6 offset:49536
  v_mfma_f32_16x16x32_bf16 v[124:127], v[16:19], v[52:55], v[124:127]
  ds_read_b64_tr_b16 v[88:89], v6 offset:47264
  v_mfma_f32_16x16x32_bf16 v[160:163], v[20:23], v[52:55], v[160:163]
  ds_read_b64_tr_b16 v[90:91], v6 offset:49568
  v_mfma_f32_16x16x32_bf16 v[128:131], v[16:19], v[56:59], v[128:131]
  ds_read_b64_tr_b16 v[92:93], v6 offset:47296
  v_mfma_f32_16x16x32_bf16 v[164:167], v[20:23], v[56:59], v[164:167]
  ds_read_b64_tr_b16 v[94:95], v6 offset:49600
  v_mfma_f32_16x16x32_bf16 v[132:135], v[16:19], v[60:63], v[132:135]
  ds_read_b64_tr_b16 v[96:97], v6 offset:47328
  v_mfma_f32_16x16x32_bf16 v[168:171], v[20:23], v[60:63], v[168:171]
  ds_read_b64_tr_b16 v[98:99], v6 offset:49632
  v_mfma_f32_16x16x32_bf16 v[136:139], v[16:19], v[64:67], v[136:139]
  ds_read_b64_tr_b16 v[100:101], v6 offset:47360
  v_mfma_f32_16x16x32_bf16 v[172:175], v[20:23], v[64:67], v[172:175]
  ds_read_b64_tr_b16 v[102:103], v6 offset:49664
  s_waitcnt lgkmcnt(0)
  s_cmp_lg_u32 s3, 0
  s_cbranch_scc1 .Lm_12
  s_cmp_lg_u32 s59, 0
  s_cbranch_scc1 .Lm_12
  s_add_u32 s45, s101, 1
  s_waitcnt vmcnt(0)
  v_subrev_u32 v233, s45, v234
  v_cmp_le_u32 vcc, 15, v233
  s_nop 3
  s_and_b64 vcc, vcc, s[48:49]
  s_cbranch_scc1 .Lm_13
  s_mov_b32 s59, 1
  v_lshlrev_b32 v236, 3, v0
  s_lshl_b32 s44, s52, 9
  s_add_u32 s44, s44, 155648
  buffer_load_dwordx2 v[240:241], v236, s[4:7], s44 offen sc1
  s_add_u32 s44, s44, 8192
  buffer_load_dwordx2 v[242:243], v236, s[4:7], s44 offen sc1
  s_mul_i32 s44, s53, 576
  s_add_u32 s44, s44, 184320
  v_min_u32 v237, 560, v1
  buffer_load_dwordx4 v[244:247], v237, s[4:7], s44 offen sc1
  s_add_u32 s44, s44, 6912
  buffer_load_dwordx4 v[248:251], v237, s[4:7], s44 offen sc1
  s_branch .Lm_12
.Lm_13:
  buffer_load_dword v234, v232, s[4:7], 0 offen sc1
.Lm_12:
  s_barrier
  v_mfma_f32_16x16x32_bf16 v[104:107], v[24:27], v[68:71], v[104:107]
  ds_read_b128 v[16:19], v3 offset:0
  ds_read_b128 v[20:23], v3 offset:2048
  v_mfma_f32_16x16x32_bf16 v[140:143], v[28:31], v[68:71], v[140:143]
  ds_read_b64_tr_b16 v[32:33], v7 offset:0
  ds_read_b64_tr_b16 v[34:35], v7 offset:2304
  v_mfma_f32_16x16x32_bf16 v[108:111], v[24:27], v[72:75], v[108:111]
  ds_read_b64_tr_b16 v[36:37], v7 offset:32
  v_mfma_f32_16x16x32_bf16 v[144:147], v[28:31], v[72:75], v[144:147]
  ds_read_b64_tr_b16 v[38:39], v7 offset:2336
  v_mfma_f32_16x16x32_bf16 v[112:115], v[24:27], v[76:79], v[112:115]
  ds_read_b64_tr_b16 v[40:41], v7 offset:64
  v_mfma_f32_16x16x32_bf16 v[148:151], v[28:31], v[76:79], v[148:151]
  ds_read_b64_tr_b16 v[42:43], v7 offset:2368
  v_mfma_f32_16x16x32_bf16 v[116:119], v[24:27], v[80:83], v[116:119]
  ds_read_b64_tr_b16 v[44:45], v7 offset:96
  v_mfma_f32_16x16x32_bf16 v[152:155], v[28:31], v[80:83], v[152:155]
  ds_read_b64_tr_b16 v[46:47], v7 offset:2400
  v_mfma_f32_16x16x32_bf16 v[120:123], v[24:27], v[84:87], v[120:123]
  ds_read_b64_tr_b16 v[48:49], v7 offset:128
  v_mfma_f32_16x16x32_bf16 v[156:159], v[28:31], v[84:87], v[156:159]
  ds_read_b64_tr_b16 v[50:51], v7 offset:2432
  v_mfma_f32_16x16x32_bf16 v[124:127], v[24:27], v[88:91], v[124:127]
  ds_read_b64_tr_b16 v[52:53], v7 offset:160
  v_mfma_f32_16x16x32_bf16 v[160:163], v[28:31], v[88:91], v[160:163]
  ds_read_b64_tr_b16 v[54:55], v7 offset:2464
  v_mfma_f32_16x16x32_bf16 v[128:131], v[24:27], v[92:95], v[128:131]
  ds_read_b64_tr_b16 v[56:57], v7 offset:192
  v_mfma_f32_16x16x32_bf16 v[164:167], v[28:31], v[92:95], v[164:167]
  ds_read_b64_tr_b16 v[58:59], v7 offset:2496
  v_mfma_f32_16x16x32_bf16 v[132:135], v[24:27], v[96:99], v[132:135]
  ds_read_b64_tr_b16 v[60:61], v7 offset:224
  v_mfma_f32_16x16x32_bf16 v[168:171], v[28:31], v[96:99], v[168:171]
  ds_read_b64_tr_b16 v[62:63], v7 offset:2528
  v_mfma_f32_16x16x32_bf16 v[136:139], v[24:27], v[100:103], v[136:139]
  ds_read_b64_tr_b16 v[64:65], v7 offset:256
  v_mfma_f32_16x16x32_bf16 v[172:175], v[28:31], v[100:103], v[172:175]
  ds_read_b64_tr_b16 v[66:67], v7 offset:2560
  s_waitcnt lgkmcnt(0)
  v_mfma_f32_16x16x32_bf16 v[104:107], v[16:19], v[32:35], v[104:107]
  ds_read_b128 v[24:27], v5 offset:0
  ds_read_b128 v[28:31], v5 offset:2048
  v_mfma_f32_16x16x32_bf16 v[140:143], v[20:23], v[32:35], v[140:143]
  ds_read_b64_tr_b16 v[68:69], v7 offset:10240
  ds_read_b64_tr_b16 v[70:71], v7 offset:12544
  v_mfma_f32_16x16x32_bf16 v[108:111], v[16:19], v[36:39], v[108:111]
  ds_read_b64_tr_b16 v[72:73], v7 offset:10272
  v_mfma_f32_16x16x32_bf16 v[144:147], v[20:23], v[36:39], v[144:147]
  ds_read_b64_tr_b16 v[74:75], v7 offset:12576
  v_mfma_f32_16x16x32_bf16 v[112:115], v[16:19], v[40:43], v[112:115]
  ds_read_b64_tr_b16 v[76:77], v7 offset:10304
  v_mfma_f32_16x16x32_bf16 v[148:151], v[20:23], v[40:43], v[148:151]
  ds_read_b64_tr_b16 v[78:79], v7 offset:12608
  v_mfma_f32_16x16x32_bf16 v[116:119], v[16:19], v[44:47], v[116:119]
  ds_read_b64_tr_b16 v[80:81], v7 offset:10336
  v_mfma_f32_16x16x32_bf16 v[152:155], v[20:23], v[44:47], v[152:155]
  ds_read_b64_tr_b16 v[82:83], v7 offset:12640
  v_mfma_f32_16x16x32_bf16 v[120:123], v[16:19], v[48:51], v[120:123]
  ds_read_b64_tr_b16 v[84:85], v7 offset:10368
  v_mfma_f32_16x16x32_bf16 v[156:159], v[20:23], v[48:51], v[156:159]
  ds_read_b64_tr_b16 v[86:87], v7 offset:12672
  v_mfma_f32_16x16x32_bf16 v[124:127], v[16:19], v[52:55], v[124:127]
  ds_read_b64_tr_b16 v[88:89], v7 offset:10400
  v_mfma_f32_16x16x32_bf16 v[160:163], v[20:23], v[52:55], v[160:163]
  ds_read_b64_tr_b16 v[90:91], v7 offset:12704
  v_mfma_f32_16x16x32_bf16 v[128:131], v[16:19], v[56:59], v[128:131]
  ds_read_b64_tr_b16 v[92:93], v7 offset:10432
  v_mfma_f32_16x16x32_bf16 v[164:167], v[20:23], v[56:59], v[164:167]
  ds_read_b64_tr_b16 v[94:95], v7 offset:12736
  v_mfma_f32_16x16x32_bf16 v[132:135], v[16:19], v[60:63], v[132:135]
  ds_read_b64_tr_b16 v[96:97], v7 offset:10464
  v_mfma_f32_16x16x32_bf16 v[168:171], v[20:23], v[60:63], v[168:171]
  ds_read_b64_tr_b16 v[98:99], v7 offset:12768
  v_mfma_f32_16x16x32_bf16 v[136:139], v[16:19], v[64:67], v[136:139]
  ds_read_b64_tr_b16 v[100:101], v7 offset:10496
  v_mfma_f32_16x16x32_bf16 v[172:175], v[20:23], v[64:67], v[172:175]
  ds_read_b64_tr_b16 v[102:103], v7 offset:12800
  s_waitcnt lgkmcnt(0)
  s_barrier
  v_mfma_f32_16x16x32_bf16 v[104:107], v[24:27], v[68:71], v[104:107]
  ds_read_b128 v[16:19], v3 offset:36864
  ds_read_b128 v[20:23], v3 offset:38912
  v_mfma_f32_16x16x32_bf16 v[140:143], v[28:31], v[68:71], v[140:143]
  ds_read_b64_tr_b16 v[32:33], v7 offset:36864
  ds_read_b64_tr_b16 v[34:35], v7 offset:39168
  v_mfma_f32_16x16x32_bf16 v[108:111], v[24:27], v[72:75], v[108:111]
  ds_read_b64_tr_b16 v[36:37], v7 offset:36896
  v_mfma_f32_16x16x32_bf16 v[144:147], v[28:31], v[72:75], v[144:147]
  ds_read_b64_tr_b16 v[38:39], v7 offset:39200
  v_mfma_f32_16x16x32_bf16 v[112:115], v[24:27], v[76:79], v[112:115]
  ds_read_b64_tr_b16 v[40:41], v7 offset:36928
  v_mfma_f32_16x16x32_bf16 v[148:151], v[28:31], v[76:79], v[148:151]
  ds_read_b64_tr_b16 v[42:43], v7 offset:39232
  v_mfma_f32_16x16x32_bf16 v[116:119], v[24:27], v[80:83], v[116:119]
  ds_read_b64_tr_b16 v[44:45], v7 offset:36960
  v_mfma_f32_16x16x32_bf16 v[152:155], v[28:31], v[80:83], v[152:155]
  ds_read_b64_tr_b16 v[46:47], v7 offset:39264
  v_mfma_f32_16x16x32_bf16 v[120:123], v[24:27], v[84:87], v[120:123]
  ds_read_b64_tr_b16 v[48:49], v7 offset:36992
  v_mfma_f32_16x16x32_bf16 v[156:159], v[28:31], v[84:87], v[156:159]
  ds_read_b64_tr_b16 v[50:51], v7 offset:39296
  v_mfma_f32_16x16x32_bf16 v[124:127], v[24:27], v[88:91], v[124:127]
  ds_read_b64_tr_b16 v[52:53], v7 offset:37024
  v_mfma_f32_16x16x32_bf16 v[160:163], v[28:31], v[88:91], v[160:163]
  ds_read_b64_tr_b16 v[54:55], v7 offset:39328
  v_mfma_f32_16x16x32_bf16 v[128:131], v[24:27], v[92:95], v[128:131]
  ds_read_b64_tr_b16 v[56:57], v7 offset:37056
  v_mfma_f32_16x16x32_bf16 v[164:167], v[28:31], v[92:95], v[164:167]
  ds_read_b64_tr_b16 v[58:59], v7 offset:39360
  v_mfma_f32_16x16x32_bf16 v[132:135], v[24:27], v[96:99], v[132:135]
  ds_read_b64_tr_b16 v[60:61], v7 offset:37088
  v_mfma_f32_16x16x32_bf16 v[168:171], v[28:31], v[96:99], v[168:171]
  ds_read_b64_tr_b16 v[62:63], v7 offset:39392
  v_mfma_f32_16x16x32_bf16 v[136:139], v[24:27], v[100:103], v[136:139]
  ds_read_b64_tr_b16 v[64:65], v7 offset:37120
  v_mfma_f32_16x16x32_bf16 v[172:175], v[28:31], v[100:103], v[172:175]
  ds_read_b64_tr_b16 v[66:67], v7 offset:39424
  s_waitcnt lgkmcnt(0)
  s_cmp_lg_u32 s3, 0
  s_cbranch_scc1 .Lm_14
  s_cmp_lg_u32 s59, 0
  s_cbranch_scc1 .Lm_14
  s_add_u32 s45, s101, 1
  s_waitcnt vmcnt(0)
  v_subrev_u32 v233, s45, v234
  v_cmp_le_u32 vcc, 15, v233
  s_nop 3
  s_and_b64 vcc, vcc, s[48:49]
  s_cbranch_scc1 .Lm_15
  s_mov_b32 s59, 1
  v_lshlrev_b32 v236, 3, v0
  s_lshl_b32 s44, s52, 9
  s_add_u32 s44, s44, 155648
  buffer_load_dwordx2 v[240:241], v236, s[4:7], s44 offen sc1
  s_add_u32 s44, s44, 8192
  buffer_load_dwordx2 v[242:243], v236, s[4:7], s44 offen sc1
  s_mul_i32 s44, s53, 576
  s_add_u32 s44, s44, 184320
  v_min_u32 v237, 560, v1
  buffer_load_dwordx4 v[244:247], v237, s[4:7], s44 offen sc1
  s_add_u32 s44, s44, 6912
  buffer_load_dwordx4 v[248:251], v237, s[4:7], s44 offen sc1
  s_branch .Lm_14
.Lm_15:
.Lm_14:
  v_mfma_f32_16x16x32_bf16 v[104:107], v[16:19], v[32:35], v[104:107]
  ds_read_b128 v[24:27], v5 offset:36864
  ds_read_b128 v[28:31], v5 offset:38912
  v_mfma_f32_16x16x32_bf16 v[140:143], v[20:23], v[32:35], v[140:143]
  ds_read_b64_tr_b16 v[68:69], v7 offset:47104
  ds_read_b64_tr_b16 v[70:71], v7 offset:49408
  v_mfma_f32_16x16x32_bf16 v[108:111], v[16:19], v[36:39], v[108:111]
  ds_read_b64_tr_b16 v[72:73], v7 offset:47136
  v_mfma_f32_16x16x32_bf16 v[144:147], v[20:23], v[36:39], v[144:147]
  ds_read_b64_tr_b16 v[74:75], v7 offset:49440
  v_mfma_f32_16x16x32_bf16 v[112:115], v[16:19], v[40:43], v[112:115]
  ds_read_b64_tr_b16 v[76:77], v7 offset:47168
  v_mfma_f32_16x16x32_bf16 v[148:151], v[20:23], v[40:43], v[148:151]
  ds_read_b64_tr_b16 v[78:79], v7 offset:49472
  v_mfma_f32_16x16x32_bf16 v[116:119], v[16:19], v[44:47], v[116:119]
  ds_read_b64_tr_b16 v[80:81], v7 offset:47200
  v_mfma_f32_16x16x32_bf16 v[152:155], v[20:23], v[44:47], v[152:155]
  ds_read_b64_tr_b16 v[82:83], v7 offset:49504
  v_mfma_f32_16x16x32_bf16 v[120:123], v[16:19], v[48:51], v[120:123]
  ds_read_b64_tr_b16 v[84:85], v7 offset:47232
  v_mfma_f32_16x16x32_bf16 v[156:159], v[20:23], v[48:51], v[156:159]
  ds_read_b64_tr_b16 v[86:87], v7 offset:49536
  v_mfma_f32_16x16x32_bf16 v[124:127], v[16:19], v[52:55], v[124:127]
  ds_read_b64_tr_b16 v[88:89], v7 offset:47264
  v_mfma_f32_16x16x32_bf16 v[160:163], v[20:23], v[52:55], v[160:163]
  ds_read_b64_tr_b16 v[90:91], v7 offset:49568
  v_mfma_f32_16x16x32_bf16 v[128:131], v[16:19], v[56:59], v[128:131]
  ds_read_b64_tr_b16 v[92:93], v7 offset:47296
  v_mfma_f32_16x16x32_bf16 v[164:167], v[20:23], v[56:59], v[164:167]
  ds_read_b64_tr_b16 v[94:95], v7 offset:49600
  v_mfma_f32_16x16x32_bf16 v[132:135], v[16:19], v[60:63], v[132:135]
  ds_read_b64_tr_b16 v[96:97], v7 offset:47328
  v_mfma_f32_16x16x32_bf16 v[168:171], v[20:23], v[60:63], v[168:171]
  ds_read_b64_tr_b16 v[98:99], v7 offset:49632
  v_mfma_f32_16x16x32_bf16 v[136:139], v[16:19], v[64:67], v[136:139]
  ds_read_b64_tr_b16 v[100:101], v7 offset:47360
  v_mfma_f32_16x16x32_bf16 v[172:175], v[20:23], v[64:67], v[172:175]
  ds_read_b64_tr_b16 v[102:103], v7 offset:49664
  s_waitcnt lgkmcnt(0)
  s_barrier
  v_mfma_f32_16x16x32_bf16 v[104:107], v[24:27], v[68:71], v[104:107]
  ds_read_b128 v[16:19], v2 offset:0
  ds_read_b128 v[20:23], v2 offset:2048
  v_mfma_f32_16x16x32_bf16 v[140:143], v[28:31], v[68:71], v[140:143]
  ds_read_b64_tr_b16 v[32:33], v6 offset:0
  ds_read_b64_tr_b16 v[34:35], v6 offset:2304
  v_mfma_f32_16x16x32_bf16 v[108:111], v[24:27], v[72:75], v[108:111]
  ds_read_b64_tr_b16 v[36:37], v6 offset:32
  v_mfma_f32_16x16x32_bf16 v[144:147], v[28:31], v[72:75], v[144:147]
  ds_read_b64_tr_b16 v[38:39], v6 offset:2336
  v_mfma_f32_16x16x32_bf16 v[112:115], v[24:27], v[76:79], v[112:115]
  ds_read_b64_tr_b16 v[40:41], v6 offset:64
  v_mfma_f32_16x16x32_bf16 v[148:151], v[28:31], v[76:79], v[148:151]
  ds_read_b64_tr_b16 v[42:43], v6 offset:2368
  v_mfma_f32_16x16x32_bf16 v[116:119], v[24:27], v[80:83], v[116:119]
  ds_read_b64_tr_b16 v[44:45], v6 offset:96
  v_mfma_f32_16x16x32_bf16 v[152:155], v[28:31], v[80:83], v[152:155]
  ds_read_b64_tr_b16 v[46:47], v6 offset:2400
  v_mfma_f32_16x16x32_bf16 v[120:123], v[24:27], v[84:87], v[120:123]
  ds_read_b64_tr_b16 v[48:49], v6 offset:128
  v_mfma_f32_16x16x32_bf16 v[156:159], v[28:31], v[84:87], v[156:159]
  ds_read_b64_tr_b16 v[50:51], v6 offset:2432
  v_mfma_f32_16x16x32_bf16 v[124:127], v[24:27], v[88:91], v[124:127]
  ds_read_b64_tr_b16 v[52:53], v6 offset:160
  v_mfma_f32_16x16x32_bf16 v[160:163], v[28:31], v[88:91], v[160:163]
  ds_read_b64_tr_b16 v[54:55], v6 offset:2464
  v_mfma_f32_16x16x32_bf16 v[128:131], v[24:27], v[92:95], v[128:131]
  ds_read_b64_tr_b16 v[56:57], v6 offset:192
  v_mfma_f32_16x16x32_bf16 v[164:167], v[28:31], v[92:95], v[164:167]
  ds_read_b64_tr_b16 v[58:59], v6 offset:2496
  v_mfma_f32_16x16x32_bf16 v[132:135], v[24:27], v[96:99], v[132:135]
  ds_read_b64_tr_b16 v[60:61], v6 offset:224
  v_mfma_f32_16x16x32_bf16 v[168:171], v[28:31], v[96:99], v[168:171]
  ds_read_b64_tr_b16 v[62:63], v6 offset:2528
  v_mfma_f32_16x16x32_bf16 v[136:139], v[24:27], v[100:103], v[136:139]
  ds_read_b64_tr_b16 v[64:65], v6 offset:256
  v_mfma_f32_16x16x32_bf16 v[172:175], v[28:31], v[100:103], v[172:175]
  ds_read_b64_tr_b16 v[66:67], v6 offset:2560
  s_waitcnt lgkmcnt(0)
  v_mfma_f32_16x16x32_bf16 v[104:107], v[16:19], v[32:35], v[104:107]
  ds_read_b128 v[24:27], v4 offset:0
  ds_read_b128 v[28:31], v4 offset:2048
  v_mfma_f32_16x16x32_bf16 v[140:143], v[20:23], v[32:35], v[140:143]
  ds_read_b64_tr_b16 v[68:69], v6 offset:10240
  ds_read_b64_tr_b16 v[70:71], v6 offset:12544
  v_mfma_f32_16x16x32_bf16 v[108:111], v[16:19], v[36:39], v[108:111]
  ds_read_b64_tr_b16 v[72:73], v6 offset:10272
  v_mfma_f32_16x16x32_bf16 v[144:147], v[20:23], v[36:39], v[144:147]
  ds_read_b64_tr_b16 v[74:75], v6 offset:12576
  v_mfma_f32_16x16x32_bf16 v[112:115], v[16:19], v[40:43], v[112:115]
  ds_read_b64_tr_b16 v[76:77], v6 offset:10304
  v_mfma_f32_16x16x32_bf16 v[148:151], v[20:23], v[40:43], v[148:151]
  ds_read_b64_tr_b16 v[78:79], v6 offset:12608
  v_mfma_f32_16x16x32_bf16 v[116:119], v[16:19], v[44:47], v[116:119]
  ds_read_b64_tr_b16 v[80:81], v6 offset:10336
  v_mfma_f32_16x16x32_bf16 v[152:155], v[20:23], v[44:47], v[152:155]
  ds_read_b64_tr_b16 v[82:83], v6 offset:12640
  v_mfma_f32_16x16x32_bf16 v[120:123], v[16:19], v[48:51], v[120:123]
  ds_read_b64_tr_b16 v[84:85], v6 offset:10368
  v_mfma_f32_16x16x32_bf16 v[156:159], v[20:23], v[48:51], v[156:159]
  ds_read_b64_tr_b16 v[86:87], v6 offset:12672
  v_mfma_f32_16x16x32_bf16 v[124:127], v[16:19], v[52:55], v[124:127]
  ds_read_b64_tr_b16 v[88:89], v6 offset:10400
  v_mfma_f32_16x16x32_bf16 v[160:163], v[20:23], v[52:55], v[160:163]
  ds_read_b64_tr_b16 v[90:91], v6 offset:12704
  v_mfma_f32_16x16x32_bf16 v[128:131], v[16:19], v[56:59], v[128:131]
  ds_read_b64_tr_b16 v[92:93], v6 offset:10432
  v_mfma_f32_16x16x32_bf16 v[164:167], v[20:23], v[56:59], v[164:167]
  ds_read_b64_tr_b16 v[94:95], v6 offset:12736
  v_mfma_f32_16x16x32_bf16 v[132:135], v[16:19], v[60:63], v[132:135]
  ds_read_b64_tr_b16 v[96:97], v6 offset:10464
  v_mfma_f32_16x16x32_bf16 v[168:171], v[20:23], v[60:63], v[168:171]
  ds_read_b64_tr_b16 v[98:99], v6 offset:12768
  v_mfma_f32_16x16x32_bf16 v[136:139], v[16:19], v[64:67], v[136:139]
  ds_read_b64_tr_b16 v[100:101], v6 offset:10496
  v_mfma_f32_16x16x32_bf16 v[172:175], v[20:23], v[64:67], v[172:175]
  ds_read_b64_tr_b16 v[102:103], v6 offset:12800
  s_waitcnt lgkmcnt(0)
  v_mfma_f32_16x16x32_bf16 v[104:107], v[24:27], v[68:71], v[104:107]
  v_mfma_f32_16x16x32_bf16 v[140:143], v[28:31], v[68:71], v[140:143]
  v_mfma_f32_16x16x32_bf16 v[108:111], v[24:27], v[72:75], v[108:111]
  v_mfma_f32_16x16x32_bf16 v[144:147], v[28:31], v[72:75], v[144:147]
  v_mfma_f32_16x16x32_bf16 v[112:115], v[24:27], v[76:79], v[112:115]
  v_mfma_f32_16x16x32_bf16 v[148:151], v[28:31], v[76:79], v[148:151]
  v_mfma_f32_16x16x32_bf16 v[116:119], v[24:27], v[80:83], v[116:119]
  v_mfma_f32_16x16x32_bf16 v[152:155], v[28:31], v[80:83], v[152:155]
  v_mfma_f32_16x16x32_bf16 v[120:123], v[24:27], v[84:87], v[120:123]
  v_mfma_f32_16x16x32_bf16 v[156:159], v[28:31], v[84:87], v[156:159]
  v_mfma_f32_16x16x32_bf16 v[124:127], v[24:27], v[88:91], v[124:127]
  v_mfma_f32_16x16x32_bf16 v[160:163], v[28:31], v[88:91], v[160:163]
  v_mfma_f32_16x16x32_bf16 v[128:131], v[24:27], v[92:95], v[128:131]
  v_mfma_f32_16x16x32_bf16 v[164:167], v[28:31], v[92:95], v[164:167]
  v_mfma_f32_16x16x32_bf16 v[132:135], v[24:27], v[96:99], v[132:135]
  v_mfma_f32_16x16x32_bf16 v[168:171], v[28:31], v[96:99], v[168:171]
  v_mfma_f32_16x16x32_bf16 v[136:139], v[24:27], v[100:103], v[136:139]
  v_mfma_f32_16x16x32_bf16 v[172:175], v[28:31], v[100:103], v[172:175]
  s_cmp_lg_u32 s3, 0
  s_cbranch_scc1 .Lm_16
  s_cmp_lg_u32 s59, 0
  s_cbranch_scc1 .Lm_17
  s_lshr_b32 s46, s2, 3
  s_mul_i32 s46, s46, 4352
  s_add_u32 s46, s46, 4096
  v_lshlrev_b32 v232, 2, v0
  v_add_u32 v232, s46, v232
  s_mov_b64 vcc, -1
  s_mul_i32 s46, s53, 9
  s_lshr_b32 s47, s46, 2
  v_lshrrev_b32 v233, 1, v0
  v_subrev_u32 v233, s47, v233
  v_cmp_gt_u32 vcc, 3, v233
  v_lshrrev_b32 v233, 2, v0
  v_cmp_eq_u32 s[46:47], s52, v233
  s_nop 3
  s_or_b64 vcc, vcc, s[46:47]
  s_add_u32 s45, s101, 1
  s_mov_b32 s44, 0
  s_nop 2
  s_mov_b64 exec, vcc
.Lm_18:
  buffer_load_dword v234, v232, s[4:7], 0 offen sc1
  s_waitcnt vmcnt(0)
  v_subrev_u32 v233, s45, v234
  v_cmp_le_u32 vcc, 15, v233
  s_add_u32 s44, s44, 1
  s_nop 2
  s_cmp_eq_u64 vcc, 0
  s_cbranch_scc1 .Lm_19
  s_sleep 1
  s_cmp_lt_u32 s44, 0x40000
  s_cbranch_scc1 .Lm_18
.Lm_19:
  s_mov_b64 exec, -1
  v_lshlrev_b32 v236, 3, v0
  s_lshl_b32 s44, s52, 9
  s_add_u32 s44, s44, 155648
  buffer_load_dwordx2 v[240:241], v236, s[4:7], s44 offen sc1
  s_add_u32 s44, s44, 8192
  buffer_load_dwordx2 v[242:243], v236, s[4:7], s44 offen sc1
  s_mul_i32 s44, s53, 576
  s_add_u32 s44, s44, 184320
  v_min_u32 v237, 560, v1
  buffer_load_dwordx4 v[244:247], v237, s[4:7], s44 offen sc1
  s_add_u32 s44, s44, 6912
  buffer_load_dwordx4 v[248:251], v237, s[4:7], s44 offen sc1
.Lm_17:
  s_mov_b32 s46, 1.0
  s_cmp_lt_u32 s53, 4
  s_cselect_b32 s46, 0x3eae1a93, s46
  v_add_u32 v236, 147456, v236
  v_add_u32 v237, 148480, v237
  s_waitcnt vmcnt(0)
  v_mul_f32 v240, s46, v240
  v_mul_f32 v241, s46, v241
  v_mul_f32 v242, s46, v242
  v_mul_f32 v243, s46, v243
  v_add_f32 v244, v244, v248
  v_add_f32 v245, v245, v249
  v_add_f32 v246, v246, v250
  v_add_f32 v247, v247, v251
  ds_write_b64 v236, v[240:241]
  ds_write_b64 v236, v[242:243] offset:512
  ds_write_b128 v237, v[244:247]
  s_waitcnt lgkmcnt(0)
.Lm_16:
  s_waitcnt vmcnt(0)
  v_and_b32 v8, 15, v0
  v_lshrrev_b32 v9, 4, v0
  s_lshl_b32 s44, s3, 7
  s_add_u32 s44, s44, 147456
  v_lshlrev_b32 v10, 4, v9
  v_add_u32 v10, s44, v10
  v_lshlrev_b32 v11, 2, v8
  v_add_u32 v11, 148480, v11
  s_and_b32 s44, s53, 3
  s_mul_i32 s44, s44, 2304
  s_lshl_b32 s45, s52, 2
  s_add_u32 s45, s45, s3
  s_mul_i32 s45, s45, 37376
  s_add_u32 s44, s44, s45
  s_add_u32 s44, s44, 7405568
  v_mul_u32_u24 v12, 9344, v9
  v_lshl_add_u32 v12, v8, 4, v12
  s_barrier
  ds_read_b128 v[212:215], v10 offset:0
  ds_read_b128 v[216:219], v10 offset:512
  ds_read_b128 v[220:223], v10 offset:64
  ds_read_b128 v[224:227], v10 offset:576
  ds_read_b32 v176, v11 offset:0
  ds_read_b32 v178, v11 offset:64
  ds_read_b32 v180, v11 offset:128
  ds_read_b32 v182, v11 offset:192
  ds_read_b32 v184, v11 offset:256
  ds_read_b32 v186, v11 offset:320
  ds_read_b32 v188, v11 offset:384
  ds_read_b32 v190, v11 offset:448
  ds_read_b32 v192, v11 offset:512
  s_waitcnt lgkmcnt(8)
  v_pk_mul_f32 v[104:105], v[104:105], v[212:213]
  v_pk_mul_f32 v[106:107], v[106:107], v[214:215]
  v_pk_fma_f32 v[104:105], v[176:177], v[216:217], v[104:105] op_sel_hi:[0,1,1]
  v_pk_fma_f32 v[106:107], v[176:177], v[218:219], v[106:107] op_sel_hi:[0,1,1]
  v_pk_mul_f32 v[140:141], v[140:141], v[220:221]
  v_pk_mul_f32 v[142:143], v[142:143], v[222:223]
  v_pk_fma_f32 v[140:141], v[176:177], v[224:225], v[140:141] op_sel_hi:[0,1,1]
  v_pk_fma_f32 v[142:143], v[176:177], v[226:227], v[142:143] op_sel_hi:[0,1,1]
  v_cvt_pk_bf16_f32 v32, v104, v105
  v_cvt_pk_bf16_f32 v33, v106, v107
  v_cvt_pk_bf16_f32 v34, v140, v141
  v_cvt_pk_bf16_f32 v35, v142, v143
  s_nop 1
  v_permlane32_swap_b32 v32, v34
  v_permlane32_swap_b32 v33, v35
  s_nop 1
  buffer_store_dwordx4 v[32:35], v12, s[4:7], s44 offen offset:0 sc1
  s_waitcnt lgkmcnt(7)
  v_pk_mul_f32 v[108:109], v[108:109], v[212:213]
  v_pk_mul_f32 v[110:111], v[110:111], v[214:215]
  v_pk_fma_f32 v[108:109], v[178:179], v[216:217], v[108:109] op_sel_hi:[0,1,1]
  v_pk_fma_f32 v[110:111], v[178:179], v[218:219], v[110:111] op_sel_hi:[0,1,1]
  v_pk_mul_f32 v[144:145], v[144:145], v[220:221]
  v_pk_mul_f32 v[146:147], v[146:147], v[222:223]
  v_pk_fma_f32 v[144:145], v[178:179], v[224:225], v[144:145] op_sel_hi:[0,1,1]
  v_pk_fma_f32 v[146:147], v[178:179], v[226:227], v[146:147] op_sel_hi:[0,1,1]
  v_cvt_pk_bf16_f32 v36, v108, v109
  v_cvt_pk_bf16_f32 v37, v110, v111
  v_cvt_pk_bf16_f32 v38, v144, v145
  v_cvt_pk_bf16_f32 v39, v146, v147
  s_nop 1
  v_permlane32_swap_b32 v36, v38
  v_permlane32_swap_b32 v37, v39
  s_nop 1
  buffer_store_dwordx4 v[36:39], v12, s[4:7], s44 offen offset:256 sc1
  s_waitcnt lgkmcnt(6)
  v_pk_mul_f32 v[112:113], v[112:113], v[212:213]
  v_pk_mul_f32 v[114:115], v[114:115], v[214:215]
  v_pk_fma_f32 v[112:113], v[180:181], v[216:217], v[112:113] op_sel_hi:[0,1,1]
  v_pk_fma_f32 v[114:115], v[180:181], v[218:219], v[114:115] op_sel_hi:[0,1,1]
  v_pk_mul_f32 v[148:149], v[148:149], v[220:221]
  v_pk_mul_f32 v[150:151], v[150:151], v[222:223]
  v_pk_fma_f32 v[148:149], v[180:181], v[224:225], v[148:149] op_sel_hi:[0,1,1]
  v_pk_fma_f32 v[150:151], v[180:181], v[226:227], v[150:151] op_sel_hi:[0,1,1]
  v_cvt_pk_bf16_f32 v40, v112, v113
  v_cvt_pk_bf16_f32 v41, v114, v115
  v_cvt_pk_bf16_f32 v42, v148, v149
  v_cvt_pk_bf16_f32 v43, v150, v151
  s_nop 1
  v_permlane32_swap_b32 v40, v42
  v_permlane32_swap_b32 v41, v43
  s_nop 1
  buffer_store_dwordx4 v[40:43], v12, s[4:7], s44 offen offset:512 sc1
  s_waitcnt lgkmcnt(5)
  v_pk_mul_f32 v[116:117], v[116:117], v[212:213]
  v_pk_mul_f32 v[118:119], v[118:119], v[214:215]
  v_pk_fma_f32 v[116:117], v[182:183], v[216:217], v[116:117] op_sel_hi:[0,1,1]
  v_pk_fma_f32 v[118:119], v[182:183], v[218:219], v[118:119] op_sel_hi:[0,1,1]
  v_pk_mul_f32 v[152:153], v[152:153], v[220:221]
  v_pk_mul_f32 v[154:155], v[154:155], v[222:223]
  v_pk_fma_f32 v[152:153], v[182:183], v[224:225], v[152:153] op_sel_hi:[0,1,1]
  v_pk_fma_f32 v[154:155], v[182:183], v[226:227], v[154:155] op_sel_hi:[0,1,1]
  v_cvt_pk_bf16_f32 v44, v116, v117
  v_cvt_pk_bf16_f32 v45, v118, v119
  v_cvt_pk_bf16_f32 v46, v152, v153
  v_cvt_pk_bf16_f32 v47, v154, v155
  s_nop 1
  v_permlane32_swap_b32 v44, v46
  v_permlane32_swap_b32 v45, v47
  s_nop 1
  buffer_store_dwordx4 v[44:47], v12, s[4:7], s44 offen offset:768 sc1
  s_waitcnt lgkmcnt(4)
  v_pk_mul_f32 v[120:121], v[120:121], v[212:213]
  v_pk_mul_f32 v[122:123], v[122:123], v[214:215]
  v_pk_fma_f32 v[120:121], v[184:185], v[216:217], v[120:121] op_sel_hi:[0,1,1]
  v_pk_fma_f32 v[122:123], v[184:185], v[218:219], v[122:123] op_sel_hi:[0,1,1]
  v_pk_mul_f32 v[156:157], v[156:157], v[220:221]
  v_pk_mul_f32 v[158:159], v[158:159], v[222:223]
  v_pk_fma_f32 v[156:157], v[184:185], v[224:225], v[156:157] op_sel_hi:[0,1,1]
  v_pk_fma_f32 v[158:159], v[184:185], v[226:227], v[158:159] op_sel_hi:[0,1,1]
  v_cvt_pk_bf16_f32 v48, v120, v121
  v_cvt_pk_bf16_f32 v49, v122, v123
  v_cvt_pk_bf16_f32 v50, v156, v157
  v_cvt_pk_bf16_f32 v51, v158, v159
  s_nop 1
  v_permlane32_swap_b32 v48, v50
  v_permlane32_swap_b32 v49, v51
  s_nop 1
  buffer_store_dwordx4 v[48:51], v12, s[4:7], s44 offen offset:1024 sc1
  s_waitcnt lgkmcnt(3)
  v_pk_mul_f32 v[124:125], v[124:125], v[212:213]
  v_pk_mul_f32 v[126:127], v[126:127], v[214:215]
  v_pk_fma_f32 v[124:125], v[186:187], v[216:217], v[124:125] op_sel_hi:[0,1,1]
  v_pk_fma_f32 v[126:127], v[186:187], v[218:219], v[126:127] op_sel_hi:[0,1,1]
  v_pk_mul_f32 v[160:161], v[160:161], v[220:221]
  v_pk_mul_f32 v[162:163], v[162:163], v[222:223]
  v_pk_fma_f32 v[160:161], v[186:187], v[224:225], v[160:161] op_sel_hi:[0,1,1]
  v_pk_fma_f32 v[162:163], v[186:187], v[226:227], v[162:163] op_sel_hi:[0,1,1]
  v_cvt_pk_bf16_f32 v52, v124, v125
  v_cvt_pk_bf16_f32 v53, v126, v127
  v_cvt_pk_bf16_f32 v54, v160, v161
  v_cvt_pk_bf16_f32 v55, v162, v163
  s_nop 1
  v_permlane32_swap_b32 v52, v54
  v_permlane32_swap_b32 v53, v55
  s_nop 1
  buffer_store_dwordx4 v[52:55], v12, s[4:7], s44 offen offset:1280 sc1
  s_waitcnt lgkmcnt(2)
  v_pk_mul_f32 v[128:129], v[128:129], v[212:213]
  v_pk_mul_f32 v[130:131], v[130:131], v[214:215]
  v_pk_fma_f32 v[128:129], v[188:189], v[216:217], v[128:129] op_sel_hi:[0,1,1]
  v_pk_fma_f32 v[130:131], v[188:189], v[218:219], v[130:131] op_sel_hi:[0,1,1]
  v_pk_mul_f32 v[164:165], v[164:165], v[220:221]
  v_pk_mul_f32 v[166:167], v[166:167], v[222:223]
  v_pk_fma_f32 v[164:165], v[188:189], v[224:225], v[164:165] op_sel_hi:[0,1,1]
  v_pk_fma_f32 v[166:167], v[188:189], v[226:227], v[166:167] op_sel_hi:[0,1,1]
  v_cvt_pk_bf16_f32 v56, v128, v129
  v_cvt_pk_bf16_f32 v57, v130, v131
  v_cvt_pk_bf16_f32 v58, v164, v165
  v_cvt_pk_bf16_f32 v59, v166, v167
  s_nop 1
  v_permlane32_swap_b32 v56, v58
  v_permlane32_swap_b32 v57, v59
  s_nop 1
  buffer_store_dwordx4 v[56:59], v12, s[4:7], s44 offen offset:1536 sc1
  s_waitcnt lgkmcnt(1)
  v_pk_mul_f32 v[132:133], v[132:133], v[212:213]
  v_pk_mul_f32 v[134:135], v[134:135], v[214:215]
  v_pk_fma_f32 v[132:133], v[190:191], v[216:217], v[132:133] op_sel_hi:[0,1,1]
  v_pk_fma_f32 v[134:135], v[190:191], v[218:219], v[134:135] op_sel_hi:[0,1,1]
  v_pk_mul_f32 v[168:169], v[168:169], v[220:221]
  v_pk_mul_f32 v[170:171], v[170:171], v[222:223]
  v_pk_fma_f32 v[168:169], v[190:191], v[224:225], v[168:169] op_sel_hi:[0,1,1]
  v_pk_fma_f32 v[170:171], v[190:191], v[226:227], v[170:171] op_sel_hi:[0,1,1]
  v_cvt_pk_bf16_f32 v60, v132, v133
  v_cvt_pk_bf16_f32 v61, v134, v135
  v_cvt_pk_bf16_f32 v62, v168, v169
  v_cvt_pk_bf16_f32 v63, v170, v171
  s_nop 1
  v_permlane32_swap_b32 v60, v62
  v_permlane32_swap_b32 v61, v63
  s_nop 1
  buffer_store_dwordx4 v[60:63], v12, s[4:7], s44 offen offset:1792 sc1
  s_waitcnt lgkmcnt(0)
  v_pk_mul_f32 v[136:137], v[136:137], v[212:213]
  v_pk_mul_f32 v[138:139], v[138:139], v[214:215]
  v_pk_fma_f32 v[136:137], v[192:193], v[216:217], v[136:137] op_sel_hi:[0,1,1]
  v_pk_fma_f32 v[138:139], v[192:193], v[218:219], v[138:139] op_sel_hi:[0,1,1]
  v_pk_mul_f32 v[172:173], v[172:173], v[220:221]
  v_pk_mul_f32 v[174:175], v[174:175], v[222:223]
  v_pk_fma_f32 v[172:173], v[192:193], v[224:225], v[172:173] op_sel_hi:[0,1,1]
  v_pk_fma_f32 v[174:175], v[192:193], v[226:227], v[174:175] op_sel_hi:[0,1,1]
  v_cvt_pk_bf16_f32 v64, v136, v137
  v_cvt_pk_bf16_f32 v65, v138, v139
  v_cvt_pk_bf16_f32 v66, v172, v173
  v_cvt_pk_bf16_f32 v67, v174, v175
  s_nop 1
  v_permlane32_swap_b32 v64, v66
  v_permlane32_swap_b32 v65, v67
  s_nop 1
  buffer_store_dwordx4 v[64:67], v12, s[4:7], s44 offen offset:2048 sc1
  s_branch .L_s1_done
.L_s1_pp:
.L_pp_A2:
  s_lshl_b32 s57, s3, 6
  s_add_u32 s57, s57, s52
  s_cmp_lt_u32 s3, 2
  s_cbranch_scc1 .Lm_20
  s_mov_b32 s12, s20
  s_and_b32 s13, s21, 0xffff
  s_mov_b32 s14, 0x000a2000
  s_mov_b32 s15, 0x00020000
  s_sub_u32 s57, s57, 128
  s_mul_i32 s46, s57, 9216
  buffer_load_dwordx4 v[120:123], v18, s[12:15], s46 offen offset:0
  buffer_load_dwordx4 v[124:127], v18, s[12:15], s46 offen offset:128
  buffer_load_dwordx4 v[128:131], v18, s[12:15], s46 offen offset:256
  buffer_load_dwordx4 v[132:135], v18, s[12:15], s46 offen offset:384
  buffer_load_dwordx4 v[136:139], v18, s[12:15], s46 offen offset:512
  buffer_load_dwordx4 v[140:143], v18, s[12:15], s46 offen offset:640
  buffer_load_dwordx4 v[144:147], v18, s[12:15], s46 offen offset:768
  buffer_load_dwordx4 v[148:151], v18, s[12:15], s46 offen offset:896
  buffer_load_dwordx4 v[152:155], v18, s[12:15], s46 offen offset:1024
  s_branch .L_pp_st
.Lm_20:
  s_cmp_ge_u32 s57, 72
  s_cbranch_scc1 .L_pp_st
  s_mul_i32 s53, s3, 10240
  s_mov_b32 s12, s20
  s_and_b32 s13, s21, 0xffff
  s_mov_b32 s14, 0x000a2000
  s_mov_b32 s15, 0x00020000
  s_and_b32 s48, s57, 3
  s_lshr_b32 s49, s57, 2
  s_cmp_ge_u32 s49, 16
  s_cbranch_scc1 .L_pp_wol
  v_add_u32 v20, 0, v0
  v_mul_u32_u24 v21, 3641, v20
  v_lshrrev_b32 v21, 16, v21
  v_mul_u32_u24 v22, 18, v21
  v_sub_u32 v20, v20, v22
  v_mul_u32_u24 v22, 1152, v21
  v_lshl_add_u32 v7, v20, 4, v22
  v_add_u32 v20, 64, v0
  v_mul_u32_u24 v21, 3641, v20
  v_lshrrev_b32 v21, 16, v21
  v_mul_u32_u24 v22, 18, v21
  v_sub_u32 v20, v20, v22
  v_mul_u32_u24 v22, 1152, v21
  v_lshl_add_u32 v8, v20, 4, v22
  v_subrev_u32 v8, 1024, v8
  v_add_u32 v20, 128, v0
  v_mul_u32_u24 v21, 3641, v20
  v_lshrrev_b32 v21, 16, v21
  v_mul_u32_u24 v22, 18, v21
  v_sub_u32 v20, v20, v22
  v_mul_u32_u24 v22, 1152, v21
  v_lshl_add_u32 v9, v20, 4, v22
  v_subrev_u32 v9, 2048, v9
  v_add_u32 v20, 192, v0
  v_mul_u32_u24 v21, 3641, v20
  v_lshrrev_b32 v21, 16, v21
  v_mul_u32_u24 v22, 18, v21
  v_sub_u32 v20, v20, v22
  v_mul_u32_u24 v22, 1152, v21
  v_lshl_add_u32 v10, v20, 4, v22
  v_subrev_u32 v10, 3072, v10
  v_add_u32 v20, 256, v0
  v_mul_u32_u24 v21, 3641, v20
  v_lshrrev_b32 v21, 16, v21
  v_mul_u32_u24 v22, 18, v21
  v_sub_u32 v20, v20, v22
  v_mul_u32_u24 v22, 1152, v21
  v_lshl_add_u32 v11, v20, 4, v22
  v_mov_b32 v22, 0x7ff00000
  v_cmp_gt_u32 vcc, 32, v0
  s_nop 1
  v_cndmask_b32 v11, v22, v11, vcc
  s_mul_i32 s55, s49, 41472
  s_mov_b32 s50, 20736
  s_branch .L_pp_wo2
.L_pp_wol:
  v_add_u32 v20, 0, v0
  v_mul_u32_u24 v21, 3641, v20
  v_lshrrev_b32 v21, 16, v21
  v_mul_u32_u24 v22, 18, v21
  v_sub_u32 v20, v20, v22
  v_lshrrev_b32 v22, 1, v21
  v_mul_u32_u24 v22, 18, v22
  v_and_b32 v21, 1, v21
  v_add3_u32 v21, v21, v22, 16
  v_mul_u32_u24 v22, 1152, v21
  v_lshl_add_u32 v7, v20, 4, v22
  v_add_u32 v20, 64, v0
  v_mul_u32_u24 v21, 3641, v20
  v_lshrrev_b32 v21, 16, v21
  v_mul_u32_u24 v22, 18, v21
  v_sub_u32 v20, v20, v22
  v_lshrrev_b32 v22, 1, v21
  v_mul_u32_u24 v22, 18, v22
  v_and_b32 v21, 1, v21
  v_add3_u32 v21, v21, v22, 16
  v_mul_u32_u24 v22, 1152, v21
  v_lshl_add_u32 v8, v20, 4, v22
  v_subrev_u32 v8, 1024, v8
  v_add_u32 v20, 128, v0
  v_mul_u32_u24 v21, 3641, v20
  v_lshrrev_b32 v21, 16, v21
  v_mul_u32_u24 v22, 18, v21
  v_sub_u32 v20, v20, v22
  v_lshrrev_b32 v22, 1, v21
  v_mul_u32_u24 v22, 18, v22
  v_and_b32 v21, 1, v21
  v_add3_u32 v21, v21, v22, 16
  v_mul_u32_u24 v22, 1152, v21
  v_lshl_add_u32 v9, v20, 4, v22
  v_subrev_u32 v9, 2048, v9
  v_add_u32 v20, 192, v0
  v_mul_u32_u24 v21, 3641, v20
  v_lshrrev_b32 v21, 16, v21
  v_mul_u32_u24 v22, 18, v21
  v_sub_u32 v20, v20, v22
  v_lshrrev_b32 v22, 1, v21
  v_mul_u32_u24 v22, 18, v22
  v_and_b32 v21, 1, v21
  v_add3_u32 v21, v21, v22, 16
  v_mul_u32_u24 v22, 1152, v21
  v_lshl_add_u32 v10, v20, 4, v22
  v_subrev_u32 v10, 3072, v10
  v_add_u32 v20, 256, v0
  v_mul_u32_u24 v21, 3641, v20
  v_lshrrev_b32 v21, 16, v21
  v_mul_u32_u24 v22, 18, v21
  v_sub_u32 v20, v20, v22
  v_lshrrev_b32 v22, 1, v21
  v_mul_u32_u24 v22, 18, v22
  v_and_b32 v21, 1, v21
  v_add3_u32 v21, v21, v22, 16
  v_mul_u32_u24 v22, 1152, v21
  v_lshl_add_u32 v11, v20, 4, v22
  v_mov_b32 v22, 0x7ff00000
  v_cmp_gt_u32 vcc, 32, v0
  s_nop 1
  v_cndmask_b32 v11, v22, v11, vcc
  s_sub_u32 s55, s49, 16
  s_mul_i32 s55, s55, 331776
  s_mov_b32 s50, 165888
.L_pp_wo2:
  s_mul_i32 s47, s48, 288
  s_add_u32 s55, s55, s47
  s_add_u32 m0, s53, 0
  s_nop 0
  buffer_load_dwordx4 v7, s[12:15], s55 offen offset:0 lds
  buffer_load_dwordx4 v8, s[12:15], s55 offen offset:1024 lds
  buffer_load_dwordx4 v9, s[12:15], s55 offen offset:2048 lds
  buffer_load_dwordx4 v10, s[12:15], s55 offen offset:3072 lds
  s_add_u32 m0, s53, 4096
  s_nop 0
  buffer_load_dwordx4 v11, s[12:15], s55 offen lds
  s_add_u32 s55, s55, s50
  s_add_u32 m0, s53, 5120
  s_nop 0
  buffer_load_dwordx4 v7, s[12:15], s55 offen offset:0 lds
  buffer_load_dwordx4 v8, s[12:15], s55 offen offset:1024 lds
  buffer_load_dwordx4 v9, s[12:15], s55 offen offset:2048 lds
  buffer_load_dwordx4 v10, s[12:15], s55 offen offset:3072 lds
  s_add_u32 m0, s53, 9216
  s_nop 0
  buffer_load_dwordx4 v11, s[12:15], s55 offen lds
.L_pp_st:
  v_mov_b32 v100, 0
  v_mov_b32 v101, 0
  v_mov_b32 v102, 0
  v_mov_b32 v103, 0
  s_waitcnt vmcnt(0)
  v_lshlrev_b32 v104, 16, v64
  v_and_b32 v105, 0xffff0000, v64
  v_add_f32 v100, v100, v104
  v_add_f32 v101, v101, v105
  v_fmac_f32 v102, v104, v104
  v_fmac_f32 v103, v105, v105
  v_lshlrev_b32 v106, 16, v65
  v_and_b32 v107, 0xffff0000, v65
  v_add_f32 v100, v100, v106
  v_add_f32 v101, v101, v107
  v_fmac_f32 v102, v106, v106
  v_fmac_f32 v103, v107, v107
  v_lshlrev_b32 v104, 16, v66
  v_and_b32 v105, 0xffff0000, v66
  v_add_f32 v100, v100, v104
  v_add_f32 v101, v101, v105
  v_fmac_f32 v102, v104, v104
  v_fmac_f32 v103, v105, v105
  v_lshlrev_b32 v106, 16, v67
  v_and_b32 v107, 0xffff0000, v67
  v_add_f32 v100, v100, v106
  v_add_f32 v101, v101, v107
  v_fmac_f32 v102, v106, v106
  v_fmac_f32 v103, v107, v107
  v_lshlrev_b32 v104, 16, v68
  v_and_b32 v105, 0xffff0000, v68
  v_add_f32 v100, v100, v104
  v_add_f32 v101, v101, v105
  v_fmac_f32 v102, v104, v104
  v_fmac_f32 v103, v105, v105
  v_lshlrev_b32 v106, 16, v69
  v_and_b32 v107, 0xffff0000, v69
  v_add_f32 v100, v100, v106
  v_add_f32 v101, v101, v107
  v_fmac_f32 v102, v106, v106
  v_fmac_f32 v103, v107, v107
  v_lshlrev_b32 v104, 16, v70
  v_and_b32 v105, 0xffff0000, v70
  v_add_f32 v100, v100, v104
  v_add_f32 v101, v101, v105
  v_fmac_f32 v102, v104, v104
  v_fmac_f32 v103, v105, v105
  v_lshlrev_b32 v106, 16, v71
  v_and_b32 v107, 0xffff0000, v71
  v_add_f32 v100, v100, v106
  v_add_f32 v101, v101, v107
  v_fmac_f32 v102, v106, v106
  v_fmac_f32 v103, v107, v107
  v_lshlrev_b32 v104, 16, v72
  v_and_b32 v105, 0xffff0000, v72
  v_add_f32 v100, v100, v104
  v_add_f32 v101, v101, v105
  v_fmac_f32 v102, v104, v104
  v_fmac_f32 v103, v105, v105
  v_lshlrev_b32 v106, 16, v73
  v_and_b32 v107, 0xffff0000, v73
  v_add_f32 v100, v100, v106
  v_add_f32 v101, v101, v107
  v_fmac_f32 v102, v106, v106
  v_fmac_f32 v103, v107, v107
  v_lshlrev_b32 v104, 16, v74
  v_and_b32 v105, 0xffff0000, v74
  v_add_f32 v100, v100, v104
  v_add_f32 v101, v101, v105
  v_fmac_f32 v102, v104, v104
  v_fmac_f32 v103, v105, v105
  v_lshlrev_b32 v106, 16, v75
  v_and_b32 v107, 0xffff0000, v75
  v_add_f32 v100, v100, v106
  v_add_f32 v101, v101, v107
  v_fmac_f32 v102, v106, v106
  v_fmac_f32 v103, v107, v107
  v_lshlrev_b32 v104, 16, v76
  v_and_b32 v105, 0xffff0000, v76
  v_add_f32 v100, v100, v104
  v_add_f32 v101, v101, v105
  v_fmac_f32 v102, v104, v104
  v_fmac_f32 v103, v105, v105
  v_lshlrev_b32 v106, 16, v77
  v_and_b32 v107, 0xffff0000, v77
  v_add_f32 v100, v100, v106
  v_add_f32 v101, v101, v107
  v_fmac_f32 v102, v106, v106
  v_fmac_f32 v103, v107, v107
  v_lshlrev_b32 v104, 16, v78
  v_and_b32 v105, 0xffff0000, v78
  v_add_f32 v100, v100, v104
  v_add_f32 v101, v101, v105
  v_fmac_f32 v102, v104, v104
  v_fmac_f32 v103, v105, v105
  v_lshlrev_b32 v106, 16, v79
  v_and_b32 v107, 0xffff0000, v79
  v_add_f32 v100, v100, v106
  v_add_f32 v101, v101, v107
  v_fmac_f32 v102, v106, v106
  v_fmac_f32 v103, v107, v107
  v_lshlrev_b32 v104, 16, v80
  v_and_b32 v105, 0xffff0000, v80
  v_add_f32 v100, v100, v104
  v_add_f32 v101, v101, v105
  v_fmac_f32 v102, v104, v104
  v_fmac_f32 v103, v105, v105
  v_lshlrev_b32 v106, 16, v81
  v_and_b32 v107, 0xffff0000, v81
  v_add_f32 v100, v100, v106
  v_add_f32 v101, v101, v107
  v_fmac_f32 v102, v106, v106
  v_fmac_f32 v103, v107, v107
  v_lshlrev_b32 v104, 16, v82
  v_and_b32 v105, 0xffff0000, v82
  v_add_f32 v100, v100, v104
  v_add_f32 v101, v101, v105
  v_fmac_f32 v102, v104, v104
  v_fmac_f32 v103, v105, v105
  v_lshlrev_b32 v106, 16, v83
  v_and_b32 v107, 0xffff0000, v83
  v_add_f32 v100, v100, v106
  v_add_f32 v101, v101, v107
  v_fmac_f32 v102, v106, v106
  v_fmac_f32 v103, v107, v107
  v_lshlrev_b32 v104, 16, v84
  v_and_b32 v105, 0xffff0000, v84
  v_add_f32 v100, v100, v104
  v_add_f32 v101, v101, v105
  v_fmac_f32 v102, v104, v104
  v_fmac_f32 v103, v105, v105
  v_lshlrev_b32 v106, 16, v85
  v_and_b32 v107, 0xffff0000, v85
  v_add_f32 v100, v100, v106
  v_add_f32 v101, v101, v107
  v_fmac_f32 v102, v106, v106
  v_fmac_f32 v103, v107, v107
  v_lshlrev_b32 v104, 16, v86
  v_and_b32 v105, 0xffff0000, v86
  v_add_f32 v100, v100, v104
  v_add_f32 v101, v101, v105
  v_fmac_f32 v102, v104, v104
  v_fmac_f32 v103, v105, v105
  v_lshlrev_b32 v106, 16, v87
  v_and_b32 v107, 0xffff0000, v87
  v_add_f32 v100, v100, v106
  v_add_f32 v101, v101, v107
  v_fmac_f32 v102, v106, v106
  v_fmac_f32 v103, v107, v107
  v_lshlrev_b32 v104, 16, v88
  v_and_b32 v105, 0xffff0000, v88
  v_add_f32 v100, v100, v104
  v_add_f32 v101, v101, v105
  v_fmac_f32 v102, v104, v104
  v_fmac_f32 v103, v105, v105
  v_lshlrev_b32 v106, 16, v89
  v_and_b32 v107, 0xffff0000, v89
  v_add_f32 v100, v100, v106
  v_add_f32 v101, v101, v107
  v_fmac_f32 v102, v106, v106
  v_fmac_f32 v103, v107, v107
  v_lshlrev_b32 v104, 16, v90
  v_and_b32 v105, 0xffff0000, v90
  v_add_f32 v100, v100, v104
  v_add_f32 v101, v101, v105
  v_fmac_f32 v102, v104, v104
  v_fmac_f32 v103, v105, v105
  v_lshlrev_b32 v106, 16, v91
  v_and_b32 v107, 0xffff0000, v91
  v_add_f32 v100, v100, v106
  v_add_f32 v101, v101, v107
  v_fmac_f32 v102, v106, v106
  v_fmac_f32 v103, v107, v107
  v_lshlrev_b32 v104, 16, v92
  v_and_b32 v105, 0xffff0000, v92
  v_add_f32 v100, v100, v104
  v_add_f32 v101, v101, v105
  v_fmac_f32 v102, v104, v104
  v_fmac_f32 v103, v105, v105
  v_lshlrev_b32 v106, 16, v93
  v_and_b32 v107, 0xffff0000, v93
  v_add_f32 v100, v100, v106
  v_add_f32 v101, v101, v107
  v_fmac_f32 v102, v106, v106
  v_fmac_f32 v103, v107, v107
  v_lshlrev_b32 v104, 16, v94
  v_and_b32 v105, 0xffff0000, v94
  v_add_f32 v100, v100, v104
  v_add_f32 v101, v101, v105
  v_fmac_f32 v102, v104, v104
  v_fmac_f32 v103, v105, v105
  v_lshlrev_b32 v106, 16, v95
  v_and_b32 v107, 0xffff0000, v95
  v_add_f32 v100, v100, v106
  v_add_f32 v101, v101, v107
  v_fmac_f32 v102, v106, v106
  v_fmac_f32 v103, v107, v107
  v_lshlrev_b32 v104, 16, v96
  v_and_b32 v105, 0xffff0000, v96
  v_add_f32 v100, v100, v104
  v_add_f32 v101, v101, v105
  v_fmac_f32 v102, v104, v104
  v_fmac_f32 v103, v105, v105
  v_lshlrev_b32 v106, 16, v97
  v_and_b32 v107, 0xffff0000, v97
  v_add_f32 v100, v100, v106
  v_add_f32 v101, v101, v107
  v_fmac_f32 v102, v106, v106
  v_fmac_f32 v103, v107, v107
  v_lshlrev_b32 v104, 16, v98
  v_and_b32 v105, 0xffff0000, v98
  v_add_f32 v100, v100, v104
  v_add_f32 v101, v101, v105
  v_fmac_f32 v102, v104, v104
  v_fmac_f32 v103, v105, v105
  v_lshlrev_b32 v106, 16, v99
  v_and_b32 v107, 0xffff0000, v99
  v_add_f32 v100, v100, v106
  v_add_f32 v101, v101, v107
  v_fmac_f32 v102, v106, v106
  v_fmac_f32 v103, v107, v107
  v_add_f32 v100, v100, v101
  v_add_f32 v102, v102, v103
  s_nop 1
  v_add_f32_dpp v101, v100, v100 quad_perm:[1,0,3,2] row_mask:0xf bank_mask:0xf
  v_add_f32_dpp v103, v102, v102 quad_perm:[1,0,3,2] row_mask:0xf bank_mask:0xf
  v_mov_b32 v100, v101
  v_mov_b32 v102, v103
  s_nop 1
  v_add_f32_dpp v101, v100, v100 quad_perm:[2,3,0,1] row_mask:0xf bank_mask:0xf
  v_add_f32_dpp v103, v102, v102 quad_perm:[2,3,0,1] row_mask:0xf bank_mask:0xf
  v_mov_b32 v100, v101
  v_mov_b32 v102, v103
  s_nop 1
  v_add_f32_dpp v101, v100, v100 row_half_mirror row_mask:0xf bank_mask:0xf
  v_add_f32_dpp v103, v102, v102 row_half_mirror row_mask:0xf bank_mask:0xf
  v_mov_b32 v100, v101
  v_mov_b32 v102, v103
  v_mul_f32 v104, 0x3ae38e39, v100
  v_mul_f32 v106, 0x3ae38e39, v102
  v_fma_f32 v106, -v104, v104, v106
  v_max_f32 v106, 0, v106
  v_cvt_pk_bf16_f32 v104, v104, v104
  v_lshlrev_b32 v104, 16, v104
  v_cvt_pk_bf16_f32 v106, v106, v106
  v_lshlrev_b32 v106, 16, v106
  v_add_f32 v106, 0x3727c5ac, v106
  v_cvt_pk_bf16_f32 v106, v106, v106
  v_lshlrev_b32 v106, 16, v106
  v_sqrt_f32 v106, v106
  s_nop 0
  v_cvt_pk_bf16_f32 v106, v106, v106
  v_lshlrev_b32 v106, 16, v106
  v_rcp_f32 v105, v106
  s_nop 0
  v_mul_f32 v104, -v104, v105
  v_lshlrev_b32 v18, 2, v16
  s_lshl_b32 s46, s45, 5
  s_add_u32 s46, s46, 155648
  s_mov_b32 exec_lo, 0x01010101
  s_mov_b32 exec_hi, 0x01010101
  buffer_store_dword v105, v18, s[4:7], s46 offen sc1
  s_add_u32 s46, s46, 8192
  buffer_store_dword v104, v18, s[4:7], s46 offen sc1
  s_add_u32 s46, s46, 8192
  buffer_store_dword v100, v18, s[4:7], s46 offen sc1
  s_mov_b64 exec, -1
  s_cmp_ge_u32 s3, 2
  s_cbranch_scc1 .L_pp_r
  s_cmp_ge_u32 s57, 72
  s_cbranch_scc1 .L_pp_bar
  v_bfe_u32 v20, v0, 5, 1
  v_mul_u32_u24 v20, 5120, v20
  v_bfe_u32 v21, v0, 2, 3
  v_mul_u32_u24 v21, 288, v21
  v_and_b32 v22, 3, v0
  v_lshlrev_b32 v22, 3, v22
  v_add3_u32 v12, v20, v21, v22
  v_add_u32 v12, s53, v12
  s_mul_i32 s56, s48, 162
  s_add_u32 s56, s56, s49
  s_lshl_b32 s56, s56, 10
  s_add_u32 s56, s56, 311296
  ds_read_b64_tr_b16 v[28:29], v12 offset:0
  ds_read_b64_tr_b16 v[30:31], v12 offset:2304
  ds_read_b64_tr_b16 v[32:33], v12 offset:32
  ds_read_b64_tr_b16 v[34:35], v12 offset:2336
  ds_read_b64_tr_b16 v[36:37], v12 offset:64
  ds_read_b64_tr_b16 v[38:39], v12 offset:2368
  ds_read_b64_tr_b16 v[40:41], v12 offset:96
  ds_read_b64_tr_b16 v[42:43], v12 offset:2400
  ds_read_b64_tr_b16 v[44:45], v12 offset:128
  ds_read_b64_tr_b16 v[46:47], v12 offset:2432
  ds_read_b64_tr_b16 v[48:49], v12 offset:160
  ds_read_b64_tr_b16 v[50:51], v12 offset:2464
  ds_read_b64_tr_b16 v[52:53], v12 offset:192
  ds_read_b64_tr_b16 v[54:55], v12 offset:2496
  ds_read_b64_tr_b16 v[56:57], v12 offset:224
  ds_read_b64_tr_b16 v[58:59], v12 offset:2528
  ds_read_b64_tr_b16 v[60:61], v12 offset:256
  ds_read_b64_tr_b16 v[62:63], v12 offset:2560
  s_waitcnt lgkmcnt(0)
  buffer_store_dwordx4 v[28:31], v1, s[4:7], s56 offen sc1
  s_add_u32 s56, s56, 18432
  buffer_store_dwordx4 v[32:35], v1, s[4:7], s56 offen sc1
  s_add_u32 s56, s56, 18432
  buffer_store_dwordx4 v[36:39], v1, s[4:7], s56 offen sc1
  s_add_u32 s56, s56, 18432
  buffer_store_dwordx4 v[40:43], v1, s[4:7], s56 offen sc1
  s_add_u32 s56, s56, 18432
  buffer_store_dwordx4 v[44:47], v1, s[4:7], s56 offen sc1
  s_add_u32 s56, s56, 18432
  buffer_store_dwordx4 v[48:51], v1, s[4:7], s56 offen sc1
  s_add_u32 s56, s56, 18432
  buffer_store_dwordx4 v[52:55], v1, s[4:7], s56 offen sc1
  s_add_u32 s56, s56, 18432
  buffer_store_dwordx4 v[56:59], v1, s[4:7], s56 offen sc1
  s_add_u32 s56, s56, 18432
  buffer_store_dwordx4 v[60:63], v1, s[4:7], s56 offen sc1
  s_add_u32 s56, s56, 18432
  s_branch .L_pp_bar
.L_pp_r:
  s_cmp_ge_u32 s57, 72
  s_cbranch_scc1 .L_pp_bar
  v_mov_b32 v100, 0
  v_mov_b32 v101, 0
  v_lshlrev_b32 v104, 16, v120
  v_and_b32 v105, 0xffff0000, v120
  v_pk_add_f32 v[100:101], v[100:101], v[104:105]
  v_lshlrev_b32 v106, 16, v121
  v_and_b32 v107, 0xffff0000, v121
  v_pk_add_f32 v[100:101], v[100:101], v[106:107]
  v_lshlrev_b32 v104, 16, v122
  v_and_b32 v105, 0xffff0000, v122
  v_pk_add_f32 v[100:101], v[100:101], v[104:105]
  v_lshlrev_b32 v106, 16, v123
  v_and_b32 v107, 0xffff0000, v123
  v_pk_add_f32 v[100:101], v[100:101], v[106:107]
  v_lshlrev_b32 v104, 16, v124
  v_and_b32 v105, 0xffff0000, v124
  v_pk_add_f32 v[100:101], v[100:101], v[104:105]
  v_lshlrev_b32 v106, 16, v125
  v_and_b32 v107, 0xffff0000, v125
  v_pk_add_f32 v[100:101], v[100:101], v[106:107]
  v_lshlrev_b32 v104, 16, v126
  v_and_b32 v105, 0xffff0000, v126
  v_pk_add_f32 v[100:101], v[100:101], v[104:105]
  v_lshlrev_b32 v106, 16, v127
  v_and_b32 v107, 0xffff0000, v127
  v_pk_add_f32 v[100:101], v[100:101], v[106:107]
  v_lshlrev_b32 v104, 16, v128
  v_and_b32 v105, 0xffff0000, v128
  v_pk_add_f32 v[100:101], v[100:101], v[104:105]
  v_lshlrev_b32 v106, 16, v129
  v_and_b32 v107, 0xffff0000, v129
  v_pk_add_f32 v[100:101], v[100:101], v[106:107]
  v_lshlrev_b32 v104, 16, v130
  v_and_b32 v105, 0xffff0000, v130
  v_pk_add_f32 v[100:101], v[100:101], v[104:105]
  v_lshlrev_b32 v106, 16, v131
  v_and_b32 v107, 0xffff0000, v131
  v_pk_add_f32 v[100:101], v[100:101], v[106:107]
  v_lshlrev_b32 v104, 16, v132
  v_and_b32 v105, 0xffff0000, v132
  v_pk_add_f32 v[100:101], v[100:101], v[104:105]
  v_lshlrev_b32 v106, 16, v133
  v_and_b32 v107, 0xffff0000, v133
  v_pk_add_f32 v[100:101], v[100:101], v[106:107]
  v_lshlrev_b32 v104, 16, v134
  v_and_b32 v105, 0xffff0000, v134
  v_pk_add_f32 v[100:101], v[100:101], v[104:105]
  v_lshlrev_b32 v106, 16, v135
  v_and_b32 v107, 0xffff0000, v135
  v_pk_add_f32 v[100:101], v[100:101], v[106:107]
  v_lshlrev_b32 v104, 16, v136
  v_and_b32 v105, 0xffff0000, v136
  v_pk_add_f32 v[100:101], v[100:101], v[104:105]
  v_lshlrev_b32 v106, 16, v137
  v_and_b32 v107, 0xffff0000, v137
  v_pk_add_f32 v[100:101], v[100:101], v[106:107]
  v_lshlrev_b32 v104, 16, v138
  v_and_b32 v105, 0xffff0000, v138
  v_pk_add_f32 v[100:101], v[100:101], v[104:105]
  v_lshlrev_b32 v106, 16, v139
  v_and_b32 v107, 0xffff0000, v139
  v_pk_add_f32 v[100:101], v[100:101], v[106:107]
  v_lshlrev_b32 v104, 16, v140
  v_and_b32 v105, 0xffff0000, v140
  v_pk_add_f32 v[100:101], v[100:101], v[104:105]
  v_lshlrev_b32 v106, 16, v141
  v_and_b32 v107, 0xffff0000, v141
  v_pk_add_f32 v[100:101], v[100:101], v[106:107]
  v_lshlrev_b32 v104, 16, v142
  v_and_b32 v105, 0xffff0000, v142
  v_pk_add_f32 v[100:101], v[100:101], v[104:105]
  v_lshlrev_b32 v106, 16, v143
  v_and_b32 v107, 0xffff0000, v143
  v_pk_add_f32 v[100:101], v[100:101], v[106:107]
  v_lshlrev_b32 v104, 16, v144
  v_and_b32 v105, 0xffff0000, v144
  v_pk_add_f32 v[100:101], v[100:101], v[104:105]
  v_lshlrev_b32 v106, 16, v145
  v_and_b32 v107, 0xffff0000, v145
  v_pk_add_f32 v[100:101], v[100:101], v[106:107]
  v_lshlrev_b32 v104, 16, v146
  v_and_b32 v105, 0xffff0000, v146
  v_pk_add_f32 v[100:101], v[100:101], v[104:105]
  v_lshlrev_b32 v106, 16, v147
  v_and_b32 v107, 0xffff0000, v147
  v_pk_add_f32 v[100:101], v[100:101], v[106:107]
  v_lshlrev_b32 v104, 16, v148
  v_and_b32 v105, 0xffff0000, v148
  v_pk_add_f32 v[100:101], v[100:101], v[104:105]
  v_lshlrev_b32 v106, 16, v149
  v_and_b32 v107, 0xffff0000, v149
  v_pk_add_f32 v[100:101], v[100:101], v[106:107]
  v_lshlrev_b32 v104, 16, v150
  v_and_b32 v105, 0xffff0000, v150
  v_pk_add_f32 v[100:101], v[100:101], v[104:105]
  v_lshlrev_b32 v106, 16, v151
  v_and_b32 v107, 0xffff0000, v151
  v_pk_add_f32 v[100:101], v[100:101], v[106:107]
  v_lshlrev_b32 v104, 16, v152
  v_and_b32 v105, 0xffff0000, v152
  v_pk_add_f32 v[100:101], v[100:101], v[104:105]
  v_lshlrev_b32 v106, 16, v153
  v_and_b32 v107, 0xffff0000, v153
  v_pk_add_f32 v[100:101], v[100:101], v[106:107]
  v_lshlrev_b32 v104, 16, v154
  v_and_b32 v105, 0xffff0000, v154
  v_pk_add_f32 v[100:101], v[100:101], v[104:105]
  v_lshlrev_b32 v106, 16, v155
  v_and_b32 v107, 0xffff0000, v155
  v_pk_add_f32 v[100:101], v[100:101], v[106:107]
  v_add_f32 v100, v100, v101
  s_nop 1
  v_add_f32_dpp v101, v100, v100 quad_perm:[1,0,3,2] row_mask:0xf bank_mask:0xf
  v_mov_b32 v100, v101
  s_nop 1
  v_add_f32_dpp v101, v100, v100 quad_perm:[2,3,0,1] row_mask:0xf bank_mask:0xf
  v_mov_b32 v100, v101
  s_nop 1
  v_add_f32_dpp v101, v100, v100 row_half_mirror row_mask:0xf bank_mask:0xf
  v_mov_b32 v100, v101
  v_cvt_pk_bf16_f32 v102, v100, v100
  v_lshlrev_b32 v103, 16, v102
  v_sub_f32 v103, v100, v103
  v_cvt_pk_bf16_f32 v103, v103, v103
  s_lshl_b32 s46, s57, 3
  v_add_u32 v20, s46, v16
  v_mul_u32_u24 v21, 3641, v20
  v_lshrrev_b32 v21, 16, v21
  v_mul_u32_u24 v23, 18, v21
  v_sub_u32 v22, v20, v23
  v_lshrrev_b32 v104, 1, v21
  v_and_b32 v105, 1, v21
  v_lshl_add_u32 v105, v105, 4, v22
  v_lshrrev_b32 v106, 4, v21
  v_add_u32 v106, 16, v106
  v_and_b32 v107, 15, v21
  v_lshl_add_u32 v107, v107, 1, v22
  v_subrev_u32 v107, 16, v107
  v_cmp_gt_u32 vcc, 16, v22
  s_nop 1
  v_cndmask_b32 v104, v106, v104, vcc
  v_cndmask_b32 v105, v107, v105, vcc
  v_lshlrev_b32 v104, 10, v104
  v_bfe_u32 v106, v105, 4, 1
  v_lshl_add_u32 v104, v106, 9, v104
  v_bfe_u32 v106, v105, 2, 1
  v_lshl_add_u32 v104, v106, 8, v104
  v_bfe_u32 v106, v105, 3, 1
  v_lshl_add_u32 v104, v106, 3, v104
  v_and_b32 v106, 3, v105
  v_lshl_add_u32 v104, v106, 1, v104
  s_mov_b32 s46, 974848
  s_mov_b32 exec_lo, 0x01010101
  s_mov_b32 exec_hi, 0x01010101
  buffer_store_short v102, v104, s[4:7], s46 offen sc1
  buffer_store_short v103, v104, s[4:7], s46 offen offset:16 sc1
  s_mov_b64 exec, -1
  s_branch .L_pp_bar
.L_pp_B2:
  v_mov_b32 v100, 0
  v_mov_b32 v101, 0
  v_mov_b32 v102, 0
  v_mov_b32 v103, 0
  v_mov_b32 v104, 0
  v_mov_b32 v105, 0
  v_mov_b32 v106, 0
  v_mov_b32 v107, 0
  s_waitcnt vmcnt(8)
  v_lshlrev_b32 v108, 16, v64
  v_and_b32 v109, 0xffff0000, v64
  v_lshlrev_b32 v110, 16, v65
  v_and_b32 v111, 0xffff0000, v65
  v_lshlrev_b32 v112, 16, v66
  v_and_b32 v113, 0xffff0000, v66
  v_lshlrev_b32 v114, 16, v67
  v_and_b32 v115, 0xffff0000, v67
  v_add_f32 v100, v100, v108
  v_add_f32 v101, v101, v109
  v_add_f32 v102, v102, v110
  v_add_f32 v103, v103, v111
  v_add_f32 v104, v104, v112
  v_add_f32 v105, v105, v113
  v_add_f32 v106, v106, v114
  v_add_f32 v107, v107, v115
  s_waitcnt vmcnt(7)
  v_lshlrev_b32 v108, 16, v68
  v_and_b32 v109, 0xffff0000, v68
  v_lshlrev_b32 v110, 16, v69
  v_and_b32 v111, 0xffff0000, v69
  v_lshlrev_b32 v112, 16, v70
  v_and_b32 v113, 0xffff0000, v70
  v_lshlrev_b32 v114, 16, v71
  v_and_b32 v115, 0xffff0000, v71
  v_add_f32 v100, v100, v108
  v_add_f32 v101, v101, v109
  v_add_f32 v102, v102, v110
  v_add_f32 v103, v103, v111
  v_add_f32 v104, v104, v112
  v_add_f32 v105, v105, v113
  v_add_f32 v106, v106, v114
  v_add_f32 v107, v107, v115
  s_waitcnt vmcnt(6)
  v_lshlrev_b32 v108, 16, v72
  v_and_b32 v109, 0xffff0000, v72
  v_lshlrev_b32 v110, 16, v73
  v_and_b32 v111, 0xffff0000, v73
  v_lshlrev_b32 v112, 16, v74
  v_and_b32 v113, 0xffff0000, v74
  v_lshlrev_b32 v114, 16, v75
  v_and_b32 v115, 0xffff0000, v75
  v_add_f32 v100, v100, v108
  v_add_f32 v101, v101, v109
  v_add_f32 v102, v102, v110
  v_add_f32 v103, v103, v111
  v_add_f32 v104, v104, v112
  v_add_f32 v105, v105, v113
  v_add_f32 v106, v106, v114
  v_add_f32 v107, v107, v115
  s_waitcnt vmcnt(5)
  v_lshlrev_b32 v108, 16, v76
  v_and_b32 v109, 0xffff0000, v76
  v_lshlrev_b32 v110, 16, v77
  v_and_b32 v111, 0xffff0000, v77
  v_lshlrev_b32 v112, 16, v78
  v_and_b32 v113, 0xffff0000, v78
  v_lshlrev_b32 v114, 16, v79
  v_and_b32 v115, 0xffff0000, v79
  v_add_f32 v100, v100, v108
  v_add_f32 v101, v101, v109
  v_add_f32 v102, v102, v110
  v_add_f32 v103, v103, v111
  v_add_f32 v104, v104, v112
  v_add_f32 v105, v105, v113
  v_add_f32 v106, v106, v114
  v_add_f32 v107, v107, v115
  s_waitcnt vmcnt(4)
  v_lshlrev_b32 v108, 16, v80
  v_and_b32 v109, 0xffff0000, v80
  v_lshlrev_b32 v110, 16, v81
  v_and_b32 v111, 0xffff0000, v81
  v_lshlrev_b32 v112, 16, v82
  v_and_b32 v113, 0xffff0000, v82
  v_lshlrev_b32 v114, 16, v83
  v_and_b32 v115, 0xffff0000, v83
  v_add_f32 v100, v100, v108
  v_add_f32 v101, v101, v109
  v_add_f32 v102, v102, v110
  v_add_f32 v103, v103, v111
  v_add_f32 v104, v104, v112
  v_add_f32 v105, v105, v113
  v_add_f32 v106, v106, v114
  v_add_f32 v107, v107, v115
  s_waitcnt vmcnt(3)
  v_lshlrev_b32 v108, 16, v84
  v_and_b32 v109, 0xffff0000, v84
  v_lshlrev_b32 v110, 16, v85
  v_and_b32 v111, 0xffff0000, v85
  v_lshlrev_b32 v112, 16, v86
  v_and_b32 v113, 0xffff0000, v86
  v_lshlrev_b32 v114, 16, v87
  v_and_b32 v115, 0xffff0000, v87
  v_add_f32 v100, v100, v108
  v_add_f32 v101, v101, v109
  v_add_f32 v102, v102, v110
  v_add_f32 v103, v103, v111
  v_add_f32 v104, v104, v112
  v_add_f32 v105, v105, v113
  v_add_f32 v106, v106, v114
  v_add_f32 v107, v107, v115
  s_waitcnt vmcnt(2)
  v_lshlrev_b32 v108, 16, v88
  v_and_b32 v109, 0xffff0000, v88
  v_lshlrev_b32 v110, 16, v89
  v_and_b32 v111, 0xffff0000, v89
  v_lshlrev_b32 v112, 16, v90
  v_and_b32 v113, 0xffff0000, v90
  v_lshlrev_b32 v114, 16, v91
  v_and_b32 v115, 0xffff0000, v91
  v_add_f32 v100, v100, v108
  v_add_f32 v101, v101, v109
  v_add_f32 v102, v102, v110
  v_add_f32 v103, v103, v111
  v_add_f32 v104, v104, v112
  v_add_f32 v105, v105, v113
  v_add_f32 v106, v106, v114
  v_add_f32 v107, v107, v115
  s_waitcnt vmcnt(1)
  v_lshlrev_b32 v108, 16, v92
  v_and_b32 v109, 0xffff0000, v92
  v_lshlrev_b32 v110, 16, v93
  v_and_b32 v111, 0xffff0000, v93
  v_lshlrev_b32 v112, 16, v94
  v_and_b32 v113, 0xffff0000, v94
  v_lshlrev_b32 v114, 16, v95
  v_and_b32 v115, 0xffff0000, v95
  v_add_f32 v100, v100, v108
  v_add_f32 v101, v101, v109
  v_add_f32 v102, v102, v110
  v_add_f32 v103, v103, v111
  v_add_f32 v104, v104, v112
  v_add_f32 v105, v105, v113
  v_add_f32 v106, v106, v114
  v_add_f32 v107, v107, v115
  s_waitcnt vmcnt(0)
  v_lshlrev_b32 v108, 16, v96
  v_and_b32 v109, 0xffff0000, v96
  v_lshlrev_b32 v110, 16, v97
  v_and_b32 v111, 0xffff0000, v97
  v_lshlrev_b32 v112, 16, v98
  v_and_b32 v113, 0xffff0000, v98
  v_lshlrev_b32 v114, 16, v99
  v_and_b32 v115, 0xffff0000, v99
  v_add_f32 v100, v100, v108
  v_add_f32 v101, v101, v109
  v_add_f32 v102, v102, v110
  v_add_f32 v103, v103, v111
  v_add_f32 v104, v104, v112
  v_add_f32 v105, v105, v113
  v_add_f32 v106, v106, v114
  v_add_f32 v107, v107, v115
  s_lshl_b32 s48, s3, 11
  s_add_u32 s48, s48, 12288
  v_lshlrev_b32 v18, 5, v0
  v_add_u32 v18, s48, v18
  ds_write_b128 v18, v[100:103]
  ds_write_b128 v18, v[104:107] offset:16
  s_waitcnt lgkmcnt(0)
.L_pp_bar:
  s_barrier
  s_cmp_lg_u32 s3, 4
  s_cbranch_scc1 .L_pp_warm
  v_lshlrev_b32 v18, 2, v0
  v_add_u32 v19, 20480, v18
  ds_read_b32 v64, v19 offset:0
  ds_read_b32 v65, v19 offset:256
  ds_read_b32 v66, v19 offset:512
  ds_read_b32 v67, v19 offset:768
  ds_read_b32 v68, v19 offset:1024
  ds_read_b32 v69, v19 offset:1280
  ds_read_b32 v70, v19 offset:1536
  ds_read_b32 v71, v19 offset:1792
  ds_read_b32 v72, v19 offset:2048
  ds_read_b32 v73, v19 offset:2304
  ds_read_b32 v74, v19 offset:2560
  ds_read_b32 v75, v19 offset:2816
  ds_read_b32 v76, v19 offset:3072
  ds_read_b32 v77, v19 offset:3328
  ds_read_b32 v78, v19 offset:3584
  ds_read_b32 v79, v19 offset:3840
  ds_read_b32 v80, v19 offset:4096
  ds_read_b32 v81, v19 offset:4352
  ds_read_b32 v82, v19 offset:4608
  ds_read_b32 v83, v19 offset:4864
  ds_read_b32 v84, v19 offset:5120
  ds_read_b32 v85, v19 offset:5376
  ds_read_b32 v86, v19 offset:5632
  ds_read_b32 v87, v19 offset:5888
  ds_read_b32 v88, v19 offset:6144
  ds_read_b32 v89, v19 offset:6400
  ds_read_b32 v90, v19 offset:6656
  ds_read_b32 v91, v19 offset:6912
  ds_read_b32 v92, v19 offset:7168
  ds_read_b32 v93, v19 offset:7424
  ds_read_b32 v94, v19 offset:7680
  ds_read_b32 v95, v19 offset:7936
  s_waitcnt lgkmcnt(0)
  v_add_f32 v64, v64, v80
  v_add_f32 v65, v65, v81
  v_add_f32 v66, v66, v82
  v_add_f32 v67, v67, v83
  v_add_f32 v68, v68, v84
  v_add_f32 v69, v69, v85
  v_add_f32 v70, v70, v86
  v_add_f32 v71, v71, v87
  v_add_f32 v72, v72, v88
  v_add_f32 v73, v73, v89
  v_add_f32 v74, v74, v90
  v_add_f32 v75, v75, v91
  v_add_f32 v76, v76, v92
  v_add_f32 v77, v77, v93
  v_add_f32 v78, v78, v94
  v_add_f32 v79, v79, v95
  v_add_f32 v64, v64, v72
  v_add_f32 v65, v65, v73
  v_add_f32 v66, v66, v74
  v_add_f32 v67, v67, v75
  v_add_f32 v68, v68, v76
  v_add_f32 v69, v69, v77
  v_add_f32 v70, v70, v78
  v_add_f32 v71, v71, v79
  v_add_f32 v64, v64, v68
  v_add_f32 v65, v65, v69
  v_add_f32 v66, v66, v70
  v_add_f32 v67, v67, v71
  v_add_f32 v64, v64, v66
  v_add_f32 v65, v65, v67
  v_add_f32 v64, v64, v65
  s_mul_i32 s46, s44, 6912
  s_lshl_b32 s48, s47, 8
  s_add_u32 s46, s46, s48
  s_add_u32 s46, s46, 184320
  s_cmp_ge_u32 s52, 54
  s_cselect_b32 s46, 0x7f000000, s46
  buffer_store_dword v64, v18, s[4:7], s46 offen sc1
.L_pp_warm:
.L_s1_done:
  s_cmp_lt_u32 s42, 6
  s_cselect_b32 s44, 0, 99
  s_cmp_eq_u32 s3, s44
  s_cbranch_scc1 .Lm_21
  s_waitcnt lgkmcnt(0)
  s_add_u32 s101, s101, 16
  s_and_b32 s101, s101, 0xfffffff0
.Lm_21:
  s_waitcnt vmcnt(0) lgkmcnt(0)
  s_barrier
  s_cmp_lg_u32 s3, 0
  s_cbranch_scc1 .Lm_22
  s_mul_i32 s44, s40, 139264
  s_lshl_b32 s45, s43, 2
  s_add_u32 s44, s44, s45
  s_add_u32 s44, s44, 1048576
  s_add_u32 s45, s101, 1
  v_mov_b32 v2, s45
  v_mul_u32_u24 v3, 4352, v0
  s_cmp_lt_u32 s42, 6
  s_cbranch_scc1 .Lm_23
  s_lshl_b32 s46, s40, 2
  s_add_u32 s46, s46, s41
  s_lshl_b32 s46, s46, 1
  s_and_b32 s47, s42, 1
  s_add_u32 s46, s46, s47
  s_lshl_b32 s46, s46, 2
  s_add_u32 s46, s46, 4096
  s_mov_b32 exec_hi, 0
  buffer_store_dword v2, v3, s[4:7], s46 offen sc1
.Lm_23:
  s_mov_b32 exec_lo, -1
  s_mov_b32 exec_hi, 0
  buffer_store_dword v2, v3, s[4:7], s44 offen sc1
  s_mov_b64 exec, -1
.Lm_22:
  s_cmp_lt_u32 s42, 6
  s_cbranch_scc1 .Lm_24
  s_cmp_lg_u32 s3, 0
  s_cbranch_scc1 .Lm_24
  s_lshr_b32 s46, s2, 3
  s_mul_i32 s46, s46, 4352
  s_add_u32 s46, s46, 4096
  v_lshlrev_b32 v30, 2, v0
  v_add_u32 v30, s46, v30
  s_mov_b64 vcc, -1
  s_add_u32 s45, s101, 1
  s_mov_b32 s44, 0
  s_nop 2
  s_mov_b64 exec, vcc
.Lm_25:
  buffer_load_dword v32, v30, s[4:7], 0 offen sc1
  s_waitcnt vmcnt(0)
  v_subrev_u32 v31, s45, v32
  v_cmp_le_u32 vcc, 15, v31
  s_add_u32 s44, s44, 1
  s_nop 2
  s_cmp_eq_u64 vcc, 0
  s_cbranch_scc1 .Lm_26
  s_sleep 1
  s_cmp_lt_u32 s44, 0x40000
  s_cbranch_scc1 .Lm_25
.Lm_26:
  s_mov_b64 exec, -1
.Lm_24:
  s_cmp_lt_u32 s42, 6
  s_cbranch_scc1 .Lm_27
  s_mov_b32 s8, s24
  s_and_b32 s9, s25, 0xffff
  s_mov_b32 s10, 0x00510000
  s_mov_b32 s11, 0x00020000
  s_mov_b32 s12, s26
  s_and_b32 s13, s27, 0xffff
  s_mov_b32 s14, 0x00510000
  s_mov_b32 s15, 0x00020000
  s_lshl_b32 s45, s40, 1
  s_and_b32 s44, s42, 1
  s_add_u32 s45, s45, s44
  s_lshl_b32 s45, s45, 3
  s_add_u32 s45, s45, s3
  s_mul_i32 s48, s45, 81
  s_mul_i32 s46, s41, 2304
  v_add_u32 v16, 0, v0
  v_min_u32 v16, 80, v16
  v_add_u32 v16, s48, v16
  v_lshlrev_b32 v24, 7, v16
  v_mul_u32_u24 v17, 58255, v16
  v_lshrrev_b32 v17, 20, v17
  v_mul_u32_u24 v17, 6912, v17
  v_add_u32 v20, v24, v17
  buffer_load_dword v244, v20, s[8:11], s46 offen
  buffer_load_dword v245, v20, s[12:15], s46 offen
  v_add_u32 v16, 64, v0
  v_min_u32 v16, 80, v16
  v_add_u32 v16, s48, v16
  v_lshlrev_b32 v25, 7, v16
  v_mul_u32_u24 v17, 58255, v16
  v_lshrrev_b32 v17, 20, v17
  v_mul_u32_u24 v17, 6912, v17
  v_add_u32 v21, v25, v17
  s_mov_b64 exec, 0x1ffff
  buffer_load_dword v246, v21, s[8:11], s46 offen
  buffer_load_dword v247, v21, s[12:15], s46 offen
  s_mov_b64 exec, -1
.Lm_27:
  s_lshl_b32 s52, s40, 3
  s_add_u32 s52, s52, s3
  s_mul_i32 s48, s43, 9
  s_lshr_b32 s48, s48, 2
  s_lshl_b32 s48, s48, 9
  s_mul_i32 s49, s40, 294912
  s_add_u32 s48, s48, s49
  s_add_u32 s49, s48, 2359296
  s_add_u32 s48, s48, 4423680
  s_mul_i32 s50, s40, 299008
  s_add_u32 s50, s50, 7106560
  s_mul_i32 s56, s43, 288
  s_lshl_b32 s51, s3, 6
  v_add_u32 v6, s51, v0
  v_mov_b32 v10, 0x7ff00000
  s_cmp_eq_u32 s40, 0
  s_cselect_b32 s54, 768, 0
  s_cselect_b32 s55, 640, 0
  s_cselect_b32 s57, 8, 0
  v_add_u32 v7, 0, v6
  v_mul_u32_u24 v8, 43691, v7
  v_lshrrev_b32 v8, 22, v8
  v_mul_u32_u24 v9, 35328, v8
  v_lshl_add_u32 v118, v7, 4, v9
  v_mul_u32_u24 v8, 3277, v7
  v_lshrrev_b32 v8, 16, v8
  v_mul_u32_u24 v9, 20, v8
  v_sub_u32 v9, v7, v9
  v_cmp_gt_u32 vcc, 18, v9
  v_lshlrev_b32 v9, 4, v9
  v_add_u32 v9, s56, v9
  v_mov_b32 v11, 9216
  v_cndmask_b32 v9, v11, v9, vcc
  v_mul_u32_u24 v8, 9344, v8
  v_add_u32 v115, v8, v9
  v_cmp_gt_u32 vcc, s54, v7
  v_cmp_gt_u32 s[80:81], s55, v7
  s_nop 1
  v_cndmask_b32 v112, v118, v10, vcc
  v_cndmask_b32 v115, v115, v10, s[80:81]
  v_add_u32 v7, 512, v6
  v_mul_u32_u24 v8, 43691, v7
  v_lshrrev_b32 v8, 22, v8
  v_mul_u32_u24 v9, 35328, v8
  v_lshl_add_u32 v119, v7, 4, v9
  v_mul_u32_u24 v8, 3277, v7
  v_lshrrev_b32 v8, 16, v8
  v_mul_u32_u24 v9, 20, v8
  v_sub_u32 v9, v7, v9
  v_cmp_gt_u32 vcc, 18, v9
  v_lshlrev_b32 v9, 4, v9
  v_add_u32 v9, s56, v9
  v_mov_b32 v11, 9216
  v_cndmask_b32 v9, v11, v9, vcc
  v_mul_u32_u24 v8, 9344, v8
  v_add_u32 v116, v8, v9
  v_cmp_gt_u32 vcc, s54, v7
  v_cmp_gt_u32 s[80:81], s55, v7
  s_nop 1
  v_cndmask_b32 v113, v119, v10, vcc
  v_cndmask_b32 v116, v116, v10, s[80:81]
  v_add_u32 v7, 1024, v6
  v_mul_u32_u24 v8, 43691, v7
  v_lshrrev_b32 v8, 22, v8
  v_mul_u32_u24 v9, 35328, v8
  v_lshl_add_u32 v120, v7, 4, v9
  v_mul_u32_u24 v8, 3277, v7
  v_lshrrev_b32 v8, 16, v8
  v_mul_u32_u24 v9, 20, v8
  v_sub_u32 v9, v7, v9
  v_cmp_gt_u32 vcc, 18, v9
  v_lshlrev_b32 v9, 4, v9
  v_add_u32 v9, s56, v9
  v_mov_b32 v11, 9216
  v_cndmask_b32 v9, v11, v9, vcc
  v_mul_u32_u24 v8, 9344, v8
  v_add_u32 v117, v8, v9
  v_cmp_gt_u32 vcc, s54, v7
  v_cmp_gt_u32 s[80:81], s55, v7
  s_nop 1
  v_cndmask_b32 v114, v120, v10, vcc
  v_cndmask_b32 v117, v117, v10, s[80:81]
  v_cmp_gt_u32 vcc, s57, v0
  v_mov_b32 v8, 0xf149
  v_mul_u32_u24 v7, 1536, v0
  v_cndmask_b32 v16, 0, v8, vcc
  v_mov_b32 v17, 0
  v_mov_b32 v18, 0
  v_mov_b32 v19, 0
  s_mov_b64 exec, 0xffff
  ds_write_b128 v7, v[16:19] offset:36864
  s_mov_b64 exec, -1
  v_and_b32 v6, 31, v0
  v_lshrrev_b32 v7, 5, v0
  s_mul_i32 s44, s3, 1536
  s_add_u32 s45, s44, 73728
  v_add_u32 v2, s45, v1
  v_lshlrev_b32 v8, 4, v6
  v_add_u32 v5, s45, v8
  v_add_u32 v5, 1024, v5
  s_add_u32 s45, s44, 36864
  v_mov_b32 v3, s45
  v_cmp_gt_u32 vcc, 32, v0
  s_mul_i32 s44, s3, 1280
  s_add_u32 s44, s44, 73728
  v_cndmask_b32 v3, v3, v5, vcc
  v_mul_u32_u24 v4, 320, v7
  v_add3_u32 v4, v4, v8, s44
  v_lshlrev_b32 v8, 2, v7
  v_sub_u32 v8, v6, v8
  v_mov_b32 v9, 0xf149f2ca
  v_cmp_le_i32 s[80:81], 0, v8
  v_cmp_le_i32 s[82:83], 1, v8
  v_cmp_le_i32 s[84:85], 2, v8
  v_cmp_le_i32 s[86:87], 3, v8
  v_cmp_le_i32 s[88:89], 8, v8
  v_cmp_le_i32 s[90:91], 9, v8
  v_cmp_le_i32 s[92:93], 10, v8
  v_cmp_le_i32 s[94:95], 11, v8
  v_cndmask_b32 v80, v9, 0, s[80:81]
  v_cndmask_b32 v64, 0, v9, s[80:81]
  v_cndmask_b32 v81, v9, 0, s[82:83]
  v_cndmask_b32 v65, 0, v9, s[82:83]
  v_cndmask_b32 v82, v9, 0, s[84:85]
  v_cndmask_b32 v66, 0, v9, s[84:85]
  v_cndmask_b32 v83, v9, 0, s[86:87]
  v_cndmask_b32 v67, 0, v9, s[86:87]
  v_cndmask_b32 v84, v9, 0, s[88:89]
  v_cndmask_b32 v68, 0, v9, s[88:89]
  v_cndmask_b32 v85, v9, 0, s[90:91]
  v_cndmask_b32 v69, 0, v9, s[90:91]
  v_cndmask_b32 v86, v9, 0, s[92:93]
  v_cndmask_b32 v70, 0, v9, s[92:93]
  v_cndmask_b32 v87, v9, 0, s[94:95]
  v_cndmask_b32 v71, 0, v9, s[94:95]
  v_cmp_le_i32 s[80:81], 16, v8
  v_cmp_le_i32 s[82:83], 17, v8
  v_cmp_le_i32 s[84:85], 18, v8
  v_cmp_le_i32 s[86:87], 19, v8
  v_cmp_le_i32 s[88:89], 24, v8
  v_cmp_le_i32 s[90:91], 25, v8
  v_cmp_le_i32 s[92:93], 26, v8
  v_cmp_le_i32 s[94:95], 27, v8
  v_cndmask_b32 v88, v9, 0, s[80:81]
  v_cndmask_b32 v72, 0, v9, s[80:81]
  v_cndmask_b32 v89, v9, 0, s[82:83]
  v_cndmask_b32 v73, 0, v9, s[82:83]
  v_cndmask_b32 v90, v9, 0, s[84:85]
  v_cndmask_b32 v74, 0, v9, s[84:85]
  v_cndmask_b32 v91, v9, 0, s[86:87]
  v_cndmask_b32 v75, 0, v9, s[86:87]
  v_cndmask_b32 v92, v9, 0, s[88:89]
  v_cndmask_b32 v76, 0, v9, s[88:89]
  v_cndmask_b32 v93, v9, 0, s[90:91]
  v_cndmask_b32 v77, 0, v9, s[90:91]
  v_cndmask_b32 v94, v9, 0, s[92:93]
  v_cndmask_b32 v78, 0, v9, s[92:93]
  v_cndmask_b32 v95, v9, 0, s[94:95]
  v_cndmask_b32 v79, 0, v9, s[94:95]
  s_lshl_b32 s44, s43, 1
  s_and_b32 s44, s44, 7
  v_lshlrev_b32 v10, 3, v7
  v_subrev_u32 v10, s44, v10
  v_add_u32 v11, 0, v10
  v_cmp_gt_u32 s[80:81], 18, v11
  v_add_u32 v11, 2, v10
  v_cmp_gt_u32 s[82:83], 18, v11
  v_add_u32 v11, 4, v10
  v_cmp_gt_u32 s[84:85], 18, v11
  v_add_u32 v11, 6, v10
  v_cmp_gt_u32 s[86:87], 18, v11
  v_add_u32 v11, 16, v10
  v_cmp_gt_u32 s[88:89], 18, v11
  v_add_u32 v11, 18, v10
  v_cmp_gt_u32 s[90:91], 18, v11
  v_add_u32 v11, 20, v10
  v_cmp_gt_u32 s[92:93], 18, v11
  v_add_u32 v11, 22, v10
  v_cmp_gt_u32 s[94:95], 18, v11
  v_mul_u32_u24 v12, 0x3f80, v7
  s_cmp_lt_u32 s3, 4
  s_cselect_b32 s46, s24, s26
  s_cselect_b32 s47, s25, s27
  s_mov_b32 s12, s46
  s_and_b32 s13, s47, 0xffff
  s_mov_b32 s14, 0x00510000
  s_mov_b32 s15, 0x00020000
  s_and_b32 s44, s3, 3
  s_mul_i32 s44, s44, 442368
  s_mul_i32 s45, s43, 288
  s_add_u32 s44, s44, s45
  v_add_u32 v210, 0, v0
  v_mul_u32_u24 v211, 10923, v210
  v_lshrrev_b32 v211, 16, v211
  v_mul_u32_u24 v211, 9120, v211
  v_lshl_add_u32 v200, v210, 4, v211
  v_add_u32 v200, s44, v200
  v_add_u32 v210, 64, v0
  v_mul_u32_u24 v211, 10923, v210
  v_lshrrev_b32 v211, 16, v211
  v_mul_u32_u24 v211, 9120, v211
  v_lshl_add_u32 v201, v210, 4, v211
  v_add_u32 v201, s44, v201
  v_subrev_u32 v201, 1024, v201
  v_add_u32 v210, 128, v0
  v_mul_u32_u24 v211, 10923, v210
  v_lshrrev_b32 v211, 16, v211
  v_mul_u32_u24 v211, 9120, v211
  v_lshl_add_u32 v202, v210, 4, v211
  v_add_u32 v202, s44, v202
  v_subrev_u32 v202, 2048, v202
  v_add_u32 v210, 192, v0
  v_mul_u32_u24 v211, 10923, v210
  v_lshrrev_b32 v211, 16, v211
  v_mul_u32_u24 v211, 9120, v211
  v_lshl_add_u32 v203, v210, 4, v211
  v_add_u32 v203, s44, v203
  v_subrev_u32 v203, 3072, v203
  v_add_u32 v210, 256, v0
  v_mul_u32_u24 v211, 10923, v210
  v_lshrrev_b32 v211, 16, v211
  v_mul_u32_u24 v211, 9120, v211
  v_lshl_add_u32 v204, v210, 4, v211
  v_add_u32 v204, s44, v204
  s_sub_u32 s53, s40, 1
  s_max_i32 s53, s53, 0
  s_lshl_b32 s51, s3, 10
  s_cmp_lg_u32 s3, 1
  s_cbranch_scc1 .Lm_28
  s_lshr_b32 s46, s2, 3
  s_mul_i32 s46, s46, 4352
  s_add_u32 s46, s46, 4096
  v_lshlrev_b32 v240, 2, v0
  v_add_u32 v240, s46, v240
  s_mov_b64 vcc, -1
  s_add_u32 s45, s101, 1
  s_mov_b32 s44, 0
  s_nop 2
  s_mov_b64 exec, vcc
.Lm_29:
  buffer_load_dword v242, v240, s[4:7], 0 offen sc1
  s_waitcnt vmcnt(0)
  v_subrev_u32 v241, s45, v242
  v_cmp_le_u32 vcc, 15, v241
  s_add_u32 s44, s44, 1
  s_nop 2
  s_cmp_eq_u64 vcc, 0
  s_cbranch_scc1 .Lm_30
  s_sleep 1
  s_cmp_lt_u32 s44, 0x40000
  s_cbranch_scc1 .Lm_29
.Lm_30:
  s_mov_b64 exec, -1
.Lm_28:
  s_cmp_lg_u32 s3, 0
  s_cbranch_scc1 .Lm_31
  s_lshl_b32 s46, s40, 5
  s_add_u32 s46, s46, s43
  s_mul_i32 s46, s46, 4352
  s_add_u32 s46, s46, 1048576
  v_and_b32 v241, 31, v0
  v_lshlrev_b32 v240, 2, v241
  s_lshl_b32 s47, s53, 5
  s_add_u32 s47, s47, s43
  s_mul_i32 s47, s47, 4352
  s_add_u32 s47, s47, 1048576
  s_mov_b32 exec_lo, 0
  v_add_u32 v240, s47, v240
  s_mov_b32 exec_lo, -1
  s_mov_b32 exec_hi, 0
  v_add_u32 v240, s46, v240
  s_mov_b32 exec_hi, -1
  v_and_b32 v241, 7, v241
  v_cmp_gt_u32 vcc, 6, v241
  s_add_u32 s45, s101, 1
  s_mov_b32 s44, 0
  s_nop 2
  s_mov_b64 exec, vcc
.Lm_32:
  buffer_load_dword v242, v240, s[4:7], 0 offen sc1
  s_waitcnt vmcnt(0)
  v_subrev_u32 v241, s45, v242
  v_cmp_le_u32 vcc, 15, v241
  s_add_u32 s44, s44, 1
  s_nop 2
  s_cmp_eq_u64 vcc, 0
  s_cbranch_scc1 .Lm_33
  s_sleep 1
  s_cmp_lt_u32 s44, 0x40000
  s_cbranch_scc1 .Lm_32
.Lm_33:
  s_mov_b64 exec, -1
.Lm_31:
  s_barrier
  s_add_u32 m0, s51, 118784
  s_nop 0
  buffer_load_dwordx4 v118, s[4:7], s49 offen sc1 lds
  s_cmp_ge_u32 s3, 4
  s_cbranch_scc1 .Lm_34
  s_add_u32 m0, s51, 126976
  s_nop 0
  buffer_load_dwordx4 v119, s[4:7], s49 offen sc1 lds
.Lm_34:
  s_add_u32 m0, s51, 73728
  s_nop 0
  buffer_load_dwordx4 v112, s[4:7], s48 offen sc1 lds
  s_add_u32 m0, s51, 81920
  s_nop 0
  buffer_load_dwordx4 v113, s[4:7], s48 offen sc1 lds
  s_add_u32 m0, s51, 90112
  s_nop 0
  buffer_load_dwordx4 v114, s[4:7], s48 offen sc1 lds
  s_cmp_ge_u32 s3, 4
  s_cbranch_scc1 .Lm_35
  s_add_u32 m0, s51, 114688
  s_nop 0
  buffer_load_dwordx4 v117, s[4:7], s50 offen sc1 lds
.Lm_35:
  s_add_u32 m0, s51, 98304
  s_nop 0
  buffer_load_dwordx4 v115, s[4:7], s50 offen sc1 lds
  s_add_u32 m0, s51, 106496
  s_nop 0
  buffer_load_dwordx4 v116, s[4:7], s50 offen sc1 lds
  s_waitcnt vmcnt(2) lgkmcnt(0)
  s_barrier
  ds_read_b128 v[232:235], v2 offset:45056
  ds_read_b128 v[236:239], v5 offset:45056
  ds_read_b128 v[112:115], v2 offset:12288
  ds_read_b128 v[116:119], v3 offset:12288
  ds_read_b128 v[120:123], v2 offset:10752
  ds_read_b128 v[124:127], v3 offset:10752
  ds_read_b128 v[128:131], v2 offset:9216
  ds_read_b128 v[132:135], v3 offset:9216
  ds_read_b128 v[136:139], v2 offset:7680
  ds_read_b128 v[140:143], v3 offset:7680
  ds_read_b128 v[144:147], v2 offset:6144
  ds_read_b128 v[148:151], v3 offset:6144
  s_waitcnt lgkmcnt(10)
  v_cndmask_b32 v232, 0, v232, s[80:81]
  v_cndmask_b32 v233, 0, v233, s[82:83]
  v_cndmask_b32 v234, 0, v234, s[84:85]
  v_cndmask_b32 v235, 0, v235, s[86:87]
  v_cndmask_b32 v236, v12, v236, s[88:89]
  v_cndmask_b32 v237, 0, v237, s[90:91]
  v_cndmask_b32 v238, 0, v238, s[92:93]
  v_cndmask_b32 v239, 0, v239, s[94:95]
  v_mov_b32 v216, 0
  v_mov_b32 v217, 0
  v_mov_b32 v218, 0
  v_mov_b32 v219, 0
  v_mov_b32 v220, 0
  v_mov_b32 v221, 0
  v_mov_b32 v222, 0
  v_mov_b32 v223, 0
  v_mov_b32 v224, 0
  v_mov_b32 v225, 0
  v_mov_b32 v226, 0
  v_mov_b32 v227, 0
  v_mov_b32 v228, 0
  v_mov_b32 v229, 0
  v_mov_b32 v230, 0
  v_mov_b32 v231, 0
  ds_read_b128 v[152:155], v2 offset:4608
  ds_read_b128 v[156:159], v3 offset:4608
  s_waitcnt lgkmcnt(10)
  v_mfma_f32_32x32x16_bf16 v[16:31], v[112:115], v[232:235], v[80:95]
  v_mfma_f32_32x32x16_bf16 v[16:31], v[116:119], v[236:239], v[16:31]
  s_nop 3
  ds_read_b128 v[160:163], v2 offset:3072
  ds_read_b128 v[164:167], v3 offset:3072
  s_waitcnt lgkmcnt(10)
  v_mfma_f32_32x32x16_bf16 v[32:47], v[120:123], v[232:235], 0
  v_mfma_f32_32x32x16_bf16 v[32:47], v[124:127], v[236:239], v[32:47]
  s_nop 3
  ds_read_b128 v[168:171], v2 offset:1536
  ds_read_b128 v[172:175], v3 offset:1536
  s_waitcnt lgkmcnt(10)
  v_max_f32 v10, v16, v17
  v_max_f32 v11, v18, v19
  v_max_f32 v14, v20, v21
  v_max_f32 v15, v22, v23
  v_mfma_f32_32x32x16_bf16 v[48:63], v[128:131], v[232:235], 0
  v_max3_f32 v10, v10, v24, v25
  v_max3_f32 v11, v11, v26, v27
  v_max3_f32 v14, v14, v28, v29
  v_max3_f32 v15, v15, v30, v31
  v_mfma_f32_32x32x16_bf16 v[48:63], v[132:135], v[236:239], v[48:63]
  s_mul_i32 s44, s3, 4608
  s_add_u32 m0, s44, 0
  s_bitcmp1_b32 s43, 0
  s_cselect_b32 s44, 192, 0
  buffer_load_dwordx4 v200, s[12:15], s44 offen offset:0 lds
  ds_read_b128 v[176:179], v2 offset:0
  ds_read_b128 v[180:183], v3 offset:0
  s_waitcnt lgkmcnt(10)
  v_max3_f32 v10, v10, v32, v33
  v_max3_f32 v11, v11, v34, v35
  v_max3_f32 v14, v14, v36, v37
  v_max3_f32 v15, v15, v38, v39
  v_mfma_f32_32x32x16_bf16 v[16:31], v[136:139], v[232:235], 0
  v_max3_f32 v10, v10, v40, v41
  v_max3_f32 v11, v11, v42, v43
  v_max3_f32 v14, v14, v44, v45
  v_max3_f32 v15, v15, v46, v47
  v_mfma_f32_32x32x16_bf16 v[16:31], v[140:143], v[236:239], v[16:31]
  s_bitcmp1_b32 s43, 0
  s_cselect_b32 s44, 192, 0
  buffer_load_dwordx4 v201, s[12:15], s44 offen offset:1024 lds
  s_waitcnt lgkmcnt(8)
  v_max3_f32 v10, v10, v48, v49
  v_max3_f32 v11, v11, v50, v51
  v_max3_f32 v14, v14, v52, v53
  v_max3_f32 v15, v15, v54, v55
  v_mfma_f32_32x32x16_bf16 v[32:47], v[144:147], v[232:235], 0
  v_max3_f32 v10, v10, v56, v57
  v_max3_f32 v11, v11, v58, v59
  v_max3_f32 v14, v14, v60, v61
  v_max3_f32 v15, v15, v62, v63
  v_mfma_f32_32x32x16_bf16 v[32:47], v[148:151], v[236:239], v[32:47]
  s_bitcmp1_b32 s43, 0
  s_cselect_b32 s44, 192, 0
  buffer_load_dwordx4 v202, s[12:15], s44 offen offset:2048 lds
  s_waitcnt lgkmcnt(6)
  v_max3_f32 v10, v10, v16, v17
  v_max3_f32 v11, v11, v18, v19
  v_max3_f32 v14, v14, v20, v21
  v_max3_f32 v15, v15, v22, v23
  v_mfma_f32_32x32x16_bf16 v[48:63], v[152:155], v[232:235], 0
  v_max3_f32 v10, v10, v24, v25
  v_max3_f32 v11, v11, v26, v27
  v_max3_f32 v14, v14, v28, v29
  v_max3_f32 v15, v15, v30, v31
  v_mfma_f32_32x32x16_bf16 v[48:63], v[156:159], v[236:239], v[48:63]
  s_bitcmp1_b32 s43, 0
  s_cselect_b32 s44, 192, 0
  buffer_load_dwordx4 v203, s[12:15], s44 offen offset:3072 lds
  s_waitcnt lgkmcnt(4)
  v_max3_f32 v10, v10, v32, v33
  v_max3_f32 v11, v11, v34, v35
  v_max3_f32 v14, v14, v36, v37
  v_max3_f32 v15, v15, v38, v39
  v_mfma_f32_32x32x16_bf16 v[16:31], v[160:163], v[232:235], 0
  v_max3_f32 v10, v10, v40, v41
  v_max3_f32 v11, v11, v42, v43
  v_max3_f32 v14, v14, v44, v45
  v_max3_f32 v15, v15, v46, v47
  v_mfma_f32_32x32x16_bf16 v[16:31], v[164:167], v[236:239], v[16:31]
  s_mul_i32 s44, s3, 4608
  s_add_u32 m0, s44, 4096
  s_bitcmp1_b32 s43, 0
  s_cselect_b32 s44, 192, 0
  s_mov_b32 exec_hi, 0
  buffer_load_dwordx4 v204, s[12:15], s44 offen offset:0 lds
  s_mov_b32 exec_hi, -1
  s_waitcnt lgkmcnt(2)
  v_max3_f32 v10, v10, v48, v49
  v_max3_f32 v11, v11, v50, v51
  v_max3_f32 v14, v14, v52, v53
  v_max3_f32 v15, v15, v54, v55
  v_mfma_f32_32x32x16_bf16 v[32:47], v[168:171], v[232:235], 0
  v_max3_f32 v10, v10, v56, v57
  v_max3_f32 v11, v11, v58, v59
  v_max3_f32 v14, v14, v60, v61
  v_max3_f32 v15, v15, v62, v63
  v_mfma_f32_32x32x16_bf16 v[32:47], v[172:175], v[236:239], v[32:47]
  s_waitcnt lgkmcnt(0)
  v_max3_f32 v10, v10, v16, v17
  v_max3_f32 v11, v11, v18, v19
  v_max3_f32 v14, v14, v20, v21
  v_max3_f32 v15, v15, v22, v23
  v_mfma_f32_32x32x16_bf16 v[48:63], v[176:179], v[232:235], v[64:79]
  v_max3_f32 v10, v10, v24, v25
  v_max3_f32 v11, v11, v26, v27
  v_max3_f32 v14, v14, v28, v29
  v_max3_f32 v15, v15, v30, v31
  v_mfma_f32_32x32x16_bf16 v[48:63], v[180:183], v[236:239], v[48:63]
  s_nop 3
  v_max3_f32 v10, v10, v32, v33
  v_max3_f32 v11, v11, v34, v35
  v_max3_f32 v14, v14, v36, v37
  v_max3_f32 v15, v15, v38, v39
  v_max3_f32 v10, v10, v40, v41
  v_max3_f32 v11, v11, v42, v43
  v_max3_f32 v14, v14, v44, v45
  v_max3_f32 v15, v15, v46, v47
  s_nop 1
  v_max3_f32 v10, v10, v48, v49
  v_max3_f32 v11, v11, v50, v51
  v_max3_f32 v14, v14, v52, v53
  v_max3_f32 v15, v15, v54, v55
  v_max3_f32 v10, v10, v56, v57
  v_max3_f32 v11, v11, v58, v59
  v_max3_f32 v14, v14, v60, v61
  v_max3_f32 v15, v15, v62, v63
  s_waitcnt vmcnt(5)
  s_barrier
  ds_read_b128 v[184:187], v4 offset:34816
  ds_read_b128 v[188:191], v4 offset:35456
  ds_read_b128 v[192:195], v4 offset:33536
  ds_read_b128 v[196:199], v4 offset:34176
  ds_read_b128 v[200:203], v4 offset:32256
  ds_read_b128 v[204:207], v4 offset:32896
  v_max3_f32 v14, v14, v10, v11
  v_max_f32 v14, v14, v15
  v_mov_b32 v15, v14
  s_nop 1
  v_permlane32_swap_b32 v14, v15
  s_nop 1
  v_max_f32 v14, v14, v15
  v_sub_f32 v80, v80, v14
  v_sub_f32 v81, v81, v14
  v_sub_f32 v82, v82, v14
  v_sub_f32 v83, v83, v14
  v_sub_f32 v84, v84, v14
  v_sub_f32 v85, v85, v14
  v_sub_f32 v86, v86, v14
  v_sub_f32 v87, v87, v14
  v_sub_f32 v88, v88, v14
  v_sub_f32 v89, v89, v14
  v_sub_f32 v90, v90, v14
  v_sub_f32 v91, v91, v14
  v_sub_f32 v92, v92, v14
  v_sub_f32 v93, v93, v14
  v_sub_f32 v94, v94, v14
  v_sub_f32 v95, v95, v14
  v_sub_f32 v96, 0, v14
  v_sub_f32 v97, 0, v14
  v_sub_f32 v98, 0, v14
  v_sub_f32 v99, 0, v14
  v_sub_f32 v100, 0, v14
  v_sub_f32 v101, 0, v14
  v_sub_f32 v102, 0, v14
  v_sub_f32 v103, 0, v14
  v_sub_f32 v104, 0, v14
  v_sub_f32 v105, 0, v14
  v_sub_f32 v106, 0, v14
  v_sub_f32 v107, 0, v14
  v_sub_f32 v108, 0, v14
  v_sub_f32 v109, 0, v14
  v_sub_f32 v110, 0, v14
  v_sub_f32 v111, 0, v14
  v_mfma_f32_32x32x16_bf16 v[16:31], v[112:115], v[232:235], v[80:95]
  v_mfma_f32_32x32x16_bf16 v[16:31], v[116:119], v[236:239], v[16:31]
  v_mfma_f32_32x32x16_bf16 v[32:47], v[120:123], v[232:235], v[96:111]
  v_mfma_f32_32x32x16_bf16 v[32:47], v[124:127], v[236:239], v[32:47]
  v_sub_f32 v64, v64, v14
  v_sub_f32 v65, v65, v14
  v_sub_f32 v66, v66, v14
  v_sub_f32 v67, v67, v14
  v_sub_f32 v68, v68, v14
  v_sub_f32 v69, v69, v14
  v_sub_f32 v70, v70, v14
  v_sub_f32 v71, v71, v14
  v_sub_f32 v72, v72, v14
  v_sub_f32 v73, v73, v14
  v_sub_f32 v74, v74, v14
  v_sub_f32 v75, v75, v14
  v_sub_f32 v76, v76, v14
  v_sub_f32 v77, v77, v14
  v_sub_f32 v78, v78, v14
  v_sub_f32 v79, v79, v14
  v_exp_f32 v16, v16
  v_exp_f32 v17, v17
  v_exp_f32 v18, v18
  v_exp_f32 v19, v19
  v_exp_f32 v20, v20
  v_exp_f32 v21, v21
  v_exp_f32 v22, v22
  v_exp_f32 v23, v23
  v_exp_f32 v24, v24
  v_exp_f32 v25, v25
  v_exp_f32 v26, v26
  v_exp_f32 v27, v27
  v_exp_f32 v28, v28
  v_exp_f32 v29, v29
  v_exp_f32 v30, v30
  v_exp_f32 v31, v31
  v_cvt_pk_bf16_f32 v16, v16, v17
  v_cvt_pk_bf16_f32 v17, v18, v19
  v_cvt_pk_bf16_f32 v18, v20, v21
  v_cvt_pk_bf16_f32 v19, v22, v23
  v_cvt_pk_bf16_f32 v20, v24, v25
  v_cvt_pk_bf16_f32 v21, v26, v27
  v_cvt_pk_bf16_f32 v22, v28, v29
  v_cvt_pk_bf16_f32 v23, v30, v31
  s_waitcnt lgkmcnt(4)
  v_mfma_f32_32x32x16_bf16 v[216:231], v[184:187], v[16:19], v[216:231]
  v_exp_f32 v32, v32
  v_exp_f32 v33, v33
  v_exp_f32 v34, v34
  v_exp_f32 v35, v35
  v_mfma_f32_32x32x16_bf16 v[216:231], v[188:191], v[20:23], v[216:231]
  v_exp_f32 v36, v36
  v_exp_f32 v37, v37
  v_exp_f32 v38, v38
  v_exp_f32 v39, v39
  v_mfma_f32_32x32x16_bf16 v[48:63], v[128:131], v[232:235], v[96:111]
  v_exp_f32 v40, v40
  v_exp_f32 v41, v41
  v_exp_f32 v42, v42
  v_exp_f32 v43, v43
  v_mfma_f32_32x32x16_bf16 v[48:63], v[132:135], v[236:239], v[48:63]
  v_exp_f32 v44, v44
  v_exp_f32 v45, v45
  v_exp_f32 v46, v46
  v_exp_f32 v47, v47
  v_cvt_pk_bf16_f32 v32, v32, v33
  v_cvt_pk_bf16_f32 v33, v34, v35
  v_cvt_pk_bf16_f32 v34, v36, v37
  v_cvt_pk_bf16_f32 v35, v38, v39
  v_cvt_pk_bf16_f32 v36, v40, v41
  v_cvt_pk_bf16_f32 v37, v42, v43
  v_cvt_pk_bf16_f32 v38, v44, v45
  v_cvt_pk_bf16_f32 v39, v46, v47
  ds_read_b128 v[208:211], v4 offset:30976
  ds_read_b128 v[212:215], v4 offset:31616
  s_waitcnt lgkmcnt(4)
  v_mfma_f32_32x32x16_bf16 v[216:231], v[192:195], v[32:35], v[216:231]
  v_exp_f32 v48, v48
  v_exp_f32 v49, v49
  v_exp_f32 v50, v50
  v_exp_f32 v51, v51
  v_mfma_f32_32x32x16_bf16 v[216:231], v[196:199], v[36:39], v[216:231]
  v_exp_f32 v52, v52
  v_exp_f32 v53, v53
  v_exp_f32 v54, v54
  v_exp_f32 v55, v55
  v_mfma_f32_32x32x16_bf16 v[16:31], v[136:139], v[232:235], v[96:111]
  v_exp_f32 v56, v56
  v_exp_f32 v57, v57
  v_exp_f32 v58, v58
  v_exp_f32 v59, v59
  v_mfma_f32_32x32x16_bf16 v[16:31], v[140:143], v[236:239], v[16:31]
  v_exp_f32 v60, v60
  v_exp_f32 v61, v61
  v_exp_f32 v62, v62
  v_exp_f32 v63, v63
  v_cvt_pk_bf16_f32 v48, v48, v49
  v_cvt_pk_bf16_f32 v49, v50, v51
  v_cvt_pk_bf16_f32 v50, v52, v53
  v_cvt_pk_bf16_f32 v51, v54, v55
  v_cvt_pk_bf16_f32 v52, v56, v57
  v_cvt_pk_bf16_f32 v53, v58, v59
  v_cvt_pk_bf16_f32 v54, v60, v61
  v_cvt_pk_bf16_f32 v55, v62, v63
  ds_read_b128 v[184:187], v4 offset:29696
  ds_read_b128 v[188:191], v4 offset:30336
  s_waitcnt lgkmcnt(4)
  v_mfma_f32_32x32x16_bf16 v[216:231], v[200:203], v[48:51], v[216:231]
  v_exp_f32 v16, v16
  v_exp_f32 v17, v17
  v_exp_f32 v18, v18
  v_exp_f32 v19, v19
  v_mfma_f32_32x32x16_bf16 v[216:231], v[204:207], v[52:55], v[216:231]
  v_exp_f32 v20, v20
  v_exp_f32 v21, v21
  v_exp_f32 v22, v22
  v_exp_f32 v23, v23
  v_mfma_f32_32x32x16_bf16 v[32:47], v[144:147], v[232:235], v[96:111]
  v_exp_f32 v24, v24
  v_exp_f32 v25, v25
  v_exp_f32 v26, v26
  v_exp_f32 v27, v27
  v_mfma_f32_32x32x16_bf16 v[32:47], v[148:151], v[236:239], v[32:47]
  v_exp_f32 v28, v28
  v_exp_f32 v29, v29
  v_exp_f32 v30, v30
  v_exp_f32 v31, v31
  v_cvt_pk_bf16_f32 v16, v16, v17
  v_cvt_pk_bf16_f32 v17, v18, v19
  v_cvt_pk_bf16_f32 v18, v20, v21
  v_cvt_pk_bf16_f32 v19, v22, v23
  v_cvt_pk_bf16_f32 v20, v24, v25
  v_cvt_pk_bf16_f32 v21, v26, v27
  v_cvt_pk_bf16_f32 v22, v28, v29
  v_cvt_pk_bf16_f32 v23, v30, v31
  ds_read_b128 v[192:195], v4 offset:28416
  ds_read_b128 v[196:199], v4 offset:29056
  s_waitcnt lgkmcnt(4)
  v_mfma_f32_32x32x16_bf16 v[216:231], v[208:211], v[16:19], v[216:231]
  v_exp_f32 v32, v32
  v_exp_f32 v33, v33
  v_exp_f32 v34, v34
  v_exp_f32 v35, v35
  v_mfma_f32_32x32x16_bf16 v[216:231], v[212:215], v[20:23], v[216:231]
  v_exp_f32 v36, v36
  v_exp_f32 v37, v37
  v_exp_f32 v38, v38
  v_exp_f32 v39, v39
  v_mfma_f32_32x32x16_bf16 v[48:63], v[152:155], v[232:235], v[96:111]
  v_exp_f32 v40, v40
  v_exp_f32 v41, v41
  v_exp_f32 v42, v42
  v_exp_f32 v43, v43
  v_mfma_f32_32x32x16_bf16 v[48:63], v[156:159], v[236:239], v[48:63]
  v_exp_f32 v44, v44
  v_exp_f32 v45, v45
  v_exp_f32 v46, v46
  v_exp_f32 v47, v47
  v_cvt_pk_bf16_f32 v32, v32, v33
  v_cvt_pk_bf16_f32 v33, v34, v35
  v_cvt_pk_bf16_f32 v34, v36, v37
  v_cvt_pk_bf16_f32 v35, v38, v39
  v_cvt_pk_bf16_f32 v36, v40, v41
  v_cvt_pk_bf16_f32 v37, v42, v43
  v_cvt_pk_bf16_f32 v38, v44, v45
  v_cvt_pk_bf16_f32 v39, v46, v47
  ds_read_b128 v[200:203], v4 offset:27136
  ds_read_b128 v[204:207], v4 offset:27776
  s_waitcnt lgkmcnt(4)
  v_mfma_f32_32x32x16_bf16 v[216:231], v[184:187], v[32:35], v[216:231]
  v_exp_f32 v48, v48
  v_exp_f32 v49, v49
  v_exp_f32 v50, v50
  v_exp_f32 v51, v51
  v_mfma_f32_32x32x16_bf16 v[216:231], v[188:191], v[36:39], v[216:231]
  v_exp_f32 v52, v52
  v_exp_f32 v53, v53
  v_exp_f32 v54, v54
  v_exp_f32 v55, v55
  v_mfma_f32_32x32x16_bf16 v[16:31], v[160:163], v[232:235], v[96:111]
  v_exp_f32 v56, v56
  v_exp_f32 v57, v57
  v_exp_f32 v58, v58
  v_exp_f32 v59, v59
  v_mfma_f32_32x32x16_bf16 v[16:31], v[164:167], v[236:239], v[16:31]
  v_exp_f32 v60, v60
  v_exp_f32 v61, v61
  v_exp_f32 v62, v62
  v_exp_f32 v63, v63
  v_cvt_pk_bf16_f32 v48, v48, v49
  v_cvt_pk_bf16_f32 v49, v50, v51
  v_cvt_pk_bf16_f32 v50, v52, v53
  v_cvt_pk_bf16_f32 v51, v54, v55
  v_cvt_pk_bf16_f32 v52, v56, v57
  v_cvt_pk_bf16_f32 v53, v58, v59
  v_cvt_pk_bf16_f32 v54, v60, v61
  v_cvt_pk_bf16_f32 v55, v62, v63
  ds_read_b128 v[208:211], v4 offset:25856
  ds_read_b128 v[212:215], v4 offset:26496
  s_waitcnt lgkmcnt(4)
  v_mfma_f32_32x32x16_bf16 v[216:231], v[192:195], v[48:51], v[216:231]
  v_exp_f32 v16, v16
  v_exp_f32 v17, v17
  v_exp_f32 v18, v18
  v_exp_f32 v19, v19
  v_mfma_f32_32x32x16_bf16 v[216:231], v[196:199], v[52:55], v[216:231]
  v_exp_f32 v20, v20
  v_exp_f32 v21, v21
  v_exp_f32 v22, v22
  v_exp_f32 v23, v23
  v_mfma_f32_32x32x16_bf16 v[32:47], v[168:171], v[232:235], v[96:111]
  v_exp_f32 v24, v24
  v_exp_f32 v25, v25
  v_exp_f32 v26, v26
  v_exp_f32 v27, v27
  v_mfma_f32_32x32x16_bf16 v[32:47], v[172:175], v[236:239], v[32:47]
  v_exp_f32 v28, v28
  v_exp_f32 v29, v29
  v_exp_f32 v30, v30
  v_exp_f32 v31, v31
  v_cvt_pk_bf16_f32 v16, v16, v17
  v_cvt_pk_bf16_f32 v17, v18, v19
  v_cvt_pk_bf16_f32 v18, v20, v21
  v_cvt_pk_bf16_f32 v19, v22, v23
  v_cvt_pk_bf16_f32 v20, v24, v25
  v_cvt_pk_bf16_f32 v21, v26, v27
  v_cvt_pk_bf16_f32 v22, v28, v29
  v_cvt_pk_bf16_f32 v23, v30, v31
  ds_read_b128 v[184:187], v4 offset:24576
  ds_read_b128 v[188:191], v4 offset:25216
  s_waitcnt lgkmcnt(4)
  v_mfma_f32_32x32x16_bf16 v[216:231], v[200:203], v[16:19], v[216:231]
  v_exp_f32 v32, v32
  v_exp_f32 v33, v33
  v_exp_f32 v34, v34
  v_exp_f32 v35, v35
  v_mfma_f32_32x32x16_bf16 v[216:231], v[204:207], v[20:23], v[216:231]
  v_exp_f32 v36, v36
  v_exp_f32 v37, v37
  v_exp_f32 v38, v38
  v_exp_f32 v39, v39
  v_mfma_f32_32x32x16_bf16 v[48:63], v[176:179], v[232:235], v[64:79]
  v_exp_f32 v40, v40
  v_exp_f32 v41, v41
  v_exp_f32 v42, v42
  v_exp_f32 v43, v43
  v_mfma_f32_32x32x16_bf16 v[48:63], v[180:183], v[236:239], v[48:63]
  v_exp_f32 v44, v44
  v_exp_f32 v45, v45
  v_exp_f32 v46, v46
  v_exp_f32 v47, v47
  v_cvt_pk_bf16_f32 v32, v32, v33
  v_cvt_pk_bf16_f32 v33, v34, v35
  v_cvt_pk_bf16_f32 v34, v36, v37
  v_cvt_pk_bf16_f32 v35, v38, v39
  v_cvt_pk_bf16_f32 v36, v40, v41
  v_cvt_pk_bf16_f32 v37, v42, v43
  v_cvt_pk_bf16_f32 v38, v44, v45
  v_cvt_pk_bf16_f32 v39, v46, v47
  s_waitcnt lgkmcnt(2)
  v_mfma_f32_32x32x16_bf16 v[216:231], v[208:211], v[32:35], v[216:231]
  v_exp_f32 v48, v48
  v_exp_f32 v49, v49
  v_exp_f32 v50, v50
  v_exp_f32 v51, v51
  v_mfma_f32_32x32x16_bf16 v[216:231], v[212:215], v[36:39], v[216:231]
  v_exp_f32 v52, v52
  v_exp_f32 v53, v53
  v_exp_f32 v54, v54
  v_exp_f32 v55, v55
  v_exp_f32 v56, v56
  v_exp_f32 v57, v57
  v_exp_f32 v58, v58
  v_exp_f32 v59, v59
  v_exp_f32 v60, v60
  v_exp_f32 v61, v61
  v_exp_f32 v62, v62
  v_exp_f32 v63, v63
  v_cvt_pk_bf16_f32 v48, v48, v49
  v_cvt_pk_bf16_f32 v49, v50, v51
  v_cvt_pk_bf16_f32 v50, v52, v53
  v_cvt_pk_bf16_f32 v51, v54, v55
  v_cvt_pk_bf16_f32 v52, v56, v57
  v_cvt_pk_bf16_f32 v53, v58, v59
  v_cvt_pk_bf16_f32 v54, v60, v61
  v_cvt_pk_bf16_f32 v55, v62, v63
  s_nop 1
  s_waitcnt lgkmcnt(0)
  v_mfma_f32_32x32x16_bf16 v[216:231], v[184:187], v[48:51], v[216:231]
  v_mfma_f32_32x32x16_bf16 v[216:231], v[188:191], v[52:55], v[216:231]
  v_lshrrev_b32 v8, 4, v6
  v_mul_u32_u24 v8, 18432, v8
  v_and_b32 v9, 15, v6
  v_lshl_add_u32 v8, v9, 4, v8
  v_lshl_add_u32 v9, v7, 8, v8
  s_mul_i32 s44, s52, 36864
  s_add_u32 s44, s44, 9863168
  s_lshl_b32 s45, s43, 9
  s_add_u32 s45, s45, s44
  s_lshr_b32 s46, s43, 4
  s_add_u32 s46, s46, 16
  s_lshl_b32 s46, s46, 10
  s_add_u32 s46, s46, s44
  s_bfe_u32 s47, s43, 0x10003
  s_lshl_b32 s47, s47, 9
  s_add_u32 s46, s46, s47
  s_bfe_u32 s47, s43, 0x10001
  s_lshl_b32 s47, s47, 8
  s_add_u32 s46, s46, s47
  s_bfe_u32 s47, s43, 0x10002
  s_lshl_b32 s47, s47, 3
  s_add_u32 s46, s46, s47
  s_bfe_u32 s47, s43, 0x10000
  s_lshl_b32 s47, s47, 2
  s_add_u32 s46, s46, s47
  v_mov_b32 v14, v226
  v_mov_b32 v15, v226
  s_nop 1
  v_permlane32_swap_b32 v14, v15
  s_nop 1
  v_rcp_f32 v14, v14
  s_nop 0
  v_mul_f32 v216, v216, v14
  v_mul_f32 v217, v217, v14
  v_mul_f32 v218, v218, v14
  v_mul_f32 v219, v219, v14
  v_mul_f32 v220, v220, v14
  v_mul_f32 v221, v221, v14
  v_mul_f32 v222, v222, v14
  v_mul_f32 v223, v223, v14
  v_mul_f32 v224, v224, v14
  v_mul_f32 v225, v225, v14
  v_cvt_pk_bf16_f32 v216, v216, v217
  v_cvt_pk_bf16_f32 v217, v218, v219
  v_cvt_pk_bf16_f32 v218, v220, v221
  v_cvt_pk_bf16_f32 v219, v222, v223
  v_cvt_pk_bf16_f32 v220, v224, v225
  buffer_store_dwordx4 v[216:219], v9, s[4:7], s45 offen sc1
  s_mov_b32 exec_hi, 0
  buffer_store_dword v220, v8, s[4:7], s46 offen sc1
  s_mov_b32 exec_hi, -1
.L_code_s3:
  s_lshl_b32 s52, s40, 3
  s_add_u32 s52, s52, s42
  s_mov_b32 s8, s16
  s_and_b32 s9, s17, 0xffff
  s_mov_b32 s10, 0x00240000
  s_mov_b32 s11, 0x00020000
  s_mul_i32 s48, s41, 9
  s_mul_i32 s50, s52, 36864
  s_mul_i32 s51, s41, 288
  s_add_u32 s50, s50, s51
  s_cmp_ge_u32 s3, 4
  s_cbranch_scc1 .Lm_36
  s_add_u32 s49, s48, s3
  s_mul_i32 s49, s49, 18432
  s_add_u32 s49, s49, 311296
  buffer_load_dwordx4 v[28:31], v1, s[4:7], s49 offen offset:0 sc1
  buffer_load_dwordx4 v[32:35], v1, s[4:7], s49 offen offset:1024 sc1
  buffer_load_dwordx4 v[36:39], v1, s[4:7], s49 offen offset:2048 sc1
  buffer_load_dwordx4 v[40:43], v1, s[4:7], s49 offen offset:3072 sc1
  s_add_u32 s49, s49, 4096
  buffer_load_dwordx4 v[44:47], v1, s[4:7], s49 offen offset:0 sc1
  buffer_load_dwordx4 v[48:51], v1, s[4:7], s49 offen offset:1024 sc1
  buffer_load_dwordx4 v[52:55], v1, s[4:7], s49 offen offset:2048 sc1
  buffer_load_dwordx4 v[56:59], v1, s[4:7], s49 offen offset:3072 sc1
  s_add_u32 s49, s49, 4096
  buffer_load_dwordx4 v[60:63], v1, s[4:7], s49 offen offset:0 sc1
  buffer_load_dwordx4 v[64:67], v1, s[4:7], s49 offen offset:1024 sc1
  buffer_load_dwordx4 v[68:71], v1, s[4:7], s49 offen offset:2048 sc1
  buffer_load_dwordx4 v[72:75], v1, s[4:7], s49 offen offset:3072 sc1
  s_add_u32 s49, s49, 4096
  buffer_load_dwordx4 v[76:79], v1, s[4:7], s49 offen offset:0 sc1
  buffer_load_dwordx4 v[80:83], v1, s[4:7], s49 offen offset:1024 sc1
  buffer_load_dwordx4 v[84:87], v1, s[4:7], s49 offen offset:2048 sc1
  buffer_load_dwordx4 v[88:91], v1, s[4:7], s49 offen offset:3072 sc1
  s_add_u32 s49, s49, 4096
  buffer_load_dwordx4 v[92:95], v1, s[4:7], s49 offen offset:0 sc1
  buffer_load_dwordx4 v[96:99], v1, s[4:7], s49 offen offset:1024 sc1
  s_lshl_b32 s51, s3, 6
  v_add_u32 v2, s51, v0
  v_mul_u32_u24 v3, 3641, v2
  v_lshrrev_b32 v3, 16, v3
  v_mul_u32_u24 v3, 864, v3
  v_lshl_add_u32 v3, v2, 4, v3
  s_lshl_b32 s51, s3, 10
  s_add_u32 m0, s51, 131072
  s_nop 0
  buffer_load_dwordx4 v3, s[8:11], s50 offen lds
  s_waitcnt vmcnt(19)
  s_cmp_ge_u32 s3, 2
  s_cbranch_scc1 .Lm_37
  s_add_u32 s49, s48, 8
  s_mul_i32 s49, s49, 18432
  s_add_u32 s49, s49, 311296
  buffer_load_dwordx4 v[100:103], v1, s[4:7], s49 offen offset:0 sc1
  buffer_load_dwordx4 v[104:107], v1, s[4:7], s49 offen offset:1024 sc1
  buffer_load_dwordx4 v[108:111], v1, s[4:7], s49 offen offset:2048 sc1
  buffer_load_dwordx4 v[112:115], v1, s[4:7], s49 offen offset:3072 sc1
  s_add_u32 s49, s49, 4096
  buffer_load_dwordx4 v[116:119], v1, s[4:7], s49 offen offset:0 sc1
  buffer_load_dwordx4 v[120:123], v1, s[4:7], s49 offen offset:1024 sc1
  buffer_load_dwordx4 v[124:127], v1, s[4:7], s49 offen offset:2048 sc1
  buffer_load_dwordx4 v[128:131], v1, s[4:7], s49 offen offset:3072 sc1
  s_add_u32 s49, s49, 4096
  buffer_load_dwordx4 v[132:135], v1, s[4:7], s49 offen offset:0 sc1
  buffer_load_dwordx4 v[136:139], v1, s[4:7], s49 offen offset:1024 sc1
  buffer_load_dwordx4 v[140:143], v1, s[4:7], s49 offen offset:2048 sc1
  buffer_load_dwordx4 v[144:147], v1, s[4:7], s49 offen offset:3072 sc1
  s_add_u32 s49, s49, 4096
  buffer_load_dwordx4 v[148:151], v1, s[4:7], s49 offen offset:0 sc1
  buffer_load_dwordx4 v[152:155], v1, s[4:7], s49 offen offset:1024 sc1
  buffer_load_dwordx4 v[156:159], v1, s[4:7], s49 offen offset:2048 sc1
  buffer_load_dwordx4 v[160:163], v1, s[4:7], s49 offen offset:3072 sc1
  s_add_u32 s49, s49, 4096
  buffer_load_dwordx4 v[164:167], v1, s[4:7], s49 offen offset:0 sc1
  buffer_load_dwordx4 v[168:171], v1, s[4:7], s49 offen offset:1024 sc1
  s_branch .Lm_38
.Lm_37:
  s_sub_u32 s53, 36, s48
  s_mov_b32 exec_lo, 0x00030003
  s_mov_b32 exec_hi, 0x00030003
  s_add_u32 s49, s48, s53
  s_mul_i32 s49, s49, 18432
  s_add_u32 s49, s49, 311296
  buffer_load_dwordx4 v[100:103], v1, s[4:7], s49 offen offset:0 sc1
  buffer_load_dwordx4 v[104:107], v1, s[4:7], s49 offen offset:1024 sc1
  buffer_load_dwordx4 v[108:111], v1, s[4:7], s49 offen offset:2048 sc1
  buffer_load_dwordx4 v[112:115], v1, s[4:7], s49 offen offset:3072 sc1
  s_add_u32 s49, s49, 4096
  buffer_load_dwordx4 v[116:119], v1, s[4:7], s49 offen offset:0 sc1
  buffer_load_dwordx4 v[120:123], v1, s[4:7], s49 offen offset:1024 sc1
  buffer_load_dwordx4 v[124:127], v1, s[4:7], s49 offen offset:2048 sc1
  buffer_load_dwordx4 v[128:131], v1, s[4:7], s49 offen offset:3072 sc1
  s_add_u32 s49, s49, 4096
  buffer_load_dwordx4 v[132:135], v1, s[4:7], s49 offen offset:0 sc1
  buffer_load_dwordx4 v[136:139], v1, s[4:7], s49 offen offset:1024 sc1
  buffer_load_dwordx4 v[140:143], v1, s[4:7], s49 offen offset:2048 sc1
  buffer_load_dwordx4 v[144:147], v1, s[4:7], s49 offen offset:3072 sc1
  s_add_u32 s49, s49, 4096
  buffer_load_dwordx4 v[148:151], v1, s[4:7], s49 offen offset:0 sc1
  buffer_load_dwordx4 v[152:155], v1, s[4:7], s49 offen offset:1024 sc1
  buffer_load_dwordx4 v[156:159], v1, s[4:7], s49 offen offset:2048 sc1
  buffer_load_dwordx4 v[160:163], v1, s[4:7], s49 offen offset:3072 sc1
  s_add_u32 s49, s49, 4096
  buffer_load_dwordx4 v[164:167], v1, s[4:7], s49 offen offset:0 sc1
  buffer_load_dwordx4 v[168:171], v1, s[4:7], s49 offen offset:1024 sc1
  s_mov_b64 exec, -1
  s_lshl_b32 s49, s52, 1
  s_and_b32 s53, s3, 1
  s_add_u32 s49, s49, s53
  s_lshl_b32 s49, s49, 6
  s_add_u32 s49, s49, 172032
  v_and_b32 v2, 15, v0
  v_lshlrev_b32 v2, 2, v2
  buffer_load_dword v198, v2, s[4:7], s49 offen sc1
  s_add_u32 s53, s3, 6
  s_cmp_eq_u32 s53, 9
  s_cbranch_scc1 .Lm_38
  s_lshl_b32 s51, s53, 6
  v_add_u32 v2, s51, v0
  v_mul_u32_u24 v3, 3641, v2
  v_lshrrev_b32 v3, 16, v3
  v_mul_u32_u24 v3, 864, v3
  v_lshl_add_u32 v3, v2, 4, v3
  s_lshl_b32 s51, s53, 10
  s_add_u32 m0, s51, 131072
  s_nop 0
  buffer_load_dwordx4 v3, s[8:11], s50 offen lds
  s_branch .Lm_38
.Lm_36:
  s_waitcnt vmcnt(0)
.Lm_38:
  s_barrier
  s_cmp_lg_u32 s3, 7
  s_cbranch_scc1 .Lm_40
  s_mul_i32 s44, s40, 139264
  s_lshl_b32 s45, s43, 2
  s_add_u32 s44, s44, s45
  s_add_u32 s44, s44, 1048576
  s_add_u32 s45, s101, 2
  v_mov_b32 v184, s45
  v_mul_u32_u24 v185, 4352, v0
  s_mov_b32 exec_lo, -1
  s_mov_b32 exec_hi, 0
  buffer_store_dword v184, v185, s[4:7], s44 offen sc1
  s_mov_b64 exec, -1
.Lm_40:
  s_cmp_lt_u32 s3, 4
  s_cbranch_scc1 .Lm_39
  s_add_u32 s49, s48, s3
  s_mul_i32 s49, s49, 18432
  s_add_u32 s49, s49, 311296
  buffer_load_dwordx4 v[28:31], v1, s[4:7], s49 offen offset:0 sc1
  buffer_load_dwordx4 v[32:35], v1, s[4:7], s49 offen offset:1024 sc1
  buffer_load_dwordx4 v[36:39], v1, s[4:7], s49 offen offset:2048 sc1
  buffer_load_dwordx4 v[40:43], v1, s[4:7], s49 offen offset:3072 sc1
  s_add_u32 s49, s49, 4096
  buffer_load_dwordx4 v[44:47], v1, s[4:7], s49 offen offset:0 sc1
  buffer_load_dwordx4 v[48:51], v1, s[4:7], s49 offen offset:1024 sc1
  buffer_load_dwordx4 v[52:55], v1, s[4:7], s49 offen offset:2048 sc1
  buffer_load_dwordx4 v[56:59], v1, s[4:7], s49 offen offset:3072 sc1
  s_add_u32 s49, s49, 4096
  buffer_load_dwordx4 v[60:63], v1, s[4:7], s49 offen offset:0 sc1
  buffer_load_dwordx4 v[64:67], v1, s[4:7], s49 offen offset:1024 sc1
  buffer_load_dwordx4 v[68:71], v1, s[4:7], s49 offen offset:2048 sc1
  buffer_load_dwordx4 v[72:75], v1, s[4:7], s49 offen offset:3072 sc1
  s_add_u32 s49, s49, 4096
  buffer_load_dwordx4 v[76:79], v1, s[4:7], s49 offen offset:0 sc1
  buffer_load_dwordx4 v[80:83], v1, s[4:7], s49 offen offset:1024 sc1
  buffer_load_dwordx4 v[84:87], v1, s[4:7], s49 offen offset:2048 sc1
  buffer_load_dwordx4 v[88:91], v1, s[4:7], s49 offen offset:3072 sc1
  s_add_u32 s49, s49, 4096
  buffer_load_dwordx4 v[92:95], v1, s[4:7], s49 offen offset:0 sc1
  buffer_load_dwordx4 v[96:99], v1, s[4:7], s49 offen offset:1024 sc1
  s_lshl_b32 s51, s3, 6
  v_add_u32 v2, s51, v0
  v_mul_u32_u24 v3, 3641, v2
  v_lshrrev_b32 v3, 16, v3
  v_mul_u32_u24 v3, 864, v3
  v_lshl_add_u32 v3, v2, 4, v3
  s_lshl_b32 s51, s3, 10
  s_add_u32 m0, s51, 131072
  s_nop 0
  buffer_load_dwordx4 v3, s[8:11], s50 offen lds
.Lm_39:
  v_and_b32 v2, 15, v0
  v_lshrrev_b32 v3, 4, v0
  v_mul_u32_u24 v4, 288, v2
  v_lshl_add_u32 v4, v3, 3, v4
  v_add_u32 v4, 131072, v4
  s_lshl_b32 s48, s3, 5
  v_add_u32 v6, s48, v4
  s_mul_i32 s48, s3, 4608
  v_add_u32 v7, s48, v4
  v_lshrrev_b32 v5, 5, v0
  v_mul_u32_u24 v5, 17920, v5
  v_add_u32 v5, v5, v1
  v_add_u32 v8, 73728, v1
  s_mul_i32 s54, s52, 36864
  s_mul_i32 s48, s41, 9
  s_add_u32 s49, s48, s3
  s_lshl_b32 s49, s49, 9
  s_add_u32 s55, s54, s49
  s_add_u32 s55, s55, 12222464
  s_add_u32 s49, s48, 8
  s_lshl_b32 s49, s49, 9
  s_add_u32 s56, s54, s49
  s_mul_i32 s49, s3, 18432
  s_add_u32 s56, s56, s49
  s_add_u32 s56, s56, 12222464
  s_mul_i32 s57, s3, 4608
  s_add_u32 s54, s54, s57
  s_add_u32 s54, s54, 9863168
  s_and_b32 s44, s3, 3
  s_mul_i32 s44, s44, 442368
  s_mul_i32 s45, s43, 288
  s_add_u32 s44, s44, s45
  v_add_u32 v20, 0, v0
  v_mul_u32_u24 v21, 10923, v20
  v_lshrrev_b32 v21, 16, v21
  v_mul_u32_u24 v21, 9120, v21
  v_lshl_add_u32 v12, v20, 4, v21
  v_add_u32 v12, s44, v12
  v_add_u32 v20, 64, v0
  v_mul_u32_u24 v21, 10923, v20
  v_lshrrev_b32 v21, 16, v21
  v_mul_u32_u24 v21, 9120, v21
  v_lshl_add_u32 v13, v20, 4, v21
  v_add_u32 v13, s44, v13
  v_subrev_u32 v13, 1024, v13
  v_add_u32 v20, 128, v0
  v_mul_u32_u24 v21, 10923, v20
  v_lshrrev_b32 v21, 16, v21
  v_mul_u32_u24 v21, 9120, v21
  v_lshl_add_u32 v14, v20, 4, v21
  v_add_u32 v14, s44, v14
  v_subrev_u32 v14, 2048, v14
  v_add_u32 v20, 192, v0
  v_mul_u32_u24 v21, 10923, v20
  v_lshrrev_b32 v21, 16, v21
  v_mul_u32_u24 v21, 9120, v21
  v_lshl_add_u32 v15, v20, 4, v21
  v_add_u32 v15, s44, v15
  v_subrev_u32 v15, 3072, v15
  v_add_u32 v20, 256, v0
  v_mul_u32_u24 v21, 10923, v20
  v_lshrrev_b32 v21, 16, v21
  v_mul_u32_u24 v21, 9120, v21
  v_lshl_add_u32 v16, v20, 4, v21
  v_add_u32 v16, s44, v16
  s_cmp_lg_u32 s3, 3
  s_cbranch_scc1 .Lm_41
  s_lshl_b32 s46, s40, 5
  s_add_u32 s46, s46, s43
  s_mul_i32 s46, s46, 4352
  s_add_u32 s46, s46, 1048576
  v_and_b32 v185, 31, v0
  v_lshlrev_b32 v184, 2, v185
  v_add_u32 v184, s46, v184
  s_mov_b64 vcc, -1
  s_nop 3
  s_mov_b32 vcc_hi, 0
  s_add_u32 s45, s101, 2
  s_mov_b32 s44, 0
  s_nop 2
  s_mov_b64 exec, vcc
.Lm_42:
  buffer_load_dword v186, v184, s[4:7], 0 offen sc1
  s_waitcnt vmcnt(0)
  v_subrev_u32 v185, s45, v186
  v_cmp_le_u32 vcc, 14, v185
  s_add_u32 s44, s44, 1
  s_nop 2
  s_cmp_eq_u64 vcc, 0
  s_cbranch_scc1 .Lm_43
  s_sleep 1
  s_cmp_lt_u32 s44, 0x40000
  s_cbranch_scc1 .Lm_42
.Lm_43:
  s_mov_b64 exec, -1
.Lm_41:
  s_barrier
  s_add_u32 m0, s57, 73728
  s_nop 0
  buffer_load_dwordx4 v1, s[4:7], s54 offen offset:0 sc1 lds
  buffer_load_dwordx4 v1, s[4:7], s54 offen offset:1024 sc1 lds
  buffer_load_dwordx4 v1, s[4:7], s54 offen offset:2048 sc1 lds
  buffer_load_dwordx4 v1, s[4:7], s54 offen offset:3072 sc1 lds
  s_add_u32 m0, s57, 77824
  s_add_u32 s54, s54, 4096
  s_mov_b32 exec_hi, 0
  buffer_load_dwordx4 v1, s[4:7], s54 offen sc1 lds
  s_mov_b32 exec_hi, -1
  s_mul_i32 s44, s3, 4608
  s_add_u32 m0, s44, 36864
  s_bitcmp1_b32 s43, 0
  s_cselect_b32 s44, 192, 0
  s_add_u32 s44, s44, 1769472
  buffer_load_dwordx4 v12, s[12:15], s44 offen offset:0 lds
  s_bitcmp1_b32 s43, 0
  s_cselect_b32 s44, 192, 0
  s_add_u32 s44, s44, 1769472
  buffer_load_dwordx4 v13, s[12:15], s44 offen offset:1024 lds
  s_bitcmp1_b32 s43, 0
  s_cselect_b32 s44, 192, 0
  s_add_u32 s44, s44, 1769472
  buffer_load_dwordx4 v14, s[12:15], s44 offen offset:2048 lds
  s_bitcmp1_b32 s43, 0
  s_cselect_b32 s44, 192, 0
  s_add_u32 s44, s44, 1769472
  buffer_load_dwordx4 v15, s[12:15], s44 offen offset:3072 lds
  s_mul_i32 s44, s3, 4608
  s_add_u32 m0, s44, 40960
  s_bitcmp1_b32 s43, 0
  s_cselect_b32 s44, 192, 0
  s_add_u32 s44, s44, 1769472
  s_mov_b32 exec_hi, 0
  buffer_load_dwordx4 v16, s[12:15], s44 offen offset:0 lds
  s_mov_b32 exec_hi, -1
  s_waitcnt vmcnt(5)
  s_barrier
  s_cmp_lt_u32 s3, 4
  s_cbranch_scc1 .L_s3_x
  ds_read_b128 v[216:219], v8 offset:0
  ds_read_b128 v[220:223], v8 offset:18432
  ds_read_b128 v[224:227], v8 offset:1024
  ds_read_b128 v[228:231], v8 offset:19456
  ds_read_b128 v[232:235], v8 offset:2048
  ds_read_b128 v[236:239], v8 offset:20480
  ds_read_b128 v[240:243], v8 offset:3072
  ds_read_b128 v[244:247], v8 offset:21504
  ds_read_b128 v[248:251], v8 offset:4096
  ds_read_b128 v[252:255], v8 offset:22528
  s_waitcnt lgkmcnt(8)
  v_mfma_f32_16x16x32_bf16 v[172:175], v[28:31], v[216:219], 0
  v_mfma_f32_16x16x32_bf16 v[176:179], v[28:31], v[220:223], 0
  ds_read_b128 v[216:219], v8 offset:5120
  ds_read_b128 v[220:223], v8 offset:23552
  s_waitcnt lgkmcnt(8)
  v_mfma_f32_16x16x32_bf16 v[172:175], v[32:35], v[224:227], v[172:175]
  v_mfma_f32_16x16x32_bf16 v[176:179], v[32:35], v[228:231], v[176:179]
  ds_read_b128 v[224:227], v8 offset:6144
  ds_read_b128 v[228:231], v8 offset:24576
  s_waitcnt lgkmcnt(8)
  v_mfma_f32_16x16x32_bf16 v[172:175], v[36:39], v[232:235], v[172:175]
  v_mfma_f32_16x16x32_bf16 v[176:179], v[36:39], v[236:239], v[176:179]
  ds_read_b128 v[232:235], v8 offset:7168
  ds_read_b128 v[236:239], v8 offset:25600
  s_waitcnt lgkmcnt(8)
  v_mfma_f32_16x16x32_bf16 v[172:175], v[40:43], v[240:243], v[172:175]
  v_mfma_f32_16x16x32_bf16 v[176:179], v[40:43], v[244:247], v[176:179]
  ds_read_b128 v[240:243], v8 offset:8192
  ds_read_b128 v[244:247], v8 offset:26624
  s_waitcnt lgkmcnt(8)
  v_mfma_f32_16x16x32_bf16 v[172:175], v[44:47], v[248:251], v[172:175]
  v_mfma_f32_16x16x32_bf16 v[176:179], v[44:47], v[252:255], v[176:179]
  ds_read_b128 v[248:251], v8 offset:9216
  ds_read_b128 v[252:255], v8 offset:27648
  s_waitcnt lgkmcnt(8)
  v_mfma_f32_16x16x32_bf16 v[172:175], v[48:51], v[216:219], v[172:175]
  v_mfma_f32_16x16x32_bf16 v[176:179], v[48:51], v[220:223], v[176:179]
  ds_read_b128 v[216:219], v8 offset:10240
  ds_read_b128 v[220:223], v8 offset:28672
  s_waitcnt lgkmcnt(8)
  v_mfma_f32_16x16x32_bf16 v[172:175], v[52:55], v[224:227], v[172:175]
  v_mfma_f32_16x16x32_bf16 v[176:179], v[52:55], v[228:231], v[176:179]
  ds_read_b128 v[224:227], v8 offset:11264
  ds_read_b128 v[228:231], v8 offset:29696
  s_waitcnt lgkmcnt(8)
  v_mfma_f32_16x16x32_bf16 v[172:175], v[56:59], v[232:235], v[172:175]
  v_mfma_f32_16x16x32_bf16 v[176:179], v[56:59], v[236:239], v[176:179]
  ds_read_b128 v[232:235], v8 offset:12288
  ds_read_b128 v[236:239], v8 offset:30720
  s_waitcnt lgkmcnt(8)
  v_mfma_f32_16x16x32_bf16 v[172:175], v[60:63], v[240:243], v[172:175]
  v_mfma_f32_16x16x32_bf16 v[176:179], v[60:63], v[244:247], v[176:179]
  ds_read_b128 v[240:243], v8 offset:13312
  ds_read_b128 v[244:247], v8 offset:31744
  s_waitcnt lgkmcnt(8)
  v_mfma_f32_16x16x32_bf16 v[172:175], v[64:67], v[248:251], v[172:175]
  v_mfma_f32_16x16x32_bf16 v[176:179], v[64:67], v[252:255], v[176:179]
  ds_read_b128 v[248:251], v8 offset:14336
  ds_read_b128 v[252:255], v8 offset:32768
  s_waitcnt lgkmcnt(8)
  v_mfma_f32_16x16x32_bf16 v[172:175], v[68:71], v[216:219], v[172:175]
  v_mfma_f32_16x16x32_bf16 v[176:179], v[68:71], v[220:223], v[176:179]
  ds_read_b128 v[216:219], v8 offset:15360
  ds_read_b128 v[220:223], v8 offset:33792
  s_waitcnt lgkmcnt(8)
  v_mfma_f32_16x16x32_bf16 v[172:175], v[72:75], v[224:227], v[172:175]
  v_mfma_f32_16x16x32_bf16 v[176:179], v[72:75], v[228:231], v[176:179]
  ds_read_b128 v[224:227], v8 offset:16384
  ds_read_b128 v[228:231], v8 offset:34816
  s_waitcnt lgkmcnt(8)
  v_mfma_f32_16x16x32_bf16 v[172:175], v[76:79], v[232:235], v[172:175]
  v_mfma_f32_16x16x32_bf16 v[176:179], v[76:79], v[236:239], v[176:179]
  ds_read_b128 v[232:235], v8 offset:17408
  ds_read_b128 v[236:239], v8 offset:35840
  s_waitcnt lgkmcnt(8)
  v_mfma_f32_16x16x32_bf16 v[172:175], v[80:83], v[240:243], v[172:175]
  v_mfma_f32_16x16x32_bf16 v[176:179], v[80:83], v[244:247], v[176:179]
  ds_read_b64 v[192:193], v6 offset:0
  ds_read_b64 v[194:195], v6 offset:4608
  s_waitcnt lgkmcnt(8)
  v_mfma_f32_16x16x32_bf16 v[172:175], v[84:87], v[248:251], v[172:175]
  v_mfma_f32_16x16x32_bf16 v[176:179], v[84:87], v[252:255], v[176:179]
  s_waitcnt lgkmcnt(6)
  v_mfma_f32_16x16x32_bf16 v[172:175], v[88:91], v[216:219], v[172:175]
  v_mfma_f32_16x16x32_bf16 v[176:179], v[88:91], v[220:223], v[176:179]
  s_waitcnt lgkmcnt(4)
  v_mfma_f32_16x16x32_bf16 v[172:175], v[92:95], v[224:227], v[172:175]
  v_mfma_f32_16x16x32_bf16 v[176:179], v[92:95], v[228:231], v[176:179]
  s_waitcnt lgkmcnt(2)
  v_mfma_f32_16x16x32_bf16 v[172:175], v[96:99], v[232:235], v[172:175]
  v_mfma_f32_16x16x32_bf16 v[176:179], v[96:99], v[236:239], v[176:179]
  s_nop 6
  s_waitcnt lgkmcnt(0)
  v_cvt_pk_bf16_f32 v184, v172, v173
  v_cvt_pk_bf16_f32 v185, v174, v175
  v_lshlrev_b32 v172, 16, v184
  v_and_b32 v173, 0xffff0000, v184
  v_lshlrev_b32 v204, 16, v192
  v_and_b32 v205, 0xffff0000, v192
  v_pk_add_f32 v[172:173], v[172:173], v[204:205]
  v_lshlrev_b32 v174, 16, v185
  v_and_b32 v175, 0xffff0000, v185
  v_lshlrev_b32 v204, 16, v193
  v_and_b32 v205, 0xffff0000, v193
  v_pk_add_f32 v[174:175], v[174:175], v[204:205]
  v_cvt_pk_bf16_f32 v184, v172, v173
  v_cvt_pk_bf16_f32 v185, v174, v175
  v_lshlrev_b32 v172, 16, v184
  v_and_b32 v173, 0xffff0000, v184
  v_lshlrev_b32 v174, 16, v185
  v_and_b32 v175, 0xffff0000, v185
  v_add_f32 v200, v172, v173
  v_mul_f32 v201, v172, v172
  v_fmac_f32 v201, v173, v173
  v_add_f32 v200, v200, v174
  v_fmac_f32 v201, v174, v174
  v_add_f32 v200, v200, v175
  v_fmac_f32 v201, v175, v175
  v_cvt_pk_bf16_f32 v186, v176, v177
  v_cvt_pk_bf16_f32 v187, v178, v179
  v_lshlrev_b32 v176, 16, v186
  v_and_b32 v177, 0xffff0000, v186
  v_lshlrev_b32 v204, 16, v194
  v_and_b32 v205, 0xffff0000, v194
  v_pk_add_f32 v[176:177], v[176:177], v[204:205]
  v_lshlrev_b32 v178, 16, v187
  v_and_b32 v179, 0xffff0000, v187
  v_lshlrev_b32 v204, 16, v195
  v_and_b32 v205, 0xffff0000, v195
  v_pk_add_f32 v[178:179], v[178:179], v[204:205]
  v_cvt_pk_bf16_f32 v186, v176, v177
  v_cvt_pk_bf16_f32 v187, v178, v179
  v_lshlrev_b32 v176, 16, v186
  v_and_b32 v177, 0xffff0000, v186
  v_lshlrev_b32 v178, 16, v187
  v_and_b32 v179, 0xffff0000, v187
  v_add_f32 v202, v176, v177
  v_mul_f32 v203, v176, v176
  v_fmac_f32 v203, v177, v177
  v_add_f32 v202, v202, v178
  v_fmac_f32 v203, v178, v178
  v_add_f32 v202, v202, v179
  v_fmac_f32 v203, v179, v179
  v_permlane32_swap_b32 v184, v186
  v_permlane32_swap_b32 v185, v187
  s_nop 1
  buffer_store_dwordx4 v[184:187], v5, s[4:7], s55 offen sc1
  s_branch .L_s3_j
.L_s3_x:
  s_bitcmp1_b32 s3, 0
  s_cbranch_scc1 .L_s3_x1
  ds_read_b128 v[216:219], v8 offset:0
  ds_read_b128 v[220:223], v8 offset:18432
  ds_read_b128 v[224:227], v8 offset:1024
  ds_read_b128 v[228:231], v8 offset:19456
  ds_read_b128 v[232:235], v8 offset:2048
  ds_read_b128 v[236:239], v8 offset:20480
  ds_read_b128 v[240:243], v8 offset:3072
  ds_read_b128 v[244:247], v8 offset:21504
  ds_read_b128 v[248:251], v8 offset:4096
  ds_read_b128 v[252:255], v8 offset:22528
  s_waitcnt lgkmcnt(8)
  v_mfma_f32_16x16x32_bf16 v[172:175], v[28:31], v[216:219], 0
  v_mfma_f32_16x16x32_bf16 v[176:179], v[28:31], v[220:223], 0
  v_mfma_f32_16x16x32_bf16 v[180:183], v[100:103], v[216:219], 0
  ds_read_b128 v[216:219], v8 offset:5120
  ds_read_b128 v[220:223], v8 offset:23552
  s_waitcnt lgkmcnt(8)
  v_mfma_f32_16x16x32_bf16 v[172:175], v[32:35], v[224:227], v[172:175]
  v_mfma_f32_16x16x32_bf16 v[176:179], v[32:35], v[228:231], v[176:179]
  v_mfma_f32_16x16x32_bf16 v[180:183], v[104:107], v[224:227], v[180:183]
  ds_read_b128 v[224:227], v8 offset:6144
  ds_read_b128 v[228:231], v8 offset:24576
  s_waitcnt lgkmcnt(8)
  v_mfma_f32_16x16x32_bf16 v[172:175], v[36:39], v[232:235], v[172:175]
  v_mfma_f32_16x16x32_bf16 v[176:179], v[36:39], v[236:239], v[176:179]
  v_mfma_f32_16x16x32_bf16 v[180:183], v[108:111], v[232:235], v[180:183]
  ds_read_b128 v[232:235], v8 offset:7168
  ds_read_b128 v[236:239], v8 offset:25600
  s_waitcnt lgkmcnt(8)
  v_mfma_f32_16x16x32_bf16 v[172:175], v[40:43], v[240:243], v[172:175]
  v_mfma_f32_16x16x32_bf16 v[176:179], v[40:43], v[244:247], v[176:179]
  v_mfma_f32_16x16x32_bf16 v[180:183], v[112:115], v[240:243], v[180:183]
  ds_read_b128 v[240:243], v8 offset:8192
  ds_read_b128 v[244:247], v8 offset:26624
  s_waitcnt lgkmcnt(8)
  v_mfma_f32_16x16x32_bf16 v[172:175], v[44:47], v[248:251], v[172:175]
  v_mfma_f32_16x16x32_bf16 v[176:179], v[44:47], v[252:255], v[176:179]
  v_mfma_f32_16x16x32_bf16 v[180:183], v[116:119], v[248:251], v[180:183]
  ds_read_b128 v[248:251], v8 offset:9216
  ds_read_b128 v[252:255], v8 offset:27648
  s_waitcnt lgkmcnt(8)
  v_mfma_f32_16x16x32_bf16 v[172:175], v[48:51], v[216:219], v[172:175]
  v_mfma_f32_16x16x32_bf16 v[176:179], v[48:51], v[220:223], v[176:179]
  v_mfma_f32_16x16x32_bf16 v[180:183], v[120:123], v[216:219], v[180:183]
  ds_read_b128 v[216:219], v8 offset:10240
  ds_read_b128 v[220:223], v8 offset:28672
  s_waitcnt lgkmcnt(8)
  v_mfma_f32_16x16x32_bf16 v[172:175], v[52:55], v[224:227], v[172:175]
  v_mfma_f32_16x16x32_bf16 v[176:179], v[52:55], v[228:231], v[176:179]
  v_mfma_f32_16x16x32_bf16 v[180:183], v[124:127], v[224:227], v[180:183]
  ds_read_b128 v[224:227], v8 offset:11264
  ds_read_b128 v[228:231], v8 offset:29696
  s_waitcnt lgkmcnt(8)
  v_mfma_f32_16x16x32_bf16 v[172:175], v[56:59], v[232:235], v[172:175]
  v_mfma_f32_16x16x32_bf16 v[176:179], v[56:59], v[236:239], v[176:179]
  v_mfma_f32_16x16x32_bf16 v[180:183], v[128:131], v[232:235], v[180:183]
  ds_read_b128 v[232:235], v8 offset:12288
  ds_read_b128 v[236:239], v8 offset:30720
  s_waitcnt lgkmcnt(8)
  v_mfma_f32_16x16x32_bf16 v[172:175], v[60:63], v[240:243], v[172:175]
  v_mfma_f32_16x16x32_bf16 v[176:179], v[60:63], v[244:247], v[176:179]
  v_mfma_f32_16x16x32_bf16 v[180:183], v[132:135], v[240:243], v[180:183]
  ds_read_b128 v[240:243], v8 offset:13312
  ds_read_b128 v[244:247], v8 offset:31744
  s_waitcnt lgkmcnt(8)
  v_mfma_f32_16x16x32_bf16 v[172:175], v[64:67], v[248:251], v[172:175]
  v_mfma_f32_16x16x32_bf16 v[176:179], v[64:67], v[252:255], v[176:179]
  v_mfma_f32_16x16x32_bf16 v[180:183], v[136:139], v[248:251], v[180:183]
  ds_read_b128 v[248:251], v8 offset:14336
  ds_read_b128 v[252:255], v8 offset:32768
  s_waitcnt lgkmcnt(8)
  v_mfma_f32_16x16x32_bf16 v[172:175], v[68:71], v[216:219], v[172:175]
  v_mfma_f32_16x16x32_bf16 v[176:179], v[68:71], v[220:223], v[176:179]
  v_mfma_f32_16x16x32_bf16 v[180:183], v[140:143], v[216:219], v[180:183]
  ds_read_b128 v[216:219], v8 offset:15360
  ds_read_b128 v[220:223], v8 offset:33792
  s_waitcnt lgkmcnt(8)
  v_mfma_f32_16x16x32_bf16 v[172:175], v[72:75], v[224:227], v[172:175]
  v_mfma_f32_16x16x32_bf16 v[176:179], v[72:75], v[228:231], v[176:179]
  v_mfma_f32_16x16x32_bf16 v[180:183], v[144:147], v[224:227], v[180:183]
  ds_read_b128 v[224:227], v8 offset:16384
  ds_read_b128 v[228:231], v8 offset:34816
  s_waitcnt lgkmcnt(8)
  v_mfma_f32_16x16x32_bf16 v[172:175], v[76:79], v[232:235], v[172:175]
  v_mfma_f32_16x16x32_bf16 v[176:179], v[76:79], v[236:239], v[176:179]
  v_mfma_f32_16x16x32_bf16 v[180:183], v[148:151], v[232:235], v[180:183]
  ds_read_b128 v[232:235], v8 offset:17408
  ds_read_b128 v[236:239], v8 offset:35840
  s_waitcnt lgkmcnt(8)
  v_mfma_f32_16x16x32_bf16 v[172:175], v[80:83], v[240:243], v[172:175]
  v_mfma_f32_16x16x32_bf16 v[176:179], v[80:83], v[244:247], v[176:179]
  v_mfma_f32_16x16x32_bf16 v[180:183], v[152:155], v[240:243], v[180:183]
  ds_read_b64 v[192:193], v6 offset:0
  ds_read_b64 v[194:195], v6 offset:4608
  ds_read_b64 v[196:197], v7 offset:256
  s_waitcnt lgkmcnt(9)
  v_mfma_f32_16x16x32_bf16 v[172:175], v[84:87], v[248:251], v[172:175]
  v_mfma_f32_16x16x32_bf16 v[176:179], v[84:87], v[252:255], v[176:179]
  v_mfma_f32_16x16x32_bf16 v[180:183], v[156:159], v[248:251], v[180:183]
  s_waitcnt lgkmcnt(7)
  v_mfma_f32_16x16x32_bf16 v[172:175], v[88:91], v[216:219], v[172:175]
  v_mfma_f32_16x16x32_bf16 v[176:179], v[88:91], v[220:223], v[176:179]
  v_mfma_f32_16x16x32_bf16 v[180:183], v[160:163], v[216:219], v[180:183]
  s_waitcnt lgkmcnt(5)
  v_mfma_f32_16x16x32_bf16 v[172:175], v[92:95], v[224:227], v[172:175]
  v_mfma_f32_16x16x32_bf16 v[176:179], v[92:95], v[228:231], v[176:179]
  v_mfma_f32_16x16x32_bf16 v[180:183], v[164:167], v[224:227], v[180:183]
  s_waitcnt lgkmcnt(3)
  v_mfma_f32_16x16x32_bf16 v[172:175], v[96:99], v[232:235], v[172:175]
  v_mfma_f32_16x16x32_bf16 v[176:179], v[96:99], v[236:239], v[176:179]
  v_mfma_f32_16x16x32_bf16 v[180:183], v[168:171], v[232:235], v[180:183]
  s_nop 6
  s_waitcnt lgkmcnt(0)
  v_cvt_pk_bf16_f32 v184, v172, v173
  v_cvt_pk_bf16_f32 v185, v174, v175
  v_lshlrev_b32 v172, 16, v184
  v_and_b32 v173, 0xffff0000, v184
  v_lshlrev_b32 v204, 16, v192
  v_and_b32 v205, 0xffff0000, v192
  v_pk_add_f32 v[172:173], v[172:173], v[204:205]
  v_lshlrev_b32 v174, 16, v185
  v_and_b32 v175, 0xffff0000, v185
  v_lshlrev_b32 v204, 16, v193
  v_and_b32 v205, 0xffff0000, v193
  v_pk_add_f32 v[174:175], v[174:175], v[204:205]
  v_cvt_pk_bf16_f32 v184, v172, v173
  v_cvt_pk_bf16_f32 v185, v174, v175
  v_lshlrev_b32 v172, 16, v184
  v_and_b32 v173, 0xffff0000, v184
  v_lshlrev_b32 v174, 16, v185
  v_and_b32 v175, 0xffff0000, v185
  v_add_f32 v200, v172, v173
  v_mul_f32 v201, v172, v172
  v_fmac_f32 v201, v173, v173
  v_add_f32 v200, v200, v174
  v_fmac_f32 v201, v174, v174
  v_add_f32 v200, v200, v175
  v_fmac_f32 v201, v175, v175
  v_cvt_pk_bf16_f32 v186, v176, v177
  v_cvt_pk_bf16_f32 v187, v178, v179
  v_lshlrev_b32 v176, 16, v186
  v_and_b32 v177, 0xffff0000, v186
  v_lshlrev_b32 v204, 16, v194
  v_and_b32 v205, 0xffff0000, v194
  v_pk_add_f32 v[176:177], v[176:177], v[204:205]
  v_lshlrev_b32 v178, 16, v187
  v_and_b32 v179, 0xffff0000, v187
  v_lshlrev_b32 v204, 16, v195
  v_and_b32 v205, 0xffff0000, v195
  v_pk_add_f32 v[178:179], v[178:179], v[204:205]
  v_cvt_pk_bf16_f32 v186, v176, v177
  v_cvt_pk_bf16_f32 v187, v178, v179
  v_lshlrev_b32 v176, 16, v186
  v_and_b32 v177, 0xffff0000, v186
  v_lshlrev_b32 v178, 16, v187
  v_and_b32 v179, 0xffff0000, v187
  v_add_f32 v202, v176, v177
  v_mul_f32 v203, v176, v176
  v_fmac_f32 v203, v177, v177
  v_add_f32 v202, v202, v178
  v_fmac_f32 v203, v178, v178
  v_add_f32 v202, v202, v179
  v_fmac_f32 v203, v179, v179
  v_permlane32_swap_b32 v184, v186
  v_permlane32_swap_b32 v185, v187
  s_nop 1
  buffer_store_dwordx4 v[184:187], v5, s[4:7], s55 offen sc1
  s_cmp_lt_u32 s3, 2
  s_cbranch_scc1 .Lm_44
  v_add_f32 v180, v180, v181
  v_add_f32 v180, v180, v198
  v_mul_f32 v180, 0x3ae38e39, v180
  v_cvt_pk_bf16_f32 v180, v180, v180
  v_lshlrev_b32 v180, 16, v180
  v_lshlrev_b32 v188, 2, v2
  v_add_u32 v188, 142336, v188
  s_mov_b64 exec, 0xffff
  ds_write_b32 v188, v180
  s_mov_b64 exec, -1
  s_branch .L_s3_j
.Lm_44:
  v_cvt_pk_bf16_f32 v188, v180, v181
  v_cvt_pk_bf16_f32 v189, v182, v183
  v_lshlrev_b32 v180, 16, v188
  v_and_b32 v181, 0xffff0000, v188
  v_lshlrev_b32 v204, 16, v196
  v_and_b32 v205, 0xffff0000, v196
  v_pk_add_f32 v[180:181], v[180:181], v[204:205]
  v_lshlrev_b32 v182, 16, v189
  v_and_b32 v183, 0xffff0000, v189
  v_lshlrev_b32 v204, 16, v197
  v_and_b32 v205, 0xffff0000, v197
  v_pk_add_f32 v[182:183], v[182:183], v[204:205]
  v_cvt_pk_bf16_f32 v188, v180, v181
  v_cvt_pk_bf16_f32 v189, v182, v183
  v_lshlrev_b32 v180, 16, v188
  v_and_b32 v181, 0xffff0000, v188
  v_lshlrev_b32 v182, 16, v189
  v_and_b32 v183, 0xffff0000, v189
  v_mov_b32 v190, v188
  v_mov_b32 v191, v189
  v_add_f32 v200, v200, v180
  v_fmac_f32 v201, v180, v180
  v_add_f32 v200, v200, v181
  v_fmac_f32 v201, v181, v181
  v_add_f32 v200, v200, v182
  v_fmac_f32 v201, v182, v182
  v_add_f32 v200, v200, v183
  v_fmac_f32 v201, v183, v183
  v_permlane32_swap_b32 v188, v190
  v_permlane32_swap_b32 v189, v191
  s_mov_b32 exec_hi, 0
  s_nop 0
  buffer_store_dwordx4 v[188:191], v1, s[4:7], s56 offen sc1
  s_mov_b32 exec_hi, -1
  s_branch .L_s3_j
.L_s3_x1:
  ds_read_b128 v[216:219], v8 offset:0
  ds_read_b128 v[220:223], v8 offset:18432
  ds_read_b128 v[224:227], v8 offset:1024
  ds_read_b128 v[228:231], v8 offset:19456
  ds_read_b128 v[232:235], v8 offset:2048
  ds_read_b128 v[236:239], v8 offset:20480
  ds_read_b128 v[240:243], v8 offset:3072
  ds_read_b128 v[244:247], v8 offset:21504
  ds_read_b128 v[248:251], v8 offset:4096
  ds_read_b128 v[252:255], v8 offset:22528
  s_waitcnt lgkmcnt(8)
  v_mfma_f32_16x16x32_bf16 v[172:175], v[28:31], v[216:219], 0
  v_mfma_f32_16x16x32_bf16 v[176:179], v[28:31], v[220:223], 0
  v_mfma_f32_16x16x32_bf16 v[180:183], v[100:103], v[220:223], 0
  ds_read_b128 v[216:219], v8 offset:5120
  ds_read_b128 v[220:223], v8 offset:23552
  s_waitcnt lgkmcnt(8)
  v_mfma_f32_16x16x32_bf16 v[172:175], v[32:35], v[224:227], v[172:175]
  v_mfma_f32_16x16x32_bf16 v[176:179], v[32:35], v[228:231], v[176:179]
  v_mfma_f32_16x16x32_bf16 v[180:183], v[104:107], v[228:231], v[180:183]
  ds_read_b128 v[224:227], v8 offset:6144
  ds_read_b128 v[228:231], v8 offset:24576
  s_waitcnt lgkmcnt(8)
  v_mfma_f32_16x16x32_bf16 v[172:175], v[36:39], v[232:235], v[172:175]
  v_mfma_f32_16x16x32_bf16 v[176:179], v[36:39], v[236:239], v[176:179]
  v_mfma_f32_16x16x32_bf16 v[180:183], v[108:111], v[236:239], v[180:183]
  ds_read_b128 v[232:235], v8 offset:7168
  ds_read_b128 v[236:239], v8 offset:25600
  s_waitcnt lgkmcnt(8)
  v_mfma_f32_16x16x32_bf16 v[172:175], v[40:43], v[240:243], v[172:175]
  v_mfma_f32_16x16x32_bf16 v[176:179], v[40:43], v[244:247], v[176:179]
  v_mfma_f32_16x16x32_bf16 v[180:183], v[112:115], v[244:247], v[180:183]
  ds_read_b128 v[240:243], v8 offset:8192
  ds_read_b128 v[244:247], v8 offset:26624
  s_waitcnt lgkmcnt(8)
  v_mfma_f32_16x16x32_bf16 v[172:175], v[44:47], v[248:251], v[172:175]
  v_mfma_f32_16x16x32_bf16 v[176:179], v[44:47], v[252:255], v[176:179]
  v_mfma_f32_16x16x32_bf16 v[180:183], v[116:119], v[252:255], v[180:183]
  ds_read_b128 v[248:251], v8 offset:9216
  ds_read_b128 v[252:255], v8 offset:27648
  s_waitcnt lgkmcnt(8)
  v_mfma_f32_16x16x32_bf16 v[172:175], v[48:51], v[216:219], v[172:175]
  v_mfma_f32_16x16x32_bf16 v[176:179], v[48:51], v[220:223], v[176:179]
  v_mfma_f32_16x16x32_bf16 v[180:183], v[120:123], v[220:223], v[180:183]
  ds_read_b128 v[216:219], v8 offset:10240
  ds_read_b128 v[220:223], v8 offset:28672
  s_waitcnt lgkmcnt(8)
  v_mfma_f32_16x16x32_bf16 v[172:175], v[52:55], v[224:227], v[172:175]
  v_mfma_f32_16x16x32_bf16 v[176:179], v[52:55], v[228:231], v[176:179]
  v_mfma_f32_16x16x32_bf16 v[180:183], v[124:127], v[228:231], v[180:183]
  ds_read_b128 v[224:227], v8 offset:11264
  ds_read_b128 v[228:231], v8 offset:29696
  s_waitcnt lgkmcnt(8)
  v_mfma_f32_16x16x32_bf16 v[172:175], v[56:59], v[232:235], v[172:175]
  v_mfma_f32_16x16x32_bf16 v[176:179], v[56:59], v[236:239], v[176:179]
  v_mfma_f32_16x16x32_bf16 v[180:183], v[128:131], v[236:239], v[180:183]
  ds_read_b128 v[232:235], v8 offset:12288
  ds_read_b128 v[236:239], v8 offset:30720
  s_waitcnt lgkmcnt(8)
  v_mfma_f32_16x16x32_bf16 v[172:175], v[60:63], v[240:243], v[172:175]
  v_mfma_f32_16x16x32_bf16 v[176:179], v[60:63], v[244:247], v[176:179]
  v_mfma_f32_16x16x32_bf16 v[180:183], v[132:135], v[244:247], v[180:183]
  ds_read_b128 v[240:243], v8 offset:13312
  ds_read_b128 v[244:247], v8 offset:31744
  s_waitcnt lgkmcnt(8)
  v_mfma_f32_16x16x32_bf16 v[172:175], v[64:67], v[248:251], v[172:175]
  v_mfma_f32_16x16x32_bf16 v[176:179], v[64:67], v[252:255], v[176:179]
  v_mfma_f32_16x16x32_bf16 v[180:183], v[136:139], v[252:255], v[180:183]
  ds_read_b128 v[248:251], v8 offset:14336
  ds_read_b128 v[252:255], v8 offset:32768
  s_waitcnt lgkmcnt(8)
  v_mfma_f32_16x16x32_bf16 v[172:175], v[68:71], v[216:219], v[172:175]
  v_mfma_f32_16x16x32_bf16 v[176:179], v[68:71], v[220:223], v[176:179]
  v_mfma_f32_16x16x32_bf16 v[180:183], v[140:143], v[220:223], v[180:183]
  ds_read_b128 v[216:219], v8 offset:15360
  ds_read_b128 v[220:223], v8 offset:33792
  s_waitcnt lgkmcnt(8)
  v_mfma_f32_16x16x32_bf16 v[172:175], v[72:75], v[224:227], v[172:175]
  v_mfma_f32_16x16x32_bf16 v[176:179], v[72:75], v[228:231], v[176:179]
  v_mfma_f32_16x16x32_bf16 v[180:183], v[144:147], v[228:231], v[180:183]
  ds_read_b128 v[224:227], v8 offset:16384
  ds_read_b128 v[228:231], v8 offset:34816
  s_waitcnt lgkmcnt(8)
  v_mfma_f32_16x16x32_bf16 v[172:175], v[76:79], v[232:235], v[172:175]
  v_mfma_f32_16x16x32_bf16 v[176:179], v[76:79], v[236:239], v[176:179]
  v_mfma_f32_16x16x32_bf16 v[180:183], v[148:151], v[236:239], v[180:183]
  ds_read_b128 v[232:235], v8 offset:17408
  ds_read_b128 v[236:239], v8 offset:35840
  s_waitcnt lgkmcnt(8)
  v_mfma_f32_16x16x32_bf16 v[172:175], v[80:83], v[240:243], v[172:175]
  v_mfma_f32_16x16x32_bf16 v[176:179], v[80:83], v[244:247], v[176:179]
  v_mfma_f32_16x16x32_bf16 v[180:183], v[152:155], v[244:247], v[180:183]
  ds_read_b64 v[192:193], v6 offset:0
  ds_read_b64 v[194:195], v6 offset:4608
  ds_read_b64 v[196:197], v7 offset:256
  s_waitcnt lgkmcnt(9)
  v_mfma_f32_16x16x32_bf16 v[172:175], v[84:87], v[248:251], v[172:175]
  v_mfma_f32_16x16x32_bf16 v[176:179], v[84:87], v[252:255], v[176:179]
  v_mfma_f32_16x16x32_bf16 v[180:183], v[156:159], v[252:255], v[180:183]
  s_waitcnt lgkmcnt(7)
  v_mfma_f32_16x16x32_bf16 v[172:175], v[88:91], v[216:219], v[172:175]
  v_mfma_f32_16x16x32_bf16 v[176:179], v[88:91], v[220:223], v[176:179]
  v_mfma_f32_16x16x32_bf16 v[180:183], v[160:163], v[220:223], v[180:183]
  s_waitcnt lgkmcnt(5)
  v_mfma_f32_16x16x32_bf16 v[172:175], v[92:95], v[224:227], v[172:175]
  v_mfma_f32_16x16x32_bf16 v[176:179], v[92:95], v[228:231], v[176:179]
  v_mfma_f32_16x16x32_bf16 v[180:183], v[164:167], v[228:231], v[180:183]
  s_waitcnt lgkmcnt(3)
  v_mfma_f32_16x16x32_bf16 v[172:175], v[96:99], v[232:235], v[172:175]
  v_mfma_f32_16x16x32_bf16 v[176:179], v[96:99], v[236:239], v[176:179]
  v_mfma_f32_16x16x32_bf16 v[180:183], v[168:171], v[236:239], v[180:183]
  s_nop 6
  s_waitcnt lgkmcnt(0)
  v_cvt_pk_bf16_f32 v184, v172, v173
  v_cvt_pk_bf16_f32 v185, v174, v175
  v_lshlrev_b32 v172, 16, v184
  v_and_b32 v173, 0xffff0000, v184
  v_lshlrev_b32 v204, 16, v192
  v_and_b32 v205, 0xffff0000, v192
  v_pk_add_f32 v[172:173], v[172:173], v[204:205]
  v_lshlrev_b32 v174, 16, v185
  v_and_b32 v175, 0xffff0000, v185
  v_lshlrev_b32 v204, 16, v193
  v_and_b32 v205, 0xffff0000, v193
  v_pk_add_f32 v[174:175], v[174:175], v[204:205]
  v_cvt_pk_bf16_f32 v184, v172, v173
  v_cvt_pk_bf16_f32 v185, v174, v175
  v_lshlrev_b32 v172, 16, v184
  v_and_b32 v173, 0xffff0000, v184
  v_lshlrev_b32 v174, 16, v185
  v_and_b32 v175, 0xffff0000, v185
  v_add_f32 v200, v172, v173
  v_mul_f32 v201, v172, v172
  v_fmac_f32 v201, v173, v173
  v_add_f32 v200, v200, v174
  v_fmac_f32 v201, v174, v174
  v_add_f32 v200, v200, v175
  v_fmac_f32 v201, v175, v175
  v_cvt_pk_bf16_f32 v186, v176, v177
  v_cvt_pk_bf16_f32 v187, v178, v179
  v_lshlrev_b32 v176, 16, v186
  v_and_b32 v177, 0xffff0000, v186
  v_lshlrev_b32 v204, 16, v194
  v_and_b32 v205, 0xffff0000, v194
  v_pk_add_f32 v[176:177], v[176:177], v[204:205]
  v_lshlrev_b32 v178, 16, v187
  v_and_b32 v179, 0xffff0000, v187
  v_lshlrev_b32 v204, 16, v195
  v_and_b32 v205, 0xffff0000, v195
  v_pk_add_f32 v[178:179], v[178:179], v[204:205]
  v_cvt_pk_bf16_f32 v186, v176, v177
  v_cvt_pk_bf16_f32 v187, v178, v179
  v_lshlrev_b32 v176, 16, v186
  v_and_b32 v177, 0xffff0000, v186
  v_lshlrev_b32 v178, 16, v187
  v_and_b32 v179, 0xffff0000, v187
  v_add_f32 v202, v176, v177
  v_mul_f32 v203, v176, v176
  v_fmac_f32 v203, v177, v177
  v_add_f32 v202, v202, v178
  v_fmac_f32 v203, v178, v178
  v_add_f32 v202, v202, v179
  v_fmac_f32 v203, v179, v179
  v_permlane32_swap_b32 v184, v186
  v_permlane32_swap_b32 v185, v187
  s_nop 1
  buffer_store_dwordx4 v[184:187], v5, s[4:7], s55 offen sc1
  s_cmp_lt_u32 s3, 2
  s_cbranch_scc1 .Lm_45
  v_add_f32 v180, v180, v181
  v_add_f32 v180, v180, v198
  v_mul_f32 v180, 0x3ae38e39, v180
  v_cvt_pk_bf16_f32 v180, v180, v180
  v_lshlrev_b32 v180, 16, v180
  v_lshlrev_b32 v188, 2, v2
  v_add_u32 v188, 142400, v188
  s_mov_b64 exec, 0xffff
  ds_write_b32 v188, v180
  s_mov_b64 exec, -1
  s_branch .L_s3_j
.Lm_45:
  v_cvt_pk_bf16_f32 v188, v180, v181
  v_cvt_pk_bf16_f32 v189, v182, v183
  v_lshlrev_b32 v180, 16, v188
  v_and_b32 v181, 0xffff0000, v188
  v_lshlrev_b32 v204, 16, v196
  v_and_b32 v205, 0xffff0000, v196
  v_pk_add_f32 v[180:181], v[180:181], v[204:205]
  v_lshlrev_b32 v182, 16, v189
  v_and_b32 v183, 0xffff0000, v189
  v_lshlrev_b32 v204, 16, v197
  v_and_b32 v205, 0xffff0000, v197
  v_pk_add_f32 v[182:183], v[182:183], v[204:205]
  v_cvt_pk_bf16_f32 v188, v180, v181
  v_cvt_pk_bf16_f32 v189, v182, v183
  v_lshlrev_b32 v180, 16, v188
  v_and_b32 v181, 0xffff0000, v188
  v_lshlrev_b32 v182, 16, v189
  v_and_b32 v183, 0xffff0000, v189
  v_mov_b32 v190, v188
  v_mov_b32 v191, v189
  v_add_f32 v202, v202, v180
  v_fmac_f32 v203, v180, v180
  v_add_f32 v202, v202, v181
  v_fmac_f32 v203, v181, v181
  v_add_f32 v202, v202, v182
  v_fmac_f32 v203, v182, v182
  v_add_f32 v202, v202, v183
  v_fmac_f32 v203, v183, v183
  v_permlane32_swap_b32 v188, v190
  v_permlane32_swap_b32 v189, v191
  s_mov_b32 exec_hi, 0
  s_nop 0
  buffer_store_dwordx4 v[188:191], v1, s[4:7], s56 offen sc1
  s_mov_b32 exec_hi, -1
.L_s3_j:
  v_mov_b32 v192, v200
  v_mov_b32 v193, v201
  v_mov_b32 v194, v202
  v_mov_b32 v195, v203
  s_nop 1
  v_permlane32_swap_b32 v200, v192
  v_permlane32_swap_b32 v201, v193
  v_permlane32_swap_b32 v202, v194
  v_permlane32_swap_b32 v203, v195
  s_nop 1
  v_add_f32 v200, v200, v192
  v_add_f32 v201, v201, v193
  v_add_f32 v202, v202, v194
  v_add_f32 v203, v203, v195
  v_mov_b32 v192, v200
  v_mov_b32 v193, v201
  v_mov_b32 v194, v202
  v_mov_b32 v195, v203
  s_nop 1
  v_permlane16_swap_b32 v200, v192
  v_permlane16_swap_b32 v201, v193
  v_permlane16_swap_b32 v202, v194
  v_permlane16_swap_b32 v203, v195
  s_nop 1
  v_add_f32 v200, v200, v192
  v_add_f32 v201, v201, v193
  v_add_f32 v202, v202, v194
  v_add_f32 v203, v203, v195
  s_lshl_b32 s48, s3, 8
  s_add_u32 s48, s48, 140288
  v_lshlrev_b32 v4, 3, v2
  v_add_u32 v4, s48, v4
  s_mov_b64 exec, 0xffff
  ds_write_b64 v4, v[200:201] offset:0
  ds_write_b64 v4, v[202:203] offset:128
  s_mov_b64 exec, -1
  v_lshlrev_b32 v4, 2, v2
  v_add_u32 v4, 142336, v4
  s_add_u32 s55, s55, 2359296
  s_add_u32 s56, s56, 2359296
  s_waitcnt lgkmcnt(0)
  s_barrier
  ds_read_b32 v192, v4 offset:0
  ds_read_b32 v194, v4 offset:64
  s_bitcmp1_b32 s3, 0
  s_cselect_b64 vcc, -1, 0
  s_waitcnt lgkmcnt(0)
  v_cndmask_b32 v196, v192, v194, vcc
  v_pk_add_f32 v[172:173], v[172:173], v[192:193] op_sel_hi:[1,0] neg_lo:[0,1] neg_hi:[0,1]
  v_pk_add_f32 v[174:175], v[174:175], v[192:193] op_sel_hi:[1,0] neg_lo:[0,1] neg_hi:[0,1]
  v_pk_add_f32 v[176:177], v[176:177], v[194:195] op_sel_hi:[1,0] neg_lo:[0,1] neg_hi:[0,1]
  v_pk_add_f32 v[178:179], v[178:179], v[194:195] op_sel_hi:[1,0] neg_lo:[0,1] neg_hi:[0,1]
  v_pk_add_f32 v[180:181], v[180:181], v[196:197] op_sel_hi:[1,0] neg_lo:[0,1] neg_hi:[0,1]
  v_pk_add_f32 v[182:183], v[182:183], v[196:197] op_sel_hi:[1,0] neg_lo:[0,1] neg_hi:[0,1]
  v_cvt_pk_bf16_f32 v184, v172, v173
  v_cvt_pk_bf16_f32 v185, v174, v175
  v_cvt_pk_bf16_f32 v186, v176, v177
  v_cvt_pk_bf16_f32 v187, v178, v179
  v_cvt_pk_bf16_f32 v188, v180, v181
  v_cvt_pk_bf16_f32 v189, v182, v183
  v_mov_b32 v190, v188
  v_mov_b32 v191, v189
  v_permlane32_swap_b32 v184, v186
  v_permlane32_swap_b32 v185, v187
  v_permlane32_swap_b32 v188, v190
  v_permlane32_swap_b32 v189, v191
  buffer_store_dwordx4 v[184:187], v5, s[4:7], s55 offen sc1
  s_cmp_ge_u32 s3, 2
  s_cbranch_scc1 .Lm_46
  s_mov_b32 exec_hi, 0
  buffer_store_dwordx4 v[188:191], v1, s[4:7], s56 offen sc1
  s_mov_b32 exec_hi, -1
.Lm_46:
  s_cmp_lg_u32 s3, 7
  s_cbranch_scc1 .Lm_47
  v_lshlrev_b32 v4, 2, v0
  v_add_u32 v6, 140288, v4
  ds_read_b32 v28, v6 offset:0
  ds_read_b32 v29, v6 offset:256
  ds_read_b32 v30, v6 offset:512
  ds_read_b32 v31, v6 offset:768
  ds_read_b32 v32, v6 offset:1024
  ds_read_b32 v33, v6 offset:1280
  ds_read_b32 v34, v6 offset:1536
  ds_read_b32 v35, v6 offset:1792
  s_lshl_b32 s48, s41, 14
  s_lshl_b32 s49, s52, 8
  s_add_u32 s48, s48, s49
  s_add_u32 s48, s48, 204800
  s_waitcnt lgkmcnt(0)
  v_add_f32 v28, v28, v32
  v_add_f32 v29, v29, v33
  v_add_f32 v30, v30, v34
  v_add_f32 v31, v31, v35
  v_add_f32 v28, v28, v30
  v_add_f32 v29, v29, v31
  v_add_f32 v28, v28, v29
  buffer_store_dword v28, v4, s[4:7], s48 offen sc1
.Lm_47:
  s_waitcnt vmcnt(0) lgkmcnt(0)
  s_barrier
  s_cmp_lg_u32 s3, 7
  s_cbranch_scc1 .Lm_48
  s_mul_i32 s44, s40, 139264
  s_lshl_b32 s45, s43, 2
  s_add_u32 s44, s44, s45
  s_add_u32 s44, s44, 1048576
  s_add_u32 s45, s101, 3
  v_mov_b32 v2, s45
  v_mul_u32_u24 v3, 4352, v0
  s_mov_b32 exec_lo, -1
  s_mov_b32 exec_hi, 0
  buffer_store_dword v2, v3, s[4:7], s44 offen sc1
  s_mov_b64 exec, -1
.Lm_48:
  s_and_b32 s44, s3, 3
  s_mul_i32 s44, s44, 442368
  s_mul_i32 s45, s43, 288
  s_add_u32 s44, s44, s45
  v_add_u32 v12, 0, v0
  v_mul_u32_u24 v13, 10923, v12
  v_lshrrev_b32 v13, 16, v13
  v_mul_u32_u24 v13, 9120, v13
  v_lshl_add_u32 v2, v12, 4, v13
  v_add_u32 v2, s44, v2
  v_add_u32 v12, 64, v0
  v_mul_u32_u24 v13, 10923, v12
  v_lshrrev_b32 v13, 16, v13
  v_mul_u32_u24 v13, 9120, v13
  v_lshl_add_u32 v3, v12, 4, v13
  v_add_u32 v3, s44, v3
  v_subrev_u32 v3, 1024, v3
  v_add_u32 v12, 128, v0
  v_mul_u32_u24 v13, 10923, v12
  v_lshrrev_b32 v13, 16, v13
  v_mul_u32_u24 v13, 9120, v13
  v_lshl_add_u32 v4, v12, 4, v13
  v_add_u32 v4, s44, v4
  v_subrev_u32 v4, 2048, v4
  v_add_u32 v12, 192, v0
  v_mul_u32_u24 v13, 10923, v12
  v_lshrrev_b32 v13, 16, v13
  v_mul_u32_u24 v13, 9120, v13
  v_lshl_add_u32 v5, v12, 4, v13
  v_add_u32 v5, s44, v5
  v_subrev_u32 v5, 3072, v5
  v_add_u32 v12, 256, v0
  v_mul_u32_u24 v13, 10923, v12
  v_lshrrev_b32 v13, 16, v13
  v_mul_u32_u24 v13, 9120, v13
  v_lshl_add_u32 v6, v12, 4, v13
  v_add_u32 v6, s44, v6
  s_cmp_eq_u32 s3, 7
  s_cbranch_scc1 .Lm_49
  s_mul_i32 s44, s3, 4608
  s_add_u32 m0, s44, 73728
  s_bitcmp1_b32 s43, 0
  s_cselect_b32 s44, 192, 0
  s_add_u32 s44, s44, 3538944
  buffer_load_dwordx4 v2, s[12:15], s44 offen offset:0 lds
  s_bitcmp1_b32 s43, 0
  s_cselect_b32 s44, 192, 0
  s_add_u32 s44, s44, 3538944
  buffer_load_dwordx4 v3, s[12:15], s44 offen offset:1024 lds
  s_bitcmp1_b32 s43, 0
  s_cselect_b32 s44, 192, 0
  s_add_u32 s44, s44, 3538944
  buffer_load_dwordx4 v4, s[12:15], s44 offen offset:2048 lds
  s_bitcmp1_b32 s43, 0
  s_cselect_b32 s44, 192, 0
  s_add_u32 s44, s44, 3538944
  buffer_load_dwordx4 v5, s[12:15], s44 offen offset:3072 lds
  s_mul_i32 s44, s3, 4608
  s_add_u32 m0, s44, 77824
  s_bitcmp1_b32 s43, 0
  s_cselect_b32 s44, 192, 0
  s_add_u32 s44, s44, 3538944
  s_mov_b32 exec_hi, 0
  buffer_load_dwordx4 v6, s[12:15], s44 offen offset:0 lds
  s_mov_b32 exec_hi, -1
  s_mul_i32 s44, s3, 4608
  s_add_u32 m0, s44, 110592
  s_mov_b32 s44, 96
  buffer_load_dwordx4 v2, s[12:15], s44 offen offset:0 lds
  s_mov_b32 s44, 96
  buffer_load_dwordx4 v3, s[12:15], s44 offen offset:1024 lds
  s_mov_b32 s44, 96
  buffer_load_dwordx4 v4, s[12:15], s44 offen offset:2048 lds
  s_mov_b32 s44, 96
  buffer_load_dwordx4 v5, s[12:15], s44 offen offset:3072 lds
  s_mul_i32 s44, s3, 4608
  s_add_u32 m0, s44, 114688
  s_mov_b32 s44, 96
  s_mov_b32 exec_hi, 0
  buffer_load_dwordx4 v6, s[12:15], s44 offen offset:0 lds
  s_mov_b32 exec_hi, -1
.Lm_49:
  v_bfe_u32 v12, v0, 5, 1
  v_lshlrev_b32 v12, 4, v12
  v_bfe_u32 v13, v0, 2, 3
  v_add_u32 v12, v12, v13
  v_mul_u32_u24 v12, 96, v12
  v_and_b32 v13, 3, v0
  v_lshl_add_u32 v7, v13, 3, v12
  v_add_u32 v8, 36864, v7
  v_add_u32 v9, 73728, v7
  v_add_u32 v10, 110592, v7
  s_lshl_b32 s45, s40, 4
  s_lshl_b32 s46, s3, 1
  s_add_u32 s45, s45, s46
  s_mul_i32 s54, s45, 147456
  s_mul_i32 s46, s43, 4608
  s_add_u32 s54, s54, s46
  s_add_u32 s54, s54, 26378240
  s_mul_i32 s55, s45, 18432
  s_add_u32 s55, s55, 14581760
  s_lshl_b32 s53, s45, 7
  s_add_u32 s53, s53, 204800
  v_and_b32 v12, 15, v0
  v_lshrrev_b32 v13, 4, v0
  v_lshlrev_b32 v13, 14, v13
  v_lshl_add_u32 v14, v12, 3, v13
  v_lshrrev_b32 v15, 5, v0
  v_mul_u32_u24 v15, 146944, v15
  v_add_u32 v11, v15, v1
  s_lshl_b32 s56, s40, 1
  s_and_b32 s44, s42, 1
  s_add_u32 s56, s56, s44
  s_lshr_b32 s57, s42, 1
  ds_read_b64_tr_b16 v[216:217], v7 offset:0
  ds_read_b64_tr_b16 v[218:219], v7 offset:768
  ds_read_b64_tr_b16 v[220:221], v7 offset:18432
  ds_read_b64_tr_b16 v[222:223], v7 offset:19200
  ds_read_b64_tr_b16 v[224:225], v7 offset:32
  ds_read_b64_tr_b16 v[226:227], v7 offset:800
  ds_read_b64_tr_b16 v[228:229], v7 offset:18464
  ds_read_b64_tr_b16 v[230:231], v7 offset:19232
  ds_read_b64_tr_b16 v[232:233], v7 offset:64
  ds_read_b64_tr_b16 v[234:235], v7 offset:832
  ds_read_b64_tr_b16 v[236:237], v7 offset:18496
  ds_read_b64_tr_b16 v[238:239], v7 offset:19264
  s_cmp_lg_u32 s3, 7
  s_cbranch_scc1 .Lm_50
  s_lshl_b32 s46, s40, 5
  s_add_u32 s46, s46, s43
  s_mul_i32 s46, s46, 4352
  s_add_u32 s46, s46, 1048576
  v_and_b32 v249, 31, v0
  v_lshlrev_b32 v248, 2, v249
  v_add_u32 v248, s46, v248
  s_mov_b64 vcc, -1
  s_nop 3
  s_mov_b32 vcc_hi, 0
  s_add_u32 s45, s101, 3
  s_mov_b32 s44, 0
  s_nop 2
  s_mov_b64 exec, vcc
.Lm_51:
  buffer_load_dword v250, v248, s[4:7], 0 offen sc1
  s_waitcnt vmcnt(0)
  v_subrev_u32 v249, s45, v250
  v_cmp_le_u32 vcc, 13, v249
  s_add_u32 s44, s44, 1
  s_nop 2
  s_cmp_eq_u64 vcc, 0
  s_cbranch_scc1 .Lm_52
  s_sleep 1
  s_cmp_lt_u32 s44, 0x40000
  s_cbranch_scc1 .Lm_51
.Lm_52:
  s_mov_b64 exec, -1
.Lm_50:
  s_barrier
  s_add_u32 s44, s55, 0
  buffer_load_dwordx4 v[24:27], v1, s[4:7], s44 offen offset:0 sc1
  s_add_u32 s44, s55, 18432
  buffer_load_dwordx4 v[28:31], v1, s[4:7], s44 offen offset:0 sc1
  s_add_u32 s44, s55, 0
  buffer_load_dwordx4 v[32:35], v1, s[4:7], s44 offen offset:1024 sc1
  s_add_u32 s44, s55, 18432
  buffer_load_dwordx4 v[36:39], v1, s[4:7], s44 offen offset:1024 sc1
  s_add_u32 s44, s55, 0
  buffer_load_dwordx4 v[40:43], v1, s[4:7], s44 offen offset:2048 sc1
  s_add_u32 s44, s55, 18432
  buffer_load_dwordx4 v[44:47], v1, s[4:7], s44 offen offset:2048 sc1
  s_add_u32 s44, s55, 0
  buffer_load_dwordx4 v[48:51], v1, s[4:7], s44 offen offset:3072 sc1
  s_add_u32 s44, s55, 18432
  buffer_load_dwordx4 v[52:55], v1, s[4:7], s44 offen offset:3072 sc1
  buffer_load_dwordx2 v[20:21], v14, s[4:7], s53 offen offset:0 sc1
  buffer_load_dwordx2 v[22:23], v14, s[4:7], s53 offen offset:128 sc1
  s_cmp_lg_u32 s3, 7
  s_cbranch_scc1 .Lm_53
  s_mul_i32 s44, s3, 4608
  s_add_u32 m0, s44, 73728
  s_bitcmp1_b32 s43, 0
  s_cselect_b32 s44, 192, 0
  s_add_u32 s44, s44, 3538944
  buffer_load_dwordx4 v2, s[12:15], s44 offen offset:0 lds
  s_bitcmp1_b32 s43, 0
  s_cselect_b32 s44, 192, 0
  s_add_u32 s44, s44, 3538944
  buffer_load_dwordx4 v3, s[12:15], s44 offen offset:1024 lds
  s_bitcmp1_b32 s43, 0
  s_cselect_b32 s44, 192, 0
  s_add_u32 s44, s44, 3538944
  buffer_load_dwordx4 v4, s[12:15], s44 offen offset:2048 lds
  s_bitcmp1_b32 s43, 0
  s_cselect_b32 s44, 192, 0
  s_add_u32 s44, s44, 3538944
  buffer_load_dwordx4 v5, s[12:15], s44 offen offset:3072 lds
  s_mul_i32 s44, s3, 4608
  s_add_u32 m0, s44, 77824
  s_bitcmp1_b32 s43, 0
  s_cselect_b32 s44, 192, 0
  s_add_u32 s44, s44, 3538944
  s_mov_b32 exec_hi, 0
  buffer_load_dwordx4 v6, s[12:15], s44 offen offset:0 lds
  s_mov_b32 exec_hi, -1
  s_mul_i32 s44, s3, 4608
  s_add_u32 m0, s44, 110592
  s_mov_b32 s44, 96
  buffer_load_dwordx4 v2, s[12:15], s44 offen offset:0 lds
  s_mov_b32 s44, 96
  buffer_load_dwordx4 v3, s[12:15], s44 offen offset:1024 lds
  s_mov_b32 s44, 96
  buffer_load_dwordx4 v4, s[12:15], s44 offen offset:2048 lds
  s_mov_b32 s44, 96
  buffer_load_dwordx4 v5, s[12:15], s44 offen offset:3072 lds
  s_mul_i32 s44, s3, 4608
  s_add_u32 m0, s44, 114688
  s_mov_b32 s44, 96
  s_mov_b32 exec_hi, 0
  buffer_load_dwordx4 v6, s[12:15], s44 offen offset:0 lds
  s_mov_b32 exec_hi, -1
.Lm_53:
  s_add_u32 s44, s55, 4096
  buffer_load_dwordx4 v[56:59], v1, s[4:7], s44 offen offset:0 sc1
  s_add_u32 s44, s55, 22528
  buffer_load_dwordx4 v[60:63], v1, s[4:7], s44 offen offset:0 sc1
  s_waitcnt vmcnt(10)
  ds_read_b64_tr_b16 v[240:241], v7 offset:3072
  ds_read_b64_tr_b16 v[242:243], v7 offset:3840
  s_waitcnt lgkmcnt(10)
  v_mfma_f32_16x16x32_bf16 v[168:171], v[216:219], v[24:27], 0
  v_mfma_f32_16x16x32_bf16 v[172:175], v[216:219], v[28:31], 0
  ds_read_b64_tr_b16 v[244:245], v7 offset:21504
  ds_read_b64_tr_b16 v[246:247], v7 offset:22272
  v_mfma_f32_16x16x32_bf16 v[176:179], v[220:223], v[24:27], 0
  v_mfma_f32_16x16x32_bf16 v[180:183], v[220:223], v[28:31], 0
  ds_read_b64_tr_b16 v[216:217], v7 offset:3104
  ds_read_b64_tr_b16 v[218:219], v7 offset:3872
  s_waitcnt lgkmcnt(10)
  v_mfma_f32_16x16x32_bf16 v[184:187], v[224:227], v[24:27], 0
  v_mfma_f32_16x16x32_bf16 v[188:191], v[224:227], v[28:31], 0
  ds_read_b64_tr_b16 v[220:221], v7 offset:21536
  ds_read_b64_tr_b16 v[222:223], v7 offset:22304
  v_mfma_f32_16x16x32_bf16 v[192:195], v[228:231], v[24:27], 0
  v_mfma_f32_16x16x32_bf16 v[196:199], v[228:231], v[28:31], 0
  ds_read_b64_tr_b16 v[224:225], v7 offset:3136
  ds_read_b64_tr_b16 v[226:227], v7 offset:3904
  s_waitcnt lgkmcnt(10)
  v_mfma_f32_16x16x32_bf16 v[200:203], v[232:235], v[24:27], 0
  v_mfma_f32_16x16x32_bf16 v[204:207], v[232:235], v[28:31], 0
  ds_read_b64_tr_b16 v[228:229], v7 offset:21568
  ds_read_b64_tr_b16 v[230:231], v7 offset:22336
  v_mfma_f32_16x16x32_bf16 v[208:211], v[236:239], v[24:27], 0
  v_mfma_f32_16x16x32_bf16 v[212:215], v[236:239], v[28:31], 0
  s_add_u32 s44, s55, 4096
  buffer_load_dwordx4 v[64:67], v1, s[4:7], s44 offen offset:1024 sc1
  s_add_u32 s44, s55, 22528
  buffer_load_dwordx4 v[68:71], v1, s[4:7], s44 offen offset:1024 sc1
  s_waitcnt vmcnt(10)
  ds_read_b64_tr_b16 v[232:233], v7 offset:6144
  ds_read_b64_tr_b16 v[234:235], v7 offset:6912
  s_waitcnt lgkmcnt(10)
  v_mfma_f32_16x16x32_bf16 v[168:171], v[240:243], v[32:35], v[168:171]
  v_mfma_f32_16x16x32_bf16 v[172:175], v[240:243], v[36:39], v[172:175]
  ds_read_b64_tr_b16 v[236:237], v7 offset:24576
  ds_read_b64_tr_b16 v[238:239], v7 offset:25344
  v_mfma_f32_16x16x32_bf16 v[176:179], v[244:247], v[32:35], v[176:179]
  v_mfma_f32_16x16x32_bf16 v[180:183], v[244:247], v[36:39], v[180:183]
  ds_read_b64_tr_b16 v[240:241], v7 offset:6176
  ds_read_b64_tr_b16 v[242:243], v7 offset:6944
  s_waitcnt lgkmcnt(10)
  v_mfma_f32_16x16x32_bf16 v[184:187], v[216:219], v[32:35], v[184:187]
  v_mfma_f32_16x16x32_bf16 v[188:191], v[216:219], v[36:39], v[188:191]
  ds_read_b64_tr_b16 v[244:245], v7 offset:24608
  ds_read_b64_tr_b16 v[246:247], v7 offset:25376
  v_mfma_f32_16x16x32_bf16 v[192:195], v[220:223], v[32:35], v[192:195]
  v_mfma_f32_16x16x32_bf16 v[196:199], v[220:223], v[36:39], v[196:199]
  ds_read_b64_tr_b16 v[216:217], v7 offset:6208
  ds_read_b64_tr_b16 v[218:219], v7 offset:6976
  s_waitcnt lgkmcnt(10)
  v_mfma_f32_16x16x32_bf16 v[200:203], v[224:227], v[32:35], v[200:203]
  v_mfma_f32_16x16x32_bf16 v[204:207], v[224:227], v[36:39], v[204:207]
  ds_read_b64_tr_b16 v[220:221], v7 offset:24640
  ds_read_b64_tr_b16 v[222:223], v7 offset:25408
  v_mfma_f32_16x16x32_bf16 v[208:211], v[228:231], v[32:35], v[208:211]
  v_mfma_f32_16x16x32_bf16 v[212:215], v[228:231], v[36:39], v[212:215]
  s_add_u32 s44, s55, 4096
  buffer_load_dwordx4 v[72:75], v1, s[4:7], s44 offen offset:2048 sc1
  s_add_u32 s44, s55, 22528
  buffer_load_dwordx4 v[76:79], v1, s[4:7], s44 offen offset:2048 sc1
  s_waitcnt vmcnt(10)
  ds_read_b64_tr_b16 v[224:225], v7 offset:9216
  ds_read_b64_tr_b16 v[226:227], v7 offset:9984
  s_waitcnt lgkmcnt(10)
  v_mfma_f32_16x16x32_bf16 v[168:171], v[232:235], v[40:43], v[168:171]
  v_mfma_f32_16x16x32_bf16 v[172:175], v[232:235], v[44:47], v[172:175]
  ds_read_b64_tr_b16 v[228:229], v7 offset:27648
  ds_read_b64_tr_b16 v[230:231], v7 offset:28416
  v_mfma_f32_16x16x32_bf16 v[176:179], v[236:239], v[40:43], v[176:179]
  v_mfma_f32_16x16x32_bf16 v[180:183], v[236:239], v[44:47], v[180:183]
  ds_read_b64_tr_b16 v[232:233], v7 offset:9248
  ds_read_b64_tr_b16 v[234:235], v7 offset:10016
  s_waitcnt lgkmcnt(10)
  v_mfma_f32_16x16x32_bf16 v[184:187], v[240:243], v[40:43], v[184:187]
  v_mfma_f32_16x16x32_bf16 v[188:191], v[240:243], v[44:47], v[188:191]
  ds_read_b64_tr_b16 v[236:237], v7 offset:27680
  ds_read_b64_tr_b16 v[238:239], v7 offset:28448
  v_mfma_f32_16x16x32_bf16 v[192:195], v[244:247], v[40:43], v[192:195]
  v_mfma_f32_16x16x32_bf16 v[196:199], v[244:247], v[44:47], v[196:199]
  ds_read_b64_tr_b16 v[240:241], v7 offset:9280
  ds_read_b64_tr_b16 v[242:243], v7 offset:10048
  s_waitcnt lgkmcnt(10)
  v_mfma_f32_16x16x32_bf16 v[200:203], v[216:219], v[40:43], v[200:203]
  v_mfma_f32_16x16x32_bf16 v[204:207], v[216:219], v[44:47], v[204:207]
  ds_read_b64_tr_b16 v[244:245], v7 offset:27712
  ds_read_b64_tr_b16 v[246:247], v7 offset:28480
  v_mfma_f32_16x16x32_bf16 v[208:211], v[220:223], v[40:43], v[208:211]
  v_mfma_f32_16x16x32_bf16 v[212:215], v[220:223], v[44:47], v[212:215]
  s_add_u32 s44, s55, 4096
  buffer_load_dwordx4 v[80:83], v1, s[4:7], s44 offen offset:3072 sc1
  s_add_u32 s44, s55, 22528
  buffer_load_dwordx4 v[84:87], v1, s[4:7], s44 offen offset:3072 sc1
  s_waitcnt vmcnt(10)
  ds_read_b64_tr_b16 v[216:217], v7 offset:12288
  ds_read_b64_tr_b16 v[218:219], v7 offset:13056
  s_waitcnt lgkmcnt(10)
  v_mfma_f32_16x16x32_bf16 v[168:171], v[224:227], v[48:51], v[168:171]
  v_mfma_f32_16x16x32_bf16 v[172:175], v[224:227], v[52:55], v[172:175]
  ds_read_b64_tr_b16 v[220:221], v7 offset:30720
  ds_read_b64_tr_b16 v[222:223], v7 offset:31488
  v_mfma_f32_16x16x32_bf16 v[176:179], v[228:231], v[48:51], v[176:179]
  v_mfma_f32_16x16x32_bf16 v[180:183], v[228:231], v[52:55], v[180:183]
  ds_read_b64_tr_b16 v[224:225], v7 offset:12320
  ds_read_b64_tr_b16 v[226:227], v7 offset:13088
  s_waitcnt lgkmcnt(10)
  v_mfma_f32_16x16x32_bf16 v[184:187], v[232:235], v[48:51], v[184:187]
  v_mfma_f32_16x16x32_bf16 v[188:191], v[232:235], v[52:55], v[188:191]
  ds_read_b64_tr_b16 v[228:229], v7 offset:30752
  ds_read_b64_tr_b16 v[230:231], v7 offset:31520
  v_mfma_f32_16x16x32_bf16 v[192:195], v[236:239], v[48:51], v[192:195]
  v_mfma_f32_16x16x32_bf16 v[196:199], v[236:239], v[52:55], v[196:199]
  ds_read_b64_tr_b16 v[232:233], v7 offset:12352
  ds_read_b64_tr_b16 v[234:235], v7 offset:13120
  s_waitcnt lgkmcnt(10)
  v_mfma_f32_16x16x32_bf16 v[200:203], v[240:243], v[48:51], v[200:203]
  v_mfma_f32_16x16x32_bf16 v[204:207], v[240:243], v[52:55], v[204:207]
  ds_read_b64_tr_b16 v[236:237], v7 offset:30784
  ds_read_b64_tr_b16 v[238:239], v7 offset:31552
  v_mfma_f32_16x16x32_bf16 v[208:211], v[244:247], v[48:51], v[208:211]
  v_mfma_f32_16x16x32_bf16 v[212:215], v[244:247], v[52:55], v[212:215]
  s_add_u32 s44, s55, 8192
  buffer_load_dwordx4 v[88:91], v1, s[4:7], s44 offen offset:0 sc1
  s_add_u32 s44, s55, 26624
  buffer_load_dwordx4 v[92:95], v1, s[4:7], s44 offen offset:0 sc1
  s_waitcnt vmcnt(8)
  ds_read_b64_tr_b16 v[240:241], v7 offset:15360
  ds_read_b64_tr_b16 v[242:243], v7 offset:16128
  s_waitcnt lgkmcnt(10)
  v_mfma_f32_16x16x32_bf16 v[168:171], v[216:219], v[56:59], v[168:171]
  v_mfma_f32_16x16x32_bf16 v[172:175], v[216:219], v[60:63], v[172:175]
  ds_read_b64_tr_b16 v[244:245], v7 offset:33792
  ds_read_b64_tr_b16 v[246:247], v7 offset:34560
  v_mfma_f32_16x16x32_bf16 v[176:179], v[220:223], v[56:59], v[176:179]
  v_mfma_f32_16x16x32_bf16 v[180:183], v[220:223], v[60:63], v[180:183]
  ds_read_b64_tr_b16 v[216:217], v7 offset:15392
  ds_read_b64_tr_b16 v[218:219], v7 offset:16160
  s_waitcnt lgkmcnt(10)
  v_mfma_f32_16x16x32_bf16 v[184:187], v[224:227], v[56:59], v[184:187]
  v_mfma_f32_16x16x32_bf16 v[188:191], v[224:227], v[60:63], v[188:191]
  ds_read_b64_tr_b16 v[220:221], v7 offset:33824
  ds_read_b64_tr_b16 v[222:223], v7 offset:34592
  v_mfma_f32_16x16x32_bf16 v[192:195], v[228:231], v[56:59], v[192:195]
  v_mfma_f32_16x16x32_bf16 v[196:199], v[228:231], v[60:63], v[196:199]
  ds_read_b64_tr_b16 v[224:225], v7 offset:15424
  ds_read_b64_tr_b16 v[226:227], v7 offset:16192
  s_waitcnt lgkmcnt(10)
  v_mfma_f32_16x16x32_bf16 v[200:203], v[232:235], v[56:59], v[200:203]
  v_mfma_f32_16x16x32_bf16 v[204:207], v[232:235], v[60:63], v[204:207]
  ds_read_b64_tr_b16 v[228:229], v7 offset:33856
  ds_read_b64_tr_b16 v[230:231], v7 offset:34624
  v_mfma_f32_16x16x32_bf16 v[208:211], v[236:239], v[56:59], v[208:211]
  v_mfma_f32_16x16x32_bf16 v[212:215], v[236:239], v[60:63], v[212:215]
  s_add_u32 s44, s55, 8192
  buffer_load_dwordx4 v[96:99], v1, s[4:7], s44 offen offset:1024 sc1
  s_add_u32 s44, s55, 26624
  buffer_load_dwordx4 v[100:103], v1, s[4:7], s44 offen offset:1024 sc1
  s_waitcnt vmcnt(8)
  ds_read_b64_tr_b16 v[232:233], v8 offset:0
  ds_read_b64_tr_b16 v[234:235], v8 offset:768
  s_waitcnt lgkmcnt(10)
  v_mfma_f32_16x16x32_bf16 v[168:171], v[240:243], v[64:67], v[168:171]
  v_mfma_f32_16x16x32_bf16 v[172:175], v[240:243], v[68:71], v[172:175]
  ds_read_b64_tr_b16 v[236:237], v8 offset:18432
  ds_read_b64_tr_b16 v[238:239], v8 offset:19200
  v_mfma_f32_16x16x32_bf16 v[176:179], v[244:247], v[64:67], v[176:179]
  v_mfma_f32_16x16x32_bf16 v[180:183], v[244:247], v[68:71], v[180:183]
  ds_read_b64_tr_b16 v[240:241], v8 offset:32
  ds_read_b64_tr_b16 v[242:243], v8 offset:800
  s_waitcnt lgkmcnt(10)
  v_mfma_f32_16x16x32_bf16 v[184:187], v[216:219], v[64:67], v[184:187]
  v_mfma_f32_16x16x32_bf16 v[188:191], v[216:219], v[68:71], v[188:191]
  ds_read_b64_tr_b16 v[244:245], v8 offset:18464
  ds_read_b64_tr_b16 v[246:247], v8 offset:19232
  v_mfma_f32_16x16x32_bf16 v[192:195], v[220:223], v[64:67], v[192:195]
  v_mfma_f32_16x16x32_bf16 v[196:199], v[220:223], v[68:71], v[196:199]
  ds_read_b64_tr_b16 v[216:217], v8 offset:64
  ds_read_b64_tr_b16 v[218:219], v8 offset:832
  s_waitcnt lgkmcnt(10)
  v_mfma_f32_16x16x32_bf16 v[200:203], v[224:227], v[64:67], v[200:203]
  v_mfma_f32_16x16x32_bf16 v[204:207], v[224:227], v[68:71], v[204:207]
  ds_read_b64_tr_b16 v[220:221], v8 offset:18496
  ds_read_b64_tr_b16 v[222:223], v8 offset:19264
  v_mfma_f32_16x16x32_bf16 v[208:211], v[228:231], v[64:67], v[208:211]
  v_mfma_f32_16x16x32_bf16 v[212:215], v[228:231], v[68:71], v[212:215]
  s_add_u32 s44, s55, 8192
  buffer_load_dwordx4 v[104:107], v1, s[4:7], s44 offen offset:2048 sc1
  s_add_u32 s44, s55, 26624
  buffer_load_dwordx4 v[108:111], v1, s[4:7], s44 offen offset:2048 sc1
  s_waitcnt vmcnt(8)
  ds_read_b64_tr_b16 v[224:225], v8 offset:3072
  ds_read_b64_tr_b16 v[226:227], v8 offset:3840
  s_waitcnt lgkmcnt(10)
  v_mfma_f32_16x16x32_bf16 v[168:171], v[232:235], v[72:75], v[168:171]
  v_mfma_f32_16x16x32_bf16 v[172:175], v[232:235], v[76:79], v[172:175]
  ds_read_b64_tr_b16 v[228:229], v8 offset:21504
  ds_read_b64_tr_b16 v[230:231], v8 offset:22272
  v_mfma_f32_16x16x32_bf16 v[176:179], v[236:239], v[72:75], v[176:179]
  v_mfma_f32_16x16x32_bf16 v[180:183], v[236:239], v[76:79], v[180:183]
  ds_read_b64_tr_b16 v[232:233], v8 offset:3104
  ds_read_b64_tr_b16 v[234:235], v8 offset:3872
  s_waitcnt lgkmcnt(10)
  v_mfma_f32_16x16x32_bf16 v[184:187], v[240:243], v[72:75], v[184:187]
  v_mfma_f32_16x16x32_bf16 v[188:191], v[240:243], v[76:79], v[188:191]
  ds_read_b64_tr_b16 v[236:237], v8 offset:21536
  ds_read_b64_tr_b16 v[238:239], v8 offset:22304
  v_mfma_f32_16x16x32_bf16 v[192:195], v[244:247], v[72:75], v[192:195]
  v_mfma_f32_16x16x32_bf16 v[196:199], v[244:247], v[76:79], v[196:199]
  ds_read_b64_tr_b16 v[240:241], v8 offset:3136
  ds_read_b64_tr_b16 v[242:243], v8 offset:3904
  s_waitcnt lgkmcnt(10)
  v_mfma_f32_16x16x32_bf16 v[200:203], v[216:219], v[72:75], v[200:203]
  v_mfma_f32_16x16x32_bf16 v[204:207], v[216:219], v[76:79], v[204:207]
  ds_read_b64_tr_b16 v[244:245], v8 offset:21568
  ds_read_b64_tr_b16 v[246:247], v8 offset:22336
  v_mfma_f32_16x16x32_bf16 v[208:211], v[220:223], v[72:75], v[208:211]
  v_mfma_f32_16x16x32_bf16 v[212:215], v[220:223], v[76:79], v[212:215]
  s_waitcnt vmcnt(14)
  s_barrier
  s_add_u32 s44, s55, 8192
  buffer_load_dwordx4 v[112:115], v1, s[4:7], s44 offen offset:3072 sc1
  s_add_u32 s44, s55, 26624
  buffer_load_dwordx4 v[116:119], v1, s[4:7], s44 offen offset:3072 sc1
  s_waitcnt vmcnt(8)
  ds_read_b64_tr_b16 v[216:217], v8 offset:6144
  ds_read_b64_tr_b16 v[218:219], v8 offset:6912
  s_waitcnt lgkmcnt(10)
  v_mfma_f32_16x16x32_bf16 v[168:171], v[224:227], v[80:83], v[168:171]
  v_mfma_f32_16x16x32_bf16 v[172:175], v[224:227], v[84:87], v[172:175]
  ds_read_b64_tr_b16 v[220:221], v8 offset:24576
  ds_read_b64_tr_b16 v[222:223], v8 offset:25344
  v_mfma_f32_16x16x32_bf16 v[176:179], v[228:231], v[80:83], v[176:179]
  v_mfma_f32_16x16x32_bf16 v[180:183], v[228:231], v[84:87], v[180:183]
  s_mul_i32 s44, s3, 4608
  s_add_u32 m0, s44, 0
  s_mov_b32 s44, 1769568
  buffer_load_dwordx4 v2, s[12:15], s44 offen offset:0 lds
  ds_read_b64_tr_b16 v[224:225], v8 offset:6176
  ds_read_b64_tr_b16 v[226:227], v8 offset:6944
  s_waitcnt lgkmcnt(10)
  v_mfma_f32_16x16x32_bf16 v[184:187], v[232:235], v[80:83], v[184:187]
  v_mfma_f32_16x16x32_bf16 v[188:191], v[232:235], v[84:87], v[188:191]
  ds_read_b64_tr_b16 v[228:229], v8 offset:24608
  ds_read_b64_tr_b16 v[230:231], v8 offset:25376
  v_mfma_f32_16x16x32_bf16 v[192:195], v[236:239], v[80:83], v[192:195]
  v_mfma_f32_16x16x32_bf16 v[196:199], v[236:239], v[84:87], v[196:199]
  s_mov_b32 s44, 1769568
  buffer_load_dwordx4 v3, s[12:15], s44 offen offset:1024 lds
  ds_read_b64_tr_b16 v[232:233], v8 offset:6208
  ds_read_b64_tr_b16 v[234:235], v8 offset:6976
  s_waitcnt lgkmcnt(10)
  v_mfma_f32_16x16x32_bf16 v[200:203], v[240:243], v[80:83], v[200:203]
  v_mfma_f32_16x16x32_bf16 v[204:207], v[240:243], v[84:87], v[204:207]
  ds_read_b64_tr_b16 v[236:237], v8 offset:24640
  ds_read_b64_tr_b16 v[238:239], v8 offset:25408
  v_mfma_f32_16x16x32_bf16 v[208:211], v[244:247], v[80:83], v[208:211]
  v_mfma_f32_16x16x32_bf16 v[212:215], v[244:247], v[84:87], v[212:215]
  s_mov_b32 s44, 1769568
  buffer_load_dwordx4 v4, s[12:15], s44 offen offset:2048 lds
  s_add_u32 s44, s55, 12288
  buffer_load_dwordx4 v[120:123], v1, s[4:7], s44 offen offset:0 sc1
  s_add_u32 s44, s55, 30720
  buffer_load_dwordx4 v[124:127], v1, s[4:7], s44 offen offset:0 sc1
  s_waitcnt vmcnt(11)
  s_waitcnt vmcnt(21)
  v_mov_b32 v248, v20
  v_mov_b32 v249, v21
  v_mov_b32 v250, v22
  v_mov_b32 v251, v23
  s_nop 1
  v_permlane32_swap_b32 v20, v248
  v_permlane32_swap_b32 v21, v249
  v_permlane32_swap_b32 v22, v250
  v_permlane32_swap_b32 v23, v251
  s_nop 1
  v_add_f32 v20, v20, v248
  v_add_f32 v21, v21, v249
  v_add_f32 v22, v22, v250
  v_add_f32 v23, v23, v251
  v_mov_b32 v248, v20
  v_mov_b32 v249, v21
  v_mov_b32 v250, v22
  v_mov_b32 v251, v23
  s_nop 1
  v_permlane16_swap_b32 v20, v248
  v_permlane16_swap_b32 v21, v249
  v_permlane16_swap_b32 v22, v250
  v_permlane16_swap_b32 v23, v251
  s_nop 1
  v_add_f32 v20, v20, v248
  v_add_f32 v21, v21, v249
  v_add_f32 v22, v22, v250
  v_add_f32 v23, v23, v251
  v_mul_f32 v17, 0x3ae38e39, v20
  v_mul_f32 v248, 0x3ae38e39, v21
  v_fma_f32 v248, -v17, v17, v248
  v_max_f32 v248, 0, v248
  v_cvt_pk_bf16_f32 v17, v17, v17
  v_lshlrev_b32 v17, 16, v17
  v_cvt_pk_bf16_f32 v248, v248, v248
  v_lshlrev_b32 v248, 16, v248
  v_add_f32 v248, 0x3727c5ac, v248
  v_cvt_pk_bf16_f32 v248, v248, v248
  v_lshlrev_b32 v248, 16, v248
  v_sqrt_f32 v248, v248
  s_nop 0
  v_cvt_pk_bf16_f32 v248, v248, v248
  v_lshlrev_b32 v248, 16, v248
  v_rcp_f32 v16, v248
  s_nop 0
  v_mul_f32 v17, 0xbfb8aa3b, v16
  v_mul_f32 v19, 0x3ae38e39, v22
  v_mul_f32 v248, 0x3ae38e39, v23
  v_fma_f32 v248, -v19, v19, v248
  v_max_f32 v248, 0, v248
  v_cvt_pk_bf16_f32 v19, v19, v19
  v_lshlrev_b32 v19, 16, v19
  v_cvt_pk_bf16_f32 v248, v248, v248
  v_lshlrev_b32 v248, 16, v248
  v_add_f32 v248, 0x3727c5ac, v248
  v_cvt_pk_bf16_f32 v248, v248, v248
  v_lshlrev_b32 v248, 16, v248
  v_sqrt_f32 v248, v248
  s_nop 0
  v_cvt_pk_bf16_f32 v248, v248, v248
  v_lshlrev_b32 v248, 16, v248
  v_rcp_f32 v18, v248
  s_nop 0
  v_mul_f32 v19, 0xbfb8aa3b, v18
  ds_read_b64_tr_b16 v[240:241], v8 offset:9216
  ds_read_b64_tr_b16 v[242:243], v8 offset:9984
  s_waitcnt lgkmcnt(10)
  v_mfma_f32_16x16x32_bf16 v[168:171], v[216:219], v[88:91], v[168:171]
  v_mfma_f32_16x16x32_bf16 v[172:175], v[216:219], v[92:95], v[172:175]
  ds_read_b64_tr_b16 v[244:245], v8 offset:27648
  ds_read_b64_tr_b16 v[246:247], v8 offset:28416
  v_mfma_f32_16x16x32_bf16 v[176:179], v[220:223], v[88:91], v[176:179]
  v_mfma_f32_16x16x32_bf16 v[180:183], v[220:223], v[92:95], v[180:183]
  s_mov_b32 s44, 1769568
  buffer_load_dwordx4 v5, s[12:15], s44 offen offset:3072 lds
  ds_read_b64_tr_b16 v[216:217], v8 offset:9248
  ds_read_b64_tr_b16 v[218:219], v8 offset:10016
  s_waitcnt lgkmcnt(10)
  v_mfma_f32_16x16x32_bf16 v[184:187], v[224:227], v[88:91], v[184:187]
  v_mfma_f32_16x16x32_bf16 v[188:191], v[224:227], v[92:95], v[188:191]
  ds_read_b64_tr_b16 v[220:221], v8 offset:27680
  ds_read_b64_tr_b16 v[222:223], v8 offset:28448
  v_mfma_f32_16x16x32_bf16 v[192:195], v[228:231], v[88:91], v[192:195]
  v_mfma_f32_16x16x32_bf16 v[196:199], v[228:231], v[92:95], v[196:199]
  s_mul_i32 s44, s3, 4608
  s_add_u32 m0, s44, 4096
  s_mov_b32 s44, 1769568
  s_mov_b32 exec_hi, 0
  buffer_load_dwordx4 v6, s[12:15], s44 offen offset:0 lds
  s_mov_b32 exec_hi, -1
  ds_read_b64_tr_b16 v[224:225], v8 offset:9280
  ds_read_b64_tr_b16 v[226:227], v8 offset:10048
  s_waitcnt lgkmcnt(10)
  v_mfma_f32_16x16x32_bf16 v[200:203], v[232:235], v[88:91], v[200:203]
  v_mfma_f32_16x16x32_bf16 v[204:207], v[232:235], v[92:95], v[204:207]
  ds_read_b64_tr_b16 v[228:229], v8 offset:27712
  ds_read_b64_tr_b16 v[230:231], v8 offset:28480
  v_mfma_f32_16x16x32_bf16 v[208:211], v[236:239], v[88:91], v[208:211]
  v_mfma_f32_16x16x32_bf16 v[212:215], v[236:239], v[92:95], v[212:215]
  s_add_u32 s44, s55, 12288
  buffer_load_dwordx4 v[128:131], v1, s[4:7], s44 offen offset:1024 sc1
  s_add_u32 s44, s55, 30720
  buffer_load_dwordx4 v[132:135], v1, s[4:7], s44 offen offset:1024 sc1
  s_waitcnt vmcnt(13)
  ds_read_b64_tr_b16 v[232:233], v8 offset:12288
  ds_read_b64_tr_b16 v[234:235], v8 offset:13056
  s_waitcnt lgkmcnt(10)
  v_mfma_f32_16x16x32_bf16 v[168:171], v[240:243], v[96:99], v[168:171]
  v_mfma_f32_16x16x32_bf16 v[172:175], v[240:243], v[100:103], v[172:175]
  ds_read_b64_tr_b16 v[236:237], v8 offset:30720
  ds_read_b64_tr_b16 v[238:239], v8 offset:31488
  v_mfma_f32_16x16x32_bf16 v[176:179], v[244:247], v[96:99], v[176:179]
  v_mfma_f32_16x16x32_bf16 v[180:183], v[244:247], v[100:103], v[180:183]
  ds_read_b64_tr_b16 v[240:241], v8 offset:12320
  ds_read_b64_tr_b16 v[242:243], v8 offset:13088
  s_waitcnt lgkmcnt(10)
  v_mfma_f32_16x16x32_bf16 v[184:187], v[216:219], v[96:99], v[184:187]
  v_mfma_f32_16x16x32_bf16 v[188:191], v[216:219], v[100:103], v[188:191]
  ds_read_b64_tr_b16 v[244:245], v8 offset:30752
  ds_read_b64_tr_b16 v[246:247], v8 offset:31520
  v_mfma_f32_16x16x32_bf16 v[192:195], v[220:223], v[96:99], v[192:195]
  v_mfma_f32_16x16x32_bf16 v[196:199], v[220:223], v[100:103], v[196:199]
  ds_read_b64_tr_b16 v[216:217], v8 offset:12352
  ds_read_b64_tr_b16 v[218:219], v8 offset:13120
  s_waitcnt lgkmcnt(10)
  v_mfma_f32_16x16x32_bf16 v[200:203], v[224:227], v[96:99], v[200:203]
  v_mfma_f32_16x16x32_bf16 v[204:207], v[224:227], v[100:103], v[204:207]
  ds_read_b64_tr_b16 v[220:221], v8 offset:30784
  ds_read_b64_tr_b16 v[222:223], v8 offset:31552
  v_mfma_f32_16x16x32_bf16 v[208:211], v[228:231], v[96:99], v[208:211]
  v_mfma_f32_16x16x32_bf16 v[212:215], v[228:231], v[100:103], v[212:215]
  s_add_u32 s44, s55, 12288
  buffer_load_dwordx4 v[136:139], v1, s[4:7], s44 offen offset:2048 sc1
  s_add_u32 s44, s55, 30720
  buffer_load_dwordx4 v[140:143], v1, s[4:7], s44 offen offset:2048 sc1
  s_waitcnt vmcnt(13)
  ds_read_b64_tr_b16 v[224:225], v8 offset:15360
  ds_read_b64_tr_b16 v[226:227], v8 offset:16128
  s_waitcnt lgkmcnt(10)
  v_mfma_f32_16x16x32_bf16 v[168:171], v[232:235], v[104:107], v[168:171]
  v_mfma_f32_16x16x32_bf16 v[172:175], v[232:235], v[108:111], v[172:175]
  ds_read_b64_tr_b16 v[228:229], v8 offset:33792
  ds_read_b64_tr_b16 v[230:231], v8 offset:34560
  v_mfma_f32_16x16x32_bf16 v[176:179], v[236:239], v[104:107], v[176:179]
  v_mfma_f32_16x16x32_bf16 v[180:183], v[236:239], v[108:111], v[180:183]
  ds_read_b64_tr_b16 v[232:233], v8 offset:15392
  ds_read_b64_tr_b16 v[234:235], v8 offset:16160
  s_waitcnt lgkmcnt(10)
  v_mfma_f32_16x16x32_bf16 v[184:187], v[240:243], v[104:107], v[184:187]
  v_mfma_f32_16x16x32_bf16 v[188:191], v[240:243], v[108:111], v[188:191]
  ds_read_b64_tr_b16 v[236:237], v8 offset:33824
  ds_read_b64_tr_b16 v[238:239], v8 offset:34592
  v_mfma_f32_16x16x32_bf16 v[192:195], v[244:247], v[104:107], v[192:195]
  v_mfma_f32_16x16x32_bf16 v[196:199], v[244:247], v[108:111], v[196:199]
  ds_read_b64_tr_b16 v[240:241], v8 offset:15424
  ds_read_b64_tr_b16 v[242:243], v8 offset:16192
  s_waitcnt lgkmcnt(10)
  v_mfma_f32_16x16x32_bf16 v[200:203], v[216:219], v[104:107], v[200:203]
  v_mfma_f32_16x16x32_bf16 v[204:207], v[216:219], v[108:111], v[204:207]
  ds_read_b64_tr_b16 v[244:245], v8 offset:33856
  ds_read_b64_tr_b16 v[246:247], v8 offset:34624
  v_mfma_f32_16x16x32_bf16 v[208:211], v[220:223], v[104:107], v[208:211]
  v_mfma_f32_16x16x32_bf16 v[212:215], v[220:223], v[108:111], v[212:215]
  s_add_u32 s44, s55, 12288
  buffer_load_dwordx4 v[144:147], v1, s[4:7], s44 offen offset:3072 sc1
  s_add_u32 s44, s55, 30720
  buffer_load_dwordx4 v[148:151], v1, s[4:7], s44 offen offset:3072 sc1
  s_waitcnt vmcnt(13)
  ds_read_b64_tr_b16 v[216:217], v9 offset:0
  ds_read_b64_tr_b16 v[218:219], v9 offset:768
  s_waitcnt lgkmcnt(10)
  v_mfma_f32_16x16x32_bf16 v[168:171], v[224:227], v[112:115], v[168:171]
  v_mfma_f32_16x16x32_bf16 v[172:175], v[224:227], v[116:119], v[172:175]
  ds_read_b64_tr_b16 v[220:221], v9 offset:18432
  ds_read_b64_tr_b16 v[222:223], v9 offset:19200
  v_mfma_f32_16x16x32_bf16 v[176:179], v[228:231], v[112:115], v[176:179]
  v_mfma_f32_16x16x32_bf16 v[180:183], v[228:231], v[116:119], v[180:183]
  ds_read_b64_tr_b16 v[224:225], v9 offset:32
  ds_read_b64_tr_b16 v[226:227], v9 offset:800
  s_waitcnt lgkmcnt(10)
  v_mfma_f32_16x16x32_bf16 v[184:187], v[232:235], v[112:115], v[184:187]
  v_mfma_f32_16x16x32_bf16 v[188:191], v[232:235], v[116:119], v[188:191]
  ds_read_b64_tr_b16 v[228:229], v9 offset:18464
  ds_read_b64_tr_b16 v[230:231], v9 offset:19232
  v_mfma_f32_16x16x32_bf16 v[192:195], v[236:239], v[112:115], v[192:195]
  v_mfma_f32_16x16x32_bf16 v[196:199], v[236:239], v[116:119], v[196:199]
  ds_read_b64_tr_b16 v[232:233], v9 offset:64
  ds_read_b64_tr_b16 v[234:235], v9 offset:832
  s_waitcnt lgkmcnt(10)
  v_mfma_f32_16x16x32_bf16 v[200:203], v[240:243], v[112:115], v[200:203]
  v_mfma_f32_16x16x32_bf16 v[204:207], v[240:243], v[116:119], v[204:207]
  ds_read_b64_tr_b16 v[236:237], v9 offset:18496
  ds_read_b64_tr_b16 v[238:239], v9 offset:19264
  v_mfma_f32_16x16x32_bf16 v[208:211], v[244:247], v[112:115], v[208:211]
  v_mfma_f32_16x16x32_bf16 v[212:215], v[244:247], v[116:119], v[212:215]
  s_add_u32 s44, s55, 16384
  buffer_load_dwordx4 v[152:155], v1, s[4:7], s44 offen offset:0 sc1
  s_add_u32 s44, s55, 34816
  buffer_load_dwordx4 v[156:159], v1, s[4:7], s44 offen offset:0 sc1
  s_waitcnt vmcnt(10)
  ds_read_b64_tr_b16 v[240:241], v9 offset:3072
  ds_read_b64_tr_b16 v[242:243], v9 offset:3840
  s_waitcnt lgkmcnt(10)
  v_mfma_f32_16x16x32_bf16 v[168:171], v[216:219], v[120:123], v[168:171]
  v_mfma_f32_16x16x32_bf16 v[172:175], v[216:219], v[124:127], v[172:175]
  ds_read_b64_tr_b16 v[244:245], v9 offset:21504
  ds_read_b64_tr_b16 v[246:247], v9 offset:22272
  v_mfma_f32_16x16x32_bf16 v[176:179], v[220:223], v[120:123], v[176:179]
  v_mfma_f32_16x16x32_bf16 v[180:183], v[220:223], v[124:127], v[180:183]
  ds_read_b64_tr_b16 v[216:217], v9 offset:3104
  ds_read_b64_tr_b16 v[218:219], v9 offset:3872
  s_waitcnt lgkmcnt(10)
  v_mfma_f32_16x16x32_bf16 v[184:187], v[224:227], v[120:123], v[184:187]
  v_mfma_f32_16x16x32_bf16 v[188:191], v[224:227], v[124:127], v[188:191]
  ds_read_b64_tr_b16 v[220:221], v9 offset:21536
  ds_read_b64_tr_b16 v[222:223], v9 offset:22304
  v_mfma_f32_16x16x32_bf16 v[192:195], v[228:231], v[120:123], v[192:195]
  v_mfma_f32_16x16x32_bf16 v[196:199], v[228:231], v[124:127], v[196:199]
  ds_read_b64_tr_b16 v[224:225], v9 offset:3136
  ds_read_b64_tr_b16 v[226:227], v9 offset:3904
  s_waitcnt lgkmcnt(10)
  v_mfma_f32_16x16x32_bf16 v[200:203], v[232:235], v[120:123], v[200:203]
  v_mfma_f32_16x16x32_bf16 v[204:207], v[232:235], v[124:127], v[204:207]
  ds_read_b64_tr_b16 v[228:229], v9 offset:21568
  ds_read_b64_tr_b16 v[230:231], v9 offset:22336
  v_mfma_f32_16x16x32_bf16 v[208:211], v[236:239], v[120:123], v[208:211]
  v_mfma_f32_16x16x32_bf16 v[212:215], v[236:239], v[124:127], v[212:215]
  s_waitcnt vmcnt(31)
  s_barrier
  s_add_u32 s44, s55, 16384
  buffer_load_dwordx4 v[160:163], v1, s[4:7], s44 offen offset:1024 sc1
  s_add_u32 s44, s55, 34816
  buffer_load_dwordx4 v[164:167], v1, s[4:7], s44 offen offset:1024 sc1
  s_waitcnt vmcnt(8)
  ds_read_b64_tr_b16 v[232:233], v9 offset:6144
  ds_read_b64_tr_b16 v[234:235], v9 offset:6912
  s_waitcnt lgkmcnt(10)
  v_mfma_f32_16x16x32_bf16 v[168:171], v[240:243], v[128:131], v[168:171]
  v_mfma_f32_16x16x32_bf16 v[172:175], v[240:243], v[132:135], v[172:175]
  ds_read_b64_tr_b16 v[236:237], v9 offset:24576
  ds_read_b64_tr_b16 v[238:239], v9 offset:25344
  v_mfma_f32_16x16x32_bf16 v[176:179], v[244:247], v[128:131], v[176:179]
  v_mfma_f32_16x16x32_bf16 v[180:183], v[244:247], v[132:135], v[180:183]
  s_mul_i32 s44, s3, 4608
  s_add_u32 m0, s44, 36864
  s_mov_b32 s44, 3539040
  buffer_load_dwordx4 v2, s[12:15], s44 offen offset:0 lds
  ds_read_b64_tr_b16 v[240:241], v9 offset:6176
  ds_read_b64_tr_b16 v[242:243], v9 offset:6944
  s_waitcnt lgkmcnt(10)
  v_mfma_f32_16x16x32_bf16 v[184:187], v[216:219], v[128:131], v[184:187]
  v_mfma_f32_16x16x32_bf16 v[188:191], v[216:219], v[132:135], v[188:191]
  ds_read_b64_tr_b16 v[244:245], v9 offset:24608
  ds_read_b64_tr_b16 v[246:247], v9 offset:25376
  v_mfma_f32_16x16x32_bf16 v[192:195], v[220:223], v[128:131], v[192:195]
  v_mfma_f32_16x16x32_bf16 v[196:199], v[220:223], v[132:135], v[196:199]
  s_mov_b32 s44, 3539040
  buffer_load_dwordx4 v3, s[12:15], s44 offen offset:1024 lds
  ds_read_b64_tr_b16 v[216:217], v9 offset:6208
  ds_read_b64_tr_b16 v[218:219], v9 offset:6976
  s_waitcnt lgkmcnt(10)
  v_mfma_f32_16x16x32_bf16 v[200:203], v[224:227], v[128:131], v[200:203]
  v_mfma_f32_16x16x32_bf16 v[204:207], v[224:227], v[132:135], v[204:207]
  ds_read_b64_tr_b16 v[220:221], v9 offset:24640
  ds_read_b64_tr_b16 v[222:223], v9 offset:25408
  v_mfma_f32_16x16x32_bf16 v[208:211], v[228:231], v[128:131], v[208:211]
  v_mfma_f32_16x16x32_bf16 v[212:215], v[228:231], v[132:135], v[212:215]
  s_mov_b32 s44, 3539040
  buffer_load_dwordx4 v4, s[12:15], s44 offen offset:2048 lds
  s_waitcnt vmcnt(9)
  ds_read_b64_tr_b16 v[224:225], v9 offset:9216
  ds_read_b64_tr_b16 v[226:227], v9 offset:9984
  s_waitcnt lgkmcnt(10)
  v_mfma_f32_16x16x32_bf16 v[168:171], v[232:235], v[136:139], v[168:171]
  v_mfma_f32_16x16x32_bf16 v[172:175], v[232:235], v[140:143], v[172:175]
  ds_read_b64_tr_b16 v[228:229], v9 offset:27648
  ds_read_b64_tr_b16 v[230:231], v9 offset:28416
  v_mfma_f32_16x16x32_bf16 v[176:179], v[236:239], v[136:139], v[176:179]
  v_mfma_f32_16x16x32_bf16 v[180:183], v[236:239], v[140:143], v[180:183]
  s_mov_b32 s44, 3539040
  buffer_load_dwordx4 v5, s[12:15], s44 offen offset:3072 lds
  ds_read_b64_tr_b16 v[232:233], v9 offset:9248
  ds_read_b64_tr_b16 v[234:235], v9 offset:10016
  s_waitcnt lgkmcnt(10)
  v_mfma_f32_16x16x32_bf16 v[184:187], v[240:243], v[136:139], v[184:187]
  v_mfma_f32_16x16x32_bf16 v[188:191], v[240:243], v[140:143], v[188:191]
  ds_read_b64_tr_b16 v[236:237], v9 offset:27680
  ds_read_b64_tr_b16 v[238:239], v9 offset:28448
  v_mfma_f32_16x16x32_bf16 v[192:195], v[244:247], v[136:139], v[192:195]
  v_mfma_f32_16x16x32_bf16 v[196:199], v[244:247], v[140:143], v[196:199]
  s_mul_i32 s44, s3, 4608
  s_add_u32 m0, s44, 40960
  s_mov_b32 s44, 3539040
  s_mov_b32 exec_hi, 0
  buffer_load_dwordx4 v6, s[12:15], s44 offen offset:0 lds
  s_mov_b32 exec_hi, -1
  ds_read_b64_tr_b16 v[240:241], v9 offset:9280
  ds_read_b64_tr_b16 v[242:243], v9 offset:10048
  s_waitcnt lgkmcnt(10)
  v_mfma_f32_16x16x32_bf16 v[200:203], v[216:219], v[136:139], v[200:203]
  v_mfma_f32_16x16x32_bf16 v[204:207], v[216:219], v[140:143], v[204:207]
  ds_read_b64_tr_b16 v[244:245], v9 offset:27712
  ds_read_b64_tr_b16 v[246:247], v9 offset:28480
  v_mfma_f32_16x16x32_bf16 v[208:211], v[220:223], v[136:139], v[208:211]
  v_mfma_f32_16x16x32_bf16 v[212:215], v[220:223], v[140:143], v[212:215]
  s_waitcnt vmcnt(9)
  ds_read_b64_tr_b16 v[216:217], v9 offset:12288
  ds_read_b64_tr_b16 v[218:219], v9 offset:13056
  s_waitcnt lgkmcnt(10)
  v_mfma_f32_16x16x32_bf16 v[168:171], v[224:227], v[144:147], v[168:171]
  v_mfma_f32_16x16x32_bf16 v[172:175], v[224:227], v[148:151], v[172:175]
  ds_read_b64_tr_b16 v[220:221], v9 offset:30720
  ds_read_b64_tr_b16 v[222:223], v9 offset:31488
  v_mfma_f32_16x16x32_bf16 v[176:179], v[228:231], v[144:147], v[176:179]
  v_mfma_f32_16x16x32_bf16 v[180:183], v[228:231], v[148:151], v[180:183]
  ds_read_b64_tr_b16 v[224:225], v9 offset:12320
  ds_read_b64_tr_b16 v[226:227], v9 offset:13088
  s_waitcnt lgkmcnt(10)
  v_mfma_f32_16x16x32_bf16 v[184:187], v[232:235], v[144:147], v[184:187]
  v_mfma_f32_16x16x32_bf16 v[188:191], v[232:235], v[148:151], v[188:191]
  ds_read_b64_tr_b16 v[228:229], v9 offset:30752
  ds_read_b64_tr_b16 v[230:231], v9 offset:31520
  v_mfma_f32_16x16x32_bf16 v[192:195], v[236:239], v[144:147], v[192:195]
  v_mfma_f32_16x16x32_bf16 v[196:199], v[236:239], v[148:151], v[196:199]
  ds_read_b64_tr_b16 v[232:233], v9 offset:12352
  ds_read_b64_tr_b16 v[234:235], v9 offset:13120
  s_waitcnt lgkmcnt(10)
  v_mfma_f32_16x16x32_bf16 v[200:203], v[240:243], v[144:147], v[200:203]
  v_mfma_f32_16x16x32_bf16 v[204:207], v[240:243], v[148:151], v[204:207]
  ds_read_b64_tr_b16 v[236:237], v9 offset:30784
  ds_read_b64_tr_b16 v[238:239], v9 offset:31552
  v_mfma_f32_16x16x32_bf16 v[208:211], v[244:247], v[144:147], v[208:211]
  v_mfma_f32_16x16x32_bf16 v[212:215], v[244:247], v[148:151], v[212:215]
  s_waitcnt vmcnt(7)
  ds_read_b64_tr_b16 v[240:241], v9 offset:15360
  ds_read_b64_tr_b16 v[242:243], v9 offset:16128
  s_waitcnt lgkmcnt(10)
  v_mfma_f32_16x16x32_bf16 v[168:171], v[216:219], v[152:155], v[168:171]
  v_mfma_f32_16x16x32_bf16 v[172:175], v[216:219], v[156:159], v[172:175]
  ds_read_b64_tr_b16 v[244:245], v9 offset:33792
  ds_read_b64_tr_b16 v[246:247], v9 offset:34560
  v_mfma_f32_16x16x32_bf16 v[176:179], v[220:223], v[152:155], v[176:179]
  v_mfma_f32_16x16x32_bf16 v[180:183], v[220:223], v[156:159], v[180:183]
  ds_read_b64_tr_b16 v[216:217], v9 offset:15392
  ds_read_b64_tr_b16 v[218:219], v9 offset:16160
  s_waitcnt lgkmcnt(10)
  v_mfma_f32_16x16x32_bf16 v[184:187], v[224:227], v[152:155], v[184:187]
  v_mfma_f32_16x16x32_bf16 v[188:191], v[224:227], v[156:159], v[188:191]
  ds_read_b64_tr_b16 v[220:221], v9 offset:33824
  ds_read_b64_tr_b16 v[222:223], v9 offset:34592
  v_mfma_f32_16x16x32_bf16 v[192:195], v[228:231], v[152:155], v[192:195]
  v_mfma_f32_16x16x32_bf16 v[196:199], v[228:231], v[156:159], v[196:199]
  ds_read_b64_tr_b16 v[224:225], v9 offset:15424
  ds_read_b64_tr_b16 v[226:227], v9 offset:16192
  s_waitcnt lgkmcnt(10)
  v_mfma_f32_16x16x32_bf16 v[200:203], v[232:235], v[152:155], v[200:203]
  v_mfma_f32_16x16x32_bf16 v[204:207], v[232:235], v[156:159], v[204:207]
  ds_read_b64_tr_b16 v[228:229], v9 offset:33856
  ds_read_b64_tr_b16 v[230:231], v9 offset:34624
  v_mfma_f32_16x16x32_bf16 v[208:211], v[236:239], v[152:155], v[208:211]
  v_mfma_f32_16x16x32_bf16 v[212:215], v[236:239], v[156:159], v[212:215]
  s_waitcnt vmcnt(5)
  ds_read_b64_tr_b16 v[232:233], v10 offset:0
  ds_read_b64_tr_b16 v[234:235], v10 offset:768
  s_waitcnt lgkmcnt(10)
  v_mfma_f32_16x16x32_bf16 v[168:171], v[240:243], v[160:163], v[168:171]
  v_mfma_f32_16x16x32_bf16 v[172:175], v[240:243], v[164:167], v[172:175]
  ds_read_b64_tr_b16 v[236:237], v10 offset:18432
  ds_read_b64_tr_b16 v[238:239], v10 offset:19200
  v_mfma_f32_16x16x32_bf16 v[176:179], v[244:247], v[160:163], v[176:179]
  v_mfma_f32_16x16x32_bf16 v[180:183], v[244:247], v[164:167], v[180:183]
  ds_read_b64_tr_b16 v[240:241], v10 offset:32
  ds_read_b64_tr_b16 v[242:243], v10 offset:800
  s_waitcnt lgkmcnt(10)
  v_mfma_f32_16x16x32_bf16 v[184:187], v[216:219], v[160:163], v[184:187]
  v_mfma_f32_16x16x32_bf16 v[188:191], v[216:219], v[164:167], v[188:191]
  ds_read_b64_tr_b16 v[244:245], v10 offset:18464
  ds_read_b64_tr_b16 v[246:247], v10 offset:19232
  v_mfma_f32_16x16x32_bf16 v[192:195], v[220:223], v[160:163], v[192:195]
  v_mfma_f32_16x16x32_bf16 v[196:199], v[220:223], v[164:167], v[196:199]
  ds_read_b64_tr_b16 v[216:217], v10 offset:64
  ds_read_b64_tr_b16 v[218:219], v10 offset:832
  s_waitcnt lgkmcnt(10)
  v_mfma_f32_16x16x32_bf16 v[200:203], v[224:227], v[160:163], v[200:203]
  v_mfma_f32_16x16x32_bf16 v[204:207], v[224:227], v[164:167], v[204:207]
  ds_read_b64_tr_b16 v[220:221], v10 offset:18496
  ds_read_b64_tr_b16 v[222:223], v10 offset:19264
  v_mfma_f32_16x16x32_bf16 v[208:211], v[228:231], v[160:163], v[208:211]
  v_mfma_f32_16x16x32_bf16 v[212:215], v[228:231], v[164:167], v[212:215]
  s_bitcmp1_b32 s43, 0
  s_cselect_b32 s45, 3072, 0
  s_add_u32 s45, s45, s54
  s_nop 6
  v_pk_mul_f32 v[168:169], v[168:169], v[16:17] op_sel:[0,1]
  v_pk_mul_f32 v[170:171], v[170:171], v[16:17] op_sel:[0,1]
  v_pk_mul_f32 v[172:173], v[172:173], v[18:19] op_sel:[0,1]
  v_pk_mul_f32 v[174:175], v[174:175], v[18:19] op_sel:[0,1]
  v_exp_f32 v168, v168
  v_exp_f32 v169, v169
  v_exp_f32 v170, v170
  v_exp_f32 v171, v171
  v_exp_f32 v172, v172
  v_exp_f32 v173, v173
  v_exp_f32 v174, v174
  v_exp_f32 v175, v175
  v_pk_mul_f32 v[176:177], v[176:177], v[16:17] op_sel_hi:[1,0]
  v_pk_mul_f32 v[178:179], v[178:179], v[16:17] op_sel_hi:[1,0]
  v_pk_mul_f32 v[180:181], v[180:181], v[18:19] op_sel_hi:[1,0]
  v_pk_mul_f32 v[182:183], v[182:183], v[18:19] op_sel_hi:[1,0]
  v_pk_add_f32 v[168:169], v[168:169], 1.0 op_sel_hi:[1,0]
  v_pk_add_f32 v[170:171], v[170:171], 1.0 op_sel_hi:[1,0]
  v_pk_add_f32 v[172:173], v[172:173], 1.0 op_sel_hi:[1,0]
  v_pk_add_f32 v[174:175], v[174:175], 1.0 op_sel_hi:[1,0]
  v_rcp_f32 v168, v168
  v_rcp_f32 v169, v169
  v_rcp_f32 v170, v170
  v_rcp_f32 v171, v171
  v_rcp_f32 v172, v172
  v_rcp_f32 v173, v173
  v_rcp_f32 v174, v174
  v_rcp_f32 v175, v175
  s_nop 0
  v_pk_mul_f32 v[168:169], v[168:169], v[176:177]
  v_pk_mul_f32 v[170:171], v[170:171], v[178:179]
  v_pk_mul_f32 v[172:173], v[172:173], v[180:181]
  v_pk_mul_f32 v[174:175], v[174:175], v[182:183]
  v_cvt_pk_bf16_f32 v248, v168, v169
  v_cvt_pk_bf16_f32 v249, v170, v171
  v_cvt_pk_bf16_f32 v250, v172, v173
  v_cvt_pk_bf16_f32 v251, v174, v175
  s_nop 1
  v_permlane32_swap_b32 v248, v250
  v_permlane32_swap_b32 v249, v251
  s_nop 1
  buffer_store_dwordx4 v[248:251], v11, s[4:7], s45 offen offset:0 sc1
  v_pk_mul_f32 v[184:185], v[184:185], v[16:17] op_sel:[0,1]
  v_pk_mul_f32 v[186:187], v[186:187], v[16:17] op_sel:[0,1]
  v_pk_mul_f32 v[188:189], v[188:189], v[18:19] op_sel:[0,1]
  v_pk_mul_f32 v[190:191], v[190:191], v[18:19] op_sel:[0,1]
  v_exp_f32 v184, v184
  v_exp_f32 v185, v185
  v_exp_f32 v186, v186
  v_exp_f32 v187, v187
  v_exp_f32 v188, v188
  v_exp_f32 v189, v189
  v_exp_f32 v190, v190
  v_exp_f32 v191, v191
  v_pk_mul_f32 v[192:193], v[192:193], v[16:17] op_sel_hi:[1,0]
  v_pk_mul_f32 v[194:195], v[194:195], v[16:17] op_sel_hi:[1,0]
  v_pk_mul_f32 v[196:197], v[196:197], v[18:19] op_sel_hi:[1,0]
  v_pk_mul_f32 v[198:199], v[198:199], v[18:19] op_sel_hi:[1,0]
  v_pk_add_f32 v[184:185], v[184:185], 1.0 op_sel_hi:[1,0]
  v_pk_add_f32 v[186:187], v[186:187], 1.0 op_sel_hi:[1,0]
  v_pk_add_f32 v[188:189], v[188:189], 1.0 op_sel_hi:[1,0]
  v_pk_add_f32 v[190:191], v[190:191], 1.0 op_sel_hi:[1,0]
  v_rcp_f32 v184, v184
  v_rcp_f32 v185, v185
  v_rcp_f32 v186, v186
  v_rcp_f32 v187, v187
  v_rcp_f32 v188, v188
  v_rcp_f32 v189, v189
  v_rcp_f32 v190, v190
  v_rcp_f32 v191, v191
  s_nop 0
  v_pk_mul_f32 v[184:185], v[184:185], v[192:193]
  v_pk_mul_f32 v[186:187], v[186:187], v[194:195]
  v_pk_mul_f32 v[188:189], v[188:189], v[196:197]
  v_pk_mul_f32 v[190:191], v[190:191], v[198:199]
  v_cvt_pk_bf16_f32 v252, v184, v185
  v_cvt_pk_bf16_f32 v253, v186, v187
  v_cvt_pk_bf16_f32 v254, v188, v189
  v_cvt_pk_bf16_f32 v255, v190, v191
  s_nop 1
  v_permlane32_swap_b32 v252, v254
  v_permlane32_swap_b32 v253, v255
  s_nop 1
  buffer_store_dwordx4 v[252:255], v11, s[4:7], s45 offen offset:512 sc1
  v_pk_mul_f32 v[200:201], v[200:201], v[16:17] op_sel:[0,1]
  v_pk_mul_f32 v[202:203], v[202:203], v[16:17] op_sel:[0,1]
  v_pk_mul_f32 v[204:205], v[204:205], v[18:19] op_sel:[0,1]
  v_pk_mul_f32 v[206:207], v[206:207], v[18:19] op_sel:[0,1]
  v_exp_f32 v200, v200
  v_exp_f32 v201, v201
  v_exp_f32 v202, v202
  v_exp_f32 v203, v203
  v_exp_f32 v204, v204
  v_exp_f32 v205, v205
  v_exp_f32 v206, v206
  v_exp_f32 v207, v207
  v_pk_mul_f32 v[208:209], v[208:209], v[16:17] op_sel_hi:[1,0]
  v_pk_mul_f32 v[210:211], v[210:211], v[16:17] op_sel_hi:[1,0]
  v_pk_mul_f32 v[212:213], v[212:213], v[18:19] op_sel_hi:[1,0]
  v_pk_mul_f32 v[214:215], v[214:215], v[18:19] op_sel_hi:[1,0]
  v_pk_add_f32 v[200:201], v[200:201], 1.0 op_sel_hi:[1,0]
  v_pk_add_f32 v[202:203], v[202:203], 1.0 op_sel_hi:[1,0]
  v_pk_add_f32 v[204:205], v[204:205], 1.0 op_sel_hi:[1,0]
  v_pk_add_f32 v[206:207], v[206:207], 1.0 op_sel_hi:[1,0]
  v_rcp_f32 v200, v200
  v_rcp_f32 v201, v201
  v_rcp_f32 v202, v202
  v_rcp_f32 v203, v203
  v_rcp_f32 v204, v204
  v_rcp_f32 v205, v205
  v_rcp_f32 v206, v206
  v_rcp_f32 v207, v207
  s_nop 0
  v_pk_mul_f32 v[200:201], v[200:201], v[208:209]
  v_pk_mul_f32 v[202:203], v[202:203], v[210:211]
  v_pk_mul_f32 v[204:205], v[204:205], v[212:213]
  v_pk_mul_f32 v[206:207], v[206:207], v[214:215]
  v_cvt_pk_bf16_f32 v248, v200, v201
  v_cvt_pk_bf16_f32 v249, v202, v203
  v_cvt_pk_bf16_f32 v250, v204, v205
  v_cvt_pk_bf16_f32 v251, v206, v207
  s_nop 1
  v_permlane32_swap_b32 v248, v250
  v_permlane32_swap_b32 v249, v251
  s_nop 1
  buffer_store_dwordx4 v[248:251], v11, s[4:7], s45 offen offset:1024 sc1
  ds_read_b64_tr_b16 v[224:225], v10 offset:3072
  ds_read_b64_tr_b16 v[226:227], v10 offset:3840
  s_waitcnt lgkmcnt(10)
  v_mfma_f32_16x16x32_bf16 v[168:171], v[232:235], v[24:27], 0
  v_mfma_f32_16x16x32_bf16 v[172:175], v[232:235], v[28:31], 0
  ds_read_b64_tr_b16 v[228:229], v10 offset:21504
  ds_read_b64_tr_b16 v[230:231], v10 offset:22272
  v_mfma_f32_16x16x32_bf16 v[176:179], v[236:239], v[24:27], 0
  v_mfma_f32_16x16x32_bf16 v[180:183], v[236:239], v[28:31], 0
  ds_read_b64_tr_b16 v[232:233], v10 offset:3104
  ds_read_b64_tr_b16 v[234:235], v10 offset:3872
  s_waitcnt lgkmcnt(10)
  v_mfma_f32_16x16x32_bf16 v[184:187], v[240:243], v[24:27], 0
  v_mfma_f32_16x16x32_bf16 v[188:191], v[240:243], v[28:31], 0
  ds_read_b64_tr_b16 v[236:237], v10 offset:21536
  ds_read_b64_tr_b16 v[238:239], v10 offset:22304
  v_mfma_f32_16x16x32_bf16 v[192:195], v[244:247], v[24:27], 0
  v_mfma_f32_16x16x32_bf16 v[196:199], v[244:247], v[28:31], 0
  ds_read_b64_tr_b16 v[240:241], v10 offset:3136
  ds_read_b64_tr_b16 v[242:243], v10 offset:3904
  s_waitcnt lgkmcnt(10)
  v_mfma_f32_16x16x32_bf16 v[200:203], v[216:219], v[24:27], 0
  v_mfma_f32_16x16x32_bf16 v[204:207], v[216:219], v[28:31], 0
  ds_read_b64_tr_b16 v[244:245], v10 offset:21568
  ds_read_b64_tr_b16 v[246:247], v10 offset:22336
  v_mfma_f32_16x16x32_bf16 v[208:211], v[220:223], v[24:27], 0
  v_mfma_f32_16x16x32_bf16 v[212:215], v[220:223], v[28:31], 0
  s_waitcnt vmcnt(18)
  s_barrier
  ds_read_b64_tr_b16 v[216:217], v10 offset:6144
  ds_read_b64_tr_b16 v[218:219], v10 offset:6912
  s_waitcnt lgkmcnt(10)
  v_mfma_f32_16x16x32_bf16 v[168:171], v[224:227], v[32:35], v[168:171]
  v_mfma_f32_16x16x32_bf16 v[172:175], v[224:227], v[36:39], v[172:175]
  ds_read_b64_tr_b16 v[220:221], v10 offset:24576
  ds_read_b64_tr_b16 v[222:223], v10 offset:25344
  v_mfma_f32_16x16x32_bf16 v[176:179], v[228:231], v[32:35], v[176:179]
  v_mfma_f32_16x16x32_bf16 v[180:183], v[228:231], v[36:39], v[180:183]
  s_mul_i32 s44, s3, 4608
  s_add_u32 m0, s44, 73728
  s_bitcmp1_b32 s43, 0
  s_cselect_b32 s44, 0, 192
  buffer_load_dwordx4 v2, s[12:15], s44 offen offset:0 lds
  ds_read_b64_tr_b16 v[224:225], v10 offset:6176
  ds_read_b64_tr_b16 v[226:227], v10 offset:6944
  s_waitcnt lgkmcnt(10)
  v_mfma_f32_16x16x32_bf16 v[184:187], v[232:235], v[32:35], v[184:187]
  v_mfma_f32_16x16x32_bf16 v[188:191], v[232:235], v[36:39], v[188:191]
  ds_read_b64_tr_b16 v[228:229], v10 offset:24608
  ds_read_b64_tr_b16 v[230:231], v10 offset:25376
  v_mfma_f32_16x16x32_bf16 v[192:195], v[236:239], v[32:35], v[192:195]
  v_mfma_f32_16x16x32_bf16 v[196:199], v[236:239], v[36:39], v[196:199]
  s_bitcmp1_b32 s43, 0
  s_cselect_b32 s44, 0, 192
  buffer_load_dwordx4 v3, s[12:15], s44 offen offset:1024 lds
  ds_read_b64_tr_b16 v[232:233], v10 offset:6208
  ds_read_b64_tr_b16 v[234:235], v10 offset:6976
  s_waitcnt lgkmcnt(10)
  v_mfma_f32_16x16x32_bf16 v[200:203], v[240:243], v[32:35], v[200:203]
  v_mfma_f32_16x16x32_bf16 v[204:207], v[240:243], v[36:39], v[204:207]
  ds_read_b64_tr_b16 v[236:237], v10 offset:24640
  ds_read_b64_tr_b16 v[238:239], v10 offset:25408
  v_mfma_f32_16x16x32_bf16 v[208:211], v[244:247], v[32:35], v[208:211]
  v_mfma_f32_16x16x32_bf16 v[212:215], v[244:247], v[36:39], v[212:215]
  s_bitcmp1_b32 s43, 0
  s_cselect_b32 s44, 0, 192
  buffer_load_dwordx4 v4, s[12:15], s44 offen offset:2048 lds
  ds_read_b64_tr_b16 v[240:241], v10 offset:9216
  ds_read_b64_tr_b16 v[242:243], v10 offset:9984
  s_waitcnt lgkmcnt(10)
  v_mfma_f32_16x16x32_bf16 v[168:171], v[216:219], v[40:43], v[168:171]
  v_mfma_f32_16x16x32_bf16 v[172:175], v[216:219], v[44:47], v[172:175]
  ds_read_b64_tr_b16 v[244:245], v10 offset:27648
  ds_read_b64_tr_b16 v[246:247], v10 offset:28416
  v_mfma_f32_16x16x32_bf16 v[176:179], v[220:223], v[40:43], v[176:179]
  v_mfma_f32_16x16x32_bf16 v[180:183], v[220:223], v[44:47], v[180:183]
  s_bitcmp1_b32 s43, 0
  s_cselect_b32 s44, 0, 192
  buffer_load_dwordx4 v5, s[12:15], s44 offen offset:3072 lds
  ds_read_b64_tr_b16 v[216:217], v10 offset:9248
  ds_read_b64_tr_b16 v[218:219], v10 offset:10016
  s_waitcnt lgkmcnt(10)
  v_mfma_f32_16x16x32_bf16 v[184:187], v[224:227], v[40:43], v[184:187]
  v_mfma_f32_16x16x32_bf16 v[188:191], v[224:227], v[44:47], v[188:191]
  ds_read_b64_tr_b16 v[220:221], v10 offset:27680
  ds_read_b64_tr_b16 v[222:223], v10 offset:28448
  v_mfma_f32_16x16x32_bf16 v[192:195], v[228:231], v[40:43], v[192:195]
  v_mfma_f32_16x16x32_bf16 v[196:199], v[228:231], v[44:47], v[196:199]
  s_mul_i32 s44, s3, 4608
  s_add_u32 m0, s44, 77824
  s_bitcmp1_b32 s43, 0
  s_cselect_b32 s44, 0, 192
  s_mov_b32 exec_hi, 0
  buffer_load_dwordx4 v6, s[12:15], s44 offen offset:0 lds
  s_mov_b32 exec_hi, -1
  ds_read_b64_tr_b16 v[224:225], v10 offset:9280
  ds_read_b64_tr_b16 v[226:227], v10 offset:10048
  s_waitcnt lgkmcnt(10)
  v_mfma_f32_16x16x32_bf16 v[200:203], v[232:235], v[40:43], v[200:203]
  v_mfma_f32_16x16x32_bf16 v[204:207], v[232:235], v[44:47], v[204:207]
  ds_read_b64_tr_b16 v[228:229], v10 offset:27712
  ds_read_b64_tr_b16 v[230:231], v10 offset:28480
  v_mfma_f32_16x16x32_bf16 v[208:211], v[236:239], v[40:43], v[208:211]
  v_mfma_f32_16x16x32_bf16 v[212:215], v[236:239], v[44:47], v[212:215]
  s_mov_b32 s8, s28
  s_and_b32 s9, s29, 0xffff
  s_mov_b32 s10, 0x00510000
  s_mov_b32 s11, 0x00020000
  s_and_b32 s44, s40, 3
  s_lshl_b32 s44, s44, 3
  s_add_u32 s44, s44, s42
  s_lshl_b32 s44, s44, 3
  s_add_u32 s44, s44, s3
  s_mul_i32 s44, s44, 21
  s_lshl_b32 s45, s41, 1
  s_lshr_b32 s46, s40, 2
  s_add_u32 s45, s45, s46
  s_mul_i32 s45, s45, 663552
  v_add_u32 v12, s44, v0
  v_min_u32 v12, 5183, v12
  v_lshlrev_b32 v12, 7, v12
  s_mov_b64 exec, 0x1fffff
  buffer_load_dword v15, v12, s[8:11], s45 offen
  s_mov_b64 exec, -1
  ds_read_b64_tr_b16 v[232:233], v10 offset:12288
  ds_read_b64_tr_b16 v[234:235], v10 offset:13056
  s_waitcnt lgkmcnt(10)
  v_mfma_f32_16x16x32_bf16 v[168:171], v[240:243], v[48:51], v[168:171]
  v_mfma_f32_16x16x32_bf16 v[172:175], v[240:243], v[52:55], v[172:175]
  ds_read_b64_tr_b16 v[236:237], v10 offset:30720
  ds_read_b64_tr_b16 v[238:239], v10 offset:31488
  v_mfma_f32_16x16x32_bf16 v[176:179], v[244:247], v[48:51], v[176:179]
  v_mfma_f32_16x16x32_bf16 v[180:183], v[244:247], v[52:55], v[180:183]
  ds_read_b64_tr_b16 v[240:241], v10 offset:12320
  ds_read_b64_tr_b16 v[242:243], v10 offset:13088
  s_waitcnt lgkmcnt(10)
  v_mfma_f32_16x16x32_bf16 v[184:187], v[216:219], v[48:51], v[184:187]
  v_mfma_f32_16x16x32_bf16 v[188:191], v[216:219], v[52:55], v[188:191]
  ds_read_b64_tr_b16 v[244:245], v10 offset:30752
  ds_read_b64_tr_b16 v[246:247], v10 offset:31520
  v_mfma_f32_16x16x32_bf16 v[192:195], v[220:223], v[48:51], v[192:195]
  v_mfma_f32_16x16x32_bf16 v[196:199], v[220:223], v[52:55], v[196:199]
  ds_read_b64_tr_b16 v[216:217], v10 offset:12352
  ds_read_b64_tr_b16 v[218:219], v10 offset:13120
  s_waitcnt lgkmcnt(10)
  v_mfma_f32_16x16x32_bf16 v[200:203], v[224:227], v[48:51], v[200:203]
  v_mfma_f32_16x16x32_bf16 v[204:207], v[224:227], v[52:55], v[204:207]
  ds_read_b64_tr_b16 v[220:221], v10 offset:30784
  ds_read_b64_tr_b16 v[222:223], v10 offset:31552
  v_mfma_f32_16x16x32_bf16 v[208:211], v[228:231], v[48:51], v[208:211]
  v_mfma_f32_16x16x32_bf16 v[212:215], v[228:231], v[52:55], v[212:215]
  ds_read_b64_tr_b16 v[224:225], v10 offset:15360
  ds_read_b64_tr_b16 v[226:227], v10 offset:16128
  s_waitcnt lgkmcnt(10)
  v_mfma_f32_16x16x32_bf16 v[168:171], v[232:235], v[56:59], v[168:171]
  v_mfma_f32_16x16x32_bf16 v[172:175], v[232:235], v[60:63], v[172:175]
  ds_read_b64_tr_b16 v[228:229], v10 offset:33792
  ds_read_b64_tr_b16 v[230:231], v10 offset:34560
  v_mfma_f32_16x16x32_bf16 v[176:179], v[236:239], v[56:59], v[176:179]
  v_mfma_f32_16x16x32_bf16 v[180:183], v[236:239], v[60:63], v[180:183]
  ds_read_b64_tr_b16 v[232:233], v10 offset:15392
  ds_read_b64_tr_b16 v[234:235], v10 offset:16160
  s_waitcnt lgkmcnt(10)
  v_mfma_f32_16x16x32_bf16 v[184:187], v[240:243], v[56:59], v[184:187]
  v_mfma_f32_16x16x32_bf16 v[188:191], v[240:243], v[60:63], v[188:191]
  ds_read_b64_tr_b16 v[236:237], v10 offset:33824
  ds_read_b64_tr_b16 v[238:239], v10 offset:34592
  v_mfma_f32_16x16x32_bf16 v[192:195], v[244:247], v[56:59], v[192:195]
  v_mfma_f32_16x16x32_bf16 v[196:199], v[244:247], v[60:63], v[196:199]
  ds_read_b64_tr_b16 v[240:241], v10 offset:15424
  ds_read_b64_tr_b16 v[242:243], v10 offset:16192
  s_waitcnt lgkmcnt(10)
  v_mfma_f32_16x16x32_bf16 v[200:203], v[216:219], v[56:59], v[200:203]
  v_mfma_f32_16x16x32_bf16 v[204:207], v[216:219], v[60:63], v[204:207]
  ds_read_b64_tr_b16 v[244:245], v10 offset:33856
  ds_read_b64_tr_b16 v[246:247], v10 offset:34624
  v_mfma_f32_16x16x32_bf16 v[208:211], v[220:223], v[56:59], v[208:211]
  v_mfma_f32_16x16x32_bf16 v[212:215], v[220:223], v[60:63], v[212:215]
  ds_read_b64_tr_b16 v[216:217], v7 offset:0
  ds_read_b64_tr_b16 v[218:219], v7 offset:768
  s_waitcnt lgkmcnt(10)
  v_mfma_f32_16x16x32_bf16 v[168:171], v[224:227], v[64:67], v[168:171]
  v_mfma_f32_16x16x32_bf16 v[172:175], v[224:227], v[68:71], v[172:175]
  ds_read_b64_tr_b16 v[220:221], v7 offset:18432
  ds_read_b64_tr_b16 v[222:223], v7 offset:19200
  v_mfma_f32_16x16x32_bf16 v[176:179], v[228:231], v[64:67], v[176:179]
  v_mfma_f32_16x16x32_bf16 v[180:183], v[228:231], v[68:71], v[180:183]
  ds_read_b64_tr_b16 v[224:225], v7 offset:32
  ds_read_b64_tr_b16 v[226:227], v7 offset:800
  s_waitcnt lgkmcnt(10)
  v_mfma_f32_16x16x32_bf16 v[184:187], v[232:235], v[64:67], v[184:187]
  v_mfma_f32_16x16x32_bf16 v[188:191], v[232:235], v[68:71], v[188:191]
  ds_read_b64_tr_b16 v[228:229], v7 offset:18464
  ds_read_b64_tr_b16 v[230:231], v7 offset:19232
  v_mfma_f32_16x16x32_bf16 v[192:195], v[236:239], v[64:67], v[192:195]
  v_mfma_f32_16x16x32_bf16 v[196:199], v[236:239], v[68:71], v[196:199]
  ds_read_b64_tr_b16 v[232:233], v7 offset:64
  ds_read_b64_tr_b16 v[234:235], v7 offset:832
  s_waitcnt lgkmcnt(10)
  v_mfma_f32_16x16x32_bf16 v[200:203], v[240:243], v[64:67], v[200:203]
  v_mfma_f32_16x16x32_bf16 v[204:207], v[240:243], v[68:71], v[204:207]
  ds_read_b64_tr_b16 v[236:237], v7 offset:18496
  ds_read_b64_tr_b16 v[238:239], v7 offset:19264
  v_mfma_f32_16x16x32_bf16 v[208:211], v[244:247], v[64:67], v[208:211]
  v_mfma_f32_16x16x32_bf16 v[212:215], v[244:247], v[68:71], v[212:215]
  ds_read_b64_tr_b16 v[240:241], v7 offset:3072
  ds_read_b64_tr_b16 v[242:243], v7 offset:3840
  s_waitcnt lgkmcnt(10)
  v_mfma_f32_16x16x32_bf16 v[168:171], v[216:219], v[72:75], v[168:171]
  v_mfma_f32_16x16x32_bf16 v[172:175], v[216:219], v[76:79], v[172:175]
  ds_read_b64_tr_b16 v[244:245], v7 offset:21504
  ds_read_b64_tr_b16 v[246:247], v7 offset:22272
  v_mfma_f32_16x16x32_bf16 v[176:179], v[220:223], v[72:75], v[176:179]
  v_mfma_f32_16x16x32_bf16 v[180:183], v[220:223], v[76:79], v[180:183]
  ds_read_b64_tr_b16 v[216:217], v7 offset:3104
  ds_read_b64_tr_b16 v[218:219], v7 offset:3872
  s_waitcnt lgkmcnt(10)
  v_mfma_f32_16x16x32_bf16 v[184:187], v[224:227], v[72:75], v[184:187]
  v_mfma_f32_16x16x32_bf16 v[188:191], v[224:227], v[76:79], v[188:191]
  ds_read_b64_tr_b16 v[220:221], v7 offset:21536
  ds_read_b64_tr_b16 v[222:223], v7 offset:22304
  v_mfma_f32_16x16x32_bf16 v[192:195], v[228:231], v[72:75], v[192:195]
  v_mfma_f32_16x16x32_bf16 v[196:199], v[228:231], v[76:79], v[196:199]
  ds_read_b64_tr_b16 v[224:225], v7 offset:3136
  ds_read_b64_tr_b16 v[226:227], v7 offset:3904
  s_waitcnt lgkmcnt(10)
  v_mfma_f32_16x16x32_bf16 v[200:203], v[232:235], v[72:75], v[200:203]
  v_mfma_f32_16x16x32_bf16 v[204:207], v[232:235], v[76:79], v[204:207]
  ds_read_b64_tr_b16 v[228:229], v7 offset:21568
  ds_read_b64_tr_b16 v[230:231], v7 offset:22336
  v_mfma_f32_16x16x32_bf16 v[208:211], v[236:239], v[72:75], v[208:211]
  v_mfma_f32_16x16x32_bf16 v[212:215], v[236:239], v[76:79], v[212:215]
  s_waitcnt vmcnt(9)
  s_barrier
  ds_read_b64_tr_b16 v[232:233], v7 offset:6144
  ds_read_b64_tr_b16 v[234:235], v7 offset:6912
  s_waitcnt lgkmcnt(10)
  v_mfma_f32_16x16x32_bf16 v[168:171], v[240:243], v[80:83], v[168:171]
  v_mfma_f32_16x16x32_bf16 v[172:175], v[240:243], v[84:87], v[172:175]
  ds_read_b64_tr_b16 v[236:237], v7 offset:24576
  ds_read_b64_tr_b16 v[238:239], v7 offset:25344
  v_mfma_f32_16x16x32_bf16 v[176:179], v[244:247], v[80:83], v[176:179]
  v_mfma_f32_16x16x32_bf16 v[180:183], v[244:247], v[84:87], v[180:183]
  s_mul_i32 s44, s3, 4608
  s_add_u32 m0, s44, 110592
  s_bitcmp1_b32 s43, 0
  s_cselect_b32 s44, 0, 192
  s_add_u32 s44, s44, 1769472
  buffer_load_dwordx4 v2, s[12:15], s44 offen offset:0 lds
  ds_read_b64_tr_b16 v[240:241], v7 offset:6176
  ds_read_b64_tr_b16 v[242:243], v7 offset:6944
  s_waitcnt lgkmcnt(10)
  v_mfma_f32_16x16x32_bf16 v[184:187], v[216:219], v[80:83], v[184:187]
  v_mfma_f32_16x16x32_bf16 v[188:191], v[216:219], v[84:87], v[188:191]
  ds_read_b64_tr_b16 v[244:245], v7 offset:24608
  ds_read_b64_tr_b16 v[246:247], v7 offset:25376
  v_mfma_f32_16x16x32_bf16 v[192:195], v[220:223], v[80:83], v[192:195]
  v_mfma_f32_16x16x32_bf16 v[196:199], v[220:223], v[84:87], v[196:199]
  s_bitcmp1_b32 s43, 0
  s_cselect_b32 s44, 0, 192
  s_add_u32 s44, s44, 1769472
  buffer_load_dwordx4 v3, s[12:15], s44 offen offset:1024 lds
  ds_read_b64_tr_b16 v[216:217], v7 offset:6208
  ds_read_b64_tr_b16 v[218:219], v7 offset:6976
  s_waitcnt lgkmcnt(10)
  v_mfma_f32_16x16x32_bf16 v[200:203], v[224:227], v[80:83], v[200:203]
  v_mfma_f32_16x16x32_bf16 v[204:207], v[224:227], v[84:87], v[204:207]
  ds_read_b64_tr_b16 v[220:221], v7 offset:24640
  ds_read_b64_tr_b16 v[222:223], v7 offset:25408
  v_mfma_f32_16x16x32_bf16 v[208:211], v[228:231], v[80:83], v[208:211]
  v_mfma_f32_16x16x32_bf16 v[212:215], v[228:231], v[84:87], v[212:215]
  s_bitcmp1_b32 s43, 0
  s_cselect_b32 s44, 0, 192
  s_add_u32 s44, s44, 1769472
  buffer_load_dwordx4 v4, s[12:15], s44 offen offset:2048 lds
  ds_read_b64_tr_b16 v[224:225], v7 offset:9216
  ds_read_b64_tr_b16 v[226:227], v7 offset:9984
  s_waitcnt lgkmcnt(10)
  v_mfma_f32_16x16x32_bf16 v[168:171], v[232:235], v[88:91], v[168:171]
  v_mfma_f32_16x16x32_bf16 v[172:175], v[232:235], v[92:95], v[172:175]
  ds_read_b64_tr_b16 v[228:229], v7 offset:27648
  ds_read_b64_tr_b16 v[230:231], v7 offset:28416
  v_mfma_f32_16x16x32_bf16 v[176:179], v[236:239], v[88:91], v[176:179]
  v_mfma_f32_16x16x32_bf16 v[180:183], v[236:239], v[92:95], v[180:183]
  s_bitcmp1_b32 s43, 0
  s_cselect_b32 s44, 0, 192
  s_add_u32 s44, s44, 1769472
  buffer_load_dwordx4 v5, s[12:15], s44 offen offset:3072 lds
  ds_read_b64_tr_b16 v[232:233], v7 offset:9248
  ds_read_b64_tr_b16 v[234:235], v7 offset:10016
  s_waitcnt lgkmcnt(10)
  v_mfma_f32_16x16x32_bf16 v[184:187], v[240:243], v[88:91], v[184:187]
  v_mfma_f32_16x16x32_bf16 v[188:191], v[240:243], v[92:95], v[188:191]
  ds_read_b64_tr_b16 v[236:237], v7 offset:27680
  ds_read_b64_tr_b16 v[238:239], v7 offset:28448
  v_mfma_f32_16x16x32_bf16 v[192:195], v[244:247], v[88:91], v[192:195]
  v_mfma_f32_16x16x32_bf16 v[196:199], v[244:247], v[92:95], v[196:199]
  s_mul_i32 s44, s3, 4608
  s_add_u32 m0, s44, 114688
  s_bitcmp1_b32 s43, 0
  s_cselect_b32 s44, 0, 192
  s_add_u32 s44, s44, 1769472
  s_mov_b32 exec_hi, 0
  buffer_load_dwordx4 v6, s[12:15], s44 offen offset:0 lds
  s_mov_b32 exec_hi, -1
  ds_read_b64_tr_b16 v[240:241], v7 offset:9280
  ds_read_b64_tr_b16 v[242:243], v7 offset:10048
  s_waitcnt lgkmcnt(10)
  v_mfma_f32_16x16x32_bf16 v[200:203], v[216:219], v[88:91], v[200:203]
  v_mfma_f32_16x16x32_bf16 v[204:207], v[216:219], v[92:95], v[204:207]
  ds_read_b64_tr_b16 v[244:245], v7 offset:27712
  ds_read_b64_tr_b16 v[246:247], v7 offset:28480
  v_mfma_f32_16x16x32_bf16 v[208:211], v[220:223], v[88:91], v[208:211]
  v_mfma_f32_16x16x32_bf16 v[212:215], v[220:223], v[92:95], v[212:215]
  ds_read_b64_tr_b16 v[216:217], v7 offset:12288
  ds_read_b64_tr_b16 v[218:219], v7 offset:13056
  s_waitcnt lgkmcnt(10)
  v_mfma_f32_16x16x32_bf16 v[168:171], v[224:227], v[96:99], v[168:171]
  v_mfma_f32_16x16x32_bf16 v[172:175], v[224:227], v[100:103], v[172:175]
  ds_read_b64_tr_b16 v[220:221], v7 offset:30720
  ds_read_b64_tr_b16 v[222:223], v7 offset:31488
  v_mfma_f32_16x16x32_bf16 v[176:179], v[228:231], v[96:99], v[176:179]
  v_mfma_f32_16x16x32_bf16 v[180:183], v[228:231], v[100:103], v[180:183]
  ds_read_b64_tr_b16 v[224:225], v7 offset:12320
  ds_read_b64_tr_b16 v[226:227], v7 offset:13088
  s_waitcnt lgkmcnt(10)
  v_mfma_f32_16x16x32_bf16 v[184:187], v[232:235], v[96:99], v[184:187]
  v_mfma_f32_16x16x32_bf16 v[188:191], v[232:235], v[100:103], v[188:191]
  ds_read_b64_tr_b16 v[228:229], v7 offset:30752
  ds_read_b64_tr_b16 v[230:231], v7 offset:31520
  v_mfma_f32_16x16x32_bf16 v[192:195], v[236:239], v[96:99], v[192:195]
  v_mfma_f32_16x16x32_bf16 v[196:199], v[236:239], v[100:103], v[196:199]
  ds_read_b64_tr_b16 v[232:233], v7 offset:12352
  ds_read_b64_tr_b16 v[234:235], v7 offset:13120
  s_waitcnt lgkmcnt(10)
  v_mfma_f32_16x16x32_bf16 v[200:203], v[240:243], v[96:99], v[200:203]
  v_mfma_f32_16x16x32_bf16 v[204:207], v[240:243], v[100:103], v[204:207]
  ds_read_b64_tr_b16 v[236:237], v7 offset:30784
  ds_read_b64_tr_b16 v[238:239], v7 offset:31552
  v_mfma_f32_16x16x32_bf16 v[208:211], v[244:247], v[96:99], v[208:211]
  v_mfma_f32_16x16x32_bf16 v[212:215], v[244:247], v[100:103], v[212:215]
  ds_read_b64_tr_b16 v[240:241], v7 offset:15360
  ds_read_b64_tr_b16 v[242:243], v7 offset:16128
  s_waitcnt lgkmcnt(10)
  v_mfma_f32_16x16x32_bf16 v[168:171], v[216:219], v[104:107], v[168:171]
  v_mfma_f32_16x16x32_bf16 v[172:175], v[216:219], v[108:111], v[172:175]
  ds_read_b64_tr_b16 v[244:245], v7 offset:33792
  ds_read_b64_tr_b16 v[246:247], v7 offset:34560
  v_mfma_f32_16x16x32_bf16 v[176:179], v[220:223], v[104:107], v[176:179]
  v_mfma_f32_16x16x32_bf16 v[180:183], v[220:223], v[108:111], v[180:183]
  ds_read_b64_tr_b16 v[216:217], v7 offset:15392
  ds_read_b64_tr_b16 v[218:219], v7 offset:16160
  s_waitcnt lgkmcnt(10)
  v_mfma_f32_16x16x32_bf16 v[184:187], v[224:227], v[104:107], v[184:187]
  v_mfma_f32_16x16x32_bf16 v[188:191], v[224:227], v[108:111], v[188:191]
  ds_read_b64_tr_b16 v[220:221], v7 offset:33824
  ds_read_b64_tr_b16 v[222:223], v7 offset:34592
  v_mfma_f32_16x16x32_bf16 v[192:195], v[228:231], v[104:107], v[192:195]
  v_mfma_f32_16x16x32_bf16 v[196:199], v[228:231], v[108:111], v[196:199]
  ds_read_b64_tr_b16 v[224:225], v7 offset:15424
  ds_read_b64_tr_b16 v[226:227], v7 offset:16192
  s_waitcnt lgkmcnt(10)
  v_mfma_f32_16x16x32_bf16 v[200:203], v[232:235], v[104:107], v[200:203]
  v_mfma_f32_16x16x32_bf16 v[204:207], v[232:235], v[108:111], v[204:207]
  ds_read_b64_tr_b16 v[228:229], v7 offset:33856
  ds_read_b64_tr_b16 v[230:231], v7 offset:34624
  v_mfma_f32_16x16x32_bf16 v[208:211], v[236:239], v[104:107], v[208:211]
  v_mfma_f32_16x16x32_bf16 v[212:215], v[236:239], v[108:111], v[212:215]
  ds_read_b64_tr_b16 v[232:233], v8 offset:0
  ds_read_b64_tr_b16 v[234:235], v8 offset:768
  s_waitcnt lgkmcnt(10)
  v_mfma_f32_16x16x32_bf16 v[168:171], v[240:243], v[112:115], v[168:171]
  v_mfma_f32_16x16x32_bf16 v[172:175], v[240:243], v[116:119], v[172:175]
  ds_read_b64_tr_b16 v[236:237], v8 offset:18432
  ds_read_b64_tr_b16 v[238:239], v8 offset:19200
  v_mfma_f32_16x16x32_bf16 v[176:179], v[244:247], v[112:115], v[176:179]
  v_mfma_f32_16x16x32_bf16 v[180:183], v[244:247], v[116:119], v[180:183]
  ds_read_b64_tr_b16 v[240:241], v8 offset:32
  ds_read_b64_tr_b16 v[242:243], v8 offset:800
  s_waitcnt lgkmcnt(10)
  v_mfma_f32_16x16x32_bf16 v[184:187], v[216:219], v[112:115], v[184:187]
  v_mfma_f32_16x16x32_bf16 v[188:191], v[216:219], v[116:119], v[188:191]
  ds_read_b64_tr_b16 v[244:245], v8 offset:18464
  ds_read_b64_tr_b16 v[246:247], v8 offset:19232
  v_mfma_f32_16x16x32_bf16 v[192:195], v[220:223], v[112:115], v[192:195]
  v_mfma_f32_16x16x32_bf16 v[196:199], v[220:223], v[116:119], v[196:199]
  ds_read_b64_tr_b16 v[216:217], v8 offset:64
  ds_read_b64_tr_b16 v[218:219], v8 offset:832
  s_waitcnt lgkmcnt(10)
  v_mfma_f32_16x16x32_bf16 v[200:203], v[224:227], v[112:115], v[200:203]
  v_mfma_f32_16x16x32_bf16 v[204:207], v[224:227], v[116:119], v[204:207]
  ds_read_b64_tr_b16 v[220:221], v8 offset:18496
  ds_read_b64_tr_b16 v[222:223], v8 offset:19264
  v_mfma_f32_16x16x32_bf16 v[208:211], v[228:231], v[112:115], v[208:211]
  v_mfma_f32_16x16x32_bf16 v[212:215], v[228:231], v[116:119], v[212:215]
  ds_read_b64_tr_b16 v[224:225], v8 offset:3072
  ds_read_b64_tr_b16 v[226:227], v8 offset:3840
  s_waitcnt lgkmcnt(10)
  v_mfma_f32_16x16x32_bf16 v[168:171], v[232:235], v[120:123], v[168:171]
  v_mfma_f32_16x16x32_bf16 v[172:175], v[232:235], v[124:127], v[172:175]
  ds_read_b64_tr_b16 v[228:229], v8 offset:21504
  ds_read_b64_tr_b16 v[230:231], v8 offset:22272
  v_mfma_f32_16x16x32_bf16 v[176:179], v[236:239], v[120:123], v[176:179]
  v_mfma_f32_16x16x32_bf16 v[180:183], v[236:239], v[124:127], v[180:183]
  ds_read_b64_tr_b16 v[232:233], v8 offset:3104
  ds_read_b64_tr_b16 v[234:235], v8 offset:3872
  s_waitcnt lgkmcnt(10)
  v_mfma_f32_16x16x32_bf16 v[184:187], v[240:243], v[120:123], v[184:187]
  v_mfma_f32_16x16x32_bf16 v[188:191], v[240:243], v[124:127], v[188:191]
  ds_read_b64_tr_b16 v[236:237], v8 offset:21536
  ds_read_b64_tr_b16 v[238:239], v8 offset:22304
  v_mfma_f32_16x16x32_bf16 v[192:195], v[244:247], v[120:123], v[192:195]
  v_mfma_f32_16x16x32_bf16 v[196:199], v[244:247], v[124:127], v[196:199]
  ds_read_b64_tr_b16 v[240:241], v8 offset:3136
  ds_read_b64_tr_b16 v[242:243], v8 offset:3904
  s_waitcnt lgkmcnt(10)
  v_mfma_f32_16x16x32_bf16 v[200:203], v[216:219], v[120:123], v[200:203]
  v_mfma_f32_16x16x32_bf16 v[204:207], v[216:219], v[124:127], v[204:207]
  ds_read_b64_tr_b16 v[244:245], v8 offset:21568
  ds_read_b64_tr_b16 v[246:247], v8 offset:22336
  v_mfma_f32_16x16x32_bf16 v[208:211], v[220:223], v[120:123], v[208:211]
  v_mfma_f32_16x16x32_bf16 v[212:215], v[220:223], v[124:127], v[212:215]
  s_waitcnt vmcnt(6)
  s_barrier
  ds_read_b64_tr_b16 v[216:217], v8 offset:6144
  ds_read_b64_tr_b16 v[218:219], v8 offset:6912
  s_waitcnt lgkmcnt(10)
  v_mfma_f32_16x16x32_bf16 v[168:171], v[224:227], v[128:131], v[168:171]
  v_mfma_f32_16x16x32_bf16 v[172:175], v[224:227], v[132:135], v[172:175]
  ds_read_b64_tr_b16 v[220:221], v8 offset:24576
  ds_read_b64_tr_b16 v[222:223], v8 offset:25344
  v_mfma_f32_16x16x32_bf16 v[176:179], v[228:231], v[128:131], v[176:179]
  v_mfma_f32_16x16x32_bf16 v[180:183], v[228:231], v[132:135], v[180:183]
  s_mul_i32 s44, s3, 4608
  s_add_u32 m0, s44, 0
  s_bitcmp1_b32 s43, 0
  s_cselect_b32 s44, 0, 192
  s_add_u32 s44, s44, 3538944
  buffer_load_dwordx4 v2, s[12:15], s44 offen offset:0 lds
  ds_read_b64_tr_b16 v[224:225], v8 offset:6176
  ds_read_b64_tr_b16 v[226:227], v8 offset:6944
  s_waitcnt lgkmcnt(10)
  v_mfma_f32_16x16x32_bf16 v[184:187], v[232:235], v[128:131], v[184:187]
  v_mfma_f32_16x16x32_bf16 v[188:191], v[232:235], v[132:135], v[188:191]
  ds_read_b64_tr_b16 v[228:229], v8 offset:24608
  ds_read_b64_tr_b16 v[230:231], v8 offset:25376
  v_mfma_f32_16x16x32_bf16 v[192:195], v[236:239], v[128:131], v[192:195]
  v_mfma_f32_16x16x32_bf16 v[196:199], v[236:239], v[132:135], v[196:199]
  s_bitcmp1_b32 s43, 0
  s_cselect_b32 s44, 0, 192
  s_add_u32 s44, s44, 3538944
  buffer_load_dwordx4 v3, s[12:15], s44 offen offset:1024 lds
  ds_read_b64_tr_b16 v[232:233], v8 offset:6208
  ds_read_b64_tr_b16 v[234:235], v8 offset:6976
  s_waitcnt lgkmcnt(10)
  v_mfma_f32_16x16x32_bf16 v[200:203], v[240:243], v[128:131], v[200:203]
  v_mfma_f32_16x16x32_bf16 v[204:207], v[240:243], v[132:135], v[204:207]
  ds_read_b64_tr_b16 v[236:237], v8 offset:24640
  ds_read_b64_tr_b16 v[238:239], v8 offset:25408
  v_mfma_f32_16x16x32_bf16 v[208:211], v[244:247], v[128:131], v[208:211]
  v_mfma_f32_16x16x32_bf16 v[212:215], v[244:247], v[132:135], v[212:215]
  s_bitcmp1_b32 s43, 0
  s_cselect_b32 s44, 0, 192
  s_add_u32 s44, s44, 3538944
  buffer_load_dwordx4 v4, s[12:15], s44 offen offset:2048 lds
  ds_read_b64_tr_b16 v[240:241], v8 offset:9216
  ds_read_b64_tr_b16 v[242:243], v8 offset:9984
  s_waitcnt lgkmcnt(10)
  v_mfma_f32_16x16x32_bf16 v[168:171], v[216:219], v[136:139], v[168:171]
  v_mfma_f32_16x16x32_bf16 v[172:175], v[216:219], v[140:143], v[172:175]
  ds_read_b64_tr_b16 v[244:245], v8 offset:27648
  ds_read_b64_tr_b16 v[246:247], v8 offset:28416
  v_mfma_f32_16x16x32_bf16 v[176:179], v[220:223], v[136:139], v[176:179]
  v_mfma_f32_16x16x32_bf16 v[180:183], v[220:223], v[140:143], v[180:183]
  s_bitcmp1_b32 s43, 0
  s_cselect_b32 s44, 0, 192
  s_add_u32 s44, s44, 3538944
  buffer_load_dwordx4 v5, s[12:15], s44 offen offset:3072 lds
  ds_read_b64_tr_b16 v[216:217], v8 offset:9248
  ds_read_b64_tr_b16 v[218:219], v8 offset:10016
  s_waitcnt lgkmcnt(10)
  v_mfma_f32_16x16x32_bf16 v[184:187], v[224:227], v[136:139], v[184:187]
  v_mfma_f32_16x16x32_bf16 v[188:191], v[224:227], v[140:143], v[188:191]
  ds_read_b64_tr_b16 v[220:221], v8 offset:27680
  ds_read_b64_tr_b16 v[222:223], v8 offset:28448
  v_mfma_f32_16x16x32_bf16 v[192:195], v[228:231], v[136:139], v[192:195]
  v_mfma_f32_16x16x32_bf16 v[196:199], v[228:231], v[140:143], v[196:199]
  s_mul_i32 s44, s3, 4608
  s_add_u32 m0, s44, 4096
  s_bitcmp1_b32 s43, 0
  s_cselect_b32 s44, 0, 192
  s_add_u32 s44, s44, 3538944
  s_mov_b32 exec_hi, 0
  buffer_load_dwordx4 v6, s[12:15], s44 offen offset:0 lds
  s_mov_b32 exec_hi, -1
  ds_read_b64_tr_b16 v[224:225], v8 offset:9280
  ds_read_b64_tr_b16 v[226:227], v8 offset:10048
  s_waitcnt lgkmcnt(10)
  v_mfma_f32_16x16x32_bf16 v[200:203], v[232:235], v[136:139], v[200:203]
  v_mfma_f32_16x16x32_bf16 v[204:207], v[232:235], v[140:143], v[204:207]
  ds_read_b64_tr_b16 v[228:229], v8 offset:27712
  ds_read_b64_tr_b16 v[230:231], v8 offset:28480
  v_mfma_f32_16x16x32_bf16 v[208:211], v[236:239], v[136:139], v[208:211]
  v_mfma_f32_16x16x32_bf16 v[212:215], v[236:239], v[140:143], v[212:215]
  ds_read_b64_tr_b16 v[232:233], v8 offset:12288
  ds_read_b64_tr_b16 v[234:235], v8 offset:13056
  s_waitcnt lgkmcnt(10)
  v_mfma_f32_16x16x32_bf16 v[168:171], v[240:243], v[144:147], v[168:171]
  v_mfma_f32_16x16x32_bf16 v[172:175], v[240:243], v[148:151], v[172:175]
  ds_read_b64_tr_b16 v[236:237], v8 offset:30720
  ds_read_b64_tr_b16 v[238:239], v8 offset:31488
  v_mfma_f32_16x16x32_bf16 v[176:179], v[244:247], v[144:147], v[176:179]
  v_mfma_f32_16x16x32_bf16 v[180:183], v[244:247], v[148:151], v[180:183]
  ds_read_b64_tr_b16 v[240:241], v8 offset:12320
  ds_read_b64_tr_b16 v[242:243], v8 offset:13088
  s_waitcnt lgkmcnt(10)
  v_mfma_f32_16x16x32_bf16 v[184:187], v[216:219], v[144:147], v[184:187]
  v_mfma_f32_16x16x32_bf16 v[188:191], v[216:219], v[148:151], v[188:191]
  ds_read_b64_tr_b16 v[244:245], v8 offset:30752
  ds_read_b64_tr_b16 v[246:247], v8 offset:31520
  v_mfma_f32_16x16x32_bf16 v[192:195], v[220:223], v[144:147], v[192:195]
  v_mfma_f32_16x16x32_bf16 v[196:199], v[220:223], v[148:151], v[196:199]
  ds_read_b64_tr_b16 v[216:217], v8 offset:12352
  ds_read_b64_tr_b16 v[218:219], v8 offset:13120
  s_waitcnt lgkmcnt(10)
  v_mfma_f32_16x16x32_bf16 v[200:203], v[224:227], v[144:147], v[200:203]
  v_mfma_f32_16x16x32_bf16 v[204:207], v[224:227], v[148:151], v[204:207]
  ds_read_b64_tr_b16 v[220:221], v8 offset:30784
  ds_read_b64_tr_b16 v[222:223], v8 offset:31552
  v_mfma_f32_16x16x32_bf16 v[208:211], v[228:231], v[144:147], v[208:211]
  v_mfma_f32_16x16x32_bf16 v[212:215], v[228:231], v[148:151], v[212:215]
  ds_read_b64_tr_b16 v[224:225], v8 offset:15360
  ds_read_b64_tr_b16 v[226:227], v8 offset:16128
  s_waitcnt lgkmcnt(10)
  v_mfma_f32_16x16x32_bf16 v[168:171], v[232:235], v[152:155], v[168:171]
  v_mfma_f32_16x16x32_bf16 v[172:175], v[232:235], v[156:159], v[172:175]
  ds_read_b64_tr_b16 v[228:229], v8 offset:33792
  ds_read_b64_tr_b16 v[230:231], v8 offset:34560
  v_mfma_f32_16x16x32_bf16 v[176:179], v[236:239], v[152:155], v[176:179]
  v_mfma_f32_16x16x32_bf16 v[180:183], v[236:239], v[156:159], v[180:183]
  ds_read_b64_tr_b16 v[232:233], v8 offset:15392
  ds_read_b64_tr_b16 v[234:235], v8 offset:16160
  s_waitcnt lgkmcnt(10)
  v_mfma_f32_16x16x32_bf16 v[184:187], v[240:243], v[152:155], v[184:187]
  v_mfma_f32_16x16x32_bf16 v[188:191], v[240:243], v[156:159], v[188:191]
  ds_read_b64_tr_b16 v[236:237], v8 offset:33824
  ds_read_b64_tr_b16 v[238:239], v8 offset:34592
  v_mfma_f32_16x16x32_bf16 v[192:195], v[244:247], v[152:155], v[192:195]
  v_mfma_f32_16x16x32_bf16 v[196:199], v[244:247], v[156:159], v[196:199]
  ds_read_b64_tr_b16 v[240:241], v8 offset:15424
  ds_read_b64_tr_b16 v[242:243], v8 offset:16192
  s_waitcnt lgkmcnt(10)
  v_mfma_f32_16x16x32_bf16 v[200:203], v[216:219], v[152:155], v[200:203]
  v_mfma_f32_16x16x32_bf16 v[204:207], v[216:219], v[156:159], v[204:207]
  ds_read_b64_tr_b16 v[244:245], v8 offset:33856
  ds_read_b64_tr_b16 v[246:247], v8 offset:34624
  v_mfma_f32_16x16x32_bf16 v[208:211], v[220:223], v[152:155], v[208:211]
  v_mfma_f32_16x16x32_bf16 v[212:215], v[220:223], v[156:159], v[212:215]
  ds_read_b64_tr_b16 v[216:217], v9 offset:0
  ds_read_b64_tr_b16 v[218:219], v9 offset:768
  s_waitcnt lgkmcnt(10)
  v_mfma_f32_16x16x32_bf16 v[168:171], v[224:227], v[160:163], v[168:171]
  v_mfma_f32_16x16x32_bf16 v[172:175], v[224:227], v[164:167], v[172:175]
  ds_read_b64_tr_b16 v[220:221], v9 offset:18432
  ds_read_b64_tr_b16 v[222:223], v9 offset:19200
  v_mfma_f32_16x16x32_bf16 v[176:179], v[228:231], v[160:163], v[176:179]
  v_mfma_f32_16x16x32_bf16 v[180:183], v[228:231], v[164:167], v[180:183]
  ds_read_b64_tr_b16 v[224:225], v9 offset:32
  ds_read_b64_tr_b16 v[226:227], v9 offset:800
  s_waitcnt lgkmcnt(10)
  v_mfma_f32_16x16x32_bf16 v[184:187], v[232:235], v[160:163], v[184:187]
  v_mfma_f32_16x16x32_bf16 v[188:191], v[232:235], v[164:167], v[188:191]
  ds_read_b64_tr_b16 v[228:229], v9 offset:18464
  ds_read_b64_tr_b16 v[230:231], v9 offset:19232
  v_mfma_f32_16x16x32_bf16 v[192:195], v[236:239], v[160:163], v[192:195]
  v_mfma_f32_16x16x32_bf16 v[196:199], v[236:239], v[164:167], v[196:199]
  ds_read_b64_tr_b16 v[232:233], v9 offset:64
  ds_read_b64_tr_b16 v[234:235], v9 offset:832
  s_waitcnt lgkmcnt(10)
  v_mfma_f32_16x16x32_bf16 v[200:203], v[240:243], v[160:163], v[200:203]
  v_mfma_f32_16x16x32_bf16 v[204:207], v[240:243], v[164:167], v[204:207]
  ds_read_b64_tr_b16 v[236:237], v9 offset:18496
  ds_read_b64_tr_b16 v[238:239], v9 offset:19264
  v_mfma_f32_16x16x32_bf16 v[208:211], v[244:247], v[160:163], v[208:211]
  v_mfma_f32_16x16x32_bf16 v[212:215], v[244:247], v[164:167], v[212:215]
  s_add_u32 s45, s54, 1536
  s_nop 6
  v_pk_mul_f32 v[168:169], v[168:169], v[16:17] op_sel:[0,1]
  v_pk_mul_f32 v[170:171], v[170:171], v[16:17] op_sel:[0,1]
  v_pk_mul_f32 v[172:173], v[172:173], v[18:19] op_sel:[0,1]
  v_pk_mul_f32 v[174:175], v[174:175], v[18:19] op_sel:[0,1]
  v_exp_f32 v168, v168
  v_exp_f32 v169, v169
  v_exp_f32 v170, v170
  v_exp_f32 v171, v171
  v_exp_f32 v172, v172
  v_exp_f32 v173, v173
  v_exp_f32 v174, v174
  v_exp_f32 v175, v175
  v_pk_mul_f32 v[176:177], v[176:177], v[16:17] op_sel_hi:[1,0]
  v_pk_mul_f32 v[178:179], v[178:179], v[16:17] op_sel_hi:[1,0]
  v_pk_mul_f32 v[180:181], v[180:181], v[18:19] op_sel_hi:[1,0]
  v_pk_mul_f32 v[182:183], v[182:183], v[18:19] op_sel_hi:[1,0]
  v_pk_add_f32 v[168:169], v[168:169], 1.0 op_sel_hi:[1,0]
  v_pk_add_f32 v[170:171], v[170:171], 1.0 op_sel_hi:[1,0]
  v_pk_add_f32 v[172:173], v[172:173], 1.0 op_sel_hi:[1,0]
  v_pk_add_f32 v[174:175], v[174:175], 1.0 op_sel_hi:[1,0]
  v_rcp_f32 v168, v168
  v_rcp_f32 v169, v169
  v_rcp_f32 v170, v170
  v_rcp_f32 v171, v171
  v_rcp_f32 v172, v172
  v_rcp_f32 v173, v173
  v_rcp_f32 v174, v174
  v_rcp_f32 v175, v175
  s_nop 0
  v_pk_mul_f32 v[168:169], v[168:169], v[176:177]
  v_pk_mul_f32 v[170:171], v[170:171], v[178:179]
  v_pk_mul_f32 v[172:173], v[172:173], v[180:181]
  v_pk_mul_f32 v[174:175], v[174:175], v[182:183]
  v_cvt_pk_bf16_f32 v248, v168, v169
  v_cvt_pk_bf16_f32 v249, v170, v171
  v_cvt_pk_bf16_f32 v250, v172, v173
  v_cvt_pk_bf16_f32 v251, v174, v175
  s_nop 1
  v_permlane32_swap_b32 v248, v250
  v_permlane32_swap_b32 v249, v251
  s_nop 1
  buffer_store_dwordx4 v[248:251], v11, s[4:7], s45 offen offset:0 sc1
  v_pk_mul_f32 v[184:185], v[184:185], v[16:17] op_sel:[0,1]
  v_pk_mul_f32 v[186:187], v[186:187], v[16:17] op_sel:[0,1]
  v_pk_mul_f32 v[188:189], v[188:189], v[18:19] op_sel:[0,1]
  v_pk_mul_f32 v[190:191], v[190:191], v[18:19] op_sel:[0,1]
  v_exp_f32 v184, v184
  v_exp_f32 v185, v185
  v_exp_f32 v186, v186
  v_exp_f32 v187, v187
  v_exp_f32 v188, v188
  v_exp_f32 v189, v189
  v_exp_f32 v190, v190
  v_exp_f32 v191, v191
  v_pk_mul_f32 v[192:193], v[192:193], v[16:17] op_sel_hi:[1,0]
  v_pk_mul_f32 v[194:195], v[194:195], v[16:17] op_sel_hi:[1,0]
  v_pk_mul_f32 v[196:197], v[196:197], v[18:19] op_sel_hi:[1,0]
  v_pk_mul_f32 v[198:199], v[198:199], v[18:19] op_sel_hi:[1,0]
  v_pk_add_f32 v[184:185], v[184:185], 1.0 op_sel_hi:[1,0]
  v_pk_add_f32 v[186:187], v[186:187], 1.0 op_sel_hi:[1,0]
  v_pk_add_f32 v[188:189], v[188:189], 1.0 op_sel_hi:[1,0]
  v_pk_add_f32 v[190:191], v[190:191], 1.0 op_sel_hi:[1,0]
  v_rcp_f32 v184, v184
  v_rcp_f32 v185, v185
  v_rcp_f32 v186, v186
  v_rcp_f32 v187, v187
  v_rcp_f32 v188, v188
  v_rcp_f32 v189, v189
  v_rcp_f32 v190, v190
  v_rcp_f32 v191, v191
  s_nop 0
  v_pk_mul_f32 v[184:185], v[184:185], v[192:193]
  v_pk_mul_f32 v[186:187], v[186:187], v[194:195]
  v_pk_mul_f32 v[188:189], v[188:189], v[196:197]
  v_pk_mul_f32 v[190:191], v[190:191], v[198:199]
  v_cvt_pk_bf16_f32 v252, v184, v185
  v_cvt_pk_bf16_f32 v253, v186, v187
  v_cvt_pk_bf16_f32 v254, v188, v189
  v_cvt_pk_bf16_f32 v255, v190, v191
  s_nop 1
  v_permlane32_swap_b32 v252, v254
  v_permlane32_swap_b32 v253, v255
  s_nop 1
  buffer_store_dwordx4 v[252:255], v11, s[4:7], s45 offen offset:512 sc1
  v_pk_mul_f32 v[200:201], v[200:201], v[16:17] op_sel:[0,1]
  v_pk_mul_f32 v[202:203], v[202:203], v[16:17] op_sel:[0,1]
  v_pk_mul_f32 v[204:205], v[204:205], v[18:19] op_sel:[0,1]
  v_pk_mul_f32 v[206:207], v[206:207], v[18:19] op_sel:[0,1]
  v_exp_f32 v200, v200
  v_exp_f32 v201, v201
  v_exp_f32 v202, v202
  v_exp_f32 v203, v203
  v_exp_f32 v204, v204
  v_exp_f32 v205, v205
  v_exp_f32 v206, v206
  v_exp_f32 v207, v207
  v_pk_mul_f32 v[208:209], v[208:209], v[16:17] op_sel_hi:[1,0]
  v_pk_mul_f32 v[210:211], v[210:211], v[16:17] op_sel_hi:[1,0]
  v_pk_mul_f32 v[212:213], v[212:213], v[18:19] op_sel_hi:[1,0]
  v_pk_mul_f32 v[214:215], v[214:215], v[18:19] op_sel_hi:[1,0]
  v_pk_add_f32 v[200:201], v[200:201], 1.0 op_sel_hi:[1,0]
  v_pk_add_f32 v[202:203], v[202:203], 1.0 op_sel_hi:[1,0]
  v_pk_add_f32 v[204:205], v[204:205], 1.0 op_sel_hi:[1,0]
  v_pk_add_f32 v[206:207], v[206:207], 1.0 op_sel_hi:[1,0]
  v_rcp_f32 v200, v200
  v_rcp_f32 v201, v201
  v_rcp_f32 v202, v202
  v_rcp_f32 v203, v203
  v_rcp_f32 v204, v204
  v_rcp_f32 v205, v205
  v_rcp_f32 v206, v206
  v_rcp_f32 v207, v207
  s_nop 0
  v_pk_mul_f32 v[200:201], v[200:201], v[208:209]
  v_pk_mul_f32 v[202:203], v[202:203], v[210:211]
  v_pk_mul_f32 v[204:205], v[204:205], v[212:213]
  v_pk_mul_f32 v[206:207], v[206:207], v[214:215]
  v_cvt_pk_bf16_f32 v248, v200, v201
  v_cvt_pk_bf16_f32 v249, v202, v203
  v_cvt_pk_bf16_f32 v250, v204, v205
  v_cvt_pk_bf16_f32 v251, v206, v207
  s_nop 1
  v_permlane32_swap_b32 v248, v250
  v_permlane32_swap_b32 v249, v251
  s_nop 1
  buffer_store_dwordx4 v[248:251], v11, s[4:7], s45 offen offset:1024 sc1
  ds_read_b64_tr_b16 v[240:241], v9 offset:3072
  ds_read_b64_tr_b16 v[242:243], v9 offset:3840
  s_waitcnt lgkmcnt(10)
  v_mfma_f32_16x16x32_bf16 v[168:171], v[216:219], v[24:27], 0
  v_mfma_f32_16x16x32_bf16 v[172:175], v[216:219], v[28:31], 0
  ds_read_b64_tr_b16 v[244:245], v9 offset:21504
  ds_read_b64_tr_b16 v[246:247], v9 offset:22272
  v_mfma_f32_16x16x32_bf16 v[176:179], v[220:223], v[24:27], 0
  v_mfma_f32_16x16x32_bf16 v[180:183], v[220:223], v[28:31], 0
  ds_read_b64_tr_b16 v[216:217], v9 offset:3104
  ds_read_b64_tr_b16 v[218:219], v9 offset:3872
  s_waitcnt lgkmcnt(10)
  v_mfma_f32_16x16x32_bf16 v[184:187], v[224:227], v[24:27], 0
  v_mfma_f32_16x16x32_bf16 v[188:191], v[224:227], v[28:31], 0
  ds_read_b64_tr_b16 v[220:221], v9 offset:21536
  ds_read_b64_tr_b16 v[222:223], v9 offset:22304
  v_mfma_f32_16x16x32_bf16 v[192:195], v[228:231], v[24:27], 0
  v_mfma_f32_16x16x32_bf16 v[196:199], v[228:231], v[28:31], 0
  ds_read_b64_tr_b16 v[224:225], v9 offset:3136
  ds_read_b64_tr_b16 v[226:227], v9 offset:3904
  s_waitcnt lgkmcnt(10)
  v_mfma_f32_16x16x32_bf16 v[200:203], v[232:235], v[24:27], 0
  v_mfma_f32_16x16x32_bf16 v[204:207], v[232:235], v[28:31], 0
  ds_read_b64_tr_b16 v[228:229], v9 offset:21568
  ds_read_b64_tr_b16 v[230:231], v9 offset:22336
  v_mfma_f32_16x16x32_bf16 v[208:211], v[236:239], v[24:27], 0
  v_mfma_f32_16x16x32_bf16 v[212:215], v[236:239], v[28:31], 0
  s_waitcnt vmcnt(8)
  s_barrier
  ds_read_b64_tr_b16 v[232:233], v9 offset:6144
  ds_read_b64_tr_b16 v[234:235], v9 offset:6912
  s_waitcnt lgkmcnt(10)
  v_mfma_f32_16x16x32_bf16 v[168:171], v[240:243], v[32:35], v[168:171]
  v_mfma_f32_16x16x32_bf16 v[172:175], v[240:243], v[36:39], v[172:175]
  ds_read_b64_tr_b16 v[236:237], v9 offset:24576
  ds_read_b64_tr_b16 v[238:239], v9 offset:25344
  v_mfma_f32_16x16x32_bf16 v[176:179], v[244:247], v[32:35], v[176:179]
  v_mfma_f32_16x16x32_bf16 v[180:183], v[244:247], v[36:39], v[180:183]
  ds_read_b64_tr_b16 v[240:241], v9 offset:6176
  ds_read_b64_tr_b16 v[242:243], v9 offset:6944
  s_waitcnt lgkmcnt(10)
  v_mfma_f32_16x16x32_bf16 v[184:187], v[216:219], v[32:35], v[184:187]
  v_mfma_f32_16x16x32_bf16 v[188:191], v[216:219], v[36:39], v[188:191]
  ds_read_b64_tr_b16 v[244:245], v9 offset:24608
  ds_read_b64_tr_b16 v[246:247], v9 offset:25376
  v_mfma_f32_16x16x32_bf16 v[192:195], v[220:223], v[32:35], v[192:195]
  v_mfma_f32_16x16x32_bf16 v[196:199], v[220:223], v[36:39], v[196:199]
  ds_read_b64_tr_b16 v[216:217], v9 offset:6208
  ds_read_b64_tr_b16 v[218:219], v9 offset:6976
  s_waitcnt lgkmcnt(10)
  v_mfma_f32_16x16x32_bf16 v[200:203], v[224:227], v[32:35], v[200:203]
  v_mfma_f32_16x16x32_bf16 v[204:207], v[224:227], v[36:39], v[204:207]
  ds_read_b64_tr_b16 v[220:221], v9 offset:24640
  ds_read_b64_tr_b16 v[222:223], v9 offset:25408
  v_mfma_f32_16x16x32_bf16 v[208:211], v[228:231], v[32:35], v[208:211]
  v_mfma_f32_16x16x32_bf16 v[212:215], v[228:231], v[36:39], v[212:215]
  ds_read_b64_tr_b16 v[224:225], v9 offset:9216
  ds_read_b64_tr_b16 v[226:227], v9 offset:9984
  s_waitcnt lgkmcnt(10)
  v_mfma_f32_16x16x32_bf16 v[168:171], v[232:235], v[40:43], v[168:171]
  v_mfma_f32_16x16x32_bf16 v[172:175], v[232:235], v[44:47], v[172:175]
  ds_read_b64_tr_b16 v[228:229], v9 offset:27648
  ds_read_b64_tr_b16 v[230:231], v9 offset:28416
  v_mfma_f32_16x16x32_bf16 v[176:179], v[236:239], v[40:43], v[176:179]
  v_mfma_f32_16x16x32_bf16 v[180:183], v[236:239], v[44:47], v[180:183]
  ds_read_b64_tr_b16 v[232:233], v9 offset:9248
  ds_read_b64_tr_b16 v[234:235], v9 offset:10016
  s_waitcnt lgkmcnt(10)
  v_mfma_f32_16x16x32_bf16 v[184:187], v[240:243], v[40:43], v[184:187]
  v_mfma_f32_16x16x32_bf16 v[188:191], v[240:243], v[44:47], v[188:191]
  ds_read_b64_tr_b16 v[236:237], v9 offset:27680
  ds_read_b64_tr_b16 v[238:239], v9 offset:28448
  v_mfma_f32_16x16x32_bf16 v[192:195], v[244:247], v[40:43], v[192:195]
  v_mfma_f32_16x16x32_bf16 v[196:199], v[244:247], v[44:47], v[196:199]
  ds_read_b64_tr_b16 v[240:241], v9 offset:9280
  ds_read_b64_tr_b16 v[242:243], v9 offset:10048
  s_waitcnt lgkmcnt(10)
  v_mfma_f32_16x16x32_bf16 v[200:203], v[216:219], v[40:43], v[200:203]
  v_mfma_f32_16x16x32_bf16 v[204:207], v[216:219], v[44:47], v[204:207]
  ds_read_b64_tr_b16 v[244:245], v9 offset:27712
  ds_read_b64_tr_b16 v[246:247], v9 offset:28480
  v_mfma_f32_16x16x32_bf16 v[208:211], v[220:223], v[40:43], v[208:211]
  v_mfma_f32_16x16x32_bf16 v[212:215], v[220:223], v[44:47], v[212:215]
  ds_read_b64_tr_b16 v[216:217], v9 offset:12288
  ds_read_b64_tr_b16 v[218:219], v9 offset:13056
  s_waitcnt lgkmcnt(10)
  v_mfma_f32_16x16x32_bf16 v[168:171], v[224:227], v[48:51], v[168:171]
  v_mfma_f32_16x16x32_bf16 v[172:175], v[224:227], v[52:55], v[172:175]
  ds_read_b64_tr_b16 v[220:221], v9 offset:30720
  ds_read_b64_tr_b16 v[222:223], v9 offset:31488
  v_mfma_f32_16x16x32_bf16 v[176:179], v[228:231], v[48:51], v[176:179]
  v_mfma_f32_16x16x32_bf16 v[180:183], v[228:231], v[52:55], v[180:183]
  ds_read_b64_tr_b16 v[224:225], v9 offset:12320
  ds_read_b64_tr_b16 v[226:227], v9 offset:13088
  s_waitcnt lgkmcnt(10)
  v_mfma_f32_16x16x32_bf16 v[184:187], v[232:235], v[48:51], v[184:187]
  v_mfma_f32_16x16x32_bf16 v[188:191], v[232:235], v[52:55], v[188:191]
  ds_read_b64_tr_b16 v[228:229], v9 offset:30752
  ds_read_b64_tr_b16 v[230:231], v9 offset:31520
  v_mfma_f32_16x16x32_bf16 v[192:195], v[236:239], v[48:51], v[192:195]
  v_mfma_f32_16x16x32_bf16 v[196:199], v[236:239], v[52:55], v[196:199]
  ds_read_b64_tr_b16 v[232:233], v9 offset:12352
  ds_read_b64_tr_b16 v[234:235], v9 offset:13120
  s_waitcnt lgkmcnt(10)
  v_mfma_f32_16x16x32_bf16 v[200:203], v[240:243], v[48:51], v[200:203]
  v_mfma_f32_16x16x32_bf16 v[204:207], v[240:243], v[52:55], v[204:207]
  ds_read_b64_tr_b16 v[236:237], v9 offset:30784
  ds_read_b64_tr_b16 v[238:239], v9 offset:31552
  v_mfma_f32_16x16x32_bf16 v[208:211], v[244:247], v[48:51], v[208:211]
  v_mfma_f32_16x16x32_bf16 v[212:215], v[244:247], v[52:55], v[212:215]
  s_waitcnt vmcnt(0)
  s_barrier
  s_cmp_lg_u32 s3, 7
  s_cbranch_scc1 .Lm_54
  s_mul_i32 s44, s40, 139264
  s_lshl_b32 s45, s43, 2
  s_add_u32 s44, s44, s45
  s_add_u32 s44, s44, 1048576
  s_add_u32 s45, s101, 4
  v_mov_b32 v12, s45
  v_mul_u32_u24 v13, 4352, v0
  s_mov_b32 exec_lo, -1
  s_mov_b32 exec_hi, 0
  buffer_store_dword v12, v13, s[4:7], s44 offen sc1
  s_mov_b64 exec, -1
.Lm_54:
  ds_read_b64_tr_b16 v[240:241], v9 offset:15360
  ds_read_b64_tr_b16 v[242:243], v9 offset:16128
  s_waitcnt lgkmcnt(10)
  v_mfma_f32_16x16x32_bf16 v[168:171], v[216:219], v[56:59], v[168:171]
  v_mfma_f32_16x16x32_bf16 v[172:175], v[216:219], v[60:63], v[172:175]
  ds_read_b64_tr_b16 v[244:245], v9 offset:33792
  ds_read_b64_tr_b16 v[246:247], v9 offset:34560
  v_mfma_f32_16x16x32_bf16 v[176:179], v[220:223], v[56:59], v[176:179]
  v_mfma_f32_16x16x32_bf16 v[180:183], v[220:223], v[60:63], v[180:183]
  ds_read_b64_tr_b16 v[216:217], v9 offset:15392
  ds_read_b64_tr_b16 v[218:219], v9 offset:16160
  s_waitcnt lgkmcnt(10)
  v_mfma_f32_16x16x32_bf16 v[184:187], v[224:227], v[56:59], v[184:187]
  v_mfma_f32_16x16x32_bf16 v[188:191], v[224:227], v[60:63], v[188:191]
  ds_read_b64_tr_b16 v[220:221], v9 offset:33824
  ds_read_b64_tr_b16 v[222:223], v9 offset:34592
  v_mfma_f32_16x16x32_bf16 v[192:195], v[228:231], v[56:59], v[192:195]
  v_mfma_f32_16x16x32_bf16 v[196:199], v[228:231], v[60:63], v[196:199]
  ds_read_b64_tr_b16 v[224:225], v9 offset:15424
  ds_read_b64_tr_b16 v[226:227], v9 offset:16192
  s_waitcnt lgkmcnt(10)
  v_mfma_f32_16x16x32_bf16 v[200:203], v[232:235], v[56:59], v[200:203]
  v_mfma_f32_16x16x32_bf16 v[204:207], v[232:235], v[60:63], v[204:207]
  ds_read_b64_tr_b16 v[228:229], v9 offset:33856
  ds_read_b64_tr_b16 v[230:231], v9 offset:34624
  v_mfma_f32_16x16x32_bf16 v[208:211], v[236:239], v[56:59], v[208:211]
  v_mfma_f32_16x16x32_bf16 v[212:215], v[236:239], v[60:63], v[212:215]
  ds_read_b64_tr_b16 v[232:233], v10 offset:0
  ds_read_b64_tr_b16 v[234:235], v10 offset:768
  s_waitcnt lgkmcnt(10)
  v_mfma_f32_16x16x32_bf16 v[168:171], v[240:243], v[64:67], v[168:171]
  v_mfma_f32_16x16x32_bf16 v[172:175], v[240:243], v[68:71], v[172:175]
  ds_read_b64_tr_b16 v[236:237], v10 offset:18432
  ds_read_b64_tr_b16 v[238:239], v10 offset:19200
  v_mfma_f32_16x16x32_bf16 v[176:179], v[244:247], v[64:67], v[176:179]
  v_mfma_f32_16x16x32_bf16 v[180:183], v[244:247], v[68:71], v[180:183]
  ds_read_b64_tr_b16 v[240:241], v10 offset:32
  ds_read_b64_tr_b16 v[242:243], v10 offset:800
  s_waitcnt lgkmcnt(10)
  v_mfma_f32_16x16x32_bf16 v[184:187], v[216:219], v[64:67], v[184:187]
  v_mfma_f32_16x16x32_bf16 v[188:191], v[216:219], v[68:71], v[188:191]
  ds_read_b64_tr_b16 v[244:245], v10 offset:18464
  ds_read_b64_tr_b16 v[246:247], v10 offset:19232
  v_mfma_f32_16x16x32_bf16 v[192:195], v[220:223], v[64:67], v[192:195]
  v_mfma_f32_16x16x32_bf16 v[196:199], v[220:223], v[68:71], v[196:199]
  ds_read_b64_tr_b16 v[216:217], v10 offset:64
  ds_read_b64_tr_b16 v[218:219], v10 offset:832
  s_waitcnt lgkmcnt(10)
  v_mfma_f32_16x16x32_bf16 v[200:203], v[224:227], v[64:67], v[200:203]
  v_mfma_f32_16x16x32_bf16 v[204:207], v[224:227], v[68:71], v[204:207]
  ds_read_b64_tr_b16 v[220:221], v10 offset:18496
  ds_read_b64_tr_b16 v[222:223], v10 offset:19264
  v_mfma_f32_16x16x32_bf16 v[208:211], v[228:231], v[64:67], v[208:211]
  v_mfma_f32_16x16x32_bf16 v[212:215], v[228:231], v[68:71], v[212:215]
  ds_read_b64_tr_b16 v[224:225], v10 offset:3072
  ds_read_b64_tr_b16 v[226:227], v10 offset:3840
  s_waitcnt lgkmcnt(10)
  v_mfma_f32_16x16x32_bf16 v[168:171], v[232:235], v[72:75], v[168:171]
  v_mfma_f32_16x16x32_bf16 v[172:175], v[232:235], v[76:79], v[172:175]
  ds_read_b64_tr_b16 v[228:229], v10 offset:21504
  ds_read_b64_tr_b16 v[230:231], v10 offset:22272
  v_mfma_f32_16x16x32_bf16 v[176:179], v[236:239], v[72:75], v[176:179]
  v_mfma_f32_16x16x32_bf16 v[180:183], v[236:239], v[76:79], v[180:183]
  ds_read_b64_tr_b16 v[232:233], v10 offset:3104
  ds_read_b64_tr_b16 v[234:235], v10 offset:3872
  s_waitcnt lgkmcnt(10)
  v_mfma_f32_16x16x32_bf16 v[184:187], v[240:243], v[72:75], v[184:187]
  v_mfma_f32_16x16x32_bf16 v[188:191], v[240:243], v[76:79], v[188:191]
  ds_read_b64_tr_b16 v[236:237], v10 offset:21536
  ds_read_b64_tr_b16 v[238:239], v10 offset:22304
  v_mfma_f32_16x16x32_bf16 v[192:195], v[244:247], v[72:75], v[192:195]
  v_mfma_f32_16x16x32_bf16 v[196:199], v[244:247], v[76:79], v[196:199]
  ds_read_b64_tr_b16 v[240:241], v10 offset:3136
  ds_read_b64_tr_b16 v[242:243], v10 offset:3904
  s_waitcnt lgkmcnt(10)
  v_mfma_f32_16x16x32_bf16 v[200:203], v[216:219], v[72:75], v[200:203]
  v_mfma_f32_16x16x32_bf16 v[204:207], v[216:219], v[76:79], v[204:207]
  ds_read_b64_tr_b16 v[244:245], v10 offset:21568
  ds_read_b64_tr_b16 v[246:247], v10 offset:22336
  v_mfma_f32_16x16x32_bf16 v[208:211], v[220:223], v[72:75], v[208:211]
  v_mfma_f32_16x16x32_bf16 v[212:215], v[220:223], v[76:79], v[212:215]
  s_waitcnt vmcnt(3)
  s_barrier
  ds_read_b64_tr_b16 v[216:217], v10 offset:6144
  ds_read_b64_tr_b16 v[218:219], v10 offset:6912
  s_waitcnt lgkmcnt(10)
  v_mfma_f32_16x16x32_bf16 v[168:171], v[224:227], v[80:83], v[168:171]
  v_mfma_f32_16x16x32_bf16 v[172:175], v[224:227], v[84:87], v[172:175]
  ds_read_b64_tr_b16 v[220:221], v10 offset:24576
  ds_read_b64_tr_b16 v[222:223], v10 offset:25344
  v_mfma_f32_16x16x32_bf16 v[176:179], v[228:231], v[80:83], v[176:179]
  v_mfma_f32_16x16x32_bf16 v[180:183], v[228:231], v[84:87], v[180:183]
  ds_read_b64_tr_b16 v[224:225], v10 offset:6176
  ds_read_b64_tr_b16 v[226:227], v10 offset:6944
  s_waitcnt lgkmcnt(10)
  v_mfma_f32_16x16x32_bf16 v[184:187], v[232:235], v[80:83], v[184:187]
  v_mfma_f32_16x16x32_bf16 v[188:191], v[232:235], v[84:87], v[188:191]
  ds_read_b64_tr_b16 v[228:229], v10 offset:24608
  ds_read_b64_tr_b16 v[230:231], v10 offset:25376
  v_mfma_f32_16x16x32_bf16 v[192:195], v[236:239], v[80:83], v[192:195]
  v_mfma_f32_16x16x32_bf16 v[196:199], v[236:239], v[84:87], v[196:199]
  ds_read_b64_tr_b16 v[232:233], v10 offset:6208
  ds_read_b64_tr_b16 v[234:235], v10 offset:6976
  s_waitcnt lgkmcnt(10)
  v_mfma_f32_16x16x32_bf16 v[200:203], v[240:243], v[80:83], v[200:203]
  v_mfma_f32_16x16x32_bf16 v[204:207], v[240:243], v[84:87], v[204:207]
  ds_read_b64_tr_b16 v[236:237], v10 offset:24640
  ds_read_b64_tr_b16 v[238:239], v10 offset:25408
  v_mfma_f32_16x16x32_bf16 v[208:211], v[244:247], v[80:83], v[208:211]
  v_mfma_f32_16x16x32_bf16 v[212:215], v[244:247], v[84:87], v[212:215]
  s_cmp_lt_u32 s3, 4
  s_cbranch_scc1 .Lm_56
  s_cmp_ge_u32 s3, 6
  s_cbranch_scc1 .Lm_55
  s_and_b32 s44, s3, 1
  s_mul_i32 s58, s41, 72
  s_add_u32 s58, s58, s44
  s_mul_i32 s58, s58, 18432
  s_mul_i32 s45, s57, 288
  s_add_u32 s58, s58, s45
  s_mul_i32 s59, s44, 4608
  s_add_u32 s59, s59, 8192
  v_add_u32 v20, 0, v0
  v_mul_u32_u24 v21, 3641, v20
  v_lshrrev_b32 v21, 16, v21
  v_mul_u32_u24 v21, 864, v21
  v_lshl_add_u32 v2, v20, 4, v21
  v_add_u32 v20, 64, v0
  v_mul_u32_u24 v21, 3641, v20
  v_lshrrev_b32 v21, 16, v21
  v_mul_u32_u24 v21, 864, v21
  v_lshl_add_u32 v3, v20, 4, v21
  v_subrev_u32 v3, 1024, v3
  v_add_u32 v20, 128, v0
  v_mul_u32_u24 v21, 3641, v20
  v_lshrrev_b32 v21, 16, v21
  v_mul_u32_u24 v21, 864, v21
  v_lshl_add_u32 v4, v20, 4, v21
  v_subrev_u32 v4, 2048, v4
  v_add_u32 v20, 192, v0
  v_mul_u32_u24 v21, 3641, v20
  v_lshrrev_b32 v21, 16, v21
  v_mul_u32_u24 v21, 864, v21
  v_lshl_add_u32 v5, v20, 4, v21
  v_subrev_u32 v5, 3072, v5
  v_add_u32 v20, 256, v0
  v_mul_u32_u24 v21, 3641, v20
  v_lshrrev_b32 v21, 16, v21
  v_mul_u32_u24 v21, 864, v21
  v_lshl_add_u32 v6, v20, 4, v21
  s_branch .Lm_56
.Lm_55:
  s_and_b32 s44, s3, 1
  s_lshl_b32 s58, s56, 1
  s_add_u32 s58, s58, s44
  s_mul_i32 s58, s58, 576
  s_mul_i32 s45, s41, 36
  s_add_u32 s58, s58, s45
  s_lshl_b32 s58, s58, 10
  s_add_u32 s58, s58, 26378240
  s_lshl_b32 s59, s44, 12
  v_add_u32 v2, 0, v1
  v_add_u32 v3, 146432, v1
  v_add_u32 v4, 292864, v1
  v_add_u32 v5, 439296, v1
.Lm_56:
  ds_read_b64_tr_b16 v[240:241], v10 offset:9216
  ds_read_b64_tr_b16 v[242:243], v10 offset:9984
  s_waitcnt lgkmcnt(10)
  v_mfma_f32_16x16x32_bf16 v[168:171], v[216:219], v[88:91], v[168:171]
  v_mfma_f32_16x16x32_bf16 v[172:175], v[216:219], v[92:95], v[172:175]
  ds_read_b64_tr_b16 v[244:245], v10 offset:27648
  ds_read_b64_tr_b16 v[246:247], v10 offset:28416
  v_mfma_f32_16x16x32_bf16 v[176:179], v[220:223], v[88:91], v[176:179]
  v_mfma_f32_16x16x32_bf16 v[180:183], v[220:223], v[92:95], v[180:183]
  ds_read_b64_tr_b16 v[216:217], v10 offset:9248
  ds_read_b64_tr_b16 v[218:219], v10 offset:10016
  s_waitcnt lgkmcnt(10)
  v_mfma_f32_16x16x32_bf16 v[184:187], v[224:227], v[88:91], v[184:187]
  v_mfma_f32_16x16x32_bf16 v[188:191], v[224:227], v[92:95], v[188:191]
  ds_read_b64_tr_b16 v[220:221], v10 offset:27680
  ds_read_b64_tr_b16 v[222:223], v10 offset:28448
  v_mfma_f32_16x16x32_bf16 v[192:195], v[228:231], v[88:91], v[192:195]
  v_mfma_f32_16x16x32_bf16 v[196:199], v[228:231], v[92:95], v[196:199]
  ds_read_b64_tr_b16 v[224:225], v10 offset:9280
  ds_read_b64_tr_b16 v[226:227], v10 offset:10048
  s_waitcnt lgkmcnt(10)
  v_mfma_f32_16x16x32_bf16 v[200:203], v[232:235], v[88:91], v[200:203]
  v_mfma_f32_16x16x32_bf16 v[204:207], v[232:235], v[92:95], v[204:207]
  ds_read_b64_tr_b16 v[228:229], v10 offset:27712
  ds_read_b64_tr_b16 v[230:231], v10 offset:28480
  v_mfma_f32_16x16x32_bf16 v[208:211], v[236:239], v[88:91], v[208:211]
  v_mfma_f32_16x16x32_bf16 v[212:215], v[236:239], v[92:95], v[212:215]
  ds_read_b64_tr_b16 v[232:233], v10 offset:12288
  ds_read_b64_tr_b16 v[234:235], v10 offset:13056
  s_waitcnt lgkmcnt(10)
  v_mfma_f32_16x16x32_bf16 v[168:171], v[240:243], v[96:99], v[168:171]
  v_mfma_f32_16x16x32_bf16 v[172:175], v[240:243], v[100:103], v[172:175]
  ds_read_b64_tr_b16 v[236:237], v10 offset:30720
  ds_read_b64_tr_b16 v[238:239], v10 offset:31488
  v_mfma_f32_16x16x32_bf16 v[176:179], v[244:247], v[96:99], v[176:179]
  v_mfma_f32_16x16x32_bf16 v[180:183], v[244:247], v[100:103], v[180:183]
  ds_read_b64_tr_b16 v[240:241], v10 offset:12320
  ds_read_b64_tr_b16 v[242:243], v10 offset:13088
  s_waitcnt lgkmcnt(10)
  v_mfma_f32_16x16x32_bf16 v[184:187], v[216:219], v[96:99], v[184:187]
  v_mfma_f32_16x16x32_bf16 v[188:191], v[216:219], v[100:103], v[188:191]
  ds_read_b64_tr_b16 v[244:245], v10 offset:30752
  ds_read_b64_tr_b16 v[246:247], v10 offset:31520
  v_mfma_f32_16x16x32_bf16 v[192:195], v[220:223], v[96:99], v[192:195]
  v_mfma_f32_16x16x32_bf16 v[196:199], v[220:223], v[100:103], v[196:199]
  ds_read_b64_tr_b16 v[216:217], v10 offset:12352
  ds_read_b64_tr_b16 v[218:219], v10 offset:13120
  s_waitcnt lgkmcnt(10)
  v_mfma_f32_16x16x32_bf16 v[200:203], v[224:227], v[96:99], v[200:203]
  v_mfma_f32_16x16x32_bf16 v[204:207], v[224:227], v[100:103], v[204:207]
  ds_read_b64_tr_b16 v[220:221], v10 offset:30784
  ds_read_b64_tr_b16 v[222:223], v10 offset:31552
  v_mfma_f32_16x16x32_bf16 v[208:211], v[228:231], v[96:99], v[208:211]
  v_mfma_f32_16x16x32_bf16 v[212:215], v[228:231], v[100:103], v[212:215]
  ds_read_b64_tr_b16 v[224:225], v10 offset:15360
  ds_read_b64_tr_b16 v[226:227], v10 offset:16128
  s_waitcnt lgkmcnt(10)
  v_mfma_f32_16x16x32_bf16 v[168:171], v[232:235], v[104:107], v[168:171]
  v_mfma_f32_16x16x32_bf16 v[172:175], v[232:235], v[108:111], v[172:175]
  ds_read_b64_tr_b16 v[228:229], v10 offset:33792
  ds_read_b64_tr_b16 v[230:231], v10 offset:34560
  v_mfma_f32_16x16x32_bf16 v[176:179], v[236:239], v[104:107], v[176:179]
  v_mfma_f32_16x16x32_bf16 v[180:183], v[236:239], v[108:111], v[180:183]
  ds_read_b64_tr_b16 v[232:233], v10 offset:15392
  ds_read_b64_tr_b16 v[234:235], v10 offset:16160
  s_waitcnt lgkmcnt(10)
  v_mfma_f32_16x16x32_bf16 v[184:187], v[240:243], v[104:107], v[184:187]
  v_mfma_f32_16x16x32_bf16 v[188:191], v[240:243], v[108:111], v[188:191]
  ds_read_b64_tr_b16 v[236:237], v10 offset:33824
  ds_read_b64_tr_b16 v[238:239], v10 offset:34592
  v_mfma_f32_16x16x32_bf16 v[192:195], v[244:247], v[104:107], v[192:195]
  v_mfma_f32_16x16x32_bf16 v[196:199], v[244:247], v[108:111], v[196:199]
  ds_read_b64_tr_b16 v[240:241], v10 offset:15424
  ds_read_b64_tr_b16 v[242:243], v10 offset:16192
  s_waitcnt lgkmcnt(10)
  v_mfma_f32_16x16x32_bf16 v[200:203], v[216:219], v[104:107], v[200:203]
  v_mfma_f32_16x16x32_bf16 v[204:207], v[216:219], v[108:111], v[204:207]
  ds_read_b64_tr_b16 v[244:245], v10 offset:33856
  ds_read_b64_tr_b16 v[246:247], v10 offset:34624
  v_mfma_f32_16x16x32_bf16 v[208:211], v[220:223], v[104:107], v[208:211]
  v_mfma_f32_16x16x32_bf16 v[212:215], v[220:223], v[108:111], v[212:215]
  s_cmp_lg_u32 s3, 3
  s_cbranch_scc1 .Lm_57
  s_lshl_b32 s46, s40, 5
  s_add_u32 s46, s46, s43
  s_mul_i32 s46, s46, 4352
  s_lshl_b32 s47, s41, 5
  s_add_u32 s46, s46, s47
  s_add_u32 s46, s46, 1048576
  v_and_b32 v12, 7, v0
  v_lshlrev_b32 v12, 2, v12
  buffer_load_dword v13, v12, s[4:7], s46 offen sc1
.Lm_57:
  ds_read_b64_tr_b16 v[216:217], v7 offset:0
  ds_read_b64_tr_b16 v[218:219], v7 offset:768
  s_waitcnt lgkmcnt(10)
  v_mfma_f32_16x16x32_bf16 v[168:171], v[224:227], v[112:115], v[168:171]
  v_mfma_f32_16x16x32_bf16 v[172:175], v[224:227], v[116:119], v[172:175]
  ds_read_b64_tr_b16 v[220:221], v7 offset:18432
  ds_read_b64_tr_b16 v[222:223], v7 offset:19200
  v_mfma_f32_16x16x32_bf16 v[176:179], v[228:231], v[112:115], v[176:179]
  v_mfma_f32_16x16x32_bf16 v[180:183], v[228:231], v[116:119], v[180:183]
  ds_read_b64_tr_b16 v[224:225], v7 offset:32
  ds_read_b64_tr_b16 v[226:227], v7 offset:800
  s_waitcnt lgkmcnt(10)
  v_mfma_f32_16x16x32_bf16 v[184:187], v[232:235], v[112:115], v[184:187]
  v_mfma_f32_16x16x32_bf16 v[188:191], v[232:235], v[116:119], v[188:191]
  ds_read_b64_tr_b16 v[228:229], v7 offset:18464
  ds_read_b64_tr_b16 v[230:231], v7 offset:19232
  v_mfma_f32_16x16x32_bf16 v[192:195], v[236:239], v[112:115], v[192:195]
  v_mfma_f32_16x16x32_bf16 v[196:199], v[236:239], v[116:119], v[196:199]
  ds_read_b64_tr_b16 v[232:233], v7 offset:64
  ds_read_b64_tr_b16 v[234:235], v7 offset:832
  s_waitcnt lgkmcnt(10)
  v_mfma_f32_16x16x32_bf16 v[200:203], v[240:243], v[112:115], v[200:203]
  v_mfma_f32_16x16x32_bf16 v[204:207], v[240:243], v[116:119], v[204:207]
  ds_read_b64_tr_b16 v[236:237], v7 offset:18496
  ds_read_b64_tr_b16 v[238:239], v7 offset:19264
  v_mfma_f32_16x16x32_bf16 v[208:211], v[244:247], v[112:115], v[208:211]
  v_mfma_f32_16x16x32_bf16 v[212:215], v[244:247], v[116:119], v[212:215]
  ds_read_b64_tr_b16 v[240:241], v7 offset:3072
  ds_read_b64_tr_b16 v[242:243], v7 offset:3840
  s_waitcnt lgkmcnt(10)
  v_mfma_f32_16x16x32_bf16 v[168:171], v[216:219], v[120:123], v[168:171]
  v_mfma_f32_16x16x32_bf16 v[172:175], v[216:219], v[124:127], v[172:175]
  ds_read_b64_tr_b16 v[244:245], v7 offset:21504
  ds_read_b64_tr_b16 v[246:247], v7 offset:22272
  v_mfma_f32_16x16x32_bf16 v[176:179], v[220:223], v[120:123], v[176:179]
  v_mfma_f32_16x16x32_bf16 v[180:183], v[220:223], v[124:127], v[180:183]
  ds_read_b64_tr_b16 v[216:217], v7 offset:3104
  ds_read_b64_tr_b16 v[218:219], v7 offset:3872
  s_waitcnt lgkmcnt(10)
  v_mfma_f32_16x16x32_bf16 v[184:187], v[224:227], v[120:123], v[184:187]
  v_mfma_f32_16x16x32_bf16 v[188:191], v[224:227], v[124:127], v[188:191]
  ds_read_b64_tr_b16 v[220:221], v7 offset:21536
  ds_read_b64_tr_b16 v[222:223], v7 offset:22304
  v_mfma_f32_16x16x32_bf16 v[192:195], v[228:231], v[120:123], v[192:195]
  v_mfma_f32_16x16x32_bf16 v[196:199], v[228:231], v[124:127], v[196:199]
  ds_read_b64_tr_b16 v[224:225], v7 offset:3136
  ds_read_b64_tr_b16 v[226:227], v7 offset:3904
  s_waitcnt lgkmcnt(10)
  v_mfma_f32_16x16x32_bf16 v[200:203], v[232:235], v[120:123], v[200:203]
  v_mfma_f32_16x16x32_bf16 v[204:207], v[232:235], v[124:127], v[204:207]
  ds_read_b64_tr_b16 v[228:229], v7 offset:21568
  ds_read_b64_tr_b16 v[230:231], v7 offset:22336
  v_mfma_f32_16x16x32_bf16 v[208:211], v[236:239], v[120:123], v[208:211]
  v_mfma_f32_16x16x32_bf16 v[212:215], v[236:239], v[124:127], v[212:215]
  s_cmp_lg_u32 s3, 3
  s_cbranch_scc1 .Lm_58
  s_add_u32 s45, s101, 4
  s_waitcnt vmcnt(0)
  v_subrev_u32 v13, s45, v13
  v_cmp_le_u32 vcc, 12, v13
  s_nop 3
  s_cmp_eq_u64 vcc, 0
  s_cbranch_scc1 .Lm_58
  s_lshl_b32 s46, s40, 5
  s_add_u32 s46, s46, s43
  s_mul_i32 s46, s46, 4352
  s_add_u32 s46, s46, 1048576
  v_and_b32 v13, 31, v0
  v_lshlrev_b32 v12, 2, v13
  v_add_u32 v12, s46, v12
  v_lshrrev_b32 v13, 3, v13
  v_cmp_eq_u32 vcc, s41, v13
  s_nop 3
  s_mov_b32 vcc_hi, 0
  s_add_u32 s45, s101, 4
  s_mov_b32 s44, 0
  s_nop 2
  s_mov_b64 exec, vcc
.Lm_59:
  buffer_load_dword v14, v12, s[4:7], 0 offen sc1
  s_waitcnt vmcnt(0)
  v_subrev_u32 v13, s45, v14
  v_cmp_le_u32 vcc, 12, v13
  s_add_u32 s44, s44, 1
  s_nop 2
  s_cmp_eq_u64 vcc, 0
  s_cbranch_scc1 .Lm_60
  s_sleep 1
  s_cmp_lt_u32 s44, 0x40000
  s_cbranch_scc1 .Lm_59
.Lm_60:
  s_mov_b64 exec, -1
.Lm_58:
  s_barrier
  s_cmp_lt_u32 s3, 4
  s_cbranch_scc1 .Lm_62
  s_cmp_ge_u32 s3, 6
  s_cbranch_scc1 .Lm_61
  s_add_u32 s46, s58, 0
  s_add_u32 m0, s59, 52224
  s_nop 0
  buffer_load_dwordx4 v2, s[8:11], s46 offen offset:0 lds
  buffer_load_dwordx4 v3, s[8:11], s46 offen offset:1024 lds
  buffer_load_dwordx4 v4, s[8:11], s46 offen offset:2048 lds
  buffer_load_dwordx4 v5, s[8:11], s46 offen offset:3072 lds
  s_add_u32 m0, s59, 56320
  s_mov_b32 exec_hi, 0
  buffer_load_dwordx4 v6, s[8:11], s46 offen lds
  s_mov_b32 exec_hi, -1
  s_branch .Lm_62
.Lm_61:
  s_add_u32 s46, s58, 0
  s_add_u32 m0, s59, 52224
  s_nop 0
  buffer_load_dwordx4 v2, s[4:7], s46 offen offset:0 sc1 lds
  buffer_load_dwordx4 v3, s[4:7], s46 offen offset:1024 sc1 lds
  buffer_load_dwordx4 v4, s[4:7], s46 offen offset:2048 sc1 lds
  buffer_load_dwordx4 v5, s[4:7], s46 offen offset:3072 sc1 lds
.Lm_62:
  ds_read_b64_tr_b16 v[232:233], v7 offset:6144
  ds_read_b64_tr_b16 v[234:235], v7 offset:6912
  s_waitcnt lgkmcnt(10)
  v_mfma_f32_16x16x32_bf16 v[168:171], v[240:243], v[128:131], v[168:171]
  v_mfma_f32_16x16x32_bf16 v[172:175], v[240:243], v[132:135], v[172:175]
  ds_read_b64_tr_b16 v[236:237], v7 offset:24576
  ds_read_b64_tr_b16 v[238:239], v7 offset:25344
  v_mfma_f32_16x16x32_bf16 v[176:179], v[244:247], v[128:131], v[176:179]
  v_mfma_f32_16x16x32_bf16 v[180:183], v[244:247], v[132:135], v[180:183]
  ds_read_b64_tr_b16 v[240:241], v7 offset:6176
  ds_read_b64_tr_b16 v[242:243], v7 offset:6944
  s_waitcnt lgkmcnt(10)
  v_mfma_f32_16x16x32_bf16 v[184:187], v[216:219], v[128:131], v[184:187]
  v_mfma_f32_16x16x32_bf16 v[188:191], v[216:219], v[132:135], v[188:191]
  ds_read_b64_tr_b16 v[244:245], v7 offset:24608
  ds_read_b64_tr_b16 v[246:247], v7 offset:25376
  v_mfma_f32_16x16x32_bf16 v[192:195], v[220:223], v[128:131], v[192:195]
  v_mfma_f32_16x16x32_bf16 v[196:199], v[220:223], v[132:135], v[196:199]
  ds_read_b64_tr_b16 v[216:217], v7 offset:6208
  ds_read_b64_tr_b16 v[218:219], v7 offset:6976
  s_waitcnt lgkmcnt(10)
  v_mfma_f32_16x16x32_bf16 v[200:203], v[224:227], v[128:131], v[200:203]
  v_mfma_f32_16x16x32_bf16 v[204:207], v[224:227], v[132:135], v[204:207]
  ds_read_b64_tr_b16 v[220:221], v7 offset:24640
  ds_read_b64_tr_b16 v[222:223], v7 offset:25408
  v_mfma_f32_16x16x32_bf16 v[208:211], v[228:231], v[128:131], v[208:211]
  v_mfma_f32_16x16x32_bf16 v[212:215], v[228:231], v[132:135], v[212:215]
  s_cmp_lt_u32 s3, 4
  s_cbranch_scc1 .Lm_64
  s_cmp_ge_u32 s3, 6
  s_cbranch_scc1 .Lm_63
  s_add_u32 s46, s58, 36864
  s_add_u32 m0, s59, 69632
  s_nop 0
  buffer_load_dwordx4 v2, s[8:11], s46 offen offset:0 lds
  buffer_load_dwordx4 v3, s[8:11], s46 offen offset:1024 lds
  buffer_load_dwordx4 v4, s[8:11], s46 offen offset:2048 lds
  buffer_load_dwordx4 v5, s[8:11], s46 offen offset:3072 lds
  s_add_u32 m0, s59, 73728
  s_mov_b32 exec_hi, 0
  buffer_load_dwordx4 v6, s[8:11], s46 offen lds
  s_mov_b32 exec_hi, -1
  s_branch .Lm_64
.Lm_63:
  s_add_u32 s46, s58, 1024
  s_add_u32 m0, s59, 69632
  s_nop 0
  buffer_load_dwordx4 v2, s[4:7], s46 offen offset:0 sc1 lds
  buffer_load_dwordx4 v3, s[4:7], s46 offen offset:1024 sc1 lds
  buffer_load_dwordx4 v4, s[4:7], s46 offen offset:2048 sc1 lds
  buffer_load_dwordx4 v5, s[4:7], s46 offen offset:3072 sc1 lds
.Lm_64:
  ds_read_b64_tr_b16 v[224:225], v7 offset:9216
  ds_read_b64_tr_b16 v[226:227], v7 offset:9984
  s_waitcnt lgkmcnt(10)
  v_mfma_f32_16x16x32_bf16 v[168:171], v[232:235], v[136:139], v[168:171]
  v_mfma_f32_16x16x32_bf16 v[172:175], v[232:235], v[140:143], v[172:175]
  ds_read_b64_tr_b16 v[228:229], v7 offset:27648
  ds_read_b64_tr_b16 v[230:231], v7 offset:28416
  v_mfma_f32_16x16x32_bf16 v[176:179], v[236:239], v[136:139], v[176:179]
  v_mfma_f32_16x16x32_bf16 v[180:183], v[236:239], v[140:143], v[180:183]
  ds_read_b64_tr_b16 v[232:233], v7 offset:9248
  ds_read_b64_tr_b16 v[234:235], v7 offset:10016
  s_waitcnt lgkmcnt(10)
  v_mfma_f32_16x16x32_bf16 v[184:187], v[240:243], v[136:139], v[184:187]
  v_mfma_f32_16x16x32_bf16 v[188:191], v[240:243], v[140:143], v[188:191]
  ds_read_b64_tr_b16 v[236:237], v7 offset:27680
  ds_read_b64_tr_b16 v[238:239], v7 offset:28448
  v_mfma_f32_16x16x32_bf16 v[192:195], v[244:247], v[136:139], v[192:195]
  v_mfma_f32_16x16x32_bf16 v[196:199], v[244:247], v[140:143], v[196:199]
  ds_read_b64_tr_b16 v[240:241], v7 offset:9280
  ds_read_b64_tr_b16 v[242:243], v7 offset:10048
  s_waitcnt lgkmcnt(10)
  v_mfma_f32_16x16x32_bf16 v[200:203], v[216:219], v[136:139], v[200:203]
  v_mfma_f32_16x16x32_bf16 v[204:207], v[216:219], v[140:143], v[204:207]
  ds_read_b64_tr_b16 v[244:245], v7 offset:27712
  ds_read_b64_tr_b16 v[246:247], v7 offset:28480
  v_mfma_f32_16x16x32_bf16 v[208:211], v[220:223], v[136:139], v[208:211]
  v_mfma_f32_16x16x32_bf16 v[212:215], v[220:223], v[140:143], v[212:215]
  s_cmp_lt_u32 s3, 4
  s_cbranch_scc1 .Lm_66
  s_cmp_ge_u32 s3, 6
  s_cbranch_scc1 .Lm_65
  s_add_u32 s46, s58, 73728
  s_add_u32 m0, s59, 87040
  s_nop 0
  buffer_load_dwordx4 v2, s[8:11], s46 offen offset:0 lds
  buffer_load_dwordx4 v3, s[8:11], s46 offen offset:1024 lds
  buffer_load_dwordx4 v4, s[8:11], s46 offen offset:2048 lds
  buffer_load_dwordx4 v5, s[8:11], s46 offen offset:3072 lds
  s_add_u32 m0, s59, 91136
  s_mov_b32 exec_hi, 0
  buffer_load_dwordx4 v6, s[8:11], s46 offen lds
  s_mov_b32 exec_hi, -1
  s_branch .Lm_66
.Lm_65:
  s_add_u32 s46, s58, 2048
  s_add_u32 m0, s59, 87040
  s_nop 0
  buffer_load_dwordx4 v2, s[4:7], s46 offen offset:0 sc1 lds
  buffer_load_dwordx4 v3, s[4:7], s46 offen offset:1024 sc1 lds
  buffer_load_dwordx4 v4, s[4:7], s46 offen offset:2048 sc1 lds
  buffer_load_dwordx4 v5, s[4:7], s46 offen offset:3072 sc1 lds
.Lm_66:
  ds_read_b64_tr_b16 v[216:217], v7 offset:12288
  ds_read_b64_tr_b16 v[218:219], v7 offset:13056
  s_waitcnt lgkmcnt(10)
  v_mfma_f32_16x16x32_bf16 v[168:171], v[224:227], v[144:147], v[168:171]
  v_mfma_f32_16x16x32_bf16 v[172:175], v[224:227], v[148:151], v[172:175]
  ds_read_b64_tr_b16 v[220:221], v7 offset:30720
  ds_read_b64_tr_b16 v[222:223], v7 offset:31488
  v_mfma_f32_16x16x32_bf16 v[176:179], v[228:231], v[144:147], v[176:179]
  v_mfma_f32_16x16x32_bf16 v[180:183], v[228:231], v[148:151], v[180:183]
  ds_read_b64_tr_b16 v[224:225], v7 offset:12320
  ds_read_b64_tr_b16 v[226:227], v7 offset:13088
  s_waitcnt lgkmcnt(10)
  v_mfma_f32_16x16x32_bf16 v[184:187], v[232:235], v[144:147], v[184:187]
  v_mfma_f32_16x16x32_bf16 v[188:191], v[232:235], v[148:151], v[188:191]
  ds_read_b64_tr_b16 v[228:229], v7 offset:30752
  ds_read_b64_tr_b16 v[230:231], v7 offset:31520
  v_mfma_f32_16x16x32_bf16 v[192:195], v[236:239], v[144:147], v[192:195]
  v_mfma_f32_16x16x32_bf16 v[196:199], v[236:239], v[148:151], v[196:199]
  ds_read_b64_tr_b16 v[232:233], v7 offset:12352
  ds_read_b64_tr_b16 v[234:235], v7 offset:13120
  s_waitcnt lgkmcnt(10)
  v_mfma_f32_16x16x32_bf16 v[200:203], v[240:243], v[144:147], v[200:203]
  v_mfma_f32_16x16x32_bf16 v[204:207], v[240:243], v[148:151], v[204:207]
  ds_read_b64_tr_b16 v[236:237], v7 offset:30784
  ds_read_b64_tr_b16 v[238:239], v7 offset:31552
  v_mfma_f32_16x16x32_bf16 v[208:211], v[244:247], v[144:147], v[208:211]
  v_mfma_f32_16x16x32_bf16 v[212:215], v[244:247], v[148:151], v[212:215]
  s_cmp_lt_u32 s3, 4
  s_cbranch_scc1 .Lm_68
  s_cmp_ge_u32 s3, 6
  s_cbranch_scc1 .Lm_67
  s_add_u32 s46, s58, 221184
  s_add_u32 m0, s59, 104448
  s_nop 0
  buffer_load_dwordx4 v2, s[8:11], s46 offen offset:0 lds
  buffer_load_dwordx4 v3, s[8:11], s46 offen offset:1024 lds
  buffer_load_dwordx4 v4, s[8:11], s46 offen offset:2048 lds
  buffer_load_dwordx4 v5, s[8:11], s46 offen offset:3072 lds
  s_add_u32 m0, s59, 108544
  s_mov_b32 exec_hi, 0
  buffer_load_dwordx4 v6, s[8:11], s46 offen lds
  s_mov_b32 exec_hi, -1
  s_branch .Lm_68
.Lm_67:
  s_add_u32 s46, s58, 6144
  s_add_u32 m0, s59, 104448
  s_nop 0
  buffer_load_dwordx4 v2, s[4:7], s46 offen offset:0 sc1 lds
  buffer_load_dwordx4 v3, s[4:7], s46 offen offset:1024 sc1 lds
  buffer_load_dwordx4 v4, s[4:7], s46 offen offset:2048 sc1 lds
  buffer_load_dwordx4 v5, s[4:7], s46 offen offset:3072 sc1 lds
.Lm_68:
  ds_read_b64_tr_b16 v[240:241], v7 offset:15360
  ds_read_b64_tr_b16 v[242:243], v7 offset:16128
  s_waitcnt lgkmcnt(10)
  v_mfma_f32_16x16x32_bf16 v[168:171], v[216:219], v[152:155], v[168:171]
  v_mfma_f32_16x16x32_bf16 v[172:175], v[216:219], v[156:159], v[172:175]
  ds_read_b64_tr_b16 v[244:245], v7 offset:33792
  ds_read_b64_tr_b16 v[246:247], v7 offset:34560
  v_mfma_f32_16x16x32_bf16 v[176:179], v[220:223], v[152:155], v[176:179]
  v_mfma_f32_16x16x32_bf16 v[180:183], v[220:223], v[156:159], v[180:183]
  ds_read_b64_tr_b16 v[216:217], v7 offset:15392
  ds_read_b64_tr_b16 v[218:219], v7 offset:16160
  s_waitcnt lgkmcnt(10)
  v_mfma_f32_16x16x32_bf16 v[184:187], v[224:227], v[152:155], v[184:187]
  v_mfma_f32_16x16x32_bf16 v[188:191], v[224:227], v[156:159], v[188:191]
  ds_read_b64_tr_b16 v[220:221], v7 offset:33824
  ds_read_b64_tr_b16 v[222:223], v7 offset:34592
  v_mfma_f32_16x16x32_bf16 v[192:195], v[228:231], v[152:155], v[192:195]
  v_mfma_f32_16x16x32_bf16 v[196:199], v[228:231], v[156:159], v[196:199]
  ds_read_b64_tr_b16 v[224:225], v7 offset:15424
  ds_read_b64_tr_b16 v[226:227], v7 offset:16192
  s_waitcnt lgkmcnt(10)
  v_mfma_f32_16x16x32_bf16 v[200:203], v[232:235], v[152:155], v[200:203]
  v_mfma_f32_16x16x32_bf16 v[204:207], v[232:235], v[156:159], v[204:207]
  ds_read_b64_tr_b16 v[228:229], v7 offset:33856
  ds_read_b64_tr_b16 v[230:231], v7 offset:34624
  v_mfma_f32_16x16x32_bf16 v[208:211], v[236:239], v[152:155], v[208:211]
  v_mfma_f32_16x16x32_bf16 v[212:215], v[236:239], v[156:159], v[212:215]
  s_cmp_lt_u32 s3, 4
  s_cbranch_scc1 .Lm_70
  s_cmp_ge_u32 s3, 6
  s_cbranch_scc1 .Lm_69
  s_add_u32 s46, s58, 258048
  s_add_u32 m0, s59, 121856
  s_nop 0
  buffer_load_dwordx4 v2, s[8:11], s46 offen offset:0 lds
  buffer_load_dwordx4 v3, s[8:11], s46 offen offset:1024 lds
  buffer_load_dwordx4 v4, s[8:11], s46 offen offset:2048 lds
  buffer_load_dwordx4 v5, s[8:11], s46 offen offset:3072 lds
  s_add_u32 m0, s59, 125952
  s_mov_b32 exec_hi, 0
  buffer_load_dwordx4 v6, s[8:11], s46 offen lds
  s_mov_b32 exec_hi, -1
  s_branch .Lm_70
.Lm_69:
  s_add_u32 s46, s58, 7168
  s_add_u32 m0, s59, 121856
  s_nop 0
  buffer_load_dwordx4 v2, s[4:7], s46 offen offset:0 sc1 lds
  buffer_load_dwordx4 v3, s[4:7], s46 offen offset:1024 sc1 lds
  buffer_load_dwordx4 v4, s[4:7], s46 offen offset:2048 sc1 lds
  buffer_load_dwordx4 v5, s[4:7], s46 offen offset:3072 sc1 lds
.Lm_70:
  s_waitcnt lgkmcnt(8)
  v_mfma_f32_16x16x32_bf16 v[168:171], v[240:243], v[160:163], v[168:171]
  v_mfma_f32_16x16x32_bf16 v[172:175], v[240:243], v[164:167], v[172:175]
  v_mfma_f32_16x16x32_bf16 v[176:179], v[244:247], v[160:163], v[176:179]
  v_mfma_f32_16x16x32_bf16 v[180:183], v[244:247], v[164:167], v[180:183]
  s_waitcnt lgkmcnt(4)
  v_mfma_f32_16x16x32_bf16 v[184:187], v[216:219], v[160:163], v[184:187]
  v_mfma_f32_16x16x32_bf16 v[188:191], v[216:219], v[164:167], v[188:191]
  v_mfma_f32_16x16x32_bf16 v[192:195], v[220:223], v[160:163], v[192:195]
  v_mfma_f32_16x16x32_bf16 v[196:199], v[220:223], v[164:167], v[196:199]
  s_waitcnt lgkmcnt(0)
  v_mfma_f32_16x16x32_bf16 v[200:203], v[224:227], v[160:163], v[200:203]
  v_mfma_f32_16x16x32_bf16 v[204:207], v[224:227], v[164:167], v[204:207]
  v_mfma_f32_16x16x32_bf16 v[208:211], v[228:231], v[160:163], v[208:211]
  v_mfma_f32_16x16x32_bf16 v[212:215], v[228:231], v[164:167], v[212:215]
.L_code_s5:
  s_barrier
  s_cmp_ge_u32 s3, 4
  s_cbranch_scc1 .L_s5_loader
  s_bitcmp1_b32 s43, 0
  s_cselect_b32 s45, 0, 3072
  s_add_u32 s45, s45, s54
  s_nop 6
  v_pk_mul_f32 v[168:169], v[168:169], v[16:17] op_sel:[0,1]
  v_pk_mul_f32 v[170:171], v[170:171], v[16:17] op_sel:[0,1]
  v_pk_mul_f32 v[172:173], v[172:173], v[18:19] op_sel:[0,1]
  v_pk_mul_f32 v[174:175], v[174:175], v[18:19] op_sel:[0,1]
  v_exp_f32 v168, v168
  v_exp_f32 v169, v169
  v_exp_f32 v170, v170
  v_exp_f32 v171, v171
  v_exp_f32 v172, v172
  v_exp_f32 v173, v173
  v_exp_f32 v174, v174
  v_exp_f32 v175, v175
  v_pk_mul_f32 v[176:177], v[176:177], v[16:17] op_sel_hi:[1,0]
  v_pk_mul_f32 v[178:179], v[178:179], v[16:17] op_sel_hi:[1,0]
  v_pk_mul_f32 v[180:181], v[180:181], v[18:19] op_sel_hi:[1,0]
  v_pk_mul_f32 v[182:183], v[182:183], v[18:19] op_sel_hi:[1,0]
  v_pk_add_f32 v[168:169], v[168:169], 1.0 op_sel_hi:[1,0]
  v_pk_add_f32 v[170:171], v[170:171], 1.0 op_sel_hi:[1,0]
  v_pk_add_f32 v[172:173], v[172:173], 1.0 op_sel_hi:[1,0]
  v_pk_add_f32 v[174:175], v[174:175], 1.0 op_sel_hi:[1,0]
  v_rcp_f32 v168, v168
  v_rcp_f32 v169, v169
  v_rcp_f32 v170, v170
  v_rcp_f32 v171, v171
  v_rcp_f32 v172, v172
  v_rcp_f32 v173, v173
  v_rcp_f32 v174, v174
  v_rcp_f32 v175, v175
  s_nop 0
  v_pk_mul_f32 v[168:169], v[168:169], v[176:177]
  v_pk_mul_f32 v[170:171], v[170:171], v[178:179]
  v_pk_mul_f32 v[172:173], v[172:173], v[180:181]
  v_pk_mul_f32 v[174:175], v[174:175], v[182:183]
  v_cvt_pk_bf16_f32 v248, v168, v169
  v_cvt_pk_bf16_f32 v249, v170, v171
  v_cvt_pk_bf16_f32 v250, v172, v173
  v_cvt_pk_bf16_f32 v251, v174, v175
  s_nop 1
  v_permlane32_swap_b32 v248, v250
  v_permlane32_swap_b32 v249, v251
  s_nop 1
  buffer_store_dwordx4 v[248:251], v11, s[4:7], s45 offen offset:0 sc1
  v_pk_mul_f32 v[184:185], v[184:185], v[16:17] op_sel:[0,1]
  v_pk_mul_f32 v[186:187], v[186:187], v[16:17] op_sel:[0,1]
  v_pk_mul_f32 v[188:189], v[188:189], v[18:19] op_sel:[0,1]
  v_pk_mul_f32 v[190:191], v[190:191], v[18:19] op_sel:[0,1]
  v_exp_f32 v184, v184
  v_exp_f32 v185, v185
  v_exp_f32 v186, v186
  v_exp_f32 v187, v187
  v_exp_f32 v188, v188
  v_exp_f32 v189, v189
  v_exp_f32 v190, v190
  v_exp_f32 v191, v191
  v_pk_mul_f32 v[192:193], v[192:193], v[16:17] op_sel_hi:[1,0]
  v_pk_mul_f32 v[194:195], v[194:195], v[16:17] op_sel_hi:[1,0]
  v_pk_mul_f32 v[196:197], v[196:197], v[18:19] op_sel_hi:[1,0]
  v_pk_mul_f32 v[198:199], v[198:199], v[18:19] op_sel_hi:[1,0]
  v_pk_add_f32 v[184:185], v[184:185], 1.0 op_sel_hi:[1,0]
  v_pk_add_f32 v[186:187], v[186:187], 1.0 op_sel_hi:[1,0]
  v_pk_add_f32 v[188:189], v[188:189], 1.0 op_sel_hi:[1,0]
  v_pk_add_f32 v[190:191], v[190:191], 1.0 op_sel_hi:[1,0]
  v_rcp_f32 v184, v184
  v_rcp_f32 v185, v185
  v_rcp_f32 v186, v186
  v_rcp_f32 v187, v187
  v_rcp_f32 v188, v188
  v_rcp_f32 v189, v189
  v_rcp_f32 v190, v190
  v_rcp_f32 v191, v191
  s_nop 0
  v_pk_mul_f32 v[184:185], v[184:185], v[192:193]
  v_pk_mul_f32 v[186:187], v[186:187], v[194:195]
  v_pk_mul_f32 v[188:189], v[188:189], v[196:197]
  v_pk_mul_f32 v[190:191], v[190:191], v[198:199]
  v_cvt_pk_bf16_f32 v252, v184, v185
  v_cvt_pk_bf16_f32 v253, v186, v187
  v_cvt_pk_bf16_f32 v254, v188, v189
  v_cvt_pk_bf16_f32 v255, v190, v191
  s_nop 1
  v_permlane32_swap_b32 v252, v254
  v_permlane32_swap_b32 v253, v255
  s_nop 1
  buffer_store_dwordx4 v[252:255], v11, s[4:7], s45 offen offset:512 sc1
  v_pk_mul_f32 v[200:201], v[200:201], v[16:17] op_sel:[0,1]
  v_pk_mul_f32 v[202:203], v[202:203], v[16:17] op_sel:[0,1]
  v_pk_mul_f32 v[204:205], v[204:205], v[18:19] op_sel:[0,1]
  v_pk_mul_f32 v[206:207], v[206:207], v[18:19] op_sel:[0,1]
  v_exp_f32 v200, v200
  v_exp_f32 v201, v201
  v_exp_f32 v202, v202
  v_exp_f32 v203, v203
  v_exp_f32 v204, v204
  v_exp_f32 v205, v205
  v_exp_f32 v206, v206
  v_exp_f32 v207, v207
  v_pk_mul_f32 v[208:209], v[208:209], v[16:17] op_sel_hi:[1,0]
  v_pk_mul_f32 v[210:211], v[210:211], v[16:17] op_sel_hi:[1,0]
  v_pk_mul_f32 v[212:213], v[212:213], v[18:19] op_sel_hi:[1,0]
  v_pk_mul_f32 v[214:215], v[214:215], v[18:19] op_sel_hi:[1,0]
  v_pk_add_f32 v[200:201], v[200:201], 1.0 op_sel_hi:[1,0]
  v_pk_add_f32 v[202:203], v[202:203], 1.0 op_sel_hi:[1,0]
  v_pk_add_f32 v[204:205], v[204:205], 1.0 op_sel_hi:[1,0]
  v_pk_add_f32 v[206:207], v[206:207], 1.0 op_sel_hi:[1,0]
  v_rcp_f32 v200, v200
  v_rcp_f32 v201, v201
  v_rcp_f32 v202, v202
  v_rcp_f32 v203, v203
  v_rcp_f32 v204, v204
  v_rcp_f32 v205, v205
  v_rcp_f32 v206, v206
  v_rcp_f32 v207, v207
  s_nop 0
  v_pk_mul_f32 v[200:201], v[200:201], v[208:209]
  v_pk_mul_f32 v[202:203], v[202:203], v[210:211]
  v_pk_mul_f32 v[204:205], v[204:205], v[212:213]
  v_pk_mul_f32 v[206:207], v[206:207], v[214:215]
  v_cvt_pk_bf16_f32 v248, v200, v201
  v_cvt_pk_bf16_f32 v249, v202, v203
  v_cvt_pk_bf16_f32 v250, v204, v205
  v_cvt_pk_bf16_f32 v251, v206, v207
  s_nop 1
  v_permlane32_swap_b32 v248, v250
  v_permlane32_swap_b32 v249, v251
  s_nop 1
  buffer_store_dwordx4 v[248:251], v11, s[4:7], s45 offen offset:1024 sc1
  s_lshl_b32 s44, s3, 11
  v_add_u32 v88, s44, v1
  v_bfe_u32 v6, v0, 5, 1
  v_mul_u32_u24 v6, 4608, v6
  v_bfe_u32 v7, v0, 2, 3
  v_mul_u32_u24 v7, 288, v7
  v_and_b32 v8, 3, v0
  v_lshlrev_b32 v8, 3, v8
  v_add3_u32 v91, v6, v7, v8
  v_add_u32 v91, 8192, v91
  v_add_u32 v89, 52224, v88
  v_add_u32 v92, 52224, v91
  v_add_u32 v90, 104448, v88
  v_add_u32 v93, 104448, v91
  s_barrier
  ds_read_b128 v[96:99], v89 offset:0
  ds_read_b128 v[100:103], v89 offset:1024
  ds_read_b64_tr_b16 v[128:129], v92 offset:0
  ds_read_b64_tr_b16 v[130:131], v92 offset:2304
  ds_read_b64_tr_b16 v[132:133], v92 offset:32
  ds_read_b64_tr_b16 v[134:135], v92 offset:2336
  ds_read_b64_tr_b16 v[136:137], v92 offset:64
  ds_read_b64_tr_b16 v[138:139], v92 offset:2368
  ds_read_b64_tr_b16 v[140:141], v92 offset:96
  ds_read_b64_tr_b16 v[142:143], v92 offset:2400
  ds_read_b64_tr_b16 v[144:145], v92 offset:128
  ds_read_b64_tr_b16 v[146:147], v92 offset:2432
  ds_read_b64_tr_b16 v[148:149], v92 offset:160
  ds_read_b64_tr_b16 v[150:151], v92 offset:2464
  s_waitcnt lgkmcnt(6)
  v_mfma_f32_16x16x32_bf16 v[16:19], v[128:131], v[96:99], 0
  ds_read_b64_tr_b16 v[152:153], v92 offset:192
  ds_read_b64_tr_b16 v[154:155], v92 offset:2496
  v_mfma_f32_16x16x32_bf16 v[52:55], v[128:131], v[100:103], 0
  v_mfma_f32_16x16x32_bf16 v[20:23], v[132:135], v[96:99], 0
  ds_read_b64_tr_b16 v[156:157], v92 offset:224
  ds_read_b64_tr_b16 v[158:159], v92 offset:2528
  v_mfma_f32_16x16x32_bf16 v[56:59], v[132:135], v[100:103], 0
  v_mfma_f32_16x16x32_bf16 v[24:27], v[136:139], v[96:99], 0
  ds_read_b64_tr_b16 v[160:161], v92 offset:256
  ds_read_b64_tr_b16 v[162:163], v92 offset:2560
  v_mfma_f32_16x16x32_bf16 v[60:63], v[136:139], v[100:103], 0
  s_waitcnt lgkmcnt(6)
  v_mfma_f32_16x16x32_bf16 v[28:31], v[140:143], v[96:99], 0
  s_barrier
  ds_read_b128 v[104:107], v89 offset:17408
  ds_read_b128 v[108:111], v89 offset:18432
  ds_read_b64_tr_b16 v[164:165], v92 offset:17408
  ds_read_b64_tr_b16 v[166:167], v92 offset:19712
  v_mfma_f32_16x16x32_bf16 v[64:67], v[140:143], v[100:103], 0
  v_mfma_f32_16x16x32_bf16 v[32:35], v[144:147], v[96:99], 0
  ds_read_b64_tr_b16 v[168:169], v92 offset:17440
  ds_read_b64_tr_b16 v[170:171], v92 offset:19744
  v_mfma_f32_16x16x32_bf16 v[68:71], v[144:147], v[100:103], 0
  v_mfma_f32_16x16x32_bf16 v[36:39], v[148:151], v[96:99], 0
  ds_read_b64_tr_b16 v[172:173], v92 offset:17472
  ds_read_b64_tr_b16 v[174:175], v92 offset:19776
  v_mfma_f32_16x16x32_bf16 v[72:75], v[148:151], v[100:103], 0
  s_waitcnt lgkmcnt(8)
  v_mfma_f32_16x16x32_bf16 v[40:43], v[152:155], v[96:99], 0
  ds_read_b64_tr_b16 v[176:177], v92 offset:17504
  ds_read_b64_tr_b16 v[178:179], v92 offset:19808
  v_mfma_f32_16x16x32_bf16 v[76:79], v[152:155], v[100:103], 0
  v_mfma_f32_16x16x32_bf16 v[44:47], v[156:159], v[96:99], 0
  ds_read_b64_tr_b16 v[180:181], v92 offset:17536
  ds_read_b64_tr_b16 v[182:183], v92 offset:19840
  v_mfma_f32_16x16x32_bf16 v[80:83], v[156:159], v[100:103], 0
  v_mfma_f32_16x16x32_bf16 v[48:51], v[160:163], v[96:99], 0
  ds_read_b64_tr_b16 v[128:129], v92 offset:17568
  ds_read_b64_tr_b16 v[130:131], v92 offset:19872
  v_mfma_f32_16x16x32_bf16 v[84:87], v[160:163], v[100:103], 0
  s_waitcnt lgkmcnt(6)
  v_mfma_f32_16x16x32_bf16 v[16:19], v[164:167], v[104:107], v[16:19]
  ds_read_b64_tr_b16 v[132:133], v92 offset:17600
  ds_read_b64_tr_b16 v[134:135], v92 offset:19904
  v_mfma_f32_16x16x32_bf16 v[52:55], v[164:167], v[108:111], v[52:55]
  v_mfma_f32_16x16x32_bf16 v[20:23], v[168:171], v[104:107], v[20:23]
  ds_read_b64_tr_b16 v[136:137], v92 offset:17632
  ds_read_b64_tr_b16 v[138:139], v92 offset:19936
  v_mfma_f32_16x16x32_bf16 v[56:59], v[168:171], v[108:111], v[56:59]
  v_mfma_f32_16x16x32_bf16 v[24:27], v[172:175], v[104:107], v[24:27]
  ds_read_b64_tr_b16 v[140:141], v92 offset:17664
  ds_read_b64_tr_b16 v[142:143], v92 offset:19968
  v_mfma_f32_16x16x32_bf16 v[60:63], v[172:175], v[108:111], v[60:63]
  s_waitcnt lgkmcnt(6)
  v_mfma_f32_16x16x32_bf16 v[28:31], v[176:179], v[104:107], v[28:31]
  s_barrier
  ds_read_b128 v[112:115], v89 offset:34816
  ds_read_b128 v[116:119], v89 offset:35840
  ds_read_b64_tr_b16 v[144:145], v92 offset:34816
  ds_read_b64_tr_b16 v[146:147], v92 offset:37120
  v_mfma_f32_16x16x32_bf16 v[64:67], v[176:179], v[108:111], v[64:67]
  v_mfma_f32_16x16x32_bf16 v[32:35], v[180:183], v[104:107], v[32:35]
  ds_read_b64_tr_b16 v[148:149], v92 offset:34848
  ds_read_b64_tr_b16 v[150:151], v92 offset:37152
  v_mfma_f32_16x16x32_bf16 v[68:71], v[180:183], v[108:111], v[68:71]
  v_mfma_f32_16x16x32_bf16 v[36:39], v[128:131], v[104:107], v[36:39]
  ds_read_b64_tr_b16 v[152:153], v92 offset:34880
  ds_read_b64_tr_b16 v[154:155], v92 offset:37184
  v_mfma_f32_16x16x32_bf16 v[72:75], v[128:131], v[108:111], v[72:75]
  s_waitcnt lgkmcnt(8)
  v_mfma_f32_16x16x32_bf16 v[40:43], v[132:135], v[104:107], v[40:43]
  ds_read_b64_tr_b16 v[156:157], v92 offset:34912
  ds_read_b64_tr_b16 v[158:159], v92 offset:37216
  v_mfma_f32_16x16x32_bf16 v[76:79], v[132:135], v[108:111], v[76:79]
  v_mfma_f32_16x16x32_bf16 v[44:47], v[136:139], v[104:107], v[44:47]
  ds_read_b64_tr_b16 v[160:161], v92 offset:34944
  ds_read_b64_tr_b16 v[162:163], v92 offset:37248
  v_mfma_f32_16x16x32_bf16 v[80:83], v[136:139], v[108:111], v[80:83]
  v_mfma_f32_16x16x32_bf16 v[48:51], v[140:143], v[104:107], v[48:51]
  ds_read_b64_tr_b16 v[164:165], v92 offset:34976
  ds_read_b64_tr_b16 v[166:167], v92 offset:37280
  v_mfma_f32_16x16x32_bf16 v[84:87], v[140:143], v[108:111], v[84:87]
  s_waitcnt lgkmcnt(6)
  v_mfma_f32_16x16x32_bf16 v[16:19], v[144:147], v[112:115], v[16:19]
  ds_read_b64_tr_b16 v[168:169], v92 offset:35008
  ds_read_b64_tr_b16 v[170:171], v92 offset:37312
  v_mfma_f32_16x16x32_bf16 v[52:55], v[144:147], v[116:119], v[52:55]
  v_mfma_f32_16x16x32_bf16 v[20:23], v[148:151], v[112:115], v[20:23]
  ds_read_b64_tr_b16 v[172:173], v92 offset:35040
  ds_read_b64_tr_b16 v[174:175], v92 offset:37344
  v_mfma_f32_16x16x32_bf16 v[56:59], v[148:151], v[116:119], v[56:59]
  v_mfma_f32_16x16x32_bf16 v[24:27], v[152:155], v[112:115], v[24:27]
  ds_read_b64_tr_b16 v[176:177], v92 offset:35072
  ds_read_b64_tr_b16 v[178:179], v92 offset:37376
  v_mfma_f32_16x16x32_bf16 v[60:63], v[152:155], v[116:119], v[60:63]
  s_waitcnt lgkmcnt(6)
  v_mfma_f32_16x16x32_bf16 v[28:31], v[156:159], v[112:115], v[28:31]
  s_barrier
  ds_read_b128 v[120:123], v90 offset:0
  ds_read_b128 v[124:127], v90 offset:1024
  ds_read_b64_tr_b16 v[180:181], v93 offset:0
  ds_read_b64_tr_b16 v[182:183], v93 offset:2304
  v_mfma_f32_16x16x32_bf16 v[64:67], v[156:159], v[116:119], v[64:67]
  v_mfma_f32_16x16x32_bf16 v[32:35], v[160:163], v[112:115], v[32:35]
  ds_read_b64_tr_b16 v[128:129], v93 offset:32
  ds_read_b64_tr_b16 v[130:131], v93 offset:2336
  v_mfma_f32_16x16x32_bf16 v[68:71], v[160:163], v[116:119], v[68:71]
  v_mfma_f32_16x16x32_bf16 v[36:39], v[164:167], v[112:115], v[36:39]
  ds_read_b64_tr_b16 v[132:133], v93 offset:64
  ds_read_b64_tr_b16 v[134:135], v93 offset:2368
  v_mfma_f32_16x16x32_bf16 v[72:75], v[164:167], v[116:119], v[72:75]
  s_waitcnt lgkmcnt(8)
  v_mfma_f32_16x16x32_bf16 v[40:43], v[168:171], v[112:115], v[40:43]
  ds_read_b64_tr_b16 v[136:137], v93 offset:96
  ds_read_b64_tr_b16 v[138:139], v93 offset:2400
  v_mfma_f32_16x16x32_bf16 v[76:79], v[168:171], v[116:119], v[76:79]
  v_mfma_f32_16x16x32_bf16 v[44:47], v[172:175], v[112:115], v[44:47]
  ds_read_b64_tr_b16 v[140:141], v93 offset:128
  ds_read_b64_tr_b16 v[142:143], v93 offset:2432
  v_mfma_f32_16x16x32_bf16 v[80:83], v[172:175], v[116:119], v[80:83]
  v_mfma_f32_16x16x32_bf16 v[48:51], v[176:179], v[112:115], v[48:51]
  ds_read_b64_tr_b16 v[144:145], v93 offset:160
  ds_read_b64_tr_b16 v[146:147], v93 offset:2464
  v_mfma_f32_16x16x32_bf16 v[84:87], v[176:179], v[116:119], v[84:87]
  s_waitcnt lgkmcnt(6)
  v_mfma_f32_16x16x32_bf16 v[16:19], v[180:183], v[120:123], v[16:19]
  ds_read_b64_tr_b16 v[148:149], v93 offset:192
  ds_read_b64_tr_b16 v[150:151], v93 offset:2496
  v_mfma_f32_16x16x32_bf16 v[52:55], v[180:183], v[124:127], v[52:55]
  v_mfma_f32_16x16x32_bf16 v[20:23], v[128:131], v[120:123], v[20:23]
  ds_read_b64_tr_b16 v[152:153], v93 offset:224
  ds_read_b64_tr_b16 v[154:155], v93 offset:2528
  v_mfma_f32_16x16x32_bf16 v[56:59], v[128:131], v[124:127], v[56:59]
  v_mfma_f32_16x16x32_bf16 v[24:27], v[132:135], v[120:123], v[24:27]
  ds_read_b64_tr_b16 v[156:157], v93 offset:256
  ds_read_b64_tr_b16 v[158:159], v93 offset:2560
  v_mfma_f32_16x16x32_bf16 v[60:63], v[132:135], v[124:127], v[60:63]
  s_waitcnt lgkmcnt(6)
  v_mfma_f32_16x16x32_bf16 v[28:31], v[136:139], v[120:123], v[28:31]
  s_barrier
  ds_read_b128 v[96:99], v90 offset:17408
  ds_read_b128 v[100:103], v90 offset:18432
  ds_read_b64_tr_b16 v[160:161], v93 offset:17408
  ds_read_b64_tr_b16 v[162:163], v93 offset:19712
  v_mfma_f32_16x16x32_bf16 v[64:67], v[136:139], v[124:127], v[64:67]
  v_mfma_f32_16x16x32_bf16 v[32:35], v[140:143], v[120:123], v[32:35]
  ds_read_b64_tr_b16 v[164:165], v93 offset:17440
  ds_read_b64_tr_b16 v[166:167], v93 offset:19744
  v_mfma_f32_16x16x32_bf16 v[68:71], v[140:143], v[124:127], v[68:71]
  v_mfma_f32_16x16x32_bf16 v[36:39], v[144:147], v[120:123], v[36:39]
  ds_read_b64_tr_b16 v[168:169], v93 offset:17472
  ds_read_b64_tr_b16 v[170:171], v93 offset:19776
  v_mfma_f32_16x16x32_bf16 v[72:75], v[144:147], v[124:127], v[72:75]
  s_waitcnt lgkmcnt(8)
  v_mfma_f32_16x16x32_bf16 v[40:43], v[148:151], v[120:123], v[40:43]
  ds_read_b64_tr_b16 v[172:173], v93 offset:17504
  ds_read_b64_tr_b16 v[174:175], v93 offset:19808
  v_mfma_f32_16x16x32_bf16 v[76:79], v[148:151], v[124:127], v[76:79]
  v_mfma_f32_16x16x32_bf16 v[44:47], v[152:155], v[120:123], v[44:47]
  ds_read_b64_tr_b16 v[176:177], v93 offset:17536
  ds_read_b64_tr_b16 v[178:179], v93 offset:19840
  v_mfma_f32_16x16x32_bf16 v[80:83], v[152:155], v[124:127], v[80:83]
  v_mfma_f32_16x16x32_bf16 v[48:51], v[156:159], v[120:123], v[48:51]
  ds_read_b64_tr_b16 v[180:181], v93 offset:17568
  ds_read_b64_tr_b16 v[182:183], v93 offset:19872
  v_mfma_f32_16x16x32_bf16 v[84:87], v[156:159], v[124:127], v[84:87]
  s_waitcnt lgkmcnt(6)
  v_mfma_f32_16x16x32_bf16 v[16:19], v[160:163], v[96:99], v[16:19]
  ds_read_b64_tr_b16 v[128:129], v93 offset:17600
  ds_read_b64_tr_b16 v[130:131], v93 offset:19904
  v_mfma_f32_16x16x32_bf16 v[52:55], v[160:163], v[100:103], v[52:55]
  v_mfma_f32_16x16x32_bf16 v[20:23], v[164:167], v[96:99], v[20:23]
  ds_read_b64_tr_b16 v[132:133], v93 offset:17632
  ds_read_b64_tr_b16 v[134:135], v93 offset:19936
  v_mfma_f32_16x16x32_bf16 v[56:59], v[164:167], v[100:103], v[56:59]
  v_mfma_f32_16x16x32_bf16 v[24:27], v[168:171], v[96:99], v[24:27]
  ds_read_b64_tr_b16 v[136:137], v93 offset:17664
  ds_read_b64_tr_b16 v[138:139], v93 offset:19968
  v_mfma_f32_16x16x32_bf16 v[60:63], v[168:171], v[100:103], v[60:63]
  s_waitcnt lgkmcnt(6)
  v_mfma_f32_16x16x32_bf16 v[28:31], v[172:175], v[96:99], v[28:31]
  s_barrier
  ds_read_b128 v[104:107], v88 offset:0
  ds_read_b128 v[108:111], v88 offset:1024
  ds_read_b64_tr_b16 v[140:141], v91 offset:0
  ds_read_b64_tr_b16 v[142:143], v91 offset:2304
  v_mfma_f32_16x16x32_bf16 v[64:67], v[172:175], v[100:103], v[64:67]
  v_mfma_f32_16x16x32_bf16 v[32:35], v[176:179], v[96:99], v[32:35]
  ds_read_b64_tr_b16 v[144:145], v91 offset:32
  ds_read_b64_tr_b16 v[146:147], v91 offset:2336
  v_mfma_f32_16x16x32_bf16 v[68:71], v[176:179], v[100:103], v[68:71]
  v_mfma_f32_16x16x32_bf16 v[36:39], v[180:183], v[96:99], v[36:39]
  ds_read_b64_tr_b16 v[148:149], v91 offset:64
  ds_read_b64_tr_b16 v[150:151], v91 offset:2368
  v_mfma_f32_16x16x32_bf16 v[72:75], v[180:183], v[100:103], v[72:75]
  s_waitcnt lgkmcnt(8)
  v_mfma_f32_16x16x32_bf16 v[40:43], v[128:131], v[96:99], v[40:43]
  ds_read_b64_tr_b16 v[152:153], v91 offset:96
  ds_read_b64_tr_b16 v[154:155], v91 offset:2400
  v_mfma_f32_16x16x32_bf16 v[76:79], v[128:131], v[100:103], v[76:79]
  v_mfma_f32_16x16x32_bf16 v[44:47], v[132:135], v[96:99], v[44:47]
  ds_read_b64_tr_b16 v[156:157], v91 offset:128
  ds_read_b64_tr_b16 v[158:159], v91 offset:2432
  v_mfma_f32_16x16x32_bf16 v[80:83], v[132:135], v[100:103], v[80:83]
  v_mfma_f32_16x16x32_bf16 v[48:51], v[136:139], v[96:99], v[48:51]
  ds_read_b64_tr_b16 v[160:161], v91 offset:160
  ds_read_b64_tr_b16 v[162:163], v91 offset:2464
  v_mfma_f32_16x16x32_bf16 v[84:87], v[136:139], v[100:103], v[84:87]
  s_waitcnt lgkmcnt(6)
  v_mfma_f32_16x16x32_bf16 v[16:19], v[140:143], v[104:107], v[16:19]
  ds_read_b64_tr_b16 v[164:165], v91 offset:192
  ds_read_b64_tr_b16 v[166:167], v91 offset:2496
  v_mfma_f32_16x16x32_bf16 v[52:55], v[140:143], v[108:111], v[52:55]
  v_mfma_f32_16x16x32_bf16 v[20:23], v[144:147], v[104:107], v[20:23]
  ds_read_b64_tr_b16 v[168:169], v91 offset:224
  ds_read_b64_tr_b16 v[170:171], v91 offset:2528
  v_mfma_f32_16x16x32_bf16 v[56:59], v[144:147], v[108:111], v[56:59]
  v_mfma_f32_16x16x32_bf16 v[24:27], v[148:151], v[104:107], v[24:27]
  ds_read_b64_tr_b16 v[172:173], v91 offset:256
  ds_read_b64_tr_b16 v[174:175], v91 offset:2560
  v_mfma_f32_16x16x32_bf16 v[60:63], v[148:151], v[108:111], v[60:63]
  s_waitcnt lgkmcnt(6)
  v_mfma_f32_16x16x32_bf16 v[28:31], v[152:155], v[104:107], v[28:31]
  s_waitcnt vmcnt(0)
  s_barrier
  s_cmp_lg_u32 s3, 1
  s_cbranch_scc1 .Lm_71
  s_mul_i32 s44, s40, 139264
  s_lshl_b32 s45, s43, 2
  s_add_u32 s44, s44, s45
  s_add_u32 s44, s44, 1048576
  s_add_u32 s45, s101, 5
  v_mov_b32 v6, s45
  v_mul_u32_u24 v7, 4352, v0
  s_mov_b32 exec_lo, -1
  s_mov_b32 exec_hi, 0
  buffer_store_dword v6, v7, s[4:7], s44 offen sc1
  s_mov_b64 exec, -1
.Lm_71:
  ds_read_b128 v[112:115], v88 offset:17408
  ds_read_b128 v[116:119], v88 offset:18432
  ds_read_b64_tr_b16 v[176:177], v91 offset:17408
  ds_read_b64_tr_b16 v[178:179], v91 offset:19712
  v_mfma_f32_16x16x32_bf16 v[64:67], v[152:155], v[108:111], v[64:67]
  v_mfma_f32_16x16x32_bf16 v[32:35], v[156:159], v[104:107], v[32:35]
  ds_read_b64_tr_b16 v[180:181], v91 offset:17440
  ds_read_b64_tr_b16 v[182:183], v91 offset:19744
  v_mfma_f32_16x16x32_bf16 v[68:71], v[156:159], v[108:111], v[68:71]
  v_mfma_f32_16x16x32_bf16 v[36:39], v[160:163], v[104:107], v[36:39]
  ds_read_b64_tr_b16 v[128:129], v91 offset:17472
  ds_read_b64_tr_b16 v[130:131], v91 offset:19776
  v_mfma_f32_16x16x32_bf16 v[72:75], v[160:163], v[108:111], v[72:75]
  s_waitcnt lgkmcnt(8)
  v_mfma_f32_16x16x32_bf16 v[40:43], v[164:167], v[104:107], v[40:43]
  ds_read_b64_tr_b16 v[132:133], v91 offset:17504
  ds_read_b64_tr_b16 v[134:135], v91 offset:19808
  v_mfma_f32_16x16x32_bf16 v[76:79], v[164:167], v[108:111], v[76:79]
  v_mfma_f32_16x16x32_bf16 v[44:47], v[168:171], v[104:107], v[44:47]
  ds_read_b64_tr_b16 v[136:137], v91 offset:17536
  ds_read_b64_tr_b16 v[138:139], v91 offset:19840
  v_mfma_f32_16x16x32_bf16 v[80:83], v[168:171], v[108:111], v[80:83]
  v_mfma_f32_16x16x32_bf16 v[48:51], v[172:175], v[104:107], v[48:51]
  ds_read_b64_tr_b16 v[140:141], v91 offset:17568
  ds_read_b64_tr_b16 v[142:143], v91 offset:19872
  v_mfma_f32_16x16x32_bf16 v[84:87], v[172:175], v[108:111], v[84:87]
  s_waitcnt lgkmcnt(6)
  v_mfma_f32_16x16x32_bf16 v[16:19], v[176:179], v[112:115], v[16:19]
  ds_read_b64_tr_b16 v[144:145], v91 offset:17600
  ds_read_b64_tr_b16 v[146:147], v91 offset:19904
  v_mfma_f32_16x16x32_bf16 v[52:55], v[176:179], v[116:119], v[52:55]
  v_mfma_f32_16x16x32_bf16 v[20:23], v[180:183], v[112:115], v[20:23]
  ds_read_b64_tr_b16 v[148:149], v91 offset:17632
  ds_read_b64_tr_b16 v[150:151], v91 offset:19936
  v_mfma_f32_16x16x32_bf16 v[56:59], v[180:183], v[116:119], v[56:59]
  v_mfma_f32_16x16x32_bf16 v[24:27], v[128:131], v[112:115], v[24:27]
  ds_read_b64_tr_b16 v[152:153], v91 offset:17664
  ds_read_b64_tr_b16 v[154:155], v91 offset:19968
  v_mfma_f32_16x16x32_bf16 v[60:63], v[128:131], v[116:119], v[60:63]
  s_waitcnt lgkmcnt(6)
  v_mfma_f32_16x16x32_bf16 v[28:31], v[132:135], v[112:115], v[28:31]
  s_barrier
  ds_read_b128 v[120:123], v88 offset:34816
  ds_read_b128 v[124:127], v88 offset:35840
  ds_read_b64_tr_b16 v[156:157], v91 offset:34816
  ds_read_b64_tr_b16 v[158:159], v91 offset:37120
  v_mfma_f32_16x16x32_bf16 v[64:67], v[132:135], v[116:119], v[64:67]
  v_mfma_f32_16x16x32_bf16 v[32:35], v[136:139], v[112:115], v[32:35]
  ds_read_b64_tr_b16 v[160:161], v91 offset:34848
  ds_read_b64_tr_b16 v[162:163], v91 offset:37152
  v_mfma_f32_16x16x32_bf16 v[68:71], v[136:139], v[116:119], v[68:71]
  v_mfma_f32_16x16x32_bf16 v[36:39], v[140:143], v[112:115], v[36:39]
  ds_read_b64_tr_b16 v[164:165], v91 offset:34880
  ds_read_b64_tr_b16 v[166:167], v91 offset:37184
  v_mfma_f32_16x16x32_bf16 v[72:75], v[140:143], v[116:119], v[72:75]
  s_waitcnt lgkmcnt(8)
  v_mfma_f32_16x16x32_bf16 v[40:43], v[144:147], v[112:115], v[40:43]
  ds_read_b64_tr_b16 v[168:169], v91 offset:34912
  ds_read_b64_tr_b16 v[170:171], v91 offset:37216
  v_mfma_f32_16x16x32_bf16 v[76:79], v[144:147], v[116:119], v[76:79]
  v_mfma_f32_16x16x32_bf16 v[44:47], v[148:151], v[112:115], v[44:47]
  ds_read_b64_tr_b16 v[172:173], v91 offset:34944
  ds_read_b64_tr_b16 v[174:175], v91 offset:37248
  v_mfma_f32_16x16x32_bf16 v[80:83], v[148:151], v[116:119], v[80:83]
  v_mfma_f32_16x16x32_bf16 v[48:51], v[152:155], v[112:115], v[48:51]
  ds_read_b64_tr_b16 v[176:177], v91 offset:34976
  ds_read_b64_tr_b16 v[178:179], v91 offset:37280
  v_mfma_f32_16x16x32_bf16 v[84:87], v[152:155], v[116:119], v[84:87]
  s_waitcnt lgkmcnt(6)
  v_mfma_f32_16x16x32_bf16 v[16:19], v[156:159], v[120:123], v[16:19]
  ds_read_b64_tr_b16 v[180:181], v91 offset:35008
  ds_read_b64_tr_b16 v[182:183], v91 offset:37312
  v_mfma_f32_16x16x32_bf16 v[52:55], v[156:159], v[124:127], v[52:55]
  v_mfma_f32_16x16x32_bf16 v[20:23], v[160:163], v[120:123], v[20:23]
  ds_read_b64_tr_b16 v[128:129], v91 offset:35040
  ds_read_b64_tr_b16 v[130:131], v91 offset:37344
  v_mfma_f32_16x16x32_bf16 v[56:59], v[160:163], v[124:127], v[56:59]
  v_mfma_f32_16x16x32_bf16 v[24:27], v[164:167], v[120:123], v[24:27]
  ds_read_b64_tr_b16 v[132:133], v91 offset:35072
  ds_read_b64_tr_b16 v[134:135], v91 offset:37376
  v_mfma_f32_16x16x32_bf16 v[60:63], v[164:167], v[124:127], v[60:63]
  s_waitcnt lgkmcnt(6)
  v_mfma_f32_16x16x32_bf16 v[28:31], v[168:171], v[120:123], v[28:31]
  s_barrier
  ds_read_b128 v[96:99], v89 offset:0
  ds_read_b128 v[100:103], v89 offset:1024
  ds_read_b64_tr_b16 v[136:137], v92 offset:0
  ds_read_b64_tr_b16 v[138:139], v92 offset:2304
  v_mfma_f32_16x16x32_bf16 v[64:67], v[168:171], v[124:127], v[64:67]
  v_mfma_f32_16x16x32_bf16 v[32:35], v[172:175], v[120:123], v[32:35]
  ds_read_b64_tr_b16 v[140:141], v92 offset:32
  ds_read_b64_tr_b16 v[142:143], v92 offset:2336
  v_mfma_f32_16x16x32_bf16 v[68:71], v[172:175], v[124:127], v[68:71]
  v_mfma_f32_16x16x32_bf16 v[36:39], v[176:179], v[120:123], v[36:39]
  ds_read_b64_tr_b16 v[144:145], v92 offset:64
  ds_read_b64_tr_b16 v[146:147], v92 offset:2368
  v_mfma_f32_16x16x32_bf16 v[72:75], v[176:179], v[124:127], v[72:75]
  s_waitcnt lgkmcnt(8)
  v_mfma_f32_16x16x32_bf16 v[40:43], v[180:183], v[120:123], v[40:43]
  ds_read_b64_tr_b16 v[148:149], v92 offset:96
  ds_read_b64_tr_b16 v[150:151], v92 offset:2400
  v_mfma_f32_16x16x32_bf16 v[76:79], v[180:183], v[124:127], v[76:79]
  v_mfma_f32_16x16x32_bf16 v[44:47], v[128:131], v[120:123], v[44:47]
  ds_read_b64_tr_b16 v[152:153], v92 offset:128
  ds_read_b64_tr_b16 v[154:155], v92 offset:2432
  v_mfma_f32_16x16x32_bf16 v[80:83], v[128:131], v[124:127], v[80:83]
  v_mfma_f32_16x16x32_bf16 v[48:51], v[132:135], v[120:123], v[48:51]
  ds_read_b64_tr_b16 v[156:157], v92 offset:160
  ds_read_b64_tr_b16 v[158:159], v92 offset:2464
  v_mfma_f32_16x16x32_bf16 v[84:87], v[132:135], v[124:127], v[84:87]
  s_waitcnt lgkmcnt(6)
  v_mfma_f32_16x16x32_bf16 v[16:19], v[136:139], v[96:99], v[16:19]
  ds_read_b64_tr_b16 v[160:161], v92 offset:192
  ds_read_b64_tr_b16 v[162:163], v92 offset:2496
  v_mfma_f32_16x16x32_bf16 v[52:55], v[136:139], v[100:103], v[52:55]
  v_mfma_f32_16x16x32_bf16 v[20:23], v[140:143], v[96:99], v[20:23]
  ds_read_b64_tr_b16 v[164:165], v92 offset:224
  ds_read_b64_tr_b16 v[166:167], v92 offset:2528
  v_mfma_f32_16x16x32_bf16 v[56:59], v[140:143], v[100:103], v[56:59]
  v_mfma_f32_16x16x32_bf16 v[24:27], v[144:147], v[96:99], v[24:27]
  ds_read_b64_tr_b16 v[168:169], v92 offset:256
  ds_read_b64_tr_b16 v[170:171], v92 offset:2560
  v_mfma_f32_16x16x32_bf16 v[60:63], v[144:147], v[100:103], v[60:63]
  s_waitcnt lgkmcnt(6)
  v_mfma_f32_16x16x32_bf16 v[28:31], v[148:151], v[96:99], v[28:31]
  s_barrier
  ds_read_b128 v[104:107], v89 offset:17408
  ds_read_b128 v[108:111], v89 offset:18432
  ds_read_b64_tr_b16 v[172:173], v92 offset:17408
  ds_read_b64_tr_b16 v[174:175], v92 offset:19712
  v_mfma_f32_16x16x32_bf16 v[64:67], v[148:151], v[100:103], v[64:67]
  v_mfma_f32_16x16x32_bf16 v[32:35], v[152:155], v[96:99], v[32:35]
  ds_read_b64_tr_b16 v[176:177], v92 offset:17440
  ds_read_b64_tr_b16 v[178:179], v92 offset:19744
  v_mfma_f32_16x16x32_bf16 v[68:71], v[152:155], v[100:103], v[68:71]
  v_mfma_f32_16x16x32_bf16 v[36:39], v[156:159], v[96:99], v[36:39]
  ds_read_b64_tr_b16 v[180:181], v92 offset:17472
  ds_read_b64_tr_b16 v[182:183], v92 offset:19776
  v_mfma_f32_16x16x32_bf16 v[72:75], v[156:159], v[100:103], v[72:75]
  s_waitcnt lgkmcnt(8)
  v_mfma_f32_16x16x32_bf16 v[40:43], v[160:163], v[96:99], v[40:43]
  ds_read_b64_tr_b16 v[128:129], v92 offset:17504
  ds_read_b64_tr_b16 v[130:131], v92 offset:19808
  v_mfma_f32_16x16x32_bf16 v[76:79], v[160:163], v[100:103], v[76:79]
  v_mfma_f32_16x16x32_bf16 v[44:47], v[164:167], v[96:99], v[44:47]
  ds_read_b64_tr_b16 v[132:133], v92 offset:17536
  ds_read_b64_tr_b16 v[134:135], v92 offset:19840
  v_mfma_f32_16x16x32_bf16 v[80:83], v[164:167], v[100:103], v[80:83]
  v_mfma_f32_16x16x32_bf16 v[48:51], v[168:171], v[96:99], v[48:51]
  ds_read_b64_tr_b16 v[136:137], v92 offset:17568
  ds_read_b64_tr_b16 v[138:139], v92 offset:19872
  v_mfma_f32_16x16x32_bf16 v[84:87], v[168:171], v[100:103], v[84:87]
  s_waitcnt lgkmcnt(6)
  v_mfma_f32_16x16x32_bf16 v[16:19], v[172:175], v[104:107], v[16:19]
  ds_read_b64_tr_b16 v[140:141], v92 offset:17600
  ds_read_b64_tr_b16 v[142:143], v92 offset:19904
  v_mfma_f32_16x16x32_bf16 v[52:55], v[172:175], v[108:111], v[52:55]
  v_mfma_f32_16x16x32_bf16 v[20:23], v[176:179], v[104:107], v[20:23]
  ds_read_b64_tr_b16 v[144:145], v92 offset:17632
  ds_read_b64_tr_b16 v[146:147], v92 offset:19936
  v_mfma_f32_16x16x32_bf16 v[56:59], v[176:179], v[108:111], v[56:59]
  v_mfma_f32_16x16x32_bf16 v[24:27], v[180:183], v[104:107], v[24:27]
  ds_read_b64_tr_b16 v[148:149], v92 offset:17664
  ds_read_b64_tr_b16 v[150:151], v92 offset:19968
  v_mfma_f32_16x16x32_bf16 v[60:63], v[180:183], v[108:111], v[60:63]
  s_waitcnt lgkmcnt(6)
  v_mfma_f32_16x16x32_bf16 v[28:31], v[128:131], v[104:107], v[28:31]
  s_barrier
  ds_read_b128 v[112:115], v89 offset:34816
  ds_read_b128 v[116:119], v89 offset:35840
  ds_read_b64_tr_b16 v[152:153], v92 offset:34816
  ds_read_b64_tr_b16 v[154:155], v92 offset:37120
  v_mfma_f32_16x16x32_bf16 v[64:67], v[128:131], v[108:111], v[64:67]
  v_mfma_f32_16x16x32_bf16 v[32:35], v[132:135], v[104:107], v[32:35]
  ds_read_b64_tr_b16 v[156:157], v92 offset:34848
  ds_read_b64_tr_b16 v[158:159], v92 offset:37152
  v_mfma_f32_16x16x32_bf16 v[68:71], v[132:135], v[108:111], v[68:71]
  v_mfma_f32_16x16x32_bf16 v[36:39], v[136:139], v[104:107], v[36:39]
  ds_read_b64_tr_b16 v[160:161], v92 offset:34880
  ds_read_b64_tr_b16 v[162:163], v92 offset:37184
  v_mfma_f32_16x16x32_bf16 v[72:75], v[136:139], v[108:111], v[72:75]
  s_waitcnt lgkmcnt(8)
  v_mfma_f32_16x16x32_bf16 v[40:43], v[140:143], v[104:107], v[40:43]
  ds_read_b64_tr_b16 v[164:165], v92 offset:34912
  ds_read_b64_tr_b16 v[166:167], v92 offset:37216
  v_mfma_f32_16x16x32_bf16 v[76:79], v[140:143], v[108:111], v[76:79]
  v_mfma_f32_16x16x32_bf16 v[44:47], v[144:147], v[104:107], v[44:47]
  ds_read_b64_tr_b16 v[168:169], v92 offset:34944
  ds_read_b64_tr_b16 v[170:171], v92 offset:37248
  v_mfma_f32_16x16x32_bf16 v[80:83], v[144:147], v[108:111], v[80:83]
  v_mfma_f32_16x16x32_bf16 v[48:51], v[148:151], v[104:107], v[48:51]
  ds_read_b64_tr_b16 v[172:173], v92 offset:34976
  ds_read_b64_tr_b16 v[174:175], v92 offset:37280
  v_mfma_f32_16x16x32_bf16 v[84:87], v[148:151], v[108:111], v[84:87]
  s_waitcnt lgkmcnt(6)
  v_mfma_f32_16x16x32_bf16 v[16:19], v[152:155], v[112:115], v[16:19]
  ds_read_b64_tr_b16 v[176:177], v92 offset:35008
  ds_read_b64_tr_b16 v[178:179], v92 offset:37312
  v_mfma_f32_16x16x32_bf16 v[52:55], v[152:155], v[116:119], v[52:55]
  v_mfma_f32_16x16x32_bf16 v[20:23], v[156:159], v[112:115], v[20:23]
  ds_read_b64_tr_b16 v[180:181], v92 offset:35040
  ds_read_b64_tr_b16 v[182:183], v92 offset:37344
  v_mfma_f32_16x16x32_bf16 v[56:59], v[156:159], v[116:119], v[56:59]
  v_mfma_f32_16x16x32_bf16 v[24:27], v[160:163], v[112:115], v[24:27]
  ds_read_b64_tr_b16 v[128:129], v92 offset:35072
  ds_read_b64_tr_b16 v[130:131], v92 offset:37376
  v_mfma_f32_16x16x32_bf16 v[60:63], v[160:163], v[116:119], v[60:63]
  s_waitcnt lgkmcnt(6)
  v_mfma_f32_16x16x32_bf16 v[28:31], v[164:167], v[112:115], v[28:31]
  s_barrier
  ds_read_b128 v[120:123], v90 offset:0
  ds_read_b128 v[124:127], v90 offset:1024
  ds_read_b64_tr_b16 v[132:133], v93 offset:0
  ds_read_b64_tr_b16 v[134:135], v93 offset:2304
  v_mfma_f32_16x16x32_bf16 v[64:67], v[164:167], v[116:119], v[64:67]
  v_mfma_f32_16x16x32_bf16 v[32:35], v[168:171], v[112:115], v[32:35]
  ds_read_b64_tr_b16 v[136:137], v93 offset:32
  ds_read_b64_tr_b16 v[138:139], v93 offset:2336
  v_mfma_f32_16x16x32_bf16 v[68:71], v[168:171], v[116:119], v[68:71]
  v_mfma_f32_16x16x32_bf16 v[36:39], v[172:175], v[112:115], v[36:39]
  ds_read_b64_tr_b16 v[140:141], v93 offset:64
  ds_read_b64_tr_b16 v[142:143], v93 offset:2368
  v_mfma_f32_16x16x32_bf16 v[72:75], v[172:175], v[116:119], v[72:75]
  s_waitcnt lgkmcnt(8)
  v_mfma_f32_16x16x32_bf16 v[40:43], v[176:179], v[112:115], v[40:43]
  ds_read_b64_tr_b16 v[144:145], v93 offset:96
  ds_read_b64_tr_b16 v[146:147], v93 offset:2400
  v_mfma_f32_16x16x32_bf16 v[76:79], v[176:179], v[116:119], v[76:79]
  v_mfma_f32_16x16x32_bf16 v[44:47], v[180:183], v[112:115], v[44:47]
  ds_read_b64_tr_b16 v[148:149], v93 offset:128
  ds_read_b64_tr_b16 v[150:151], v93 offset:2432
  v_mfma_f32_16x16x32_bf16 v[80:83], v[180:183], v[116:119], v[80:83]
  v_mfma_f32_16x16x32_bf16 v[48:51], v[128:131], v[112:115], v[48:51]
  ds_read_b64_tr_b16 v[152:153], v93 offset:160
  ds_read_b64_tr_b16 v[154:155], v93 offset:2464
  v_mfma_f32_16x16x32_bf16 v[84:87], v[128:131], v[116:119], v[84:87]
  s_waitcnt lgkmcnt(6)
  v_mfma_f32_16x16x32_bf16 v[16:19], v[132:135], v[120:123], v[16:19]
  ds_read_b64_tr_b16 v[156:157], v93 offset:192
  ds_read_b64_tr_b16 v[158:159], v93 offset:2496
  v_mfma_f32_16x16x32_bf16 v[52:55], v[132:135], v[124:127], v[52:55]
  v_mfma_f32_16x16x32_bf16 v[20:23], v[136:139], v[120:123], v[20:23]
  ds_read_b64_tr_b16 v[160:161], v93 offset:224
  ds_read_b64_tr_b16 v[162:163], v93 offset:2528
  v_mfma_f32_16x16x32_bf16 v[56:59], v[136:139], v[124:127], v[56:59]
  v_mfma_f32_16x16x32_bf16 v[24:27], v[140:143], v[120:123], v[24:27]
  ds_read_b64_tr_b16 v[164:165], v93 offset:256
  ds_read_b64_tr_b16 v[166:167], v93 offset:2560
  v_mfma_f32_16x16x32_bf16 v[60:63], v[140:143], v[124:127], v[60:63]
  s_waitcnt lgkmcnt(6)
  v_mfma_f32_16x16x32_bf16 v[28:31], v[144:147], v[120:123], v[28:31]
  s_barrier
  ds_read_b128 v[96:99], v90 offset:17408
  ds_read_b128 v[100:103], v90 offset:18432
  ds_read_b64_tr_b16 v[168:169], v93 offset:17408
  ds_read_b64_tr_b16 v[170:171], v93 offset:19712
  v_mfma_f32_16x16x32_bf16 v[64:67], v[144:147], v[124:127], v[64:67]
  v_mfma_f32_16x16x32_bf16 v[32:35], v[148:151], v[120:123], v[32:35]
  ds_read_b64_tr_b16 v[172:173], v93 offset:17440
  ds_read_b64_tr_b16 v[174:175], v93 offset:19744
  v_mfma_f32_16x16x32_bf16 v[68:71], v[148:151], v[124:127], v[68:71]
  v_mfma_f32_16x16x32_bf16 v[36:39], v[152:155], v[120:123], v[36:39]
  ds_read_b64_tr_b16 v[176:177], v93 offset:17472
  ds_read_b64_tr_b16 v[178:179], v93 offset:19776
  v_mfma_f32_16x16x32_bf16 v[72:75], v[152:155], v[124:127], v[72:75]
  s_waitcnt lgkmcnt(8)
  v_mfma_f32_16x16x32_bf16 v[40:43], v[156:159], v[120:123], v[40:43]
  ds_read_b64_tr_b16 v[180:181], v93 offset:17504
  ds_read_b64_tr_b16 v[182:183], v93 offset:19808
  v_mfma_f32_16x16x32_bf16 v[76:79], v[156:159], v[124:127], v[76:79]
  v_mfma_f32_16x16x32_bf16 v[44:47], v[160:163], v[120:123], v[44:47]
  ds_read_b64_tr_b16 v[128:129], v93 offset:17536
  ds_read_b64_tr_b16 v[130:131], v93 offset:19840
  v_mfma_f32_16x16x32_bf16 v[80:83], v[160:163], v[124:127], v[80:83]
  v_mfma_f32_16x16x32_bf16 v[48:51], v[164:167], v[120:123], v[48:51]
  ds_read_b64_tr_b16 v[132:133], v93 offset:17568
  ds_read_b64_tr_b16 v[134:135], v93 offset:19872
  v_mfma_f32_16x16x32_bf16 v[84:87], v[164:167], v[124:127], v[84:87]
  s_waitcnt lgkmcnt(6)
  v_mfma_f32_16x16x32_bf16 v[16:19], v[168:171], v[96:99], v[16:19]
  ds_read_b64_tr_b16 v[136:137], v93 offset:17600
  ds_read_b64_tr_b16 v[138:139], v93 offset:19904
  v_mfma_f32_16x16x32_bf16 v[52:55], v[168:171], v[100:103], v[52:55]
  v_mfma_f32_16x16x32_bf16 v[20:23], v[172:175], v[96:99], v[20:23]
  ds_read_b64_tr_b16 v[140:141], v93 offset:17632
  ds_read_b64_tr_b16 v[142:143], v93 offset:19936
  v_mfma_f32_16x16x32_bf16 v[56:59], v[172:175], v[100:103], v[56:59]
  v_mfma_f32_16x16x32_bf16 v[24:27], v[176:179], v[96:99], v[24:27]
  ds_read_b64_tr_b16 v[144:145], v93 offset:17664
  ds_read_b64_tr_b16 v[146:147], v93 offset:19968
  v_mfma_f32_16x16x32_bf16 v[60:63], v[176:179], v[100:103], v[60:63]
  s_waitcnt lgkmcnt(6)
  v_mfma_f32_16x16x32_bf16 v[28:31], v[180:183], v[96:99], v[28:31]
  s_barrier
  ds_read_b128 v[104:107], v88 offset:0
  ds_read_b128 v[108:111], v88 offset:1024
  ds_read_b64_tr_b16 v[148:149], v91 offset:0
  ds_read_b64_tr_b16 v[150:151], v91 offset:2304
  v_mfma_f32_16x16x32_bf16 v[64:67], v[180:183], v[100:103], v[64:67]
  v_mfma_f32_16x16x32_bf16 v[32:35], v[128:131], v[96:99], v[32:35]
  ds_read_b64_tr_b16 v[152:153], v91 offset:32
  ds_read_b64_tr_b16 v[154:155], v91 offset:2336
  v_mfma_f32_16x16x32_bf16 v[68:71], v[128:131], v[100:103], v[68:71]
  v_mfma_f32_16x16x32_bf16 v[36:39], v[132:135], v[96:99], v[36:39]
  ds_read_b64_tr_b16 v[156:157], v91 offset:64
  ds_read_b64_tr_b16 v[158:159], v91 offset:2368
  v_mfma_f32_16x16x32_bf16 v[72:75], v[132:135], v[100:103], v[72:75]
  s_waitcnt lgkmcnt(8)
  v_mfma_f32_16x16x32_bf16 v[40:43], v[136:139], v[96:99], v[40:43]
  ds_read_b64_tr_b16 v[160:161], v91 offset:96
  ds_read_b64_tr_b16 v[162:163], v91 offset:2400
  v_mfma_f32_16x16x32_bf16 v[76:79], v[136:139], v[100:103], v[76:79]
  v_mfma_f32_16x16x32_bf16 v[44:47], v[140:143], v[96:99], v[44:47]
  ds_read_b64_tr_b16 v[164:165], v91 offset:128
  ds_read_b64_tr_b16 v[166:167], v91 offset:2432
  v_mfma_f32_16x16x32_bf16 v[80:83], v[140:143], v[100:103], v[80:83]
  v_mfma_f32_16x16x32_bf16 v[48:51], v[144:147], v[96:99], v[48:51]
  ds_read_b64_tr_b16 v[168:169], v91 offset:160
  ds_read_b64_tr_b16 v[170:171], v91 offset:2464
  v_mfma_f32_16x16x32_bf16 v[84:87], v[144:147], v[100:103], v[84:87]
  s_waitcnt lgkmcnt(6)
  v_mfma_f32_16x16x32_bf16 v[16:19], v[148:151], v[104:107], v[16:19]
  ds_read_b64_tr_b16 v[172:173], v91 offset:192
  ds_read_b64_tr_b16 v[174:175], v91 offset:2496
  v_mfma_f32_16x16x32_bf16 v[52:55], v[148:151], v[108:111], v[52:55]
  v_mfma_f32_16x16x32_bf16 v[20:23], v[152:155], v[104:107], v[20:23]
  ds_read_b64_tr_b16 v[176:177], v91 offset:224
  ds_read_b64_tr_b16 v[178:179], v91 offset:2528
  v_mfma_f32_16x16x32_bf16 v[56:59], v[152:155], v[108:111], v[56:59]
  v_mfma_f32_16x16x32_bf16 v[24:27], v[156:159], v[104:107], v[24:27]
  ds_read_b64_tr_b16 v[180:181], v91 offset:256
  ds_read_b64_tr_b16 v[182:183], v91 offset:2560
  v_mfma_f32_16x16x32_bf16 v[60:63], v[156:159], v[108:111], v[60:63]
  s_waitcnt lgkmcnt(6)
  v_mfma_f32_16x16x32_bf16 v[28:31], v[160:163], v[104:107], v[28:31]
  s_barrier
  s_cmp_lg_u32 s3, 0
  s_cbranch_scc1 .Lm_72
  s_lshl_b32 s46, s40, 5
  s_add_u32 s46, s46, s43
  s_mul_i32 s46, s46, 4352
  s_lshl_b32 s47, s41, 5
  s_add_u32 s46, s46, s47
  s_add_u32 s46, s46, 1048576
  v_and_b32 v6, 7, v0
  v_lshlrev_b32 v6, 2, v6
  buffer_load_dword v7, v6, s[4:7], s46 offen sc1
.Lm_72:
  ds_read_b128 v[112:115], v88 offset:17408
  ds_read_b128 v[116:119], v88 offset:18432
  ds_read_b64_tr_b16 v[128:129], v91 offset:17408
  ds_read_b64_tr_b16 v[130:131], v91 offset:19712
  v_mfma_f32_16x16x32_bf16 v[64:67], v[160:163], v[108:111], v[64:67]
  v_mfma_f32_16x16x32_bf16 v[32:35], v[164:167], v[104:107], v[32:35]
  ds_read_b64_tr_b16 v[132:133], v91 offset:17440
  ds_read_b64_tr_b16 v[134:135], v91 offset:19744
  v_mfma_f32_16x16x32_bf16 v[68:71], v[164:167], v[108:111], v[68:71]
  v_mfma_f32_16x16x32_bf16 v[36:39], v[168:171], v[104:107], v[36:39]
  ds_read_b64_tr_b16 v[136:137], v91 offset:17472
  ds_read_b64_tr_b16 v[138:139], v91 offset:19776
  v_mfma_f32_16x16x32_bf16 v[72:75], v[168:171], v[108:111], v[72:75]
  s_waitcnt lgkmcnt(8)
  v_mfma_f32_16x16x32_bf16 v[40:43], v[172:175], v[104:107], v[40:43]
  ds_read_b64_tr_b16 v[140:141], v91 offset:17504
  ds_read_b64_tr_b16 v[142:143], v91 offset:19808
  v_mfma_f32_16x16x32_bf16 v[76:79], v[172:175], v[108:111], v[76:79]
  v_mfma_f32_16x16x32_bf16 v[44:47], v[176:179], v[104:107], v[44:47]
  ds_read_b64_tr_b16 v[144:145], v91 offset:17536
  ds_read_b64_tr_b16 v[146:147], v91 offset:19840
  v_mfma_f32_16x16x32_bf16 v[80:83], v[176:179], v[108:111], v[80:83]
  v_mfma_f32_16x16x32_bf16 v[48:51], v[180:183], v[104:107], v[48:51]
  ds_read_b64_tr_b16 v[148:149], v91 offset:17568
  ds_read_b64_tr_b16 v[150:151], v91 offset:19872
  v_mfma_f32_16x16x32_bf16 v[84:87], v[180:183], v[108:111], v[84:87]
  s_waitcnt lgkmcnt(6)
  v_mfma_f32_16x16x32_bf16 v[16:19], v[128:131], v[112:115], v[16:19]
  ds_read_b64_tr_b16 v[152:153], v91 offset:17600
  ds_read_b64_tr_b16 v[154:155], v91 offset:19904
  v_mfma_f32_16x16x32_bf16 v[52:55], v[128:131], v[116:119], v[52:55]
  v_mfma_f32_16x16x32_bf16 v[20:23], v[132:135], v[112:115], v[20:23]
  ds_read_b64_tr_b16 v[156:157], v91 offset:17632
  ds_read_b64_tr_b16 v[158:159], v91 offset:19936
  v_mfma_f32_16x16x32_bf16 v[56:59], v[132:135], v[116:119], v[56:59]
  v_mfma_f32_16x16x32_bf16 v[24:27], v[136:139], v[112:115], v[24:27]
  ds_read_b64_tr_b16 v[160:161], v91 offset:17664
  ds_read_b64_tr_b16 v[162:163], v91 offset:19968
  v_mfma_f32_16x16x32_bf16 v[60:63], v[136:139], v[116:119], v[60:63]
  s_waitcnt lgkmcnt(6)
  v_mfma_f32_16x16x32_bf16 v[28:31], v[140:143], v[112:115], v[28:31]
  s_barrier
  ds_read_b128 v[120:123], v88 offset:34816
  ds_read_b128 v[124:127], v88 offset:35840
  ds_read_b64_tr_b16 v[164:165], v91 offset:34816
  ds_read_b64_tr_b16 v[166:167], v91 offset:37120
  v_mfma_f32_16x16x32_bf16 v[64:67], v[140:143], v[116:119], v[64:67]
  v_mfma_f32_16x16x32_bf16 v[32:35], v[144:147], v[112:115], v[32:35]
  ds_read_b64_tr_b16 v[168:169], v91 offset:34848
  ds_read_b64_tr_b16 v[170:171], v91 offset:37152
  v_mfma_f32_16x16x32_bf16 v[68:71], v[144:147], v[116:119], v[68:71]
  v_mfma_f32_16x16x32_bf16 v[36:39], v[148:151], v[112:115], v[36:39]
  ds_read_b64_tr_b16 v[172:173], v91 offset:34880
  ds_read_b64_tr_b16 v[174:175], v91 offset:37184
  v_mfma_f32_16x16x32_bf16 v[72:75], v[148:151], v[116:119], v[72:75]
  s_waitcnt lgkmcnt(8)
  v_mfma_f32_16x16x32_bf16 v[40:43], v[152:155], v[112:115], v[40:43]
  ds_read_b64_tr_b16 v[176:177], v91 offset:34912
  ds_read_b64_tr_b16 v[178:179], v91 offset:37216
  v_mfma_f32_16x16x32_bf16 v[76:79], v[152:155], v[116:119], v[76:79]
  v_mfma_f32_16x16x32_bf16 v[44:47], v[156:159], v[112:115], v[44:47]
  ds_read_b64_tr_b16 v[180:181], v91 offset:34944
  ds_read_b64_tr_b16 v[182:183], v91 offset:37248
  v_mfma_f32_16x16x32_bf16 v[80:83], v[156:159], v[116:119], v[80:83]
  v_mfma_f32_16x16x32_bf16 v[48:51], v[160:163], v[112:115], v[48:51]
  ds_read_b64_tr_b16 v[128:129], v91 offset:34976
  ds_read_b64_tr_b16 v[130:131], v91 offset:37280
  v_mfma_f32_16x16x32_bf16 v[84:87], v[160:163], v[116:119], v[84:87]
  s_waitcnt lgkmcnt(6)
  v_mfma_f32_16x16x32_bf16 v[16:19], v[164:167], v[120:123], v[16:19]
  ds_read_b64_tr_b16 v[132:133], v91 offset:35008
  ds_read_b64_tr_b16 v[134:135], v91 offset:37312
  v_mfma_f32_16x16x32_bf16 v[52:55], v[164:167], v[124:127], v[52:55]
  v_mfma_f32_16x16x32_bf16 v[20:23], v[168:171], v[120:123], v[20:23]
  ds_read_b64_tr_b16 v[136:137], v91 offset:35040
  ds_read_b64_tr_b16 v[138:139], v91 offset:37344
  v_mfma_f32_16x16x32_bf16 v[56:59], v[168:171], v[124:127], v[56:59]
  v_mfma_f32_16x16x32_bf16 v[24:27], v[172:175], v[120:123], v[24:27]
  ds_read_b64_tr_b16 v[140:141], v91 offset:35072
  ds_read_b64_tr_b16 v[142:143], v91 offset:37376
  v_mfma_f32_16x16x32_bf16 v[60:63], v[172:175], v[124:127], v[60:63]
  s_waitcnt lgkmcnt(6)
  v_mfma_f32_16x16x32_bf16 v[28:31], v[176:179], v[120:123], v[28:31]
  s_barrier
  ds_read_b128 v[96:99], v89 offset:0
  ds_read_b128 v[100:103], v89 offset:1024
  ds_read_b64_tr_b16 v[144:145], v92 offset:0
  ds_read_b64_tr_b16 v[146:147], v92 offset:2304
  v_mfma_f32_16x16x32_bf16 v[64:67], v[176:179], v[124:127], v[64:67]
  v_mfma_f32_16x16x32_bf16 v[32:35], v[180:183], v[120:123], v[32:35]
  ds_read_b64_tr_b16 v[148:149], v92 offset:32
  ds_read_b64_tr_b16 v[150:151], v92 offset:2336
  v_mfma_f32_16x16x32_bf16 v[68:71], v[180:183], v[124:127], v[68:71]
  v_mfma_f32_16x16x32_bf16 v[36:39], v[128:131], v[120:123], v[36:39]
  ds_read_b64_tr_b16 v[152:153], v92 offset:64
  ds_read_b64_tr_b16 v[154:155], v92 offset:2368
  v_mfma_f32_16x16x32_bf16 v[72:75], v[128:131], v[124:127], v[72:75]
  s_waitcnt lgkmcnt(8)
  v_mfma_f32_16x16x32_bf16 v[40:43], v[132:135], v[120:123], v[40:43]
  ds_read_b64_tr_b16 v[156:157], v92 offset:96
  ds_read_b64_tr_b16 v[158:159], v92 offset:2400
  v_mfma_f32_16x16x32_bf16 v[76:79], v[132:135], v[124:127], v[76:79]
  v_mfma_f32_16x16x32_bf16 v[44:47], v[136:139], v[120:123], v[44:47]
  ds_read_b64_tr_b16 v[160:161], v92 offset:128
  ds_read_b64_tr_b16 v[162:163], v92 offset:2432
  v_mfma_f32_16x16x32_bf16 v[80:83], v[136:139], v[124:127], v[80:83]
  v_mfma_f32_16x16x32_bf16 v[48:51], v[140:143], v[120:123], v[48:51]
  ds_read_b64_tr_b16 v[164:165], v92 offset:160
  ds_read_b64_tr_b16 v[166:167], v92 offset:2464
  v_mfma_f32_16x16x32_bf16 v[84:87], v[140:143], v[124:127], v[84:87]
  s_waitcnt lgkmcnt(6)
  v_mfma_f32_16x16x32_bf16 v[16:19], v[144:147], v[96:99], v[16:19]
  ds_read_b64_tr_b16 v[168:169], v92 offset:192
  ds_read_b64_tr_b16 v[170:171], v92 offset:2496
  v_mfma_f32_16x16x32_bf16 v[52:55], v[144:147], v[100:103], v[52:55]
  v_mfma_f32_16x16x32_bf16 v[20:23], v[148:151], v[96:99], v[20:23]
  ds_read_b64_tr_b16 v[172:173], v92 offset:224
  ds_read_b64_tr_b16 v[174:175], v92 offset:2528
  v_mfma_f32_16x16x32_bf16 v[56:59], v[148:151], v[100:103], v[56:59]
  v_mfma_f32_16x16x32_bf16 v[24:27], v[152:155], v[96:99], v[24:27]
  ds_read_b64_tr_b16 v[176:177], v92 offset:256
  ds_read_b64_tr_b16 v[178:179], v92 offset:2560
  v_mfma_f32_16x16x32_bf16 v[60:63], v[152:155], v[100:103], v[60:63]
  s_waitcnt lgkmcnt(6)
  v_mfma_f32_16x16x32_bf16 v[28:31], v[156:159], v[96:99], v[28:31]
  s_barrier
  ds_read_b128 v[104:107], v89 offset:17408
  ds_read_b128 v[108:111], v89 offset:18432
  ds_read_b64_tr_b16 v[180:181], v92 offset:17408
  ds_read_b64_tr_b16 v[182:183], v92 offset:19712
  v_mfma_f32_16x16x32_bf16 v[64:67], v[156:159], v[100:103], v[64:67]
  v_mfma_f32_16x16x32_bf16 v[32:35], v[160:163], v[96:99], v[32:35]
  ds_read_b64_tr_b16 v[128:129], v92 offset:17440
  ds_read_b64_tr_b16 v[130:131], v92 offset:19744
  v_mfma_f32_16x16x32_bf16 v[68:71], v[160:163], v[100:103], v[68:71]
  v_mfma_f32_16x16x32_bf16 v[36:39], v[164:167], v[96:99], v[36:39]
  ds_read_b64_tr_b16 v[132:133], v92 offset:17472
  ds_read_b64_tr_b16 v[134:135], v92 offset:19776
  v_mfma_f32_16x16x32_bf16 v[72:75], v[164:167], v[100:103], v[72:75]
  s_waitcnt lgkmcnt(8)
  v_mfma_f32_16x16x32_bf16 v[40:43], v[168:171], v[96:99], v[40:43]
  ds_read_b64_tr_b16 v[136:137], v92 offset:17504
  ds_read_b64_tr_b16 v[138:139], v92 offset:19808
  v_mfma_f32_16x16x32_bf16 v[76:79], v[168:171], v[100:103], v[76:79]
  v_mfma_f32_16x16x32_bf16 v[44:47], v[172:175], v[96:99], v[44:47]
  ds_read_b64_tr_b16 v[140:141], v92 offset:17536
  ds_read_b64_tr_b16 v[142:143], v92 offset:19840
  v_mfma_f32_16x16x32_bf16 v[80:83], v[172:175], v[100:103], v[80:83]
  v_mfma_f32_16x16x32_bf16 v[48:51], v[176:179], v[96:99], v[48:51]
  ds_read_b64_tr_b16 v[144:145], v92 offset:17568
  ds_read_b64_tr_b16 v[146:147], v92 offset:19872
  v_mfma_f32_16x16x32_bf16 v[84:87], v[176:179], v[100:103], v[84:87]
  s_waitcnt lgkmcnt(6)
  v_mfma_f32_16x16x32_bf16 v[16:19], v[180:183], v[104:107], v[16:19]
  ds_read_b64_tr_b16 v[148:149], v92 offset:17600
  ds_read_b64_tr_b16 v[150:151], v92 offset:19904
  v_mfma_f32_16x16x32_bf16 v[52:55], v[180:183], v[108:111], v[52:55]
  v_mfma_f32_16x16x32_bf16 v[20:23], v[128:131], v[104:107], v[20:23]
  ds_read_b64_tr_b16 v[152:153], v92 offset:17632
  ds_read_b64_tr_b16 v[154:155], v92 offset:19936
  v_mfma_f32_16x16x32_bf16 v[56:59], v[128:131], v[108:111], v[56:59]
  v_mfma_f32_16x16x32_bf16 v[24:27], v[132:135], v[104:107], v[24:27]
  ds_read_b64_tr_b16 v[156:157], v92 offset:17664
  ds_read_b64_tr_b16 v[158:159], v92 offset:19968
  v_mfma_f32_16x16x32_bf16 v[60:63], v[132:135], v[108:111], v[60:63]
  s_waitcnt lgkmcnt(6)
  v_mfma_f32_16x16x32_bf16 v[28:31], v[136:139], v[104:107], v[28:31]
  s_cmp_lg_u32 s3, 0
  s_cbranch_scc1 .Lm_73
  s_add_u32 s45, s101, 5
  s_waitcnt vmcnt(0)
  v_subrev_u32 v7, s45, v7
  v_cmp_le_u32 vcc, 11, v7
  s_nop 3
  s_cmp_eq_u64 vcc, 0
  s_cbranch_scc1 .Lm_73
  s_lshl_b32 s46, s40, 5
  s_add_u32 s46, s46, s43
  s_mul_i32 s46, s46, 4352
  s_add_u32 s46, s46, 1048576
  v_and_b32 v7, 31, v0
  v_lshlrev_b32 v6, 2, v7
  v_add_u32 v6, s46, v6
  v_lshrrev_b32 v7, 3, v7
  v_cmp_eq_u32 vcc, s41, v7
  s_nop 3
  s_mov_b32 vcc_hi, 0
  s_add_u32 s45, s101, 5
  s_mov_b32 s44, 0
  s_nop 2
  s_mov_b64 exec, vcc
.Lm_74:
  buffer_load_dword v8, v6, s[4:7], 0 offen sc1
  s_waitcnt vmcnt(0)
  v_subrev_u32 v7, s45, v8
  v_cmp_le_u32 vcc, 11, v7
  s_add_u32 s44, s44, 1
  s_nop 2
  s_cmp_eq_u64 vcc, 0
  s_cbranch_scc1 .Lm_75
  s_sleep 1
  s_cmp_lt_u32 s44, 0x40000
  s_cbranch_scc1 .Lm_74
.Lm_75:
  s_mov_b64 exec, -1
.Lm_73:
  s_barrier
  ds_read_b128 v[112:115], v89 offset:34816
  ds_read_b128 v[116:119], v89 offset:35840
  ds_read_b64_tr_b16 v[160:161], v92 offset:34816
  ds_read_b64_tr_b16 v[162:163], v92 offset:37120
  v_mfma_f32_16x16x32_bf16 v[64:67], v[136:139], v[108:111], v[64:67]
  v_mfma_f32_16x16x32_bf16 v[32:35], v[140:143], v[104:107], v[32:35]
  ds_read_b64_tr_b16 v[164:165], v92 offset:34848
  ds_read_b64_tr_b16 v[166:167], v92 offset:37152
  v_mfma_f32_16x16x32_bf16 v[68:71], v[140:143], v[108:111], v[68:71]
  v_mfma_f32_16x16x32_bf16 v[36:39], v[144:147], v[104:107], v[36:39]
  ds_read_b64_tr_b16 v[168:169], v92 offset:34880
  ds_read_b64_tr_b16 v[170:171], v92 offset:37184
  v_mfma_f32_16x16x32_bf16 v[72:75], v[144:147], v[108:111], v[72:75]
  s_waitcnt lgkmcnt(8)
  v_mfma_f32_16x16x32_bf16 v[40:43], v[148:151], v[104:107], v[40:43]
  ds_read_b64_tr_b16 v[172:173], v92 offset:34912
  ds_read_b64_tr_b16 v[174:175], v92 offset:37216
  v_mfma_f32_16x16x32_bf16 v[76:79], v[148:151], v[108:111], v[76:79]
  v_mfma_f32_16x16x32_bf16 v[44:47], v[152:155], v[104:107], v[44:47]
  ds_read_b64_tr_b16 v[176:177], v92 offset:34944
  ds_read_b64_tr_b16 v[178:179], v92 offset:37248
  v_mfma_f32_16x16x32_bf16 v[80:83], v[152:155], v[108:111], v[80:83]
  v_mfma_f32_16x16x32_bf16 v[48:51], v[156:159], v[104:107], v[48:51]
  ds_read_b64_tr_b16 v[180:181], v92 offset:34976
  ds_read_b64_tr_b16 v[182:183], v92 offset:37280
  v_mfma_f32_16x16x32_bf16 v[84:87], v[156:159], v[108:111], v[84:87]
  s_waitcnt lgkmcnt(6)
  v_mfma_f32_16x16x32_bf16 v[16:19], v[160:163], v[112:115], v[16:19]
  ds_read_b64_tr_b16 v[128:129], v92 offset:35008
  ds_read_b64_tr_b16 v[130:131], v92 offset:37312
  v_mfma_f32_16x16x32_bf16 v[52:55], v[160:163], v[116:119], v[52:55]
  v_mfma_f32_16x16x32_bf16 v[20:23], v[164:167], v[112:115], v[20:23]
  ds_read_b64_tr_b16 v[132:133], v92 offset:35040
  ds_read_b64_tr_b16 v[134:135], v92 offset:37344
  v_mfma_f32_16x16x32_bf16 v[56:59], v[164:167], v[116:119], v[56:59]
  v_mfma_f32_16x16x32_bf16 v[24:27], v[168:171], v[112:115], v[24:27]
  ds_read_b64_tr_b16 v[136:137], v92 offset:35072
  ds_read_b64_tr_b16 v[138:139], v92 offset:37376
  v_mfma_f32_16x16x32_bf16 v[60:63], v[168:171], v[116:119], v[60:63]
  s_waitcnt lgkmcnt(6)
  v_mfma_f32_16x16x32_bf16 v[28:31], v[172:175], v[112:115], v[28:31]
  s_barrier
  ds_read_b128 v[120:123], v90 offset:0
  ds_read_b128 v[124:127], v90 offset:1024
  ds_read_b64_tr_b16 v[140:141], v93 offset:0
  ds_read_b64_tr_b16 v[142:143], v93 offset:2304
  v_mfma_f32_16x16x32_bf16 v[64:67], v[172:175], v[116:119], v[64:67]
  v_mfma_f32_16x16x32_bf16 v[32:35], v[176:179], v[112:115], v[32:35]
  ds_read_b64_tr_b16 v[144:145], v93 offset:32
  ds_read_b64_tr_b16 v[146:147], v93 offset:2336
  v_mfma_f32_16x16x32_bf16 v[68:71], v[176:179], v[116:119], v[68:71]
  v_mfma_f32_16x16x32_bf16 v[36:39], v[180:183], v[112:115], v[36:39]
  ds_read_b64_tr_b16 v[148:149], v93 offset:64
  ds_read_b64_tr_b16 v[150:151], v93 offset:2368
  v_mfma_f32_16x16x32_bf16 v[72:75], v[180:183], v[116:119], v[72:75]
  s_waitcnt lgkmcnt(8)
  v_mfma_f32_16x16x32_bf16 v[40:43], v[128:131], v[112:115], v[40:43]
  ds_read_b64_tr_b16 v[152:153], v93 offset:96
  ds_read_b64_tr_b16 v[154:155], v93 offset:2400
  v_mfma_f32_16x16x32_bf16 v[76:79], v[128:131], v[116:119], v[76:79]
  v_mfma_f32_16x16x32_bf16 v[44:47], v[132:135], v[112:115], v[44:47]
  ds_read_b64_tr_b16 v[156:157], v93 offset:128
  ds_read_b64_tr_b16 v[158:159], v93 offset:2432
  v_mfma_f32_16x16x32_bf16 v[80:83], v[132:135], v[116:119], v[80:83]
  v_mfma_f32_16x16x32_bf16 v[48:51], v[136:139], v[112:115], v[48:51]
  ds_read_b64_tr_b16 v[160:161], v93 offset:160
  ds_read_b64_tr_b16 v[162:163], v93 offset:2464
  v_mfma_f32_16x16x32_bf16 v[84:87], v[136:139], v[116:119], v[84:87]
  s_waitcnt lgkmcnt(6)
  v_mfma_f32_16x16x32_bf16 v[16:19], v[140:143], v[120:123], v[16:19]
  ds_read_b64_tr_b16 v[164:165], v93 offset:192
  ds_read_b64_tr_b16 v[166:167], v93 offset:2496
  v_mfma_f32_16x16x32_bf16 v[52:55], v[140:143], v[124:127], v[52:55]
  v_mfma_f32_16x16x32_bf16 v[20:23], v[144:147], v[120:123], v[20:23]
  ds_read_b64_tr_b16 v[168:169], v93 offset:224
  ds_read_b64_tr_b16 v[170:171], v93 offset:2528
  v_mfma_f32_16x16x32_bf16 v[56:59], v[144:147], v[124:127], v[56:59]
  v_mfma_f32_16x16x32_bf16 v[24:27], v[148:151], v[120:123], v[24:27]
  ds_read_b64_tr_b16 v[172:173], v93 offset:256
  ds_read_b64_tr_b16 v[174:175], v93 offset:2560
  v_mfma_f32_16x16x32_bf16 v[60:63], v[148:151], v[124:127], v[60:63]
  s_waitcnt lgkmcnt(6)
  v_mfma_f32_16x16x32_bf16 v[28:31], v[152:155], v[120:123], v[28:31]
  s_barrier
  ds_read_b128 v[96:99], v90 offset:17408
  ds_read_b128 v[100:103], v90 offset:18432
  ds_read_b64_tr_b16 v[176:177], v93 offset:17408
  ds_read_b64_tr_b16 v[178:179], v93 offset:19712
  v_mfma_f32_16x16x32_bf16 v[64:67], v[152:155], v[124:127], v[64:67]
  v_mfma_f32_16x16x32_bf16 v[32:35], v[156:159], v[120:123], v[32:35]
  ds_read_b64_tr_b16 v[180:181], v93 offset:17440
  ds_read_b64_tr_b16 v[182:183], v93 offset:19744
  v_mfma_f32_16x16x32_bf16 v[68:71], v[156:159], v[124:127], v[68:71]
  v_mfma_f32_16x16x32_bf16 v[36:39], v[160:163], v[120:123], v[36:39]
  ds_read_b64_tr_b16 v[128:129], v93 offset:17472
  ds_read_b64_tr_b16 v[130:131], v93 offset:19776
  v_mfma_f32_16x16x32_bf16 v[72:75], v[160:163], v[124:127], v[72:75]
  s_waitcnt lgkmcnt(8)
  v_mfma_f32_16x16x32_bf16 v[40:43], v[164:167], v[120:123], v[40:43]
  ds_read_b64_tr_b16 v[132:133], v93 offset:17504
  ds_read_b64_tr_b16 v[134:135], v93 offset:19808
  v_mfma_f32_16x16x32_bf16 v[76:79], v[164:167], v[124:127], v[76:79]
  v_mfma_f32_16x16x32_bf16 v[44:47], v[168:171], v[120:123], v[44:47]
  ds_read_b64_tr_b16 v[136:137], v93 offset:17536
  ds_read_b64_tr_b16 v[138:139], v93 offset:19840
  v_mfma_f32_16x16x32_bf16 v[80:83], v[168:171], v[124:127], v[80:83]
  v_mfma_f32_16x16x32_bf16 v[48:51], v[172:175], v[120:123], v[48:51]
  ds_read_b64_tr_b16 v[140:141], v93 offset:17568
  ds_read_b64_tr_b16 v[142:143], v93 offset:19872
  v_mfma_f32_16x16x32_bf16 v[84:87], v[172:175], v[124:127], v[84:87]
  s_waitcnt lgkmcnt(6)
  v_mfma_f32_16x16x32_bf16 v[16:19], v[176:179], v[96:99], v[16:19]
  ds_read_b64_tr_b16 v[144:145], v93 offset:17600
  ds_read_b64_tr_b16 v[146:147], v93 offset:19904
  v_mfma_f32_16x16x32_bf16 v[52:55], v[176:179], v[100:103], v[52:55]
  v_mfma_f32_16x16x32_bf16 v[20:23], v[180:183], v[96:99], v[20:23]
  ds_read_b64_tr_b16 v[148:149], v93 offset:17632
  ds_read_b64_tr_b16 v[150:151], v93 offset:19936
  v_mfma_f32_16x16x32_bf16 v[56:59], v[180:183], v[100:103], v[56:59]
  v_mfma_f32_16x16x32_bf16 v[24:27], v[128:131], v[96:99], v[24:27]
  ds_read_b64_tr_b16 v[152:153], v93 offset:17664
  ds_read_b64_tr_b16 v[154:155], v93 offset:19968
  v_mfma_f32_16x16x32_bf16 v[60:63], v[128:131], v[100:103], v[60:63]
  s_waitcnt lgkmcnt(6)
  v_mfma_f32_16x16x32_bf16 v[28:31], v[132:135], v[96:99], v[28:31]
  s_barrier
  ds_read_b128 v[104:107], v88 offset:0
  ds_read_b128 v[108:111], v88 offset:1024
  ds_read_b64_tr_b16 v[156:157], v91 offset:0
  ds_read_b64_tr_b16 v[158:159], v91 offset:2304
  v_mfma_f32_16x16x32_bf16 v[64:67], v[132:135], v[100:103], v[64:67]
  v_mfma_f32_16x16x32_bf16 v[32:35], v[136:139], v[96:99], v[32:35]
  ds_read_b64_tr_b16 v[160:161], v91 offset:32
  ds_read_b64_tr_b16 v[162:163], v91 offset:2336
  v_mfma_f32_16x16x32_bf16 v[68:71], v[136:139], v[100:103], v[68:71]
  v_mfma_f32_16x16x32_bf16 v[36:39], v[140:143], v[96:99], v[36:39]
  ds_read_b64_tr_b16 v[164:165], v91 offset:64
  ds_read_b64_tr_b16 v[166:167], v91 offset:2368
  v_mfma_f32_16x16x32_bf16 v[72:75], v[140:143], v[100:103], v[72:75]
  s_waitcnt lgkmcnt(8)
  v_mfma_f32_16x16x32_bf16 v[40:43], v[144:147], v[96:99], v[40:43]
  ds_read_b64_tr_b16 v[168:169], v91 offset:96
  ds_read_b64_tr_b16 v[170:171], v91 offset:2400
  v_mfma_f32_16x16x32_bf16 v[76:79], v[144:147], v[100:103], v[76:79]
  v_mfma_f32_16x16x32_bf16 v[44:47], v[148:151], v[96:99], v[44:47]
  ds_read_b64_tr_b16 v[172:173], v91 offset:128
  ds_read_b64_tr_b16 v[174:175], v91 offset:2432
  v_mfma_f32_16x16x32_bf16 v[80:83], v[148:151], v[100:103], v[80:83]
  v_mfma_f32_16x16x32_bf16 v[48:51], v[152:155], v[96:99], v[48:51]
  ds_read_b64_tr_b16 v[176:177], v91 offset:160
  ds_read_b64_tr_b16 v[178:179], v91 offset:2464
  v_mfma_f32_16x16x32_bf16 v[84:87], v[152:155], v[100:103], v[84:87]
  s_waitcnt lgkmcnt(6)
  v_mfma_f32_16x16x32_bf16 v[16:19], v[156:159], v[104:107], v[16:19]
  ds_read_b64_tr_b16 v[180:181], v91 offset:192
  ds_read_b64_tr_b16 v[182:183], v91 offset:2496
  v_mfma_f32_16x16x32_bf16 v[52:55], v[156:159], v[108:111], v[52:55]
  v_mfma_f32_16x16x32_bf16 v[20:23], v[160:163], v[104:107], v[20:23]
  ds_read_b64_tr_b16 v[128:129], v91 offset:224
  ds_read_b64_tr_b16 v[130:131], v91 offset:2528
  v_mfma_f32_16x16x32_bf16 v[56:59], v[160:163], v[108:111], v[56:59]
  v_mfma_f32_16x16x32_bf16 v[24:27], v[164:167], v[104:107], v[24:27]
  ds_read_b64_tr_b16 v[132:133], v91 offset:256
  ds_read_b64_tr_b16 v[134:135], v91 offset:2560
  v_mfma_f32_16x16x32_bf16 v[60:63], v[164:167], v[108:111], v[60:63]
  s_waitcnt lgkmcnt(6)
  v_mfma_f32_16x16x32_bf16 v[28:31], v[168:171], v[104:107], v[28:31]
  s_barrier
  ds_read_b128 v[112:115], v88 offset:17408
  ds_read_b128 v[116:119], v88 offset:18432
  ds_read_b64_tr_b16 v[136:137], v91 offset:17408
  ds_read_b64_tr_b16 v[138:139], v91 offset:19712
  v_mfma_f32_16x16x32_bf16 v[64:67], v[168:171], v[108:111], v[64:67]
  v_mfma_f32_16x16x32_bf16 v[32:35], v[172:175], v[104:107], v[32:35]
  ds_read_b64_tr_b16 v[140:141], v91 offset:17440
  ds_read_b64_tr_b16 v[142:143], v91 offset:19744
  v_mfma_f32_16x16x32_bf16 v[68:71], v[172:175], v[108:111], v[68:71]
  v_mfma_f32_16x16x32_bf16 v[36:39], v[176:179], v[104:107], v[36:39]
  ds_read_b64_tr_b16 v[144:145], v91 offset:17472
  ds_read_b64_tr_b16 v[146:147], v91 offset:19776
  v_mfma_f32_16x16x32_bf16 v[72:75], v[176:179], v[108:111], v[72:75]
  s_waitcnt lgkmcnt(8)
  v_mfma_f32_16x16x32_bf16 v[40:43], v[180:183], v[104:107], v[40:43]
  ds_read_b64_tr_b16 v[148:149], v91 offset:17504
  ds_read_b64_tr_b16 v[150:151], v91 offset:19808
  v_mfma_f32_16x16x32_bf16 v[76:79], v[180:183], v[108:111], v[76:79]
  v_mfma_f32_16x16x32_bf16 v[44:47], v[128:131], v[104:107], v[44:47]
  ds_read_b64_tr_b16 v[152:153], v91 offset:17536
  ds_read_b64_tr_b16 v[154:155], v91 offset:19840
  v_mfma_f32_16x16x32_bf16 v[80:83], v[128:131], v[108:111], v[80:83]
  v_mfma_f32_16x16x32_bf16 v[48:51], v[132:135], v[104:107], v[48:51]
  ds_read_b64_tr_b16 v[156:157], v91 offset:17568
  ds_read_b64_tr_b16 v[158:159], v91 offset:19872
  v_mfma_f32_16x16x32_bf16 v[84:87], v[132:135], v[108:111], v[84:87]
  s_waitcnt lgkmcnt(6)
  v_mfma_f32_16x16x32_bf16 v[16:19], v[136:139], v[112:115], v[16:19]
  ds_read_b64_tr_b16 v[160:161], v91 offset:17600
  ds_read_b64_tr_b16 v[162:163], v91 offset:19904
  v_mfma_f32_16x16x32_bf16 v[52:55], v[136:139], v[116:119], v[52:55]
  v_mfma_f32_16x16x32_bf16 v[20:23], v[140:143], v[112:115], v[20:23]
  ds_read_b64_tr_b16 v[164:165], v91 offset:17632
  ds_read_b64_tr_b16 v[166:167], v91 offset:19936
  v_mfma_f32_16x16x32_bf16 v[56:59], v[140:143], v[116:119], v[56:59]
  v_mfma_f32_16x16x32_bf16 v[24:27], v[144:147], v[112:115], v[24:27]
  ds_read_b64_tr_b16 v[168:169], v91 offset:17664
  ds_read_b64_tr_b16 v[170:171], v91 offset:19968
  v_mfma_f32_16x16x32_bf16 v[60:63], v[144:147], v[116:119], v[60:63]
  s_waitcnt lgkmcnt(6)
  v_mfma_f32_16x16x32_bf16 v[28:31], v[148:151], v[112:115], v[28:31]
  s_barrier
  ds_read_b128 v[120:123], v88 offset:34816
  ds_read_b128 v[124:127], v88 offset:35840
  ds_read_b64_tr_b16 v[172:173], v91 offset:34816
  ds_read_b64_tr_b16 v[174:175], v91 offset:37120
  v_mfma_f32_16x16x32_bf16 v[64:67], v[148:151], v[116:119], v[64:67]
  v_mfma_f32_16x16x32_bf16 v[32:35], v[152:155], v[112:115], v[32:35]
  ds_read_b64_tr_b16 v[176:177], v91 offset:34848
  ds_read_b64_tr_b16 v[178:179], v91 offset:37152
  v_mfma_f32_16x16x32_bf16 v[68:71], v[152:155], v[116:119], v[68:71]
  v_mfma_f32_16x16x32_bf16 v[36:39], v[156:159], v[112:115], v[36:39]
  ds_read_b64_tr_b16 v[180:181], v91 offset:34880
  ds_read_b64_tr_b16 v[182:183], v91 offset:37184
  v_mfma_f32_16x16x32_bf16 v[72:75], v[156:159], v[116:119], v[72:75]
  s_waitcnt lgkmcnt(8)
  v_mfma_f32_16x16x32_bf16 v[40:43], v[160:163], v[112:115], v[40:43]
  ds_read_b64_tr_b16 v[128:129], v91 offset:34912
  ds_read_b64_tr_b16 v[130:131], v91 offset:37216
  v_mfma_f32_16x16x32_bf16 v[76:79], v[160:163], v[116:119], v[76:79]
  v_mfma_f32_16x16x32_bf16 v[44:47], v[164:167], v[112:115], v[44:47]
  ds_read_b64_tr_b16 v[132:133], v91 offset:34944
  ds_read_b64_tr_b16 v[134:135], v91 offset:37248
  v_mfma_f32_16x16x32_bf16 v[80:83], v[164:167], v[116:119], v[80:83]
  v_mfma_f32_16x16x32_bf16 v[48:51], v[168:171], v[112:115], v[48:51]
  ds_read_b64_tr_b16 v[136:137], v91 offset:34976
  ds_read_b64_tr_b16 v[138:139], v91 offset:37280
  v_mfma_f32_16x16x32_bf16 v[84:87], v[168:171], v[116:119], v[84:87]
  s_waitcnt lgkmcnt(6)
  v_mfma_f32_16x16x32_bf16 v[16:19], v[172:175], v[120:123], v[16:19]
  ds_read_b64_tr_b16 v[140:141], v91 offset:35008
  ds_read_b64_tr_b16 v[142:143], v91 offset:37312
  v_mfma_f32_16x16x32_bf16 v[52:55], v[172:175], v[124:127], v[52:55]
  v_mfma_f32_16x16x32_bf16 v[20:23], v[176:179], v[120:123], v[20:23]
  ds_read_b64_tr_b16 v[144:145], v91 offset:35040
  ds_read_b64_tr_b16 v[146:147], v91 offset:37344
  v_mfma_f32_16x16x32_bf16 v[56:59], v[176:179], v[124:127], v[56:59]
  v_mfma_f32_16x16x32_bf16 v[24:27], v[180:183], v[120:123], v[24:27]
  ds_read_b64_tr_b16 v[148:149], v91 offset:35072
  ds_read_b64_tr_b16 v[150:151], v91 offset:37376
  v_mfma_f32_16x16x32_bf16 v[60:63], v[180:183], v[124:127], v[60:63]
  s_waitcnt lgkmcnt(6)
  v_mfma_f32_16x16x32_bf16 v[28:31], v[128:131], v[120:123], v[28:31]
  s_barrier
  ds_read_b128 v[96:99], v89 offset:0
  ds_read_b128 v[100:103], v89 offset:1024
  ds_read_b64_tr_b16 v[152:153], v92 offset:0
  ds_read_b64_tr_b16 v[154:155], v92 offset:2304
  v_mfma_f32_16x16x32_bf16 v[64:67], v[128:131], v[124:127], v[64:67]
  v_mfma_f32_16x16x32_bf16 v[32:35], v[132:135], v[120:123], v[32:35]
  ds_read_b64_tr_b16 v[156:157], v92 offset:32
  ds_read_b64_tr_b16 v[158:159], v92 offset:2336
  v_mfma_f32_16x16x32_bf16 v[68:71], v[132:135], v[124:127], v[68:71]
  v_mfma_f32_16x16x32_bf16 v[36:39], v[136:139], v[120:123], v[36:39]
  ds_read_b64_tr_b16 v[160:161], v92 offset:64
  ds_read_b64_tr_b16 v[162:163], v92 offset:2368
  v_mfma_f32_16x16x32_bf16 v[72:75], v[136:139], v[124:127], v[72:75]
  s_waitcnt lgkmcnt(8)
  v_mfma_f32_16x16x32_bf16 v[40:43], v[140:143], v[120:123], v[40:43]
  ds_read_b64_tr_b16 v[164:165], v92 offset:96
  ds_read_b64_tr_b16 v[166:167], v92 offset:2400
  v_mfma_f32_16x16x32_bf16 v[76:79], v[140:143], v[124:127], v[76:79]
  v_mfma_f32_16x16x32_bf16 v[44:47], v[144:147], v[120:123], v[44:47]
  ds_read_b64_tr_b16 v[168:169], v92 offset:128
  ds_read_b64_tr_b16 v[170:171], v92 offset:2432
  v_mfma_f32_16x16x32_bf16 v[80:83], v[144:147], v[124:127], v[80:83]
  v_mfma_f32_16x16x32_bf16 v[48:51], v[148:151], v[120:123], v[48:51]
  ds_read_b64_tr_b16 v[172:173], v92 offset:160
  ds_read_b64_tr_b16 v[174:175], v92 offset:2464
  v_mfma_f32_16x16x32_bf16 v[84:87], v[148:151], v[124:127], v[84:87]
  s_waitcnt lgkmcnt(6)
  v_mfma_f32_16x16x32_bf16 v[16:19], v[152:155], v[96:99], v[16:19]
  ds_read_b64_tr_b16 v[176:177], v92 offset:192
  ds_read_b64_tr_b16 v[178:179], v92 offset:2496
  v_mfma_f32_16x16x32_bf16 v[52:55], v[152:155], v[100:103], v[52:55]
  v_mfma_f32_16x16x32_bf16 v[20:23], v[156:159], v[96:99], v[20:23]
  ds_read_b64_tr_b16 v[180:181], v92 offset:224
  ds_read_b64_tr_b16 v[182:183], v92 offset:2528
  v_mfma_f32_16x16x32_bf16 v[56:59], v[156:159], v[100:103], v[56:59]
  v_mfma_f32_16x16x32_bf16 v[24:27], v[160:163], v[96:99], v[24:27]
  ds_read_b64_tr_b16 v[128:129], v92 offset:256
  ds_read_b64_tr_b16 v[130:131], v92 offset:2560
  v_mfma_f32_16x16x32_bf16 v[60:63], v[160:163], v[100:103], v[60:63]
  s_waitcnt lgkmcnt(6)
  v_mfma_f32_16x16x32_bf16 v[28:31], v[164:167], v[96:99], v[28:31]
  s_barrier
  ds_read_b128 v[104:107], v89 offset:17408
  ds_read_b128 v[108:111], v89 offset:18432
  ds_read_b64_tr_b16 v[132:133], v92 offset:17408
  ds_read_b64_tr_b16 v[134:135], v92 offset:19712
  v_mfma_f32_16x16x32_bf16 v[64:67], v[164:167], v[100:103], v[64:67]
  v_mfma_f32_16x16x32_bf16 v[32:35], v[168:171], v[96:99], v[32:35]
  ds_read_b64_tr_b16 v[136:137], v92 offset:17440
  ds_read_b64_tr_b16 v[138:139], v92 offset:19744
  v_mfma_f32_16x16x32_bf16 v[68:71], v[168:171], v[100:103], v[68:71]
  v_mfma_f32_16x16x32_bf16 v[36:39], v[172:175], v[96:99], v[36:39]
  ds_read_b64_tr_b16 v[140:141], v92 offset:17472
  ds_read_b64_tr_b16 v[142:143], v92 offset:19776
  v_mfma_f32_16x16x32_bf16 v[72:75], v[172:175], v[100:103], v[72:75]
  s_waitcnt lgkmcnt(8)
  v_mfma_f32_16x16x32_bf16 v[40:43], v[176:179], v[96:99], v[40:43]
  ds_read_b64_tr_b16 v[144:145], v92 offset:17504
  ds_read_b64_tr_b16 v[146:147], v92 offset:19808
  v_mfma_f32_16x16x32_bf16 v[76:79], v[176:179], v[100:103], v[76:79]
  v_mfma_f32_16x16x32_bf16 v[44:47], v[180:183], v[96:99], v[44:47]
  ds_read_b64_tr_b16 v[148:149], v92 offset:17536
  ds_read_b64_tr_b16 v[150:151], v92 offset:19840
  v_mfma_f32_16x16x32_bf16 v[80:83], v[180:183], v[100:103], v[80:83]
  v_mfma_f32_16x16x32_bf16 v[48:51], v[128:131], v[96:99], v[48:51]
  ds_read_b64_tr_b16 v[152:153], v92 offset:17568
  ds_read_b64_tr_b16 v[154:155], v92 offset:19872
  v_mfma_f32_16x16x32_bf16 v[84:87], v[128:131], v[100:103], v[84:87]
  s_waitcnt lgkmcnt(6)
  v_mfma_f32_16x16x32_bf16 v[16:19], v[132:135], v[104:107], v[16:19]
  ds_read_b64_tr_b16 v[156:157], v92 offset:17600
  ds_read_b64_tr_b16 v[158:159], v92 offset:19904
  v_mfma_f32_16x16x32_bf16 v[52:55], v[132:135], v[108:111], v[52:55]
  v_mfma_f32_16x16x32_bf16 v[20:23], v[136:139], v[104:107], v[20:23]
  ds_read_b64_tr_b16 v[160:161], v92 offset:17632
  ds_read_b64_tr_b16 v[162:163], v92 offset:19936
  v_mfma_f32_16x16x32_bf16 v[56:59], v[136:139], v[108:111], v[56:59]
  v_mfma_f32_16x16x32_bf16 v[24:27], v[140:143], v[104:107], v[24:27]
  ds_read_b64_tr_b16 v[164:165], v92 offset:17664
  ds_read_b64_tr_b16 v[166:167], v92 offset:19968
  v_mfma_f32_16x16x32_bf16 v[60:63], v[140:143], v[108:111], v[60:63]
  s_waitcnt lgkmcnt(6)
  v_mfma_f32_16x16x32_bf16 v[28:31], v[144:147], v[104:107], v[28:31]
  s_barrier
  ds_read_b128 v[112:115], v89 offset:34816
  ds_read_b128 v[116:119], v89 offset:35840
  ds_read_b64_tr_b16 v[168:169], v92 offset:34816
  ds_read_b64_tr_b16 v[170:171], v92 offset:37120
  v_mfma_f32_16x16x32_bf16 v[64:67], v[144:147], v[108:111], v[64:67]
  v_mfma_f32_16x16x32_bf16 v[32:35], v[148:151], v[104:107], v[32:35]
  ds_read_b64_tr_b16 v[172:173], v92 offset:34848
  ds_read_b64_tr_b16 v[174:175], v92 offset:37152
  v_mfma_f32_16x16x32_bf16 v[68:71], v[148:151], v[108:111], v[68:71]
  v_mfma_f32_16x16x32_bf16 v[36:39], v[152:155], v[104:107], v[36:39]
  ds_read_b64_tr_b16 v[176:177], v92 offset:34880
  ds_read_b64_tr_b16 v[178:179], v92 offset:37184
  v_mfma_f32_16x16x32_bf16 v[72:75], v[152:155], v[108:111], v[72:75]
  s_waitcnt lgkmcnt(8)
  v_mfma_f32_16x16x32_bf16 v[40:43], v[156:159], v[104:107], v[40:43]
  ds_read_b64_tr_b16 v[180:181], v92 offset:34912
  ds_read_b64_tr_b16 v[182:183], v92 offset:37216
  v_mfma_f32_16x16x32_bf16 v[76:79], v[156:159], v[108:111], v[76:79]
  v_mfma_f32_16x16x32_bf16 v[44:47], v[160:163], v[104:107], v[44:47]
  ds_read_b64_tr_b16 v[128:129], v92 offset:34944
  ds_read_b64_tr_b16 v[130:131], v92 offset:37248
  v_mfma_f32_16x16x32_bf16 v[80:83], v[160:163], v[108:111], v[80:83]
  v_mfma_f32_16x16x32_bf16 v[48:51], v[164:167], v[104:107], v[48:51]
  ds_read_b64_tr_b16 v[132:133], v92 offset:34976
  ds_read_b64_tr_b16 v[134:135], v92 offset:37280
  v_mfma_f32_16x16x32_bf16 v[84:87], v[164:167], v[108:111], v[84:87]
  s_waitcnt lgkmcnt(6)
  v_mfma_f32_16x16x32_bf16 v[16:19], v[168:171], v[112:115], v[16:19]
  ds_read_b64_tr_b16 v[136:137], v92 offset:35008
  ds_read_b64_tr_b16 v[138:139], v92 offset:37312
  v_mfma_f32_16x16x32_bf16 v[52:55], v[168:171], v[116:119], v[52:55]
  v_mfma_f32_16x16x32_bf16 v[20:23], v[172:175], v[112:115], v[20:23]
  ds_read_b64_tr_b16 v[140:141], v92 offset:35040
  ds_read_b64_tr_b16 v[142:143], v92 offset:37344
  v_mfma_f32_16x16x32_bf16 v[56:59], v[172:175], v[116:119], v[56:59]
  v_mfma_f32_16x16x32_bf16 v[24:27], v[176:179], v[112:115], v[24:27]
  ds_read_b64_tr_b16 v[144:145], v92 offset:35072
  ds_read_b64_tr_b16 v[146:147], v92 offset:37376
  v_mfma_f32_16x16x32_bf16 v[60:63], v[176:179], v[116:119], v[60:63]
  s_waitcnt lgkmcnt(6)
  v_mfma_f32_16x16x32_bf16 v[28:31], v[180:183], v[112:115], v[28:31]
  s_barrier
  ds_read_b128 v[120:123], v90 offset:0
  ds_read_b128 v[124:127], v90 offset:1024
  ds_read_b64_tr_b16 v[148:149], v93 offset:0
  ds_read_b64_tr_b16 v[150:151], v93 offset:2304
  v_mfma_f32_16x16x32_bf16 v[64:67], v[180:183], v[116:119], v[64:67]
  v_mfma_f32_16x16x32_bf16 v[32:35], v[128:131], v[112:115], v[32:35]
  ds_read_b64_tr_b16 v[152:153], v93 offset:32
  ds_read_b64_tr_b16 v[154:155], v93 offset:2336
  v_mfma_f32_16x16x32_bf16 v[68:71], v[128:131], v[116:119], v[68:71]
  v_mfma_f32_16x16x32_bf16 v[36:39], v[132:135], v[112:115], v[36:39]
  ds_read_b64_tr_b16 v[156:157], v93 offset:64
  ds_read_b64_tr_b16 v[158:159], v93 offset:2368
  v_mfma_f32_16x16x32_bf16 v[72:75], v[132:135], v[116:119], v[72:75]
  s_waitcnt lgkmcnt(8)
  v_mfma_f32_16x16x32_bf16 v[40:43], v[136:139], v[112:115], v[40:43]
  ds_read_b64_tr_b16 v[160:161], v93 offset:96
  ds_read_b64_tr_b16 v[162:163], v93 offset:2400
  v_mfma_f32_16x16x32_bf16 v[76:79], v[136:139], v[116:119], v[76:79]
  v_mfma_f32_16x16x32_bf16 v[44:47], v[140:143], v[112:115], v[44:47]
  ds_read_b64_tr_b16 v[164:165], v93 offset:128
  ds_read_b64_tr_b16 v[166:167], v93 offset:2432
  v_mfma_f32_16x16x32_bf16 v[80:83], v[140:143], v[116:119], v[80:83]
  v_mfma_f32_16x16x32_bf16 v[48:51], v[144:147], v[112:115], v[48:51]
  ds_read_b64_tr_b16 v[168:169], v93 offset:160
  ds_read_b64_tr_b16 v[170:171], v93 offset:2464
  v_mfma_f32_16x16x32_bf16 v[84:87], v[144:147], v[116:119], v[84:87]
  s_waitcnt lgkmcnt(6)
  v_mfma_f32_16x16x32_bf16 v[16:19], v[148:151], v[120:123], v[16:19]
  ds_read_b64_tr_b16 v[172:173], v93 offset:192
  ds_read_b64_tr_b16 v[174:175], v93 offset:2496
  v_mfma_f32_16x16x32_bf16 v[52:55], v[148:151], v[124:127], v[52:55]
  v_mfma_f32_16x16x32_bf16 v[20:23], v[152:155], v[120:123], v[20:23]
  ds_read_b64_tr_b16 v[176:177], v93 offset:224
  ds_read_b64_tr_b16 v[178:179], v93 offset:2528
  v_mfma_f32_16x16x32_bf16 v[56:59], v[152:155], v[124:127], v[56:59]
  v_mfma_f32_16x16x32_bf16 v[24:27], v[156:159], v[120:123], v[24:27]
  ds_read_b64_tr_b16 v[180:181], v93 offset:256
  ds_read_b64_tr_b16 v[182:183], v93 offset:2560
  v_mfma_f32_16x16x32_bf16 v[60:63], v[156:159], v[124:127], v[60:63]
  s_waitcnt lgkmcnt(6)
  v_mfma_f32_16x16x32_bf16 v[28:31], v[160:163], v[120:123], v[28:31]
  s_barrier
  ds_read_b128 v[96:99], v90 offset:17408
  ds_read_b128 v[100:103], v90 offset:18432
  ds_read_b64_tr_b16 v[128:129], v93 offset:17408
  ds_read_b64_tr_b16 v[130:131], v93 offset:19712
  v_mfma_f32_16x16x32_bf16 v[64:67], v[160:163], v[124:127], v[64:67]
  v_mfma_f32_16x16x32_bf16 v[32:35], v[164:167], v[120:123], v[32:35]
  ds_read_b64_tr_b16 v[132:133], v93 offset:17440
  ds_read_b64_tr_b16 v[134:135], v93 offset:19744
  v_mfma_f32_16x16x32_bf16 v[68:71], v[164:167], v[124:127], v[68:71]
  v_mfma_f32_16x16x32_bf16 v[36:39], v[168:171], v[120:123], v[36:39]
  ds_read_b64_tr_b16 v[136:137], v93 offset:17472
  ds_read_b64_tr_b16 v[138:139], v93 offset:19776
  v_mfma_f32_16x16x32_bf16 v[72:75], v[168:171], v[124:127], v[72:75]
  s_waitcnt lgkmcnt(8)
  v_mfma_f32_16x16x32_bf16 v[40:43], v[172:175], v[120:123], v[40:43]
  ds_read_b64_tr_b16 v[140:141], v93 offset:17504
  ds_read_b64_tr_b16 v[142:143], v93 offset:19808
  v_mfma_f32_16x16x32_bf16 v[76:79], v[172:175], v[124:127], v[76:79]
  v_mfma_f32_16x16x32_bf16 v[44:47], v[176:179], v[120:123], v[44:47]
  ds_read_b64_tr_b16 v[144:145], v93 offset:17536
  ds_read_b64_tr_b16 v[146:147], v93 offset:19840
  v_mfma_f32_16x16x32_bf16 v[80:83], v[176:179], v[124:127], v[80:83]
  v_mfma_f32_16x16x32_bf16 v[48:51], v[180:183], v[120:123], v[48:51]
  ds_read_b64_tr_b16 v[148:149], v93 offset:17568
  ds_read_b64_tr_b16 v[150:151], v93 offset:19872
  v_mfma_f32_16x16x32_bf16 v[84:87], v[180:183], v[124:127], v[84:87]
  s_waitcnt lgkmcnt(6)
  v_mfma_f32_16x16x32_bf16 v[16:19], v[128:131], v[96:99], v[16:19]
  ds_read_b64_tr_b16 v[152:153], v93 offset:17600
  ds_read_b64_tr_b16 v[154:155], v93 offset:19904
  v_mfma_f32_16x16x32_bf16 v[52:55], v[128:131], v[100:103], v[52:55]
  v_mfma_f32_16x16x32_bf16 v[20:23], v[132:135], v[96:99], v[20:23]
  ds_read_b64_tr_b16 v[156:157], v93 offset:17632
  ds_read_b64_tr_b16 v[158:159], v93 offset:19936
  v_mfma_f32_16x16x32_bf16 v[56:59], v[132:135], v[100:103], v[56:59]
  v_mfma_f32_16x16x32_bf16 v[24:27], v[136:139], v[96:99], v[24:27]
  ds_read_b64_tr_b16 v[160:161], v93 offset:17664
  ds_read_b64_tr_b16 v[162:163], v93 offset:19968
  v_mfma_f32_16x16x32_bf16 v[60:63], v[136:139], v[100:103], v[60:63]
  s_waitcnt lgkmcnt(6)
  v_mfma_f32_16x16x32_bf16 v[28:31], v[140:143], v[96:99], v[28:31]
  s_barrier
  ds_read_b128 v[104:107], v88 offset:0
  ds_read_b128 v[108:111], v88 offset:1024
  ds_read_b64_tr_b16 v[164:165], v91 offset:0
  ds_read_b64_tr_b16 v[166:167], v91 offset:2304
  v_mfma_f32_16x16x32_bf16 v[64:67], v[140:143], v[100:103], v[64:67]
  v_mfma_f32_16x16x32_bf16 v[32:35], v[144:147], v[96:99], v[32:35]
  ds_read_b64_tr_b16 v[168:169], v91 offset:32
  ds_read_b64_tr_b16 v[170:171], v91 offset:2336
  v_mfma_f32_16x16x32_bf16 v[68:71], v[144:147], v[100:103], v[68:71]
  v_mfma_f32_16x16x32_bf16 v[36:39], v[148:151], v[96:99], v[36:39]
  ds_read_b64_tr_b16 v[172:173], v91 offset:64
  ds_read_b64_tr_b16 v[174:175], v91 offset:2368
  v_mfma_f32_16x16x32_bf16 v[72:75], v[148:151], v[100:103], v[72:75]
  s_waitcnt lgkmcnt(8)
  v_mfma_f32_16x16x32_bf16 v[40:43], v[152:155], v[96:99], v[40:43]
  ds_read_b64_tr_b16 v[176:177], v91 offset:96
  ds_read_b64_tr_b16 v[178:179], v91 offset:2400
  v_mfma_f32_16x16x32_bf16 v[76:79], v[152:155], v[100:103], v[76:79]
  v_mfma_f32_16x16x32_bf16 v[44:47], v[156:159], v[96:99], v[44:47]
  ds_read_b64_tr_b16 v[180:181], v91 offset:128
  ds_read_b64_tr_b16 v[182:183], v91 offset:2432
  v_mfma_f32_16x16x32_bf16 v[80:83], v[156:159], v[100:103], v[80:83]
  v_mfma_f32_16x16x32_bf16 v[48:51], v[160:163], v[96:99], v[48:51]
  ds_read_b64_tr_b16 v[128:129], v91 offset:160
  ds_read_b64_tr_b16 v[130:131], v91 offset:2464
  v_mfma_f32_16x16x32_bf16 v[84:87], v[160:163], v[100:103], v[84:87]
  s_waitcnt lgkmcnt(6)
  v_mfma_f32_16x16x32_bf16 v[16:19], v[164:167], v[104:107], v[16:19]
  ds_read_b64_tr_b16 v[132:133], v91 offset:192
  ds_read_b64_tr_b16 v[134:135], v91 offset:2496
  v_mfma_f32_16x16x32_bf16 v[52:55], v[164:167], v[108:111], v[52:55]
  v_mfma_f32_16x16x32_bf16 v[20:23], v[168:171], v[104:107], v[20:23]
  ds_read_b64_tr_b16 v[136:137], v91 offset:224
  ds_read_b64_tr_b16 v[138:139], v91 offset:2528
  v_mfma_f32_16x16x32_bf16 v[56:59], v[168:171], v[108:111], v[56:59]
  v_mfma_f32_16x16x32_bf16 v[24:27], v[172:175], v[104:107], v[24:27]
  ds_read_b64_tr_b16 v[140:141], v91 offset:256
  ds_read_b64_tr_b16 v[142:143], v91 offset:2560
  v_mfma_f32_16x16x32_bf16 v[60:63], v[172:175], v[108:111], v[60:63]
  s_waitcnt lgkmcnt(6)
  v_mfma_f32_16x16x32_bf16 v[28:31], v[176:179], v[104:107], v[28:31]
  s_barrier
  ds_read_b128 v[112:115], v88 offset:17408
  ds_read_b128 v[116:119], v88 offset:18432
  ds_read_b64_tr_b16 v[144:145], v91 offset:17408
  ds_read_b64_tr_b16 v[146:147], v91 offset:19712
  v_mfma_f32_16x16x32_bf16 v[64:67], v[176:179], v[108:111], v[64:67]
  v_mfma_f32_16x16x32_bf16 v[32:35], v[180:183], v[104:107], v[32:35]
  ds_read_b64_tr_b16 v[148:149], v91 offset:17440
  ds_read_b64_tr_b16 v[150:151], v91 offset:19744
  v_mfma_f32_16x16x32_bf16 v[68:71], v[180:183], v[108:111], v[68:71]
  v_mfma_f32_16x16x32_bf16 v[36:39], v[128:131], v[104:107], v[36:39]
  ds_read_b64_tr_b16 v[152:153], v91 offset:17472
  ds_read_b64_tr_b16 v[154:155], v91 offset:19776
  v_mfma_f32_16x16x32_bf16 v[72:75], v[128:131], v[108:111], v[72:75]
  s_waitcnt lgkmcnt(8)
  v_mfma_f32_16x16x32_bf16 v[40:43], v[132:135], v[104:107], v[40:43]
  ds_read_b64_tr_b16 v[156:157], v91 offset:17504
  ds_read_b64_tr_b16 v[158:159], v91 offset:19808
  v_mfma_f32_16x16x32_bf16 v[76:79], v[132:135], v[108:111], v[76:79]
  v_mfma_f32_16x16x32_bf16 v[44:47], v[136:139], v[104:107], v[44:47]
  ds_read_b64_tr_b16 v[160:161], v91 offset:17536
  ds_read_b64_tr_b16 v[162:163], v91 offset:19840
  v_mfma_f32_16x16x32_bf16 v[80:83], v[136:139], v[108:111], v[80:83]
  v_mfma_f32_16x16x32_bf16 v[48:51], v[140:143], v[104:107], v[48:51]
  ds_read_b64_tr_b16 v[164:165], v91 offset:17568
  ds_read_b64_tr_b16 v[166:167], v91 offset:19872
  v_mfma_f32_16x16x32_bf16 v[84:87], v[140:143], v[108:111], v[84:87]
  s_waitcnt lgkmcnt(6)
  v_mfma_f32_16x16x32_bf16 v[16:19], v[144:147], v[112:115], v[16:19]
  ds_read_b64_tr_b16 v[168:169], v91 offset:17600
  ds_read_b64_tr_b16 v[170:171], v91 offset:19904
  v_mfma_f32_16x16x32_bf16 v[52:55], v[144:147], v[116:119], v[52:55]
  v_mfma_f32_16x16x32_bf16 v[20:23], v[148:151], v[112:115], v[20:23]
  ds_read_b64_tr_b16 v[172:173], v91 offset:17632
  ds_read_b64_tr_b16 v[174:175], v91 offset:19936
  v_mfma_f32_16x16x32_bf16 v[56:59], v[148:151], v[116:119], v[56:59]
  v_mfma_f32_16x16x32_bf16 v[24:27], v[152:155], v[112:115], v[24:27]
  ds_read_b64_tr_b16 v[176:177], v91 offset:17664
  ds_read_b64_tr_b16 v[178:179], v91 offset:19968
  v_mfma_f32_16x16x32_bf16 v[60:63], v[152:155], v[116:119], v[60:63]
  s_waitcnt lgkmcnt(6)
  v_mfma_f32_16x16x32_bf16 v[28:31], v[156:159], v[112:115], v[28:31]
  s_barrier
  ds_read_b128 v[120:123], v88 offset:34816
  ds_read_b128 v[124:127], v88 offset:35840
  ds_read_b64_tr_b16 v[180:181], v91 offset:34816
  ds_read_b64_tr_b16 v[182:183], v91 offset:37120
  v_mfma_f32_16x16x32_bf16 v[64:67], v[156:159], v[116:119], v[64:67]
  v_mfma_f32_16x16x32_bf16 v[32:35], v[160:163], v[112:115], v[32:35]
  ds_read_b64_tr_b16 v[128:129], v91 offset:34848
  ds_read_b64_tr_b16 v[130:131], v91 offset:37152
  v_mfma_f32_16x16x32_bf16 v[68:71], v[160:163], v[116:119], v[68:71]
  v_mfma_f32_16x16x32_bf16 v[36:39], v[164:167], v[112:115], v[36:39]
  ds_read_b64_tr_b16 v[132:133], v91 offset:34880
  ds_read_b64_tr_b16 v[134:135], v91 offset:37184
  v_mfma_f32_16x16x32_bf16 v[72:75], v[164:167], v[116:119], v[72:75]
  s_waitcnt lgkmcnt(8)
  v_mfma_f32_16x16x32_bf16 v[40:43], v[168:171], v[112:115], v[40:43]
  ds_read_b64_tr_b16 v[136:137], v91 offset:34912
  ds_read_b64_tr_b16 v[138:139], v91 offset:37216
  v_mfma_f32_16x16x32_bf16 v[76:79], v[168:171], v[116:119], v[76:79]
  v_mfma_f32_16x16x32_bf16 v[44:47], v[172:175], v[112:115], v[44:47]
  ds_read_b64_tr_b16 v[140:141], v91 offset:34944
  ds_read_b64_tr_b16 v[142:143], v91 offset:37248
  v_mfma_f32_16x16x32_bf16 v[80:83], v[172:175], v[116:119], v[80:83]
  v_mfma_f32_16x16x32_bf16 v[48:51], v[176:179], v[112:115], v[48:51]
  ds_read_b64_tr_b16 v[144:145], v91 offset:34976
  ds_read_b64_tr_b16 v[146:147], v91 offset:37280
  v_mfma_f32_16x16x32_bf16 v[84:87], v[176:179], v[116:119], v[84:87]
  s_waitcnt lgkmcnt(6)
  v_mfma_f32_16x16x32_bf16 v[16:19], v[180:183], v[120:123], v[16:19]
  ds_read_b64_tr_b16 v[148:149], v91 offset:35008
  ds_read_b64_tr_b16 v[150:151], v91 offset:37312
  v_mfma_f32_16x16x32_bf16 v[52:55], v[180:183], v[124:127], v[52:55]
  v_mfma_f32_16x16x32_bf16 v[20:23], v[128:131], v[120:123], v[20:23]
  ds_read_b64_tr_b16 v[152:153], v91 offset:35040
  ds_read_b64_tr_b16 v[154:155], v91 offset:37344
  v_mfma_f32_16x16x32_bf16 v[56:59], v[128:131], v[124:127], v[56:59]
  v_mfma_f32_16x16x32_bf16 v[24:27], v[132:135], v[120:123], v[24:27]
  ds_read_b64_tr_b16 v[156:157], v91 offset:35072
  ds_read_b64_tr_b16 v[158:159], v91 offset:37376
  v_mfma_f32_16x16x32_bf16 v[60:63], v[132:135], v[124:127], v[60:63]
  s_waitcnt lgkmcnt(6)
  v_mfma_f32_16x16x32_bf16 v[28:31], v[136:139], v[120:123], v[28:31]
  s_barrier
  ds_read_b128 v[96:99], v89 offset:0
  ds_read_b128 v[100:103], v89 offset:1024
  ds_read_b64_tr_b16 v[160:161], v92 offset:0
  ds_read_b64_tr_b16 v[162:163], v92 offset:2304
  v_mfma_f32_16x16x32_bf16 v[64:67], v[136:139], v[124:127], v[64:67]
  v_mfma_f32_16x16x32_bf16 v[32:35], v[140:143], v[120:123], v[32:35]
  ds_read_b64_tr_b16 v[164:165], v92 offset:32
  ds_read_b64_tr_b16 v[166:167], v92 offset:2336
  v_mfma_f32_16x16x32_bf16 v[68:71], v[140:143], v[124:127], v[68:71]
  v_mfma_f32_16x16x32_bf16 v[36:39], v[144:147], v[120:123], v[36:39]
  ds_read_b64_tr_b16 v[168:169], v92 offset:64
  ds_read_b64_tr_b16 v[170:171], v92 offset:2368
  v_mfma_f32_16x16x32_bf16 v[72:75], v[144:147], v[124:127], v[72:75]
  s_waitcnt lgkmcnt(8)
  v_mfma_f32_16x16x32_bf16 v[40:43], v[148:151], v[120:123], v[40:43]
  ds_read_b64_tr_b16 v[172:173], v92 offset:96
  ds_read_b64_tr_b16 v[174:175], v92 offset:2400
  v_mfma_f32_16x16x32_bf16 v[76:79], v[148:151], v[124:127], v[76:79]
  v_mfma_f32_16x16x32_bf16 v[44:47], v[152:155], v[120:123], v[44:47]
  ds_read_b64_tr_b16 v[176:177], v92 offset:128
  ds_read_b64_tr_b16 v[178:179], v92 offset:2432
  v_mfma_f32_16x16x32_bf16 v[80:83], v[152:155], v[124:127], v[80:83]
  v_mfma_f32_16x16x32_bf16 v[48:51], v[156:159], v[120:123], v[48:51]
  ds_read_b64_tr_b16 v[180:181], v92 offset:160
  ds_read_b64_tr_b16 v[182:183], v92 offset:2464
  v_mfma_f32_16x16x32_bf16 v[84:87], v[156:159], v[124:127], v[84:87]
  s_waitcnt lgkmcnt(6)
  v_mfma_f32_16x16x32_bf16 v[16:19], v[160:163], v[96:99], v[16:19]
  ds_read_b64_tr_b16 v[128:129], v92 offset:192
  ds_read_b64_tr_b16 v[130:131], v92 offset:2496
  v_mfma_f32_16x16x32_bf16 v[52:55], v[160:163], v[100:103], v[52:55]
  v_mfma_f32_16x16x32_bf16 v[20:23], v[164:167], v[96:99], v[20:23]
  ds_read_b64_tr_b16 v[132:133], v92 offset:224
  ds_read_b64_tr_b16 v[134:135], v92 offset:2528
  v_mfma_f32_16x16x32_bf16 v[56:59], v[164:167], v[100:103], v[56:59]
  v_mfma_f32_16x16x32_bf16 v[24:27], v[168:171], v[96:99], v[24:27]
  ds_read_b64_tr_b16 v[136:137], v92 offset:256
  ds_read_b64_tr_b16 v[138:139], v92 offset:2560
  v_mfma_f32_16x16x32_bf16 v[60:63], v[168:171], v[100:103], v[60:63]
  s_waitcnt lgkmcnt(6)
  v_mfma_f32_16x16x32_bf16 v[28:31], v[172:175], v[96:99], v[28:31]
  s_barrier
  ds_read_b128 v[104:107], v89 offset:17408
  ds_read_b128 v[108:111], v89 offset:18432
  ds_read_b64_tr_b16 v[140:141], v92 offset:17408
  ds_read_b64_tr_b16 v[142:143], v92 offset:19712
  v_mfma_f32_16x16x32_bf16 v[64:67], v[172:175], v[100:103], v[64:67]
  v_mfma_f32_16x16x32_bf16 v[32:35], v[176:179], v[96:99], v[32:35]
  ds_read_b64_tr_b16 v[144:145], v92 offset:17440
  ds_read_b64_tr_b16 v[146:147], v92 offset:19744
  v_mfma_f32_16x16x32_bf16 v[68:71], v[176:179], v[100:103], v[68:71]
  v_mfma_f32_16x16x32_bf16 v[36:39], v[180:183], v[96:99], v[36:39]
  ds_read_b64_tr_b16 v[148:149], v92 offset:17472
  ds_read_b64_tr_b16 v[150:151], v92 offset:19776
  v_mfma_f32_16x16x32_bf16 v[72:75], v[180:183], v[100:103], v[72:75]
  s_waitcnt lgkmcnt(8)
  v_mfma_f32_16x16x32_bf16 v[40:43], v[128:131], v[96:99], v[40:43]
  ds_read_b64_tr_b16 v[152:153], v92 offset:17504
  ds_read_b64_tr_b16 v[154:155], v92 offset:19808
  v_mfma_f32_16x16x32_bf16 v[76:79], v[128:131], v[100:103], v[76:79]
  v_mfma_f32_16x16x32_bf16 v[44:47], v[132:135], v[96:99], v[44:47]
  ds_read_b64_tr_b16 v[156:157], v92 offset:17536
  ds_read_b64_tr_b16 v[158:159], v92 offset:19840
  v_mfma_f32_16x16x32_bf16 v[80:83], v[132:135], v[100:103], v[80:83]
  v_mfma_f32_16x16x32_bf16 v[48:51], v[136:139], v[96:99], v[48:51]
  ds_read_b64_tr_b16 v[160:161], v92 offset:17568
  ds_read_b64_tr_b16 v[162:163], v92 offset:19872
  v_mfma_f32_16x16x32_bf16 v[84:87], v[136:139], v[100:103], v[84:87]
  s_waitcnt lgkmcnt(6)
  v_mfma_f32_16x16x32_bf16 v[16:19], v[140:143], v[104:107], v[16:19]
  ds_read_b64_tr_b16 v[164:165], v92 offset:17600
  ds_read_b64_tr_b16 v[166:167], v92 offset:19904
  v_mfma_f32_16x16x32_bf16 v[52:55], v[140:143], v[108:111], v[52:55]
  v_mfma_f32_16x16x32_bf16 v[20:23], v[144:147], v[104:107], v[20:23]
  ds_read_b64_tr_b16 v[168:169], v92 offset:17632
  ds_read_b64_tr_b16 v[170:171], v92 offset:19936
  v_mfma_f32_16x16x32_bf16 v[56:59], v[144:147], v[108:111], v[56:59]
  v_mfma_f32_16x16x32_bf16 v[24:27], v[148:151], v[104:107], v[24:27]
  ds_read_b64_tr_b16 v[172:173], v92 offset:17664
  ds_read_b64_tr_b16 v[174:175], v92 offset:19968
  v_mfma_f32_16x16x32_bf16 v[60:63], v[148:151], v[108:111], v[60:63]
  s_waitcnt lgkmcnt(6)
  v_mfma_f32_16x16x32_bf16 v[28:31], v[152:155], v[104:107], v[28:31]
  s_barrier
  ds_read_b128 v[112:115], v89 offset:34816
  ds_read_b128 v[116:119], v89 offset:35840
  ds_read_b64_tr_b16 v[176:177], v92 offset:34816
  ds_read_b64_tr_b16 v[178:179], v92 offset:37120
  v_mfma_f32_16x16x32_bf16 v[64:67], v[152:155], v[108:111], v[64:67]
  v_mfma_f32_16x16x32_bf16 v[32:35], v[156:159], v[104:107], v[32:35]
  ds_read_b64_tr_b16 v[180:181], v92 offset:34848
  ds_read_b64_tr_b16 v[182:183], v92 offset:37152
  v_mfma_f32_16x16x32_bf16 v[68:71], v[156:159], v[108:111], v[68:71]
  v_mfma_f32_16x16x32_bf16 v[36:39], v[160:163], v[104:107], v[36:39]
  ds_read_b64_tr_b16 v[128:129], v92 offset:34880
  ds_read_b64_tr_b16 v[130:131], v92 offset:37184
  v_mfma_f32_16x16x32_bf16 v[72:75], v[160:163], v[108:111], v[72:75]
  s_waitcnt lgkmcnt(8)
  v_mfma_f32_16x16x32_bf16 v[40:43], v[164:167], v[104:107], v[40:43]
  ds_read_b64_tr_b16 v[132:133], v92 offset:34912
  ds_read_b64_tr_b16 v[134:135], v92 offset:37216
  v_mfma_f32_16x16x32_bf16 v[76:79], v[164:167], v[108:111], v[76:79]
  v_mfma_f32_16x16x32_bf16 v[44:47], v[168:171], v[104:107], v[44:47]
  ds_read_b64_tr_b16 v[136:137], v92 offset:34944
  ds_read_b64_tr_b16 v[138:139], v92 offset:37248
  v_mfma_f32_16x16x32_bf16 v[80:83], v[168:171], v[108:111], v[80:83]
  v_mfma_f32_16x16x32_bf16 v[48:51], v[172:175], v[104:107], v[48:51]
  ds_read_b64_tr_b16 v[140:141], v92 offset:34976
  ds_read_b64_tr_b16 v[142:143], v92 offset:37280
  v_mfma_f32_16x16x32_bf16 v[84:87], v[172:175], v[108:111], v[84:87]
  s_waitcnt lgkmcnt(6)
  v_mfma_f32_16x16x32_bf16 v[16:19], v[176:179], v[112:115], v[16:19]
  ds_read_b64_tr_b16 v[144:145], v92 offset:35008
  ds_read_b64_tr_b16 v[146:147], v92 offset:37312
  v_mfma_f32_16x16x32_bf16 v[52:55], v[176:179], v[116:119], v[52:55]
  v_mfma_f32_16x16x32_bf16 v[20:23], v[180:183], v[112:115], v[20:23]
  ds_read_b64_tr_b16 v[148:149], v92 offset:35040
  ds_read_b64_tr_b16 v[150:151], v92 offset:37344
  v_mfma_f32_16x16x32_bf16 v[56:59], v[180:183], v[116:119], v[56:59]
  v_mfma_f32_16x16x32_bf16 v[24:27], v[128:131], v[112:115], v[24:27]
  ds_read_b64_tr_b16 v[152:153], v92 offset:35072
  ds_read_b64_tr_b16 v[154:155], v92 offset:37376
  v_mfma_f32_16x16x32_bf16 v[60:63], v[128:131], v[116:119], v[60:63]
  s_waitcnt lgkmcnt(6)
  v_mfma_f32_16x16x32_bf16 v[28:31], v[132:135], v[112:115], v[28:31]
  s_barrier
  ds_read_b128 v[120:123], v90 offset:0
  ds_read_b128 v[124:127], v90 offset:1024
  ds_read_b64_tr_b16 v[156:157], v93 offset:0
  ds_read_b64_tr_b16 v[158:159], v93 offset:2304
  v_mfma_f32_16x16x32_bf16 v[64:67], v[132:135], v[116:119], v[64:67]
  v_mfma_f32_16x16x32_bf16 v[32:35], v[136:139], v[112:115], v[32:35]
  ds_read_b64_tr_b16 v[160:161], v93 offset:32
  ds_read_b64_tr_b16 v[162:163], v93 offset:2336
  v_mfma_f32_16x16x32_bf16 v[68:71], v[136:139], v[116:119], v[68:71]
  v_mfma_f32_16x16x32_bf16 v[36:39], v[140:143], v[112:115], v[36:39]
  ds_read_b64_tr_b16 v[164:165], v93 offset:64
  ds_read_b64_tr_b16 v[166:167], v93 offset:2368
  v_mfma_f32_16x16x32_bf16 v[72:75], v[140:143], v[116:119], v[72:75]
  s_waitcnt lgkmcnt(8)
  v_mfma_f32_16x16x32_bf16 v[40:43], v[144:147], v[112:115], v[40:43]
  ds_read_b64_tr_b16 v[168:169], v93 offset:96
  ds_read_b64_tr_b16 v[170:171], v93 offset:2400
  v_mfma_f32_16x16x32_bf16 v[76:79], v[144:147], v[116:119], v[76:79]
  v_mfma_f32_16x16x32_bf16 v[44:47], v[148:151], v[112:115], v[44:47]
  ds_read_b64_tr_b16 v[172:173], v93 offset:128
  ds_read_b64_tr_b16 v[174:175], v93 offset:2432
  v_mfma_f32_16x16x32_bf16 v[80:83], v[148:151], v[116:119], v[80:83]
  v_mfma_f32_16x16x32_bf16 v[48:51], v[152:155], v[112:115], v[48:51]
  ds_read_b64_tr_b16 v[176:177], v93 offset:160
  ds_read_b64_tr_b16 v[178:179], v93 offset:2464
  v_mfma_f32_16x16x32_bf16 v[84:87], v[152:155], v[116:119], v[84:87]
  s_waitcnt lgkmcnt(6)
  v_mfma_f32_16x16x32_bf16 v[16:19], v[156:159], v[120:123], v[16:19]
  ds_read_b64_tr_b16 v[180:181], v93 offset:192
  ds_read_b64_tr_b16 v[182:183], v93 offset:2496
  v_mfma_f32_16x16x32_bf16 v[52:55], v[156:159], v[124:127], v[52:55]
  v_mfma_f32_16x16x32_bf16 v[20:23], v[160:163], v[120:123], v[20:23]
  ds_read_b64_tr_b16 v[128:129], v93 offset:224
  ds_read_b64_tr_b16 v[130:131], v93 offset:2528
  v_mfma_f32_16x16x32_bf16 v[56:59], v[160:163], v[124:127], v[56:59]
  v_mfma_f32_16x16x32_bf16 v[24:27], v[164:167], v[120:123], v[24:27]
  ds_read_b64_tr_b16 v[132:133], v93 offset:256
  ds_read_b64_tr_b16 v[134:135], v93 offset:2560
  v_mfma_f32_16x16x32_bf16 v[60:63], v[164:167], v[124:127], v[60:63]
  s_waitcnt lgkmcnt(6)
  v_mfma_f32_16x16x32_bf16 v[28:31], v[168:171], v[120:123], v[28:31]
  v_mfma_f32_16x16x32_bf16 v[64:67], v[168:171], v[124:127], v[64:67]
  v_mfma_f32_16x16x32_bf16 v[32:35], v[172:175], v[120:123], v[32:35]
  v_mfma_f32_16x16x32_bf16 v[68:71], v[172:175], v[124:127], v[68:71]
  v_mfma_f32_16x16x32_bf16 v[36:39], v[176:179], v[120:123], v[36:39]
  v_mfma_f32_16x16x32_bf16 v[72:75], v[176:179], v[124:127], v[72:75]
  s_waitcnt lgkmcnt(0)
  v_mfma_f32_16x16x32_bf16 v[40:43], v[180:183], v[120:123], v[40:43]
  v_mfma_f32_16x16x32_bf16 v[76:79], v[180:183], v[124:127], v[76:79]
  v_mfma_f32_16x16x32_bf16 v[44:47], v[128:131], v[120:123], v[44:47]
  v_mfma_f32_16x16x32_bf16 v[80:83], v[128:131], v[124:127], v[80:83]
  v_mfma_f32_16x16x32_bf16 v[48:51], v[132:135], v[120:123], v[48:51]
  v_mfma_f32_16x16x32_bf16 v[84:87], v[132:135], v[124:127], v[84:87]
  s_lshl_b32 s46, s56, 2
  s_add_u32 s46, s46, s57
  s_lshl_b32 s46, s46, 2
  s_add_u32 s46, s46, s3
  s_lshl_b32 s46, s46, 2
  s_add_u32 s46, s46, s41
  s_mul_i32 s46, s46, 9216
  s_add_u32 s46, s46, 16941056
  v_add_u32 v7, 139264, v1
  s_cmp_eq_u32 s3, s41
  s_cbranch_scc1 .Lm_76
  v_cvt_pk_bf16_f32 v96, v16, v17
  v_cvt_pk_bf16_f32 v97, v18, v19
  v_cvt_pk_bf16_f32 v98, v52, v53
  v_cvt_pk_bf16_f32 v99, v54, v55
  buffer_store_dwordx4 v[96:99], v1, s[4:7], s46 offen offset:0 sc1
  v_cvt_pk_bf16_f32 v100, v20, v21
  v_cvt_pk_bf16_f32 v101, v22, v23
  v_cvt_pk_bf16_f32 v102, v56, v57
  v_cvt_pk_bf16_f32 v103, v58, v59
  buffer_store_dwordx4 v[100:103], v1, s[4:7], s46 offen offset:1024 sc1
  v_cvt_pk_bf16_f32 v104, v24, v25
  v_cvt_pk_bf16_f32 v105, v26, v27
  v_cvt_pk_bf16_f32 v106, v60, v61
  v_cvt_pk_bf16_f32 v107, v62, v63
  buffer_store_dwordx4 v[104:107], v1, s[4:7], s46 offen offset:2048 sc1
  v_cvt_pk_bf16_f32 v108, v28, v29
  v_cvt_pk_bf16_f32 v109, v30, v31
  v_cvt_pk_bf16_f32 v110, v64, v65
  v_cvt_pk_bf16_f32 v111, v66, v67
  buffer_store_dwordx4 v[108:111], v1, s[4:7], s46 offen offset:3072 sc1
  v_cvt_pk_bf16_f32 v112, v32, v33
  v_cvt_pk_bf16_f32 v113, v34, v35
  v_cvt_pk_bf16_f32 v114, v68, v69
  v_cvt_pk_bf16_f32 v115, v70, v71
  s_add_u32 s46, s46, 4096
  buffer_store_dwordx4 v[112:115], v1, s[4:7], s46 offen offset:0 sc1
  v_cvt_pk_bf16_f32 v116, v36, v37
  v_cvt_pk_bf16_f32 v117, v38, v39
  v_cvt_pk_bf16_f32 v118, v72, v73
  v_cvt_pk_bf16_f32 v119, v74, v75
  buffer_store_dwordx4 v[116:119], v1, s[4:7], s46 offen offset:1024 sc1
  v_cvt_pk_bf16_f32 v120, v40, v41
  v_cvt_pk_bf16_f32 v121, v42, v43
  v_cvt_pk_bf16_f32 v122, v76, v77
  v_cvt_pk_bf16_f32 v123, v78, v79
  buffer_store_dwordx4 v[120:123], v1, s[4:7], s46 offen offset:2048 sc1
  v_cvt_pk_bf16_f32 v124, v44, v45
  v_cvt_pk_bf16_f32 v125, v46, v47
  v_cvt_pk_bf16_f32 v126, v80, v81
  v_cvt_pk_bf16_f32 v127, v82, v83
  buffer_store_dwordx4 v[124:127], v1, s[4:7], s46 offen offset:3072 sc1
  v_cvt_pk_bf16_f32 v96, v48, v49
  v_cvt_pk_bf16_f32 v97, v50, v51
  v_cvt_pk_bf16_f32 v98, v84, v85
  v_cvt_pk_bf16_f32 v99, v86, v87
  s_add_u32 s46, s46, 4096
  buffer_store_dwordx4 v[96:99], v1, s[4:7], s46 offen offset:0 sc1
  s_branch .L_s5_done
.Lm_76:
  ds_write_b128 v7, v[16:19] offset:0
  ds_write_b128 v7, v[20:23] offset:1024
  ds_write_b128 v7, v[24:27] offset:2048
  ds_write_b128 v7, v[28:31] offset:3072
  ds_write_b128 v7, v[32:35] offset:4096
  ds_write_b128 v7, v[36:39] offset:5120
  ds_write_b128 v7, v[40:43] offset:6144
  ds_write_b128 v7, v[44:47] offset:7168
  ds_write_b128 v7, v[48:51] offset:8192
  ds_write_b128 v7, v[52:55] offset:9216
  ds_write_b128 v7, v[56:59] offset:10240
  ds_write_b128 v7, v[60:63] offset:11264
  ds_write_b128 v7, v[64:67] offset:12288
  ds_write_b128 v7, v[68:71] offset:13312
  ds_write_b128 v7, v[72:75] offset:14336
  ds_write_b128 v7, v[76:79] offset:15360
  ds_write_b128 v7, v[80:83] offset:16384
  ds_write_b128 v7, v[84:87] offset:17408
  s_branch .L_s5_done
.L_s5_loader:
  s_cmp_ge_u32 s3, 6
  s_cbranch_scc1 .L_s5_ldh
  s_bitcmp1_b32 s43, 0
  s_cselect_b32 s45, 0, 3072
  s_add_u32 s45, s45, s54
  s_nop 6
  v_pk_mul_f32 v[168:169], v[168:169], v[16:17] op_sel:[0,1]
  v_pk_mul_f32 v[170:171], v[170:171], v[16:17] op_sel:[0,1]
  v_pk_mul_f32 v[172:173], v[172:173], v[18:19] op_sel:[0,1]
  v_pk_mul_f32 v[174:175], v[174:175], v[18:19] op_sel:[0,1]
  v_exp_f32 v168, v168
  v_exp_f32 v169, v169
  v_exp_f32 v170, v170
  v_exp_f32 v171, v171
  v_exp_f32 v172, v172
  v_exp_f32 v173, v173
  v_exp_f32 v174, v174
  v_exp_f32 v175, v175
  v_pk_mul_f32 v[176:177], v[176:177], v[16:17] op_sel_hi:[1,0]
  v_pk_mul_f32 v[178:179], v[178:179], v[16:17] op_sel_hi:[1,0]
  v_pk_mul_f32 v[180:181], v[180:181], v[18:19] op_sel_hi:[1,0]
  v_pk_mul_f32 v[182:183], v[182:183], v[18:19] op_sel_hi:[1,0]
  v_pk_add_f32 v[168:169], v[168:169], 1.0 op_sel_hi:[1,0]
  v_pk_add_f32 v[170:171], v[170:171], 1.0 op_sel_hi:[1,0]
  v_pk_add_f32 v[172:173], v[172:173], 1.0 op_sel_hi:[1,0]
  v_pk_add_f32 v[174:175], v[174:175], 1.0 op_sel_hi:[1,0]
  v_rcp_f32 v168, v168
  v_rcp_f32 v169, v169
  v_rcp_f32 v170, v170
  v_rcp_f32 v171, v171
  v_rcp_f32 v172, v172
  v_rcp_f32 v173, v173
  v_rcp_f32 v174, v174
  v_rcp_f32 v175, v175
  s_nop 0
  v_pk_mul_f32 v[168:169], v[168:169], v[176:177]
  v_pk_mul_f32 v[170:171], v[170:171], v[178:179]
  v_pk_mul_f32 v[172:173], v[172:173], v[180:181]
  v_pk_mul_f32 v[174:175], v[174:175], v[182:183]
  v_cvt_pk_bf16_f32 v248, v168, v169
  v_cvt_pk_bf16_f32 v249, v170, v171
  v_cvt_pk_bf16_f32 v250, v172, v173
  v_cvt_pk_bf16_f32 v251, v174, v175
  s_nop 1
  v_permlane32_swap_b32 v248, v250
  v_permlane32_swap_b32 v249, v251
  s_nop 1
  buffer_store_dwordx4 v[248:251], v11, s[4:7], s45 offen offset:0 sc1
  v_pk_mul_f32 v[184:185], v[184:185], v[16:17] op_sel:[0,1]
  v_pk_mul_f32 v[186:187], v[186:187], v[16:17] op_sel:[0,1]
  v_pk_mul_f32 v[188:189], v[188:189], v[18:19] op_sel:[0,1]
  v_pk_mul_f32 v[190:191], v[190:191], v[18:19] op_sel:[0,1]
  v_exp_f32 v184, v184
  v_exp_f32 v185, v185
  v_exp_f32 v186, v186
  v_exp_f32 v187, v187
  v_exp_f32 v188, v188
  v_exp_f32 v189, v189
  v_exp_f32 v190, v190
  v_exp_f32 v191, v191
  v_pk_mul_f32 v[192:193], v[192:193], v[16:17] op_sel_hi:[1,0]
  v_pk_mul_f32 v[194:195], v[194:195], v[16:17] op_sel_hi:[1,0]
  v_pk_mul_f32 v[196:197], v[196:197], v[18:19] op_sel_hi:[1,0]
  v_pk_mul_f32 v[198:199], v[198:199], v[18:19] op_sel_hi:[1,0]
  v_pk_add_f32 v[184:185], v[184:185], 1.0 op_sel_hi:[1,0]
  v_pk_add_f32 v[186:187], v[186:187], 1.0 op_sel_hi:[1,0]
  v_pk_add_f32 v[188:189], v[188:189], 1.0 op_sel_hi:[1,0]
  v_pk_add_f32 v[190:191], v[190:191], 1.0 op_sel_hi:[1,0]
  v_rcp_f32 v184, v184
  v_rcp_f32 v185, v185
  v_rcp_f32 v186, v186
  v_rcp_f32 v187, v187
  v_rcp_f32 v188, v188
  v_rcp_f32 v189, v189
  v_rcp_f32 v190, v190
  v_rcp_f32 v191, v191
  s_nop 0
  v_pk_mul_f32 v[184:185], v[184:185], v[192:193]
  v_pk_mul_f32 v[186:187], v[186:187], v[194:195]
  v_pk_mul_f32 v[188:189], v[188:189], v[196:197]
  v_pk_mul_f32 v[190:191], v[190:191], v[198:199]
  v_cvt_pk_bf16_f32 v252, v184, v185
  v_cvt_pk_bf16_f32 v253, v186, v187
  v_cvt_pk_bf16_f32 v254, v188, v189
  v_cvt_pk_bf16_f32 v255, v190, v191
  s_nop 1
  v_permlane32_swap_b32 v252, v254
  v_permlane32_swap_b32 v253, v255
  s_nop 1
  buffer_store_dwordx4 v[252:255], v11, s[4:7], s45 offen offset:512 sc1
  v_pk_mul_f32 v[200:201], v[200:201], v[16:17] op_sel:[0,1]
  v_pk_mul_f32 v[202:203], v[202:203], v[16:17] op_sel:[0,1]
  v_pk_mul_f32 v[204:205], v[204:205], v[18:19] op_sel:[0,1]
  v_pk_mul_f32 v[206:207], v[206:207], v[18:19] op_sel:[0,1]
  v_exp_f32 v200, v200
  v_exp_f32 v201, v201
  v_exp_f32 v202, v202
  v_exp_f32 v203, v203
  v_exp_f32 v204, v204
  v_exp_f32 v205, v205
  v_exp_f32 v206, v206
  v_exp_f32 v207, v207
  v_pk_mul_f32 v[208:209], v[208:209], v[16:17] op_sel_hi:[1,0]
  v_pk_mul_f32 v[210:211], v[210:211], v[16:17] op_sel_hi:[1,0]
  v_pk_mul_f32 v[212:213], v[212:213], v[18:19] op_sel_hi:[1,0]
  v_pk_mul_f32 v[214:215], v[214:215], v[18:19] op_sel_hi:[1,0]
  v_pk_add_f32 v[200:201], v[200:201], 1.0 op_sel_hi:[1,0]
  v_pk_add_f32 v[202:203], v[202:203], 1.0 op_sel_hi:[1,0]
  v_pk_add_f32 v[204:205], v[204:205], 1.0 op_sel_hi:[1,0]
  v_pk_add_f32 v[206:207], v[206:207], 1.0 op_sel_hi:[1,0]
  v_rcp_f32 v200, v200
  v_rcp_f32 v201, v201
  v_rcp_f32 v202, v202
  v_rcp_f32 v203, v203
  v_rcp_f32 v204, v204
  v_rcp_f32 v205, v205
  v_rcp_f32 v206, v206
  v_rcp_f32 v207, v207
  s_nop 0
  v_pk_mul_f32 v[200:201], v[200:201], v[208:209]
  v_pk_mul_f32 v[202:203], v[202:203], v[210:211]
  v_pk_mul_f32 v[204:205], v[204:205], v[212:213]
  v_pk_mul_f32 v[206:207], v[206:207], v[214:215]
  v_cvt_pk_bf16_f32 v248, v200, v201
  v_cvt_pk_bf16_f32 v249, v202, v203
  v_cvt_pk_bf16_f32 v250, v204, v205
  v_cvt_pk_bf16_f32 v251, v206, v207
  s_nop 1
  v_permlane32_swap_b32 v248, v250
  v_permlane32_swap_b32 v249, v251
  s_nop 1
  buffer_store_dwordx4 v[248:251], v11, s[4:7], s45 offen offset:1024 sc1
  s_waitcnt vmcnt(23)
  s_barrier
  s_add_u32 s46, s58, 294912
  s_add_u32 m0, s59, 0
  s_nop 0
  buffer_load_dwordx4 v2, s[8:11], s46 offen offset:0 lds
  buffer_load_dwordx4 v3, s[8:11], s46 offen offset:1024 lds
  buffer_load_dwordx4 v4, s[8:11], s46 offen offset:2048 lds
  buffer_load_dwordx4 v5, s[8:11], s46 offen offset:3072 lds
  s_add_u32 m0, s59, 4096
  s_mov_b32 exec_hi, 0
  buffer_load_dwordx4 v6, s[8:11], s46 offen lds
  s_mov_b32 exec_hi, -1
  s_add_u32 s46, s58, 331776
  s_add_u32 m0, s59, 17408
  s_nop 0
  buffer_load_dwordx4 v2, s[8:11], s46 offen offset:0 lds
  buffer_load_dwordx4 v3, s[8:11], s46 offen offset:1024 lds
  buffer_load_dwordx4 v4, s[8:11], s46 offen offset:2048 lds
  buffer_load_dwordx4 v5, s[8:11], s46 offen offset:3072 lds
  s_add_u32 m0, s59, 21504
  s_mov_b32 exec_hi, 0
  buffer_load_dwordx4 v6, s[8:11], s46 offen lds
  s_mov_b32 exec_hi, -1
  s_waitcnt vmcnt(28)
  s_barrier
  s_add_u32 s46, s58, 368640
  s_add_u32 m0, s59, 34816
  s_nop 0
  buffer_load_dwordx4 v2, s[8:11], s46 offen offset:0 lds
  buffer_load_dwordx4 v3, s[8:11], s46 offen offset:1024 lds
  buffer_load_dwordx4 v4, s[8:11], s46 offen offset:2048 lds
  buffer_load_dwordx4 v5, s[8:11], s46 offen offset:3072 lds
  s_add_u32 m0, s59, 38912
  s_mov_b32 exec_hi, 0
  buffer_load_dwordx4 v6, s[8:11], s46 offen lds
  s_mov_b32 exec_hi, -1
  s_waitcnt vmcnt(28)
  s_barrier
  s_add_u32 s46, s58, 405504
  s_add_u32 m0, s59, 52224
  s_nop 0
  buffer_load_dwordx4 v2, s[8:11], s46 offen offset:0 lds
  buffer_load_dwordx4 v3, s[8:11], s46 offen offset:1024 lds
  buffer_load_dwordx4 v4, s[8:11], s46 offen offset:2048 lds
  buffer_load_dwordx4 v5, s[8:11], s46 offen offset:3072 lds
  s_add_u32 m0, s59, 56320
  s_mov_b32 exec_hi, 0
  buffer_load_dwordx4 v6, s[8:11], s46 offen lds
  s_mov_b32 exec_hi, -1
  s_waitcnt vmcnt(28)
  s_barrier
  s_add_u32 s46, s58, 552960
  s_add_u32 m0, s59, 69632
  s_nop 0
  buffer_load_dwordx4 v2, s[8:11], s46 offen offset:0 lds
  buffer_load_dwordx4 v3, s[8:11], s46 offen offset:1024 lds
  buffer_load_dwordx4 v4, s[8:11], s46 offen offset:2048 lds
  buffer_load_dwordx4 v5, s[8:11], s46 offen offset:3072 lds
  s_add_u32 m0, s59, 73728
  s_mov_b32 exec_hi, 0
  buffer_load_dwordx4 v6, s[8:11], s46 offen lds
  s_mov_b32 exec_hi, -1
  s_waitcnt vmcnt(28)
  s_barrier
  s_add_u32 s46, s58, 589824
  s_add_u32 m0, s59, 87040
  s_nop 0
  buffer_load_dwordx4 v2, s[8:11], s46 offen offset:0 lds
  buffer_load_dwordx4 v3, s[8:11], s46 offen offset:1024 lds
  buffer_load_dwordx4 v4, s[8:11], s46 offen offset:2048 lds
  buffer_load_dwordx4 v5, s[8:11], s46 offen offset:3072 lds
  s_add_u32 m0, s59, 91136
  s_mov_b32 exec_hi, 0
  buffer_load_dwordx4 v6, s[8:11], s46 offen lds
  s_mov_b32 exec_hi, -1
  s_waitcnt vmcnt(25)
  s_barrier
  s_add_u32 s46, s58, 626688
  s_add_u32 m0, s59, 104448
  s_nop 0
  buffer_load_dwordx4 v2, s[8:11], s46 offen offset:0 lds
  buffer_load_dwordx4 v3, s[8:11], s46 offen offset:1024 lds
  buffer_load_dwordx4 v4, s[8:11], s46 offen offset:2048 lds
  buffer_load_dwordx4 v5, s[8:11], s46 offen offset:3072 lds
  s_add_u32 m0, s59, 108544
  s_mov_b32 exec_hi, 0
  buffer_load_dwordx4 v6, s[8:11], s46 offen lds
  s_mov_b32 exec_hi, -1
  s_waitcnt vmcnt(35)
  s_waitcnt vmcnt(25)
  s_barrier
  s_add_u32 s46, s58, 663552
  s_add_u32 m0, s59, 121856
  s_nop 0
  buffer_load_dwordx4 v2, s[8:11], s46 offen offset:0 lds
  buffer_load_dwordx4 v3, s[8:11], s46 offen offset:1024 lds
  buffer_load_dwordx4 v4, s[8:11], s46 offen offset:2048 lds
  buffer_load_dwordx4 v5, s[8:11], s46 offen offset:3072 lds
  s_add_u32 m0, s59, 125952
  s_mov_b32 exec_hi, 0
  buffer_load_dwordx4 v6, s[8:11], s46 offen lds
  s_mov_b32 exec_hi, -1
  s_waitcnt vmcnt(25)
  s_barrier
  s_add_u32 s46, s58, 700416
  s_add_u32 m0, s59, 0
  s_nop 0
  buffer_load_dwordx4 v2, s[8:11], s46 offen offset:0 lds
  buffer_load_dwordx4 v3, s[8:11], s46 offen offset:1024 lds
  buffer_load_dwordx4 v4, s[8:11], s46 offen offset:2048 lds
  buffer_load_dwordx4 v5, s[8:11], s46 offen offset:3072 lds
  s_add_u32 m0, s59, 4096
  s_mov_b32 exec_hi, 0
  buffer_load_dwordx4 v6, s[8:11], s46 offen lds
  s_mov_b32 exec_hi, -1
  s_waitcnt vmcnt(25)
  s_barrier
  s_add_u32 s46, s58, 737280
  s_add_u32 m0, s59, 17408
  s_nop 0
  buffer_load_dwordx4 v2, s[8:11], s46 offen offset:0 lds
  buffer_load_dwordx4 v3, s[8:11], s46 offen offset:1024 lds
  buffer_load_dwordx4 v4, s[8:11], s46 offen offset:2048 lds
  buffer_load_dwordx4 v5, s[8:11], s46 offen offset:3072 lds
  s_add_u32 m0, s59, 21504
  s_mov_b32 exec_hi, 0
  buffer_load_dwordx4 v6, s[8:11], s46 offen lds
  s_mov_b32 exec_hi, -1
  s_waitcnt vmcnt(25)
  s_barrier
  s_add_u32 s46, s58, 884736
  s_add_u32 m0, s59, 34816
  s_nop 0
  buffer_load_dwordx4 v2, s[8:11], s46 offen offset:0 lds
  buffer_load_dwordx4 v3, s[8:11], s46 offen offset:1024 lds
  buffer_load_dwordx4 v4, s[8:11], s46 offen offset:2048 lds
  buffer_load_dwordx4 v5, s[8:11], s46 offen offset:3072 lds
  s_add_u32 m0, s59, 38912
  s_mov_b32 exec_hi, 0
  buffer_load_dwordx4 v6, s[8:11], s46 offen lds
  s_mov_b32 exec_hi, -1
  s_waitcnt vmcnt(25)
  s_barrier
  s_add_u32 s46, s58, 921600
  s_add_u32 m0, s59, 52224
  s_nop 0
  buffer_load_dwordx4 v2, s[8:11], s46 offen offset:0 lds
  buffer_load_dwordx4 v3, s[8:11], s46 offen offset:1024 lds
  buffer_load_dwordx4 v4, s[8:11], s46 offen offset:2048 lds
  buffer_load_dwordx4 v5, s[8:11], s46 offen offset:3072 lds
  s_add_u32 m0, s59, 56320
  s_mov_b32 exec_hi, 0
  buffer_load_dwordx4 v6, s[8:11], s46 offen lds
  s_mov_b32 exec_hi, -1
  s_waitcnt vmcnt(25)
  s_barrier
  s_add_u32 s46, s58, 958464
  s_add_u32 m0, s59, 69632
  s_nop 0
  buffer_load_dwordx4 v2, s[8:11], s46 offen offset:0 lds
  buffer_load_dwordx4 v3, s[8:11], s46 offen offset:1024 lds
  buffer_load_dwordx4 v4, s[8:11], s46 offen offset:2048 lds
  buffer_load_dwordx4 v5, s[8:11], s46 offen offset:3072 lds
  s_add_u32 m0, s59, 73728
  s_mov_b32 exec_hi, 0
  buffer_load_dwordx4 v6, s[8:11], s46 offen lds
  s_mov_b32 exec_hi, -1
  s_waitcnt vmcnt(25)
  s_barrier
  s_add_u32 s46, s58, 995328
  s_add_u32 m0, s59, 87040
  s_nop 0
  buffer_load_dwordx4 v2, s[8:11], s46 offen offset:0 lds
  buffer_load_dwordx4 v3, s[8:11], s46 offen offset:1024 lds
  buffer_load_dwordx4 v4, s[8:11], s46 offen offset:2048 lds
  buffer_load_dwordx4 v5, s[8:11], s46 offen offset:3072 lds
  s_add_u32 m0, s59, 91136
  s_mov_b32 exec_hi, 0
  buffer_load_dwordx4 v6, s[8:11], s46 offen lds
  s_mov_b32 exec_hi, -1
  s_waitcnt vmcnt(25)
  s_barrier
  s_add_u32 s46, s58, 1032192
  s_add_u32 m0, s59, 104448
  s_nop 0
  buffer_load_dwordx4 v2, s[8:11], s46 offen offset:0 lds
  buffer_load_dwordx4 v3, s[8:11], s46 offen offset:1024 lds
  buffer_load_dwordx4 v4, s[8:11], s46 offen offset:2048 lds
  buffer_load_dwordx4 v5, s[8:11], s46 offen offset:3072 lds
  s_add_u32 m0, s59, 108544
  s_mov_b32 exec_hi, 0
  buffer_load_dwordx4 v6, s[8:11], s46 offen lds
  s_mov_b32 exec_hi, -1
  s_waitcnt vmcnt(25)
  s_barrier
  s_add_u32 s46, s58, 1069056
  s_add_u32 m0, s59, 121856
  s_nop 0
  buffer_load_dwordx4 v2, s[8:11], s46 offen offset:0 lds
  buffer_load_dwordx4 v3, s[8:11], s46 offen offset:1024 lds
  buffer_load_dwordx4 v4, s[8:11], s46 offen offset:2048 lds
  buffer_load_dwordx4 v5, s[8:11], s46 offen offset:3072 lds
  s_add_u32 m0, s59, 125952
  s_mov_b32 exec_hi, 0
  buffer_load_dwordx4 v6, s[8:11], s46 offen lds
  s_mov_b32 exec_hi, -1
  s_waitcnt vmcnt(25)
  s_barrier
  s_add_u32 s46, s58, 1216512
  s_add_u32 m0, s59, 0
  s_nop 0
  buffer_load_dwordx4 v2, s[8:11], s46 offen offset:0 lds
  buffer_load_dwordx4 v3, s[8:11], s46 offen offset:1024 lds
  buffer_load_dwordx4 v4, s[8:11], s46 offen offset:2048 lds
  buffer_load_dwordx4 v5, s[8:11], s46 offen offset:3072 lds
  s_add_u32 m0, s59, 4096
  s_mov_b32 exec_hi, 0
  buffer_load_dwordx4 v6, s[8:11], s46 offen lds
  s_mov_b32 exec_hi, -1
  s_waitcnt vmcnt(25)
  s_barrier
  s_add_u32 s46, s58, 1253376
  s_add_u32 m0, s59, 17408
  s_nop 0
  buffer_load_dwordx4 v2, s[8:11], s46 offen offset:0 lds
  buffer_load_dwordx4 v3, s[8:11], s46 offen offset:1024 lds
  buffer_load_dwordx4 v4, s[8:11], s46 offen offset:2048 lds
  buffer_load_dwordx4 v5, s[8:11], s46 offen offset:3072 lds
  s_add_u32 m0, s59, 21504
  s_mov_b32 exec_hi, 0
  buffer_load_dwordx4 v6, s[8:11], s46 offen lds
  s_mov_b32 exec_hi, -1
  s_waitcnt vmcnt(25)
  s_barrier
  s_add_u32 s46, s58, 1290240
  s_add_u32 m0, s59, 34816
  s_nop 0
  buffer_load_dwordx4 v2, s[8:11], s46 offen offset:0 lds
  buffer_load_dwordx4 v3, s[8:11], s46 offen offset:1024 lds
  buffer_load_dwordx4 v4, s[8:11], s46 offen offset:2048 lds
  buffer_load_dwordx4 v5, s[8:11], s46 offen offset:3072 lds
  s_add_u32 m0, s59, 38912
  s_mov_b32 exec_hi, 0
  buffer_load_dwordx4 v6, s[8:11], s46 offen lds
  s_mov_b32 exec_hi, -1
  s_waitcnt vmcnt(25)
  s_barrier
  s_add_u32 s46, s58, 110592
  s_add_u32 m0, s59, 52224
  s_nop 0
  buffer_load_dwordx4 v2, s[8:11], s46 offen offset:0 lds
  buffer_load_dwordx4 v3, s[8:11], s46 offen offset:1024 lds
  buffer_load_dwordx4 v4, s[8:11], s46 offen offset:2048 lds
  buffer_load_dwordx4 v5, s[8:11], s46 offen offset:3072 lds
  s_add_u32 m0, s59, 56320
  s_mov_b32 exec_hi, 0
  buffer_load_dwordx4 v6, s[8:11], s46 offen lds
  s_mov_b32 exec_hi, -1
  s_waitcnt vmcnt(25)
  s_barrier
  s_add_u32 s46, s58, 147456
  s_add_u32 m0, s59, 69632
  s_nop 0
  buffer_load_dwordx4 v2, s[8:11], s46 offen offset:0 lds
  buffer_load_dwordx4 v3, s[8:11], s46 offen offset:1024 lds
  buffer_load_dwordx4 v4, s[8:11], s46 offen offset:2048 lds
  buffer_load_dwordx4 v5, s[8:11], s46 offen offset:3072 lds
  s_add_u32 m0, s59, 73728
  s_mov_b32 exec_hi, 0
  buffer_load_dwordx4 v6, s[8:11], s46 offen lds
  s_mov_b32 exec_hi, -1
  s_waitcnt vmcnt(25)
  s_barrier
  s_add_u32 s46, s58, 184320
  s_add_u32 m0, s59, 87040
  s_nop 0
  buffer_load_dwordx4 v2, s[8:11], s46 offen offset:0 lds
  buffer_load_dwordx4 v3, s[8:11], s46 offen offset:1024 lds
  buffer_load_dwordx4 v4, s[8:11], s46 offen offset:2048 lds
  buffer_load_dwordx4 v5, s[8:11], s46 offen offset:3072 lds
  s_add_u32 m0, s59, 91136
  s_mov_b32 exec_hi, 0
  buffer_load_dwordx4 v6, s[8:11], s46 offen lds
  s_mov_b32 exec_hi, -1
  s_waitcnt vmcnt(25)
  s_barrier
  s_add_u32 s46, s58, 442368
  s_add_u32 m0, s59, 104448
  s_nop 0
  buffer_load_dwordx4 v2, s[8:11], s46 offen offset:0 lds
  buffer_load_dwordx4 v3, s[8:11], s46 offen offset:1024 lds
  buffer_load_dwordx4 v4, s[8:11], s46 offen offset:2048 lds
  buffer_load_dwordx4 v5, s[8:11], s46 offen offset:3072 lds
  s_add_u32 m0, s59, 108544
  s_mov_b32 exec_hi, 0
  buffer_load_dwordx4 v6, s[8:11], s46 offen lds
  s_mov_b32 exec_hi, -1
  s_waitcnt vmcnt(25)
  s_barrier
  s_add_u32 s46, s58, 479232
  s_add_u32 m0, s59, 121856
  s_nop 0
  buffer_load_dwordx4 v2, s[8:11], s46 offen offset:0 lds
  buffer_load_dwordx4 v3, s[8:11], s46 offen offset:1024 lds
  buffer_load_dwordx4 v4, s[8:11], s46 offen offset:2048 lds
  buffer_load_dwordx4 v5, s[8:11], s46 offen offset:3072 lds
  s_add_u32 m0, s59, 125952
  s_mov_b32 exec_hi, 0
  buffer_load_dwordx4 v6, s[8:11], s46 offen lds
  s_mov_b32 exec_hi, -1
  s_waitcnt vmcnt(25)
  s_barrier
  s_add_u32 s46, s58, 516096
  s_add_u32 m0, s59, 0
  s_nop 0
  buffer_load_dwordx4 v2, s[8:11], s46 offen offset:0 lds
  buffer_load_dwordx4 v3, s[8:11], s46 offen offset:1024 lds
  buffer_load_dwordx4 v4, s[8:11], s46 offen offset:2048 lds
  buffer_load_dwordx4 v5, s[8:11], s46 offen offset:3072 lds
  s_add_u32 m0, s59, 4096
  s_mov_b32 exec_hi, 0
  buffer_load_dwordx4 v6, s[8:11], s46 offen lds
  s_mov_b32 exec_hi, -1
  s_waitcnt vmcnt(25)
  s_barrier
  s_add_u32 s46, s58, 774144
  s_add_u32 m0, s59, 17408
  s_nop 0
  buffer_load_dwordx4 v2, s[8:11], s46 offen offset:0 lds
  buffer_load_dwordx4 v3, s[8:11], s46 offen offset:1024 lds
  buffer_load_dwordx4 v4, s[8:11], s46 offen offset:2048 lds
  buffer_load_dwordx4 v5, s[8:11], s46 offen offset:3072 lds
  s_add_u32 m0, s59, 21504
  s_mov_b32 exec_hi, 0
  buffer_load_dwordx4 v6, s[8:11], s46 offen lds
  s_mov_b32 exec_hi, -1
  s_waitcnt vmcnt(25)
  s_barrier
  s_add_u32 s46, s58, 811008
  s_add_u32 m0, s59, 34816
  s_nop 0
  buffer_load_dwordx4 v2, s[8:11], s46 offen offset:0 lds
  buffer_load_dwordx4 v3, s[8:11], s46 offen offset:1024 lds
  buffer_load_dwordx4 v4, s[8:11], s46 offen offset:2048 lds
  buffer_load_dwordx4 v5, s[8:11], s46 offen offset:3072 lds
  s_add_u32 m0, s59, 38912
  s_mov_b32 exec_hi, 0
  buffer_load_dwordx4 v6, s[8:11], s46 offen lds
  s_mov_b32 exec_hi, -1
  s_waitcnt vmcnt(25)
  s_barrier
  s_add_u32 s46, s58, 847872
  s_add_u32 m0, s59, 52224
  s_nop 0
  buffer_load_dwordx4 v2, s[8:11], s46 offen offset:0 lds
  buffer_load_dwordx4 v3, s[8:11], s46 offen offset:1024 lds
  buffer_load_dwordx4 v4, s[8:11], s46 offen offset:2048 lds
  buffer_load_dwordx4 v5, s[8:11], s46 offen offset:3072 lds
  s_add_u32 m0, s59, 56320
  s_mov_b32 exec_hi, 0
  buffer_load_dwordx4 v6, s[8:11], s46 offen lds
  s_mov_b32 exec_hi, -1
  s_waitcnt vmcnt(25)
  s_barrier
  s_add_u32 s46, s58, 1105920
  s_add_u32 m0, s59, 69632
  s_nop 0
  buffer_load_dwordx4 v2, s[8:11], s46 offen offset:0 lds
  buffer_load_dwordx4 v3, s[8:11], s46 offen offset:1024 lds
  buffer_load_dwordx4 v4, s[8:11], s46 offen offset:2048 lds
  buffer_load_dwordx4 v5, s[8:11], s46 offen offset:3072 lds
  s_add_u32 m0, s59, 73728
  s_mov_b32 exec_hi, 0
  buffer_load_dwordx4 v6, s[8:11], s46 offen lds
  s_mov_b32 exec_hi, -1
  s_waitcnt vmcnt(25)
  s_barrier
  s_add_u32 s46, s58, 1142784
  s_add_u32 m0, s59, 87040
  s_nop 0
  buffer_load_dwordx4 v2, s[8:11], s46 offen offset:0 lds
  buffer_load_dwordx4 v3, s[8:11], s46 offen offset:1024 lds
  buffer_load_dwordx4 v4, s[8:11], s46 offen offset:2048 lds
  buffer_load_dwordx4 v5, s[8:11], s46 offen offset:3072 lds
  s_add_u32 m0, s59, 91136
  s_mov_b32 exec_hi, 0
  buffer_load_dwordx4 v6, s[8:11], s46 offen lds
  s_mov_b32 exec_hi, -1
  s_waitcnt vmcnt(25)
  s_barrier
  s_add_u32 s46, s58, 1179648
  s_add_u32 m0, s59, 104448
  s_nop 0
  buffer_load_dwordx4 v2, s[8:11], s46 offen offset:0 lds
  buffer_load_dwordx4 v3, s[8:11], s46 offen offset:1024 lds
  buffer_load_dwordx4 v4, s[8:11], s46 offen offset:2048 lds
  buffer_load_dwordx4 v5, s[8:11], s46 offen offset:3072 lds
  s_add_u32 m0, s59, 108544
  s_mov_b32 exec_hi, 0
  buffer_load_dwordx4 v6, s[8:11], s46 offen lds
  s_mov_b32 exec_hi, -1
  s_waitcnt vmcnt(25)
  s_barrier
  s_waitcnt vmcnt(20)
  s_barrier
  s_waitcnt vmcnt(15)
  s_barrier
  s_waitcnt vmcnt(10)
  s_barrier
  s_waitcnt vmcnt(5)
  s_barrier
  s_waitcnt vmcnt(0)
  s_barrier
  s_branch .L_s5_done
.L_s5_ldh:
  s_bitcmp1_b32 s43, 0
  s_cselect_b32 s45, 0, 3072
  s_add_u32 s45, s45, s54
  s_nop 6
  v_pk_mul_f32 v[168:169], v[168:169], v[16:17] op_sel:[0,1]
  v_pk_mul_f32 v[170:171], v[170:171], v[16:17] op_sel:[0,1]
  v_pk_mul_f32 v[172:173], v[172:173], v[18:19] op_sel:[0,1]
  v_pk_mul_f32 v[174:175], v[174:175], v[18:19] op_sel:[0,1]
  v_exp_f32 v168, v168
  v_exp_f32 v169, v169
  v_exp_f32 v170, v170
  v_exp_f32 v171, v171
  v_exp_f32 v172, v172
  v_exp_f32 v173, v173
  v_exp_f32 v174, v174
  v_exp_f32 v175, v175
  v_pk_mul_f32 v[176:177], v[176:177], v[16:17] op_sel_hi:[1,0]
  v_pk_mul_f32 v[178:179], v[178:179], v[16:17] op_sel_hi:[1,0]
  v_pk_mul_f32 v[180:181], v[180:181], v[18:19] op_sel_hi:[1,0]
  v_pk_mul_f32 v[182:183], v[182:183], v[18:19] op_sel_hi:[1,0]
  v_pk_add_f32 v[168:169], v[168:169], 1.0 op_sel_hi:[1,0]
  v_pk_add_f32 v[170:171], v[170:171], 1.0 op_sel_hi:[1,0]
  v_pk_add_f32 v[172:173], v[172:173], 1.0 op_sel_hi:[1,0]
  v_pk_add_f32 v[174:175], v[174:175], 1.0 op_sel_hi:[1,0]
  v_rcp_f32 v168, v168
  v_rcp_f32 v169, v169
  v_rcp_f32 v170, v170
  v_rcp_f32 v171, v171
  v_rcp_f32 v172, v172
  v_rcp_f32 v173, v173
  v_rcp_f32 v174, v174
  v_rcp_f32 v175, v175
  s_nop 0
  v_pk_mul_f32 v[168:169], v[168:169], v[176:177]
  v_pk_mul_f32 v[170:171], v[170:171], v[178:179]
  v_pk_mul_f32 v[172:173], v[172:173], v[180:181]
  v_pk_mul_f32 v[174:175], v[174:175], v[182:183]
  v_cvt_pk_bf16_f32 v248, v168, v169
  v_cvt_pk_bf16_f32 v249, v170, v171
  v_cvt_pk_bf16_f32 v250, v172, v173
  v_cvt_pk_bf16_f32 v251, v174, v175
  s_nop 1
  v_permlane32_swap_b32 v248, v250
  v_permlane32_swap_b32 v249, v251
  s_nop 1
  buffer_store_dwordx4 v[248:251], v11, s[4:7], s45 offen offset:0 sc1
  v_pk_mul_f32 v[184:185], v[184:185], v[16:17] op_sel:[0,1]
  v_pk_mul_f32 v[186:187], v[186:187], v[16:17] op_sel:[0,1]
  v_pk_mul_f32 v[188:189], v[188:189], v[18:19] op_sel:[0,1]
  v_pk_mul_f32 v[190:191], v[190:191], v[18:19] op_sel:[0,1]
  v_exp_f32 v184, v184
  v_exp_f32 v185, v185
  v_exp_f32 v186, v186
  v_exp_f32 v187, v187
  v_exp_f32 v188, v188
  v_exp_f32 v189, v189
  v_exp_f32 v190, v190
  v_exp_f32 v191, v191
  v_pk_mul_f32 v[192:193], v[192:193], v[16:17] op_sel_hi:[1,0]
  v_pk_mul_f32 v[194:195], v[194:195], v[16:17] op_sel_hi:[1,0]
  v_pk_mul_f32 v[196:197], v[196:197], v[18:19] op_sel_hi:[1,0]
  v_pk_mul_f32 v[198:199], v[198:199], v[18:19] op_sel_hi:[1,0]
  v_pk_add_f32 v[184:185], v[184:185], 1.0 op_sel_hi:[1,0]
  v_pk_add_f32 v[186:187], v[186:187], 1.0 op_sel_hi:[1,0]
  v_pk_add_f32 v[188:189], v[188:189], 1.0 op_sel_hi:[1,0]
  v_pk_add_f32 v[190:191], v[190:191], 1.0 op_sel_hi:[1,0]
  v_rcp_f32 v184, v184
  v_rcp_f32 v185, v185
  v_rcp_f32 v186, v186
  v_rcp_f32 v187, v187
  v_rcp_f32 v188, v188
  v_rcp_f32 v189, v189
  v_rcp_f32 v190, v190
  v_rcp_f32 v191, v191
  s_nop 0
  v_pk_mul_f32 v[184:185], v[184:185], v[192:193]
  v_pk_mul_f32 v[186:187], v[186:187], v[194:195]
  v_pk_mul_f32 v[188:189], v[188:189], v[196:197]
  v_pk_mul_f32 v[190:191], v[190:191], v[198:199]
  v_cvt_pk_bf16_f32 v252, v184, v185
  v_cvt_pk_bf16_f32 v253, v186, v187
  v_cvt_pk_bf16_f32 v254, v188, v189
  v_cvt_pk_bf16_f32 v255, v190, v191
  s_nop 1
  v_permlane32_swap_b32 v252, v254
  v_permlane32_swap_b32 v253, v255
  s_nop 1
  buffer_store_dwordx4 v[252:255], v11, s[4:7], s45 offen offset:512 sc1
  v_pk_mul_f32 v[200:201], v[200:201], v[16:17] op_sel:[0,1]
  v_pk_mul_f32 v[202:203], v[202:203], v[16:17] op_sel:[0,1]
  v_pk_mul_f32 v[204:205], v[204:205], v[18:19] op_sel:[0,1]
  v_pk_mul_f32 v[206:207], v[206:207], v[18:19] op_sel:[0,1]
  v_exp_f32 v200, v200
  v_exp_f32 v201, v201
  v_exp_f32 v202, v202
  v_exp_f32 v203, v203
  v_exp_f32 v204, v204
  v_exp_f32 v205, v205
  v_exp_f32 v206, v206
  v_exp_f32 v207, v207
  v_pk_mul_f32 v[208:209], v[208:209], v[16:17] op_sel_hi:[1,0]
  v_pk_mul_f32 v[210:211], v[210:211], v[16:17] op_sel_hi:[1,0]
  v_pk_mul_f32 v[212:213], v[212:213], v[18:19] op_sel_hi:[1,0]
  v_pk_mul_f32 v[214:215], v[214:215], v[18:19] op_sel_hi:[1,0]
  v_pk_add_f32 v[200:201], v[200:201], 1.0 op_sel_hi:[1,0]
  v_pk_add_f32 v[202:203], v[202:203], 1.0 op_sel_hi:[1,0]
  v_pk_add_f32 v[204:205], v[204:205], 1.0 op_sel_hi:[1,0]
  v_pk_add_f32 v[206:207], v[206:207], 1.0 op_sel_hi:[1,0]
  v_rcp_f32 v200, v200
  v_rcp_f32 v201, v201
  v_rcp_f32 v202, v202
  v_rcp_f32 v203, v203
  v_rcp_f32 v204, v204
  v_rcp_f32 v205, v205
  v_rcp_f32 v206, v206
  v_rcp_f32 v207, v207
  s_nop 0
  v_pk_mul_f32 v[200:201], v[200:201], v[208:209]
  v_pk_mul_f32 v[202:203], v[202:203], v[210:211]
  v_pk_mul_f32 v[204:205], v[204:205], v[212:213]
  v_pk_mul_f32 v[206:207], v[206:207], v[214:215]
  v_cvt_pk_bf16_f32 v248, v200, v201
  v_cvt_pk_bf16_f32 v249, v202, v203
  v_cvt_pk_bf16_f32 v250, v204, v205
  v_cvt_pk_bf16_f32 v251, v206, v207
  s_nop 1
  v_permlane32_swap_b32 v248, v250
  v_permlane32_swap_b32 v249, v251
  s_nop 1
  buffer_store_dwordx4 v[248:251], v11, s[4:7], s45 offen offset:1024 sc1
  s_waitcnt vmcnt(19)
  s_barrier
  s_add_u32 s46, s58, 8192
  s_add_u32 m0, s59, 0
  s_nop 0
  buffer_load_dwordx4 v2, s[4:7], s46 offen offset:0 sc1 lds
  buffer_load_dwordx4 v3, s[4:7], s46 offen offset:1024 sc1 lds
  buffer_load_dwordx4 v4, s[4:7], s46 offen offset:2048 sc1 lds
  buffer_load_dwordx4 v5, s[4:7], s46 offen offset:3072 sc1 lds
  s_add_u32 s46, s58, 9216
  s_add_u32 m0, s59, 17408
  s_nop 0
  buffer_load_dwordx4 v2, s[4:7], s46 offen offset:0 sc1 lds
  buffer_load_dwordx4 v3, s[4:7], s46 offen offset:1024 sc1 lds
  buffer_load_dwordx4 v4, s[4:7], s46 offen offset:2048 sc1 lds
  buffer_load_dwordx4 v5, s[4:7], s46 offen offset:3072 sc1 lds
  s_waitcnt vmcnt(23)
  s_barrier
  s_add_u32 s46, s58, 10240
  s_add_u32 m0, s59, 34816
  s_nop 0
  buffer_load_dwordx4 v2, s[4:7], s46 offen offset:0 sc1 lds
  buffer_load_dwordx4 v3, s[4:7], s46 offen offset:1024 sc1 lds
  buffer_load_dwordx4 v4, s[4:7], s46 offen offset:2048 sc1 lds
  buffer_load_dwordx4 v5, s[4:7], s46 offen offset:3072 sc1 lds
  s_waitcnt vmcnt(23)
  s_barrier
  s_add_u32 s46, s58, 11264
  s_add_u32 m0, s59, 52224
  s_nop 0
  buffer_load_dwordx4 v2, s[4:7], s46 offen offset:0 sc1 lds
  buffer_load_dwordx4 v3, s[4:7], s46 offen offset:1024 sc1 lds
  buffer_load_dwordx4 v4, s[4:7], s46 offen offset:2048 sc1 lds
  buffer_load_dwordx4 v5, s[4:7], s46 offen offset:3072 sc1 lds
  s_waitcnt vmcnt(23)
  s_barrier
  s_add_u32 s46, s58, 15360
  s_add_u32 m0, s59, 69632
  s_nop 0
  buffer_load_dwordx4 v2, s[4:7], s46 offen offset:0 sc1 lds
  buffer_load_dwordx4 v3, s[4:7], s46 offen offset:1024 sc1 lds
  buffer_load_dwordx4 v4, s[4:7], s46 offen offset:2048 sc1 lds
  buffer_load_dwordx4 v5, s[4:7], s46 offen offset:3072 sc1 lds
  s_waitcnt vmcnt(23)
  s_barrier
  s_add_u32 s46, s58, 16384
  s_add_u32 m0, s59, 87040
  s_nop 0
  buffer_load_dwordx4 v2, s[4:7], s46 offen offset:0 sc1 lds
  buffer_load_dwordx4 v3, s[4:7], s46 offen offset:1024 sc1 lds
  buffer_load_dwordx4 v4, s[4:7], s46 offen offset:2048 sc1 lds
  buffer_load_dwordx4 v5, s[4:7], s46 offen offset:3072 sc1 lds
  s_waitcnt vmcnt(20)
  s_barrier
  s_add_u32 s46, s58, 17408
  s_add_u32 m0, s59, 104448
  s_nop 0
  buffer_load_dwordx4 v2, s[4:7], s46 offen offset:0 sc1 lds
  buffer_load_dwordx4 v3, s[4:7], s46 offen offset:1024 sc1 lds
  buffer_load_dwordx4 v4, s[4:7], s46 offen offset:2048 sc1 lds
  buffer_load_dwordx4 v5, s[4:7], s46 offen offset:3072 sc1 lds
  s_waitcnt vmcnt(28)
  s_waitcnt vmcnt(20)
  s_barrier
  s_add_u32 s46, s58, 18432
  s_add_u32 m0, s59, 121856
  s_nop 0
  buffer_load_dwordx4 v2, s[4:7], s46 offen offset:0 sc1 lds
  buffer_load_dwordx4 v3, s[4:7], s46 offen offset:1024 sc1 lds
  buffer_load_dwordx4 v4, s[4:7], s46 offen offset:2048 sc1 lds
  buffer_load_dwordx4 v5, s[4:7], s46 offen offset:3072 sc1 lds
  s_waitcnt vmcnt(20)
  s_barrier
  s_add_u32 s46, s58, 19456
  s_add_u32 m0, s59, 0
  s_nop 0
  buffer_load_dwordx4 v2, s[4:7], s46 offen offset:0 sc1 lds
  buffer_load_dwordx4 v3, s[4:7], s46 offen offset:1024 sc1 lds
  buffer_load_dwordx4 v4, s[4:7], s46 offen offset:2048 sc1 lds
  buffer_load_dwordx4 v5, s[4:7], s46 offen offset:3072 sc1 lds
  s_waitcnt vmcnt(20)
  s_barrier
  s_add_u32 s46, s58, 20480
  s_add_u32 m0, s59, 17408
  s_nop 0
  buffer_load_dwordx4 v2, s[4:7], s46 offen offset:0 sc1 lds
  buffer_load_dwordx4 v3, s[4:7], s46 offen offset:1024 sc1 lds
  buffer_load_dwordx4 v4, s[4:7], s46 offen offset:2048 sc1 lds
  buffer_load_dwordx4 v5, s[4:7], s46 offen offset:3072 sc1 lds
  s_waitcnt vmcnt(20)
  s_barrier
  s_add_u32 s46, s58, 24576
  s_add_u32 m0, s59, 34816
  s_nop 0
  buffer_load_dwordx4 v2, s[4:7], s46 offen offset:0 sc1 lds
  buffer_load_dwordx4 v3, s[4:7], s46 offen offset:1024 sc1 lds
  buffer_load_dwordx4 v4, s[4:7], s46 offen offset:2048 sc1 lds
  buffer_load_dwordx4 v5, s[4:7], s46 offen offset:3072 sc1 lds
  s_waitcnt vmcnt(20)
  s_barrier
  s_add_u32 s46, s58, 25600
  s_add_u32 m0, s59, 52224
  s_nop 0
  buffer_load_dwordx4 v2, s[4:7], s46 offen offset:0 sc1 lds
  buffer_load_dwordx4 v3, s[4:7], s46 offen offset:1024 sc1 lds
  buffer_load_dwordx4 v4, s[4:7], s46 offen offset:2048 sc1 lds
  buffer_load_dwordx4 v5, s[4:7], s46 offen offset:3072 sc1 lds
  s_waitcnt vmcnt(20)
  s_barrier
  s_add_u32 s46, s58, 26624
  s_add_u32 m0, s59, 69632
  s_nop 0
  buffer_load_dwordx4 v2, s[4:7], s46 offen offset:0 sc1 lds
  buffer_load_dwordx4 v3, s[4:7], s46 offen offset:1024 sc1 lds
  buffer_load_dwordx4 v4, s[4:7], s46 offen offset:2048 sc1 lds
  buffer_load_dwordx4 v5, s[4:7], s46 offen offset:3072 sc1 lds
  s_waitcnt vmcnt(20)
  s_barrier
  s_add_u32 s46, s58, 27648
  s_add_u32 m0, s59, 87040
  s_nop 0
  buffer_load_dwordx4 v2, s[4:7], s46 offen offset:0 sc1 lds
  buffer_load_dwordx4 v3, s[4:7], s46 offen offset:1024 sc1 lds
  buffer_load_dwordx4 v4, s[4:7], s46 offen offset:2048 sc1 lds
  buffer_load_dwordx4 v5, s[4:7], s46 offen offset:3072 sc1 lds
  s_waitcnt vmcnt(20)
  s_barrier
  s_add_u32 s46, s58, 28672
  s_add_u32 m0, s59, 104448
  s_nop 0
  buffer_load_dwordx4 v2, s[4:7], s46 offen offset:0 sc1 lds
  buffer_load_dwordx4 v3, s[4:7], s46 offen offset:1024 sc1 lds
  buffer_load_dwordx4 v4, s[4:7], s46 offen offset:2048 sc1 lds
  buffer_load_dwordx4 v5, s[4:7], s46 offen offset:3072 sc1 lds
  s_waitcnt vmcnt(20)
  s_barrier
  s_add_u32 s46, s58, 29696
  s_add_u32 m0, s59, 121856
  s_nop 0
  buffer_load_dwordx4 v2, s[4:7], s46 offen offset:0 sc1 lds
  buffer_load_dwordx4 v3, s[4:7], s46 offen offset:1024 sc1 lds
  buffer_load_dwordx4 v4, s[4:7], s46 offen offset:2048 sc1 lds
  buffer_load_dwordx4 v5, s[4:7], s46 offen offset:3072 sc1 lds
  s_waitcnt vmcnt(20)
  s_barrier
  s_add_u32 s46, s58, 33792
  s_add_u32 m0, s59, 0
  s_nop 0
  buffer_load_dwordx4 v2, s[4:7], s46 offen offset:0 sc1 lds
  buffer_load_dwordx4 v3, s[4:7], s46 offen offset:1024 sc1 lds
  buffer_load_dwordx4 v4, s[4:7], s46 offen offset:2048 sc1 lds
  buffer_load_dwordx4 v5, s[4:7], s46 offen offset:3072 sc1 lds
  s_waitcnt vmcnt(20)
  s_barrier
  s_add_u32 s46, s58, 34816
  s_add_u32 m0, s59, 17408
  s_nop 0
  buffer_load_dwordx4 v2, s[4:7], s46 offen offset:0 sc1 lds
  buffer_load_dwordx4 v3, s[4:7], s46 offen offset:1024 sc1 lds
  buffer_load_dwordx4 v4, s[4:7], s46 offen offset:2048 sc1 lds
  buffer_load_dwordx4 v5, s[4:7], s46 offen offset:3072 sc1 lds
  s_waitcnt vmcnt(20)
  s_barrier
  s_add_u32 s46, s58, 35840
  s_add_u32 m0, s59, 34816
  s_nop 0
  buffer_load_dwordx4 v2, s[4:7], s46 offen offset:0 sc1 lds
  buffer_load_dwordx4 v3, s[4:7], s46 offen offset:1024 sc1 lds
  buffer_load_dwordx4 v4, s[4:7], s46 offen offset:2048 sc1 lds
  buffer_load_dwordx4 v5, s[4:7], s46 offen offset:3072 sc1 lds
  s_waitcnt vmcnt(20)
  s_barrier
  s_add_u32 s46, s58, 3072
  s_add_u32 m0, s59, 52224
  s_nop 0
  buffer_load_dwordx4 v2, s[4:7], s46 offen offset:0 sc1 lds
  buffer_load_dwordx4 v3, s[4:7], s46 offen offset:1024 sc1 lds
  buffer_load_dwordx4 v4, s[4:7], s46 offen offset:2048 sc1 lds
  buffer_load_dwordx4 v5, s[4:7], s46 offen offset:3072 sc1 lds
  s_waitcnt vmcnt(20)
  s_barrier
  s_add_u32 s46, s58, 4096
  s_add_u32 m0, s59, 69632
  s_nop 0
  buffer_load_dwordx4 v2, s[4:7], s46 offen offset:0 sc1 lds
  buffer_load_dwordx4 v3, s[4:7], s46 offen offset:1024 sc1 lds
  buffer_load_dwordx4 v4, s[4:7], s46 offen offset:2048 sc1 lds
  buffer_load_dwordx4 v5, s[4:7], s46 offen offset:3072 sc1 lds
  s_waitcnt vmcnt(20)
  s_barrier
  s_add_u32 s46, s58, 5120
  s_add_u32 m0, s59, 87040
  s_nop 0
  buffer_load_dwordx4 v2, s[4:7], s46 offen offset:0 sc1 lds
  buffer_load_dwordx4 v3, s[4:7], s46 offen offset:1024 sc1 lds
  buffer_load_dwordx4 v4, s[4:7], s46 offen offset:2048 sc1 lds
  buffer_load_dwordx4 v5, s[4:7], s46 offen offset:3072 sc1 lds
  s_waitcnt vmcnt(20)
  s_barrier
  s_add_u32 s46, s58, 12288
  s_add_u32 m0, s59, 104448
  s_nop 0
  buffer_load_dwordx4 v2, s[4:7], s46 offen offset:0 sc1 lds
  buffer_load_dwordx4 v3, s[4:7], s46 offen offset:1024 sc1 lds
  buffer_load_dwordx4 v4, s[4:7], s46 offen offset:2048 sc1 lds
  buffer_load_dwordx4 v5, s[4:7], s46 offen offset:3072 sc1 lds
  s_waitcnt vmcnt(20)
  s_barrier
  s_add_u32 s46, s58, 13312
  s_add_u32 m0, s59, 121856
  s_nop 0
  buffer_load_dwordx4 v2, s[4:7], s46 offen offset:0 sc1 lds
  buffer_load_dwordx4 v3, s[4:7], s46 offen offset:1024 sc1 lds
  buffer_load_dwordx4 v4, s[4:7], s46 offen offset:2048 sc1 lds
  buffer_load_dwordx4 v5, s[4:7], s46 offen offset:3072 sc1 lds
  s_waitcnt vmcnt(20)
  s_barrier
  s_add_u32 s46, s58, 14336
  s_add_u32 m0, s59, 0
  s_nop 0
  buffer_load_dwordx4 v2, s[4:7], s46 offen offset:0 sc1 lds
  buffer_load_dwordx4 v3, s[4:7], s46 offen offset:1024 sc1 lds
  buffer_load_dwordx4 v4, s[4:7], s46 offen offset:2048 sc1 lds
  buffer_load_dwordx4 v5, s[4:7], s46 offen offset:3072 sc1 lds
  s_waitcnt vmcnt(20)
  s_barrier
  s_add_u32 s46, s58, 21504
  s_add_u32 m0, s59, 17408
  s_nop 0
  buffer_load_dwordx4 v2, s[4:7], s46 offen offset:0 sc1 lds
  buffer_load_dwordx4 v3, s[4:7], s46 offen offset:1024 sc1 lds
  buffer_load_dwordx4 v4, s[4:7], s46 offen offset:2048 sc1 lds
  buffer_load_dwordx4 v5, s[4:7], s46 offen offset:3072 sc1 lds
  s_waitcnt vmcnt(20)
  s_barrier
  s_add_u32 s46, s58, 22528
  s_add_u32 m0, s59, 34816
  s_nop 0
  buffer_load_dwordx4 v2, s[4:7], s46 offen offset:0 sc1 lds
  buffer_load_dwordx4 v3, s[4:7], s46 offen offset:1024 sc1 lds
  buffer_load_dwordx4 v4, s[4:7], s46 offen offset:2048 sc1 lds
  buffer_load_dwordx4 v5, s[4:7], s46 offen offset:3072 sc1 lds
  s_waitcnt vmcnt(20)
  s_barrier
  s_add_u32 s46, s58, 23552
  s_add_u32 m0, s59, 52224
  s_nop 0
  buffer_load_dwordx4 v2, s[4:7], s46 offen offset:0 sc1 lds
  buffer_load_dwordx4 v3, s[4:7], s46 offen offset:1024 sc1 lds
  buffer_load_dwordx4 v4, s[4:7], s46 offen offset:2048 sc1 lds
  buffer_load_dwordx4 v5, s[4:7], s46 offen offset:3072 sc1 lds
  s_waitcnt vmcnt(20)
  s_barrier
  s_add_u32 s46, s58, 30720
  s_add_u32 m0, s59, 69632
  s_nop 0
  buffer_load_dwordx4 v2, s[4:7], s46 offen offset:0 sc1 lds
  buffer_load_dwordx4 v3, s[4:7], s46 offen offset:1024 sc1 lds
  buffer_load_dwordx4 v4, s[4:7], s46 offen offset:2048 sc1 lds
  buffer_load_dwordx4 v5, s[4:7], s46 offen offset:3072 sc1 lds
  s_waitcnt vmcnt(20)
  s_barrier
  s_add_u32 s46, s58, 31744
  s_add_u32 m0, s59, 87040
  s_nop 0
  buffer_load_dwordx4 v2, s[4:7], s46 offen offset:0 sc1 lds
  buffer_load_dwordx4 v3, s[4:7], s46 offen offset:1024 sc1 lds
  buffer_load_dwordx4 v4, s[4:7], s46 offen offset:2048 sc1 lds
  buffer_load_dwordx4 v5, s[4:7], s46 offen offset:3072 sc1 lds
  s_waitcnt vmcnt(20)
  s_barrier
  s_add_u32 s46, s58, 32768
  s_add_u32 m0, s59, 104448
  s_nop 0
  buffer_load_dwordx4 v2, s[4:7], s46 offen offset:0 sc1 lds
  buffer_load_dwordx4 v3, s[4:7], s46 offen offset:1024 sc1 lds
  buffer_load_dwordx4 v4, s[4:7], s46 offen offset:2048 sc1 lds
  buffer_load_dwordx4 v5, s[4:7], s46 offen offset:3072 sc1 lds
  s_waitcnt vmcnt(20)
  s_barrier
  s_waitcnt vmcnt(16)
  s_barrier
  s_waitcnt vmcnt(12)
  s_barrier
  s_waitcnt vmcnt(8)
  s_barrier
  s_waitcnt vmcnt(4)
  s_barrier
  s_waitcnt vmcnt(0)
  s_barrier
.L_s5_done:
  s_waitcnt vmcnt(0) lgkmcnt(0)
  s_barrier
  s_cmp_lg_u32 s3, 7
  s_cbranch_scc1 .Lm_77
  s_mul_i32 s44, s40, 139264
  s_lshl_b32 s45, s43, 2
  s_add_u32 s44, s44, s45
  s_add_u32 s44, s44, 1048576
  s_add_u32 s45, s101, 6
  v_mov_b32 v120, s45
  v_mul_u32_u24 v121, 4352, v0
  s_mov_b32 exec_lo, -1
  s_mov_b32 exec_hi, 0
  buffer_store_dword v120, v121, s[4:7], s44 offen sc1
  s_mov_b64 exec, -1
.Lm_77:
  s_add_u32 s55, s3, 4
  s_and_b32 s55, s55, 7
  s_mov_b32 s8, s30
  s_and_b32 s9, s31, 0xffff
  s_mov_b32 s10, 0x00240000
  s_mov_b32 s11, 0x00020000
  s_lshl_b32 s48, s56, 2
  s_add_u32 s48, s48, s57
  s_lshl_b32 s48, s48, 2
  s_add_u32 s48, s48, s41
  s_mul_i32 s48, s48, 36864
  s_lshl_b32 s52, s55, 11
  s_add_u32 s48, s48, s52
  s_add_u32 s48, s48, 16941056
  s_lshl_b32 s53, s56, 3
  s_lshl_b32 s51, s41, 1
  s_add_u32 s53, s53, s51
  s_mul_i32 s53, s53, 18432
  s_mul_i32 s51, s57, 9
  s_lshl_b32 s54, s55, 1
  s_add_u32 s51, s51, s54
  s_lshl_b32 s54, s51, 9
  s_add_u32 s54, s54, s53
  s_add_u32 s54, s54, 12222464
  s_lshl_b32 s51, s51, 5
  s_add_u32 s53, s53, s51
  s_add_u32 s58, s53, 32
  s_cmp_ge_u32 s55, 4
  s_cselect_b32 s58, 0x7f000000, s58
  v_and_b32 v6, 15, v0
  v_lshrrev_b32 v7, 4, v0
  v_and_b32 v8, 1, v7
  v_lshlrev_b32 v8, 8, v8
  v_lshl_add_u32 v8, v6, 4, v8
  v_lshrrev_b32 v9, 1, v7
  v_lshl_add_u32 v8, v9, 3, v8
  v_add_u32 v11, 18432, v8
  v_and_b32 v10, 31, v0
  v_mul_u32_u24 v10, 1152, v10
  v_lshl_add_u32 v9, v9, 4, v10
  s_add_u32 s52, s52, 139264
  v_add_u32 v10, s52, v1
  s_add_u32 s49, s41, 1
  s_and_b32 s49, s49, 3
  s_mul_i32 s49, s49, 9216
  s_add_u32 s49, s49, s48
  s_add_u32 s50, s41, 2
  s_and_b32 s50, s50, 3
  s_mul_i32 s50, s50, 9216
  s_add_u32 s50, s50, s48
  s_add_u32 s51, s41, 3
  s_and_b32 s51, s51, 3
  s_mul_i32 s51, s51, 9216
  s_add_u32 s51, s51, s48
  s_cmp_ge_u32 s55, 5
  s_cbranch_scc1 .Lm_78
  buffer_load_dwordx2 v[80:81], v8, s[4:7], s54 offen offset:0 sc1
  ds_read_b128 v[96:99], v10 offset:0
  buffer_load_dwordx2 v[82:83], v11, s[4:7], s54 offen offset:0 sc1
  ds_read_b128 v[100:103], v10 offset:9216
  buffer_load_dwordx2 v[84:85], v8, s[4:7], s54 offen offset:512 sc1
  ds_read_b128 v[104:107], v10 offset:1024
  buffer_load_dwordx2 v[86:87], v11, s[4:7], s54 offen offset:512 sc1
  ds_read_b128 v[108:111], v10 offset:10240
.Lm_78:
  s_cmp_lg_u32 s3, 3
  s_cbranch_scc1 .Lm_79
  s_lshl_b32 s46, s40, 5
  s_add_u32 s46, s46, s43
  s_mul_i32 s46, s46, 4352
  s_add_u32 s46, s46, 1048576
  v_and_b32 v121, 31, v0
  v_lshlrev_b32 v120, 2, v121
  v_add_u32 v120, s46, v120
  v_and_b32 v121, 7, v121
  v_cmp_eq_u32 vcc, s42, v121
  s_nop 3
  s_mov_b32 vcc_hi, 0
  s_add_u32 s45, s101, 6
  s_mov_b32 s44, 0
  s_nop 2
  s_mov_b64 exec, vcc
.Lm_80:
  buffer_load_dword v122, v120, s[4:7], 0 offen sc1
  s_waitcnt vmcnt(0)
  v_subrev_u32 v121, s45, v122
  v_cmp_le_u32 vcc, 10, v121
  s_add_u32 s44, s44, 1
  s_nop 2
  s_cmp_eq_u64 vcc, 0
  s_cbranch_scc1 .Lm_81
  s_sleep 1
  s_cmp_lt_u32 s44, 0x40000
  s_cbranch_scc1 .Lm_80
.Lm_81:
  s_mov_b64 exec, -1
.Lm_79:
  s_barrier
  s_cmp_ge_u32 s55, 5
  s_cbranch_scc1 .L_fin
  buffer_load_dwordx4 v[16:19], v1, s[4:7], s49 offen offset:0 sc1
  buffer_load_dwordx4 v[20:23], v1, s[4:7], s50 offen offset:0 sc1
  buffer_load_dwordx4 v[24:27], v1, s[4:7], s51 offen offset:0 sc1
  buffer_load_dwordx4 v[28:31], v1, s[4:7], s49 offen offset:1024 sc1
  buffer_load_dwordx4 v[32:35], v1, s[4:7], s50 offen offset:1024 sc1
  buffer_load_dwordx4 v[36:39], v1, s[4:7], s51 offen offset:1024 sc1
  s_waitcnt vmcnt(3) lgkmcnt(0)
  v_lshlrev_b32 v48, 16, v16
  v_and_b32 v49, 0xffff0000, v16
  v_pk_add_f32 v[96:97], v[96:97], v[48:49]
  v_lshlrev_b32 v50, 16, v17
  v_and_b32 v51, 0xffff0000, v17
  v_pk_add_f32 v[98:99], v[98:99], v[50:51]
  v_lshlrev_b32 v48, 16, v20
  v_and_b32 v49, 0xffff0000, v20
  v_pk_add_f32 v[96:97], v[96:97], v[48:49]
  v_lshlrev_b32 v50, 16, v21
  v_and_b32 v51, 0xffff0000, v21
  v_pk_add_f32 v[98:99], v[98:99], v[50:51]
  v_lshlrev_b32 v48, 16, v24
  v_and_b32 v49, 0xffff0000, v24
  v_pk_add_f32 v[96:97], v[96:97], v[48:49]
  v_lshlrev_b32 v50, 16, v25
  v_and_b32 v51, 0xffff0000, v25
  v_pk_add_f32 v[98:99], v[98:99], v[50:51]
  v_cvt_pk_bf16_f32 v56, v96, v97
  v_cvt_pk_bf16_f32 v57, v98, v99
  v_lshlrev_b32 v96, 16, v56
  v_and_b32 v97, 0xffff0000, v56
  v_lshlrev_b32 v48, 16, v80
  v_and_b32 v49, 0xffff0000, v80
  v_pk_add_f32 v[96:97], v[96:97], v[48:49]
  v_lshlrev_b32 v98, 16, v57
  v_and_b32 v99, 0xffff0000, v57
  v_lshlrev_b32 v48, 16, v81
  v_and_b32 v49, 0xffff0000, v81
  v_pk_add_f32 v[98:99], v[98:99], v[48:49]
  v_cvt_pk_bf16_f32 v56, v96, v97
  v_cvt_pk_bf16_f32 v57, v98, v99
  v_lshlrev_b32 v48, 16, v18
  v_and_b32 v49, 0xffff0000, v18
  v_pk_add_f32 v[100:101], v[100:101], v[48:49]
  v_lshlrev_b32 v50, 16, v19
  v_and_b32 v51, 0xffff0000, v19
  v_pk_add_f32 v[102:103], v[102:103], v[50:51]
  v_lshlrev_b32 v48, 16, v22
  v_and_b32 v49, 0xffff0000, v22
  v_pk_add_f32 v[100:101], v[100:101], v[48:49]
  v_lshlrev_b32 v50, 16, v23
  v_and_b32 v51, 0xffff0000, v23
  v_pk_add_f32 v[102:103], v[102:103], v[50:51]
  v_lshlrev_b32 v48, 16, v26
  v_and_b32 v49, 0xffff0000, v26
  v_pk_add_f32 v[100:101], v[100:101], v[48:49]
  v_lshlrev_b32 v50, 16, v27
  v_and_b32 v51, 0xffff0000, v27
  v_pk_add_f32 v[102:103], v[102:103], v[50:51]
  v_cvt_pk_bf16_f32 v58, v100, v101
  v_cvt_pk_bf16_f32 v59, v102, v103
  v_lshlrev_b32 v100, 16, v58
  v_and_b32 v101, 0xffff0000, v58
  v_lshlrev_b32 v48, 16, v82
  v_and_b32 v49, 0xffff0000, v82
  v_pk_add_f32 v[100:101], v[100:101], v[48:49]
  v_lshlrev_b32 v102, 16, v59
  v_and_b32 v103, 0xffff0000, v59
  v_lshlrev_b32 v48, 16, v83
  v_and_b32 v49, 0xffff0000, v83
  v_pk_add_f32 v[102:103], v[102:103], v[48:49]
  v_cvt_pk_bf16_f32 v58, v100, v101
  v_cvt_pk_bf16_f32 v59, v102, v103
  s_nop 1
  v_permlane16_swap_b32 v56, v58
  v_permlane16_swap_b32 v57, v59
  s_nop 1
  buffer_store_dwordx4 v[56:59], v9, s[8:11], s53 offen
  s_waitcnt vmcnt(1) lgkmcnt(0)
  v_lshlrev_b32 v48, 16, v28
  v_and_b32 v49, 0xffff0000, v28
  v_pk_add_f32 v[104:105], v[104:105], v[48:49]
  v_lshlrev_b32 v50, 16, v29
  v_and_b32 v51, 0xffff0000, v29
  v_pk_add_f32 v[106:107], v[106:107], v[50:51]
  v_lshlrev_b32 v48, 16, v32
  v_and_b32 v49, 0xffff0000, v32
  v_pk_add_f32 v[104:105], v[104:105], v[48:49]
  v_lshlrev_b32 v50, 16, v33
  v_and_b32 v51, 0xffff0000, v33
  v_pk_add_f32 v[106:107], v[106:107], v[50:51]
  v_lshlrev_b32 v48, 16, v36
  v_and_b32 v49, 0xffff0000, v36
  v_pk_add_f32 v[104:105], v[104:105], v[48:49]
  v_lshlrev_b32 v50, 16, v37
  v_and_b32 v51, 0xffff0000, v37
  v_pk_add_f32 v[106:107], v[106:107], v[50:51]
  v_cvt_pk_bf16_f32 v60, v104, v105
  v_cvt_pk_bf16_f32 v61, v106, v107
  v_lshlrev_b32 v104, 16, v60
  v_and_b32 v105, 0xffff0000, v60
  v_lshlrev_b32 v48, 16, v84
  v_and_b32 v49, 0xffff0000, v84
  v_pk_add_f32 v[104:105], v[104:105], v[48:49]
  v_lshlrev_b32 v106, 16, v61
  v_and_b32 v107, 0xffff0000, v61
  v_lshlrev_b32 v48, 16, v85
  v_and_b32 v49, 0xffff0000, v85
  v_pk_add_f32 v[106:107], v[106:107], v[48:49]
  v_cvt_pk_bf16_f32 v60, v104, v105
  v_cvt_pk_bf16_f32 v61, v106, v107
  v_lshlrev_b32 v48, 16, v30
  v_and_b32 v49, 0xffff0000, v30
  v_pk_add_f32 v[108:109], v[108:109], v[48:49]
  v_lshlrev_b32 v50, 16, v31
  v_and_b32 v51, 0xffff0000, v31
  v_pk_add_f32 v[110:111], v[110:111], v[50:51]
  v_lshlrev_b32 v48, 16, v34
  v_and_b32 v49, 0xffff0000, v34
  v_pk_add_f32 v[108:109], v[108:109], v[48:49]
  v_lshlrev_b32 v50, 16, v35
  v_and_b32 v51, 0xffff0000, v35
  v_pk_add_f32 v[110:111], v[110:111], v[50:51]
  v_lshlrev_b32 v48, 16, v38
  v_and_b32 v49, 0xffff0000, v38
  v_pk_add_f32 v[108:109], v[108:109], v[48:49]
  v_lshlrev_b32 v50, 16, v39
  v_and_b32 v51, 0xffff0000, v39
  v_pk_add_f32 v[110:111], v[110:111], v[50:51]
  v_cvt_pk_bf16_f32 v62, v108, v109
  v_cvt_pk_bf16_f32 v63, v110, v111
  v_lshlrev_b32 v108, 16, v62
  v_and_b32 v109, 0xffff0000, v62
  v_lshlrev_b32 v48, 16, v86
  v_and_b32 v49, 0xffff0000, v86
  v_pk_add_f32 v[108:109], v[108:109], v[48:49]
  v_lshlrev_b32 v110, 16, v63
  v_and_b32 v111, 0xffff0000, v63
  v_lshlrev_b32 v48, 16, v87
  v_and_b32 v49, 0xffff0000, v87
  v_pk_add_f32 v[110:111], v[110:111], v[48:49]
  v_cvt_pk_bf16_f32 v62, v108, v109
  v_cvt_pk_bf16_f32 v63, v110, v111
  s_nop 1
  v_permlane16_swap_b32 v60, v62
  v_permlane16_swap_b32 v61, v63
  s_nop 1
  buffer_store_dwordx4 v[60:63], v9, s[8:11], s58 offen
.L_fin:
  s_cmp_lg_u32 s2, 0
  s_cbranch_scc1 .Lm_82
  s_cmp_lg_u32 s3, 2
  s_cbranch_scc1 .Lm_82
  v_lshrrev_b32 v3, 5, v0
  v_mul_u32_u24 v3, 139264, v3
  v_and_b32 v2, 31, v0
  v_lshl_add_u32 v2, v2, 2, v3
  s_add_u32 s45, s101, 1
  s_mov_b32 s44, 0
.Lm_83:
  s_mov_b32 s46, 1048576
  buffer_load_dword v4, v2, s[4:7], s46 offen sc1
  s_mov_b32 s46, 1327104
  buffer_load_dword v5, v2, s[4:7], s46 offen sc1
  s_mov_b32 s46, 1605632
  buffer_load_dword v6, v2, s[4:7], s46 offen sc1
  s_mov_b32 s46, 1884160
  buffer_load_dword v7, v2, s[4:7], s46 offen sc1
  s_add_u32 s44, s44, 1
  s_waitcnt vmcnt(0)
  v_subrev_u32 v4, s45, v4
  v_subrev_u32 v5, s45, v5
  v_subrev_u32 v6, s45, v6
  v_subrev_u32 v7, s45, v7
  v_max3_u32 v4, v4, v5, v6
  v_max_u32 v4, v4, v7
  v_cmp_le_u32 vcc, 15, v4
  s_nop 3
  s_cmp_eq_u64 vcc, 0
  s_cbranch_scc1 .Lm_84
  s_sleep 4
  s_cmp_lt_u32 s44, 0x40000
  s_cbranch_scc1 .Lm_83
.Lm_84:
  v_mov_b32 v2, s101
  s_mov_b32 s44, 0
  s_mov_b64 exec, 1
  buffer_store_dword v2, off, s[4:7], s44 sc1
  s_mov_b64 exec, -1
.Lm_82:
.L_end:
  s_endpgm
.section .rodata,"a"
.p2align 6
.amdhsa_kernel sequential_preLN__sliding_block__glu_gated_glu__prompt_kernel
  .amdhsa_next_free_vgpr 256
  .amdhsa_next_free_sgpr 102
  .amdhsa_accum_offset 256
  .amdhsa_group_segment_fixed_size 0
  .amdhsa_kernarg_size 80
  .amdhsa_user_sgpr_count 2
  .amdhsa_user_sgpr_kernarg_segment_ptr 1
  .amdhsa_system_sgpr_workgroup_id_x 1
.end_amdhsa_kernel
```
